```python
import torch

def _softmax(x, axis=-1):
    return torch.softmax(x, dim=axis)

def _gelu(x):
    return torch.nn.functional.gelu(x, approximate='tanh')

def _silu(x):
    return torch.nn.functional.silu(x)

def _sigmoid(x):
    return torch.sigmoid(x)

def _layernorm(x, axis=-1, eps=1e-05):
    m = x.mean(dim=axis, keepdim=True)
    v = x.var(dim=axis, keepdim=True, unbiased=False)
    return (x - m) / torch.sqrt(v + eps)

def _scatter_add(tgt, idx, src, axis=0):
    return tgt.clone().index_add_(axis, idx, src)

def _segment_sum(src, seg, n):
    out = torch.zeros((n,) + src.shape[1:], dtype=src.dtype)
    return out.index_add_(0, seg, src)

def _pad(x, pw):
    flat = tuple((v for pair in reversed(pw) for v in pair))
    return torch.nn.functional.pad(x, flat)
kernel_name = 'adaLN_cond__memory_aug_recurrent_mem_tr__dense_activation_mish__prompt'

def setup_inputs():

    _w = lambda a: (lambda t: t.to(torch.bfloat16) if t.is_floating_point() else t)(torch.as_tensor(a))

    def _A_setup():
        B, S, Dm = (1, 2048, 448)
        H, Dh = (16, 256)
        M, seg = (8, 32)
        seg = min(seg, S)
        S = S // seg * seg
        return {'x': _w((lambda *s: torch.randn(*s, dtype=torch.bfloat16) * 0.05)(B, S, Dm)), 'mem0': _w((lambda *s: torch.randn(*s, dtype=torch.bfloat16) * 0.8)(B, M, Dm)), 'Wq': _w((lambda *s: torch.randn(*s, dtype=torch.bfloat16) * 0.8)(Dm, H, Dh) * Dm ** (-0.5)), 'Wk': _w((lambda *s: torch.randn(*s, dtype=torch.bfloat16) * 0.8)(Dm, H, Dh) * Dm ** (-0.5)), 'Wv': _w((lambda *s: torch.randn(*s, dtype=torch.bfloat16) * 0.8)(Dm, H, Dh) * Dm ** (-0.5)), 'Wo': _w((lambda *s: torch.randn(*s, dtype=torch.bfloat16) * 0.8)(H, Dh, Dm) * (H * Dh) ** (-0.5)), 'seg_len': seg}
    _A_in = _A_setup()

    def _B_setup():
        B, S, D, F = (1, 2048, 448, 1792)
        return {'x': _w((lambda *s: torch.randn(*s, dtype=torch.bfloat16) * 0.05)(B, S, D)), 'w1': _w((lambda *s: torch.randn(*s, dtype=torch.bfloat16) * 0.8)(D, F) * D ** (-0.5)), 'b1': _w((lambda *s: torch.randn(*s, dtype=torch.bfloat16) * 0.2)(F)), 'w2': _w((lambda *s: torch.randn(*s, dtype=torch.bfloat16) * 0.2)(F, D) * F ** (-0.5))}
    _B_in = _B_setup()
    return {'A_x': _A_in['x'], 'A_mem0': _A_in['mem0'], 'A_Wq': _A_in['Wq'], 'A_Wk': _A_in['Wk'], 'A_Wv': _A_in['Wv'], 'A_Wo': _A_in['Wo'], 'A_seg_len': _A_in['seg_len'], 'B_x': _B_in['x'], 'B_w1': _B_in['w1'], 'B_b1': _B_in['b1'], 'B_w2': _B_in['w2'], 'c': _w((lambda *s: torch.randn(*s, dtype=torch.bfloat16) * 0.05)(1, 448) * 8.0), 'w_mod': _w((lambda *s: torch.randn(*s, dtype=torch.bfloat16) * 0.05)(448, 6 * 448) * 448 ** (-0.5) * 8.0)}

def reference(A_x, A_mem0, A_Wq, A_Wk, A_Wv, A_Wo, A_seg_len, B_x, B_w1, B_b1, B_w2, c, w_mod):

    def _A_ref(x, mem0, Wq, Wk, Wv, Wo, seg_len):
        B, S, Dm = x.shape
        H, Dh = (Wq.shape[1], Wq.shape[2])
        M = mem0.shape[1]
        scale = Dh ** (-0.5)
        n_seg = S // seg_len
        L = M + seg_len
        idx = torch.arange(L)
        mask = (idx[:, None] < M) | (idx[:, None] >= idx[None, :])
        mem = mem0
        outs = []
        for s in range(n_seg):
            xs = x[:, s * seg_len:(s + 1) * seg_len, :].clone()
            h = torch.concatenate([mem, xs], axis=1)
            q = torch.einsum('btd,dhe->bhte', h, Wq)
            k = torch.einsum('btd,dhe->bhte', h, Wk)
            v = torch.einsum('btd,dhe->bhte', h, Wv)
            scores = torch.einsum('bhqe,bhke->bhqk', q, k) * scale
            scores = torch.where(mask[None, None], scores, -1000000000.0)
            p = _softmax(scores, axis=-1)
            o = torch.einsum('bhqk,bhke->bhqe', p, v)
            o = torch.einsum('bhte,hed->btd', o, Wo)
            mem = o[:, :M, :].clone()
            outs.append(o[:, M:, :])
        return torch.concatenate(outs, axis=1)

    def _B_ref(x, w1, b1, w2):
        h = torch.einsum('bsd,df->bsf', x, w1) + b1
        sp = torch.log1p(torch.exp(-torch.abs(h))) + torch.where(h > 0, h, torch.zeros_like(h))
        act = h * torch.tanh(sp)
        return torch.einsum('bsf,fd->bsd', act, w2)
    x = A_x
    mod = (_silu(c) @ w_mod).reshape(c.shape[0], 6, 1, -1)
    sa, ca, ga, sb, cb, gb = (mod[:, 0].clone(), mod[:, 1].clone(), mod[:, 2].clone(), mod[:, 3].clone(), mod[:, 4].clone(), mod[:, 5].clone())
    h = _layernorm(x, axis=-1) * (1 + ca) + sa
    x = x + ga * _A_ref(h, A_mem0, A_Wq, A_Wk, A_Wv, A_Wo, A_seg_len)
    h = _layernorm(x, axis=-1) * (1 + cb) + sb
    x = x + gb * _B_ref(h, B_w1, B_b1, B_w2)
    return x
```

```asm
; @launch grid=(256,1,1) block=(256,1,1) lds=163840
.amdgcn_target "amdgcn-amd-amdhsa--gfx950"
.text
.globl adaLN_cond__memory_aug_recurrent_mem_tr__dense_activation_mish__prompt_kernel
.p2align 8
.type adaLN_cond__memory_aug_recurrent_mem_tr__dense_activation_mish__prompt_kernel,@function
adaLN_cond__memory_aug_recurrent_mem_tr__dense_activation_mish__prompt_kernel:
    s_cmp_ge_u32 s2, 256
    s_cbranch_scc1 L_exit
    s_load_dwordx4 s[4:7], s[0:1], 112
    s_getpc_b64 s[56:57]
L0_pc:
    s_getreg_b32 s14, hwreg(HW_REG_XCC_ID)
    s_and_b32 s14, s14, 15
    v_lshrrev_b32 v1, 6, v0
    s_mov_b32 s15, 0
    v_readfirstlane_b32 s12, v1
    v_and_b32 v2, 63, v0
    v_lshlrev_b32 v2, 4, v2
    s_and_b32 s16, s14, 7
    s_lshl_b32 s16, s16, 5
    s_lshr_b32 s18, s14, 3
    s_lshl_b32 s18, s18, 2
    s_add_u32 s16, s16, s18
    s_mov_b32 s58, L_code_end - L0_pc
    s_mov_b32 s59, 0x00020000
    s_lshr_b32 s20, s2, 3
    s_lshl_b32 s20, s20, 2
    s_add_u32 s20, s20, s12
    s_lshl_b32 s20, s20, 10
    buffer_load_dwordx4 v[240:243], v2, s[56:59], s20 offen
    s_waitcnt lgkmcnt(0)
    s_mov_b32 s8, s6
    s_mov_b32 s9, s7
    s_mov_b32 s10, 268435456
    s_mov_b32 s11, 0x00020000
    s_mov_b32 s84, s4
    s_mov_b32 s85, s5
    s_mov_b32 s86, 256
    s_mov_b32 s87, 0x00020000
    s_add_u32 s50, s6, 44797952
    s_addc_u32 s51, s7, 0
    s_load_dword s17, s[50:51], 0
    s_waitcnt lgkmcnt(0)
    s_add_u32 s17, s17, 1
    s_max_u32 s17, s17, 1
    s_load_dwordx8 s[40:47], s[0:1], 16
    s_load_dwordx2 s[48:49], s[0:1], 8
    s_load_dwordx4 s[52:55], s[0:1], 88
    v_and_b32 v2, 63, v0
    v_lshrrev_b32 v3, 4, v2
    v_and_b32 v4, 15, v2
    s_and_b32 s13, s2, 7
    s_lshr_b32 s18, s2, 3
    s_lshr_b32 s19, s13, 1
    s_lshl_b32 s19, s19, 2
    s_lshr_b32 s20, s18, 3
    s_add_u32 s19, s19, s20
    s_and_b32 s22, s18, 3
    s_bfe_u32 s20, s18, 0x10002
    s_waitcnt lgkmcnt(0)
    s_mov_b32 s64, s54
    s_mov_b32 s65, s55
    s_mov_b32 s66, 2408448
    s_mov_b32 s67, 0x00020000
    s_mov_b32 s68, s52
    s_mov_b32 s69, s53
    s_mov_b32 s70, 896
    s_mov_b32 s71, 0x00020000
    s_mov_b32 s72, s48
    s_mov_b32 s73, s49
    s_mov_b32 s74, 7168
    s_mov_b32 s75, 0x00020000
    v_lshrrev_b32 v5, 2, v0
    v_and_b32 v6, 3, v0
    v_mul_u32_u24 v7, 5376, v5
    v_lshl_add_u32 v7, v6, 3, v7
    v_lshlrev_b32 v8, 1, v5
    s_mul_i32 s39, s13, 21
    s_add_u32 s39, s39, s18
    s_lshl_b32 s30, s39, 5
    s_cmp_lt_u32 s2, 168
    s_cselect_b32 s30, s30, 1073741824
    buffer_load_dwordx2 v[192:193], v7, s[64:67], s30 offen
    buffer_load_ushort v206, v8, s[68:71], 0 offen offset:0
    s_add_u32 s30, s30, 344064
    buffer_load_dwordx2 v[194:195], v7, s[64:67], s30 offen
    buffer_load_ushort v207, v8, s[68:71], 0 offen offset:128
    s_add_u32 s30, s30, 344064
    buffer_load_dwordx2 v[196:197], v7, s[64:67], s30 offen
    buffer_load_ushort v208, v8, s[68:71], 0 offen offset:256
    s_add_u32 s30, s30, 344064
    buffer_load_dwordx2 v[198:199], v7, s[64:67], s30 offen
    buffer_load_ushort v209, v8, s[68:71], 0 offen offset:384
    s_add_u32 s30, s30, 344064
    buffer_load_dwordx2 v[200:201], v7, s[64:67], s30 offen
    buffer_load_ushort v210, v8, s[68:71], 0 offen offset:512
    s_add_u32 s30, s30, 344064
    buffer_load_dwordx2 v[202:203], v7, s[64:67], s30 offen
    buffer_load_ushort v211, v8, s[68:71], 0 offen offset:640
    s_add_u32 s30, s30, 344064
    buffer_load_dwordx2 v[204:205], v7, s[64:67], s30 offen
    buffer_load_ushort v212, v8, s[68:71], 0 offen offset:768
    v_bfe_u32 v9, v0, 3, 3
    v_mul_u32_u24 v9, 896, v9
    v_bfe_u32 v10, v0, 1, 1
    v_lshl_add_u32 v9, v10, 5, v9
    v_bfe_u32 v10, v0, 7, 1
    v_lshl_add_u32 v9, v10, 4, v9
    v_bfe_u32 v10, v0, 2, 1
    v_lshl_add_u32 v9, v10, 3, v9
    v_bfe_u32 v10, v0, 6, 1
    v_lshl_add_u32 v9, v10, 2, v9
    v_bfe_u32 v10, v0, 0, 1
    v_lshl_add_u32 v9, v10, 1, v9
    s_lshl_b32 s30, s2, 6
    s_cmp_lt_u32 s2, 14
    s_cselect_b32 s30, s30, 1073741824
    buffer_load_ushort v213, v9, s[72:75], s30 offen
    s_bitcmp1_b32 s2, 0
    s_cbranch_scc1 L0_B
    s_mov_b32 s56, s40
    s_mov_b32 s57, s41
    s_mov_b32 s58, 3670016
    s_mov_b32 s59, 0x00020000
    s_mov_b32 s60, s42
    s_mov_b32 s61, s43
    s_mov_b32 s62, 3670016
    s_mov_b32 s63, 0x00020000
    v_lshlrev_b32 v145, 4, v2
    s_lshl_b32 s21, s12, 1
    s_mul_i32 s20, s20, 7
    s_add_u32 s21, s21, s20
    s_lshl_b32 s23, s19, 9
    s_lshl_b32 s24, s21, 18
    s_add_u32 s24, s24, s23
    s_cmp_eq_u32 s12, 3
    s_cselect_b32 s25, 1073741824, 0
    v_add_u32 v146, s25, v145
    s_add_u32 s25, s25, s24
    s_lshl_b32 s38, s12, 14
    v_lshrrev_b32 v11, 5, v2
    v_and_b32 v12, 31, v2
    v_add_u32 v9, 0, v11
    v_xor_b32 v9, v9, v12
    v_lshlrev_b32 v9, 4, v9
    v_lshl_add_u32 v160, v11, 13, v9
    v_add_u32 v9, 2, v11
    v_xor_b32 v9, v9, v12
    v_lshlrev_b32 v9, 4, v9
    v_lshl_add_u32 v161, v11, 13, v9
    v_add_u32 v9, 4, v11
    v_xor_b32 v9, v9, v12
    v_lshlrev_b32 v9, 4, v9
    v_lshl_add_u32 v162, v11, 13, v9
    v_add_u32 v9, 6, v11
    v_xor_b32 v9, v9, v12
    v_lshlrev_b32 v9, 4, v9
    v_lshl_add_u32 v163, v11, 13, v9
    v_add_u32 v9, 8, v11
    v_xor_b32 v9, v9, v12
    v_lshlrev_b32 v9, 4, v9
    v_lshl_add_u32 v164, v11, 13, v9
    v_add_u32 v9, 10, v11
    v_xor_b32 v9, v9, v12
    v_lshlrev_b32 v9, 4, v9
    v_lshl_add_u32 v165, v11, 13, v9
    v_add_u32 v9, 12, v11
    v_xor_b32 v9, v9, v12
    v_lshlrev_b32 v9, 4, v9
    v_lshl_add_u32 v166, v11, 13, v9
    v_add_u32 v9, 14, v11
    v_xor_b32 v9, v9, v12
    v_lshlrev_b32 v9, 4, v9
    v_lshl_add_u32 v167, v11, 13, v9
    s_add_u32 m0, s38, 0
    s_add_u32 s30, s24, 0
    buffer_load_dwordx4 v160, s[56:59], s30 offen nt lds
    s_add_u32 m0, s38, 1024
    s_add_u32 s30, s24, 16384
    buffer_load_dwordx4 v161, s[56:59], s30 offen nt lds
    s_add_u32 m0, s38, 2048
    s_add_u32 s30, s24, 32768
    buffer_load_dwordx4 v162, s[56:59], s30 offen nt lds
    s_add_u32 m0, s38, 3072
    s_add_u32 s30, s24, 49152
    buffer_load_dwordx4 v163, s[56:59], s30 offen nt lds
    s_add_u32 m0, s38, 4096
    s_add_u32 s30, s24, 65536
    buffer_load_dwordx4 v164, s[56:59], s30 offen nt lds
    s_add_u32 m0, s38, 5120
    s_add_u32 s30, s24, 81920
    buffer_load_dwordx4 v165, s[56:59], s30 offen nt lds
    s_add_u32 m0, s38, 6144
    s_add_u32 s30, s24, 98304
    buffer_load_dwordx4 v166, s[56:59], s30 offen nt lds
    s_add_u32 m0, s38, 7168
    s_add_u32 s30, s24, 114688
    buffer_load_dwordx4 v167, s[56:59], s30 offen nt lds
    s_add_u32 m0, s38, 8192
    s_add_u32 s30, s24, 131072
    buffer_load_dwordx4 v160, s[56:59], s30 offen nt lds
    s_add_u32 m0, s38, 9216
    s_add_u32 s30, s24, 147456
    buffer_load_dwordx4 v161, s[56:59], s30 offen nt lds
    s_add_u32 m0, s38, 10240
    s_add_u32 s30, s24, 163840
    buffer_load_dwordx4 v162, s[56:59], s30 offen nt lds
    s_add_u32 m0, s38, 11264
    s_add_u32 s30, s24, 180224
    buffer_load_dwordx4 v163, s[56:59], s30 offen nt lds
    s_add_u32 m0, s38, 12288
    s_add_u32 s30, s24, 196608
    buffer_load_dwordx4 v164, s[56:59], s30 offen nt lds
    s_add_u32 m0, s38, 13312
    s_add_u32 s30, s24, 212992
    buffer_load_dwordx4 v165, s[56:59], s30 offen nt lds
    s_add_u32 m0, s38, 14336
    s_add_u32 s30, s24, 229376
    buffer_load_dwordx4 v166, s[56:59], s30 offen nt lds
    s_add_u32 m0, s38, 15360
    s_add_u32 s30, s24, 245760
    buffer_load_dwordx4 v167, s[56:59], s30 offen nt lds
    s_lshl_b32 s30, s22, 3
    s_lshr_b32 s36, 185009152, s30
    s_and_b32 s36, s36, 255
    s_lshr_b32 s37, 168428291, s30
    s_and_b32 s37, s37, 255
    s_lshl_b32 s36, s36, 18
    s_lshl_b32 s37, s37, 18
    s_and_b32 s30, s22, 1
    s_lshl_b32 s30, s30, 14
    s_add_u32 s37, s37, s30
    s_lshl_b32 s30, s12, 15
    s_add_u32 s30, s30, s23
    s_add_u32 s36, s36, s30
    s_add_u32 s37, s37, s30
    s_lshl_b32 s31, s12, 11
    s_lshl_b32 s32, s12, 2
    s_add_u32 s33, s32, 0
    v_add_u32 v9, s33, v11
    v_xor_b32 v9, v9, v12
    v_lshlrev_b32 v9, 4, v9
    v_lshl_add_u32 v148, v11, 13, v9
    s_add_u32 s33, s32, 2
    v_add_u32 v9, s33, v11
    v_xor_b32 v9, v9, v12
    v_lshlrev_b32 v9, 4, v9
    v_lshl_add_u32 v149, v11, 13, v9
    s_add_u32 m0, s31, 65536
    s_add_u32 s30, s36, 0
    buffer_load_dwordx4 v148, s[60:63], s30 offen nt lds
    s_add_u32 m0, s31, 66560
    s_add_u32 s30, s36, 131072
    buffer_load_dwordx4 v149, s[60:63], s30 offen nt lds
    s_add_u32 m0, s31, 73728
    s_add_u32 s30, s36, 16384
    buffer_load_dwordx4 v148, s[60:63], s30 offen nt lds
    s_add_u32 m0, s31, 74752
    s_add_u32 s30, s36, 147456
    buffer_load_dwordx4 v149, s[60:63], s30 offen nt lds
    s_add_u32 m0, s31, 81920
    s_add_u32 s30, s36, 262144
    buffer_load_dwordx4 v148, s[60:63], s30 offen nt lds
    s_add_u32 m0, s31, 82944
    s_add_u32 s30, s36, 393216
    buffer_load_dwordx4 v149, s[60:63], s30 offen nt lds
    s_add_u32 m0, s31, 90112
    s_add_u32 s30, s36, 278528
    buffer_load_dwordx4 v148, s[60:63], s30 offen nt lds
    s_add_u32 m0, s31, 91136
    s_add_u32 s30, s36, 409600
    buffer_load_dwordx4 v149, s[60:63], s30 offen nt lds
    s_add_u32 m0, s31, 98304
    s_add_u32 s30, s36, 524288
    buffer_load_dwordx4 v148, s[60:63], s30 offen nt lds
    s_add_u32 m0, s31, 99328
    s_add_u32 s30, s36, 655360
    buffer_load_dwordx4 v149, s[60:63], s30 offen nt lds
    s_add_u32 m0, s31, 106496
    s_add_u32 s30, s36, 540672
    buffer_load_dwordx4 v148, s[60:63], s30 offen nt lds
    s_add_u32 m0, s31, 107520
    s_add_u32 s30, s36, 671744
    buffer_load_dwordx4 v149, s[60:63], s30 offen nt lds
    s_add_u32 m0, s31, 114688
    s_add_u32 s30, s37, 0
    buffer_load_dwordx4 v148, s[60:63], s30 offen nt lds
    s_add_u32 m0, s31, 115712
    s_add_u32 s30, s37, 131072
    buffer_load_dwordx4 v149, s[60:63], s30 offen nt lds
    s_mov_b32 s34, 1035512379
    s_mul_i32 s30, s19, 401408
    s_mul_i32 s31, s22, 100352
    s_add_u32 s30, s30, s31
    s_lshl_b32 s31, s21, 10
    s_add_u32 s30, s30, s31
    s_add_u32 s40, s30, 0
    s_add_u32 s41, s30, 14336
    s_add_u32 s42, s30, 28672
    s_add_u32 s43, s30, 43008
    s_add_u32 s44, s30, 57344
    s_add_u32 s45, s30, 71680
    s_add_u32 s46, s30, 86016
    v_add_u32 v9, 0, v3
    v_xor_b32 v9, v9, v4
    v_lshlrev_b32 v9, 4, v9
    v_lshl_add_u32 v9, v4, 9, v9
    v_add_u32 v168, s38, v9
    v_add_u32 v172, 65536, v9
    v_add_u32 v9, 4, v3
    v_xor_b32 v9, v9, v4
    v_lshlrev_b32 v9, 4, v9
    v_lshl_add_u32 v9, v4, 9, v9
    v_add_u32 v169, s38, v9
    v_add_u32 v173, 65536, v9
    v_add_u32 v9, 8, v3
    v_xor_b32 v9, v9, v4
    v_lshlrev_b32 v9, 4, v9
    v_lshl_add_u32 v9, v4, 9, v9
    v_add_u32 v170, s38, v9
    v_add_u32 v174, 65536, v9
    v_add_u32 v9, 12, v3
    v_xor_b32 v9, v9, v4
    v_lshlrev_b32 v9, 4, v9
    v_lshl_add_u32 v9, v4, 9, v9
    v_add_u32 v171, s38, v9
    v_add_u32 v175, 65536, v9
    v_mov_b32 v128, -1
    v_mov_b32 v132, 0
    v_mov_b32 v129, -1
    v_mov_b32 v133, 0
    v_mov_b32 v130, -1
    v_mov_b32 v134, 0
    v_mov_b32 v131, -1
    v_mov_b32 v135, 0
    s_mul_i32 s30, s2, 148
    v_add_u32 v9, s30, v0
    v_lshlrev_b32 v9, 4, v9
    v_add_u32 v10, 8192, v9
    v_cmp_le_u32 vcc, 516096, v9
    v_mov_b32 v11, 1073741824
    s_nop 0
    v_cndmask_b32 v9, v9, v10, vcc
    v_cmp_gt_u32 vcc, 148, v0
    s_nop 1
    v_cndmask_b32 v9, v11, v9, vcc
    s_mov_b32 s30, 44048384
    buffer_store_dwordx4 v[128:131], v9, s[8:11], s30 offen sc1
    v_lshlrev_b32 v9, 4, v0
    v_cmp_gt_u32 vcc, 32, v0
    s_lshl_b32 s30, s2, 9
    s_add_u32 s30, s30, 44662784
    v_cndmask_b32 v9, v11, v9, vcc
    buffer_store_dwordx4 v[132:135], v9, s[8:11], s30 offen sc1
    s_cmp_eq_u32 s12, 0
    s_cselect_b32 s30, s16, 1073741824
    v_mov_b32 v190, 1
    s_mov_b64 exec, 1
    buffer_atomic_add v190, off, s[84:87], s30 sc0
    s_mov_b64 exec, -1
    s_waitcnt vmcnt(33)
    s_mov_b32 s30, 3216550459
    v_mov_b32 v12, 0
    v_mov_b32 v13, 0
    v_mov_b32 v14, 0
    v_mov_b32 v15, 0
    v_lshlrev_b32 v206, 16, v206
    v_mul_f32 v9, s30, v206
    v_exp_f32 v9, v9
    s_nop 0
    v_add_f32 v9, 1.0, v9
    v_rcp_f32 v9, v9
    s_nop 0
    v_mul_f32 v206, v206, v9
    v_lshlrev_b32 v10, 16, v192
    v_and_b32 v11, 0xffff0000, v192
    v_fmac_f32 v12, v10, v206
    v_fmac_f32 v13, v11, v206
    v_lshlrev_b32 v10, 16, v193
    v_and_b32 v11, 0xffff0000, v193
    v_fmac_f32 v14, v10, v206
    v_fmac_f32 v15, v11, v206
    v_lshlrev_b32 v207, 16, v207
    v_mul_f32 v9, s30, v207
    v_exp_f32 v9, v9
    s_nop 0
    v_add_f32 v9, 1.0, v9
    v_rcp_f32 v9, v9
    s_nop 0
    v_mul_f32 v207, v207, v9
    v_lshlrev_b32 v10, 16, v194
    v_and_b32 v11, 0xffff0000, v194
    v_fmac_f32 v12, v10, v207
    v_fmac_f32 v13, v11, v207
    v_lshlrev_b32 v10, 16, v195
    v_and_b32 v11, 0xffff0000, v195
    v_fmac_f32 v14, v10, v207
    v_fmac_f32 v15, v11, v207
    v_lshlrev_b32 v208, 16, v208
    v_mul_f32 v9, s30, v208
    v_exp_f32 v9, v9
    s_nop 0
    v_add_f32 v9, 1.0, v9
    v_rcp_f32 v9, v9
    s_nop 0
    v_mul_f32 v208, v208, v9
    v_lshlrev_b32 v10, 16, v196
    v_and_b32 v11, 0xffff0000, v196
    v_fmac_f32 v12, v10, v208
    v_fmac_f32 v13, v11, v208
    v_lshlrev_b32 v10, 16, v197
    v_and_b32 v11, 0xffff0000, v197
    v_fmac_f32 v14, v10, v208
    v_fmac_f32 v15, v11, v208
    v_lshlrev_b32 v209, 16, v209
    v_mul_f32 v9, s30, v209
    v_exp_f32 v9, v9
    s_nop 0
    v_add_f32 v9, 1.0, v9
    v_rcp_f32 v9, v9
    s_nop 0
    v_mul_f32 v209, v209, v9
    v_lshlrev_b32 v10, 16, v198
    v_and_b32 v11, 0xffff0000, v198
    v_fmac_f32 v12, v10, v209
    v_fmac_f32 v13, v11, v209
    v_lshlrev_b32 v10, 16, v199
    v_and_b32 v11, 0xffff0000, v199
    v_fmac_f32 v14, v10, v209
    v_fmac_f32 v15, v11, v209
    v_lshlrev_b32 v210, 16, v210
    v_mul_f32 v9, s30, v210
    v_exp_f32 v9, v9
    s_nop 0
    v_add_f32 v9, 1.0, v9
    v_rcp_f32 v9, v9
    s_nop 0
    v_mul_f32 v210, v210, v9
    v_lshlrev_b32 v10, 16, v200
    v_and_b32 v11, 0xffff0000, v200
    v_fmac_f32 v12, v10, v210
    v_fmac_f32 v13, v11, v210
    v_lshlrev_b32 v10, 16, v201
    v_and_b32 v11, 0xffff0000, v201
    v_fmac_f32 v14, v10, v210
    v_fmac_f32 v15, v11, v210
    v_lshlrev_b32 v211, 16, v211
    v_mul_f32 v9, s30, v211
    v_exp_f32 v9, v9
    s_nop 0
    v_add_f32 v9, 1.0, v9
    v_rcp_f32 v9, v9
    s_nop 0
    v_mul_f32 v211, v211, v9
    v_lshlrev_b32 v10, 16, v202
    v_and_b32 v11, 0xffff0000, v202
    v_fmac_f32 v12, v10, v211
    v_fmac_f32 v13, v11, v211
    v_lshlrev_b32 v10, 16, v203
    v_and_b32 v11, 0xffff0000, v203
    v_fmac_f32 v14, v10, v211
    v_fmac_f32 v15, v11, v211
    v_lshlrev_b32 v212, 16, v212
    v_mul_f32 v9, s30, v212
    v_exp_f32 v9, v9
    s_nop 0
    v_add_f32 v9, 1.0, v9
    v_rcp_f32 v9, v9
    s_nop 0
    v_mul_f32 v212, v212, v9
    v_lshlrev_b32 v10, 16, v204
    v_and_b32 v11, 0xffff0000, v204
    v_fmac_f32 v12, v10, v212
    v_fmac_f32 v13, v11, v212
    v_lshlrev_b32 v10, 16, v205
    v_and_b32 v11, 0xffff0000, v205
    v_fmac_f32 v14, v10, v212
    v_fmac_f32 v15, v11, v212
    s_nop 1
    v_add_f32_dpp v12, v12, v12 row_ror:4 row_mask:0xf bank_mask:0xf
    v_add_f32_dpp v13, v13, v13 row_ror:4 row_mask:0xf bank_mask:0xf
    v_add_f32_dpp v14, v14, v14 row_ror:4 row_mask:0xf bank_mask:0xf
    v_add_f32_dpp v15, v15, v15 row_ror:4 row_mask:0xf bank_mask:0xf
    s_nop 1
    v_add_f32_dpp v12, v12, v12 row_ror:8 row_mask:0xf bank_mask:0xf
    v_add_f32_dpp v13, v13, v13 row_ror:8 row_mask:0xf bank_mask:0xf
    v_add_f32_dpp v14, v14, v14 row_ror:8 row_mask:0xf bank_mask:0xf
    v_add_f32_dpp v15, v15, v15 row_ror:8 row_mask:0xf bank_mask:0xf
    v_lshrrev_b32 v9, 4, v0
    v_lshlrev_b32 v9, 6, v9
    v_lshl_add_u32 v9, v6, 4, v9
    v_add_u32 v9, 131072, v9
    ds_write_b128 v9, v[12:15]
    s_waitcnt vmcnt(17)
    ds_read_b128 a[0:3], v168 offset:0
    ds_read_b128 a[4:7], v168 offset:8192
    ds_read_b128 a[8:11], v169 offset:0
    ds_read_b128 a[12:15], v169 offset:8192
    ds_read_b128 a[16:19], v170 offset:0
    ds_read_b128 a[20:23], v170 offset:8192
    ds_read_b128 a[24:27], v171 offset:0
    ds_read_b128 a[28:31], v171 offset:8192
    ds_read_b128 a[32:35], v168 offset:256
    ds_read_b128 a[36:39], v168 offset:8448
    ds_read_b128 a[40:43], v169 offset:256
    ds_read_b128 a[44:47], v169 offset:8448
    ds_read_b128 a[48:51], v170 offset:256
    ds_read_b128 a[52:55], v170 offset:8448
    ds_read_b128 a[56:59], v171 offset:256
    ds_read_b128 a[60:63], v171 offset:8448
    s_waitcnt lgkmcnt(0)
    s_add_u32 m0, s38, 0
    s_add_u32 s30, s25, 262144
    buffer_load_dwordx4 v160, s[56:59], s30 offen nt lds
    s_add_u32 m0, s38, 1024
    s_add_u32 s30, s25, 278528
    buffer_load_dwordx4 v161, s[56:59], s30 offen nt lds
    s_add_u32 m0, s38, 2048
    s_add_u32 s30, s25, 294912
    buffer_load_dwordx4 v162, s[56:59], s30 offen nt lds
    s_add_u32 m0, s38, 3072
    s_add_u32 s30, s25, 311296
    buffer_load_dwordx4 v163, s[56:59], s30 offen nt lds
    s_add_u32 m0, s38, 4096
    s_add_u32 s30, s25, 327680
    buffer_load_dwordx4 v164, s[56:59], s30 offen nt lds
    s_add_u32 m0, s38, 5120
    s_add_u32 s30, s25, 344064
    buffer_load_dwordx4 v165, s[56:59], s30 offen nt lds
    s_add_u32 m0, s38, 6144
    s_add_u32 s30, s25, 360448
    buffer_load_dwordx4 v166, s[56:59], s30 offen nt lds
    s_add_u32 m0, s38, 7168
    s_add_u32 s30, s25, 376832
    buffer_load_dwordx4 v167, s[56:59], s30 offen nt lds
    s_add_u32 m0, s38, 8192
    s_add_u32 s30, s25, 393216
    buffer_load_dwordx4 v160, s[56:59], s30 offen nt lds
    s_add_u32 m0, s38, 9216
    s_add_u32 s30, s25, 409600
    buffer_load_dwordx4 v161, s[56:59], s30 offen nt lds
    s_add_u32 m0, s38, 10240
    s_add_u32 s30, s25, 425984
    buffer_load_dwordx4 v162, s[56:59], s30 offen nt lds
    s_add_u32 m0, s38, 11264
    s_add_u32 s30, s25, 442368
    buffer_load_dwordx4 v163, s[56:59], s30 offen nt lds
    s_add_u32 m0, s38, 12288
    s_add_u32 s30, s25, 458752
    buffer_load_dwordx4 v164, s[56:59], s30 offen nt lds
    s_add_u32 m0, s38, 13312
    s_add_u32 s30, s25, 475136
    buffer_load_dwordx4 v165, s[56:59], s30 offen nt lds
    s_add_u32 m0, s38, 14336
    s_add_u32 s30, s25, 491520
    buffer_load_dwordx4 v166, s[56:59], s30 offen nt lds
    s_add_u32 m0, s38, 15360
    s_add_u32 s30, s25, 507904
    buffer_load_dwordx4 v167, s[56:59], s30 offen nt lds
    s_waitcnt vmcnt(16)
    s_barrier
    v_lshlrev_b32 v9, 2, v2
    v_add_u32 v9, 131072, v9
    ds_read_b32 v12, v9 offset:0
    ds_read_b32 v13, v9 offset:256
    ds_read_b32 v14, v9 offset:512
    ds_read_b32 v15, v9 offset:768
    s_waitcnt lgkmcnt(0)
    v_add_f32 v12, v12, v13
    v_add_f32 v14, v14, v15
    v_add_f32 v12, v12, v14
    v_mov_b32 v13, v12
    s_nop 1
    v_permlane16_swap_b32 v12, v13
    v_add_f32 v12, v12, v13
    v_mov_b32 v13, v12
    s_nop 1
    v_permlane32_swap_b32 v12, v13
    v_add_f32 v12, v12, v13
    v_lshlrev_b32 v9, 2, v4
    s_lshl_b32 s30, s39, 6
    s_add_u32 s30, s30, 44859392
    s_cmp_lt_u32 s2, 168
    s_cselect_b32 s30, s30, 1073741824
    s_cmp_eq_u32 s12, 0
    s_cselect_b32 s30, s30, 1073741824
    buffer_store_dword v12, v9, s[8:11], s30 offen sc1
    v_min_u32 v213, 0xfffe, v213
    v_lshlrev_b32 v9, 1, v0
    s_lshl_b32 s30, s2, 9
    s_cmp_lt_u32 s2, 14
    s_cselect_b32 s30, s30, 1073741824
    s_add_u32 s31, s30, 44564480
    s_add_u32 s30, s30, 44040192
    buffer_store_short v213, v9, s[8:11], s30 offen sc1
    buffer_store_short v213, v9, s[8:11], s31 offen sc1
    ds_read_b128 v[128:131], v172 offset:0
    ds_read_b128 v[132:135], v173 offset:0
    ds_read_b128 v[136:139], v174 offset:0
    s_waitcnt lgkmcnt(2)
    v_mfma_f32_16x16x32_bf16 v[16:19], a[0:3], v[128:131], 0
    v_mfma_f32_16x16x32_bf16 v[20:23], a[4:7], v[128:131], 0
    ds_read_b128 v[128:131], v175 offset:0
    s_waitcnt lgkmcnt(2)
    v_mfma_f32_16x16x32_bf16 v[16:19], a[8:11], v[132:135], v[16:19]
    v_mfma_f32_16x16x32_bf16 v[20:23], a[12:15], v[132:135], v[20:23]
    ds_read_b128 v[132:135], v172 offset:256
    s_waitcnt lgkmcnt(2)
    v_mfma_f32_16x16x32_bf16 v[16:19], a[16:19], v[136:139], v[16:19]
    v_mfma_f32_16x16x32_bf16 v[20:23], a[20:23], v[136:139], v[20:23]
    ds_read_b128 v[136:139], v173 offset:256
    s_waitcnt lgkmcnt(2)
    v_mfma_f32_16x16x32_bf16 v[16:19], a[24:27], v[128:131], v[16:19]
    v_mfma_f32_16x16x32_bf16 v[20:23], a[28:31], v[128:131], v[20:23]
    ds_read_b128 v[128:131], v174 offset:256
    s_waitcnt lgkmcnt(2)
    v_mfma_f32_16x16x32_bf16 v[16:19], a[32:35], v[132:135], v[16:19]
    v_mfma_f32_16x16x32_bf16 v[20:23], a[36:39], v[132:135], v[20:23]
    ds_read_b128 v[132:135], v175 offset:256
    s_waitcnt lgkmcnt(2)
    v_mfma_f32_16x16x32_bf16 v[16:19], a[40:43], v[136:139], v[16:19]
    v_mfma_f32_16x16x32_bf16 v[20:23], a[44:47], v[136:139], v[20:23]
    ds_read_b128 v[136:139], v172 offset:8192
    s_waitcnt lgkmcnt(2)
    v_mfma_f32_16x16x32_bf16 v[16:19], a[48:51], v[128:131], v[16:19]
    v_mfma_f32_16x16x32_bf16 v[20:23], a[52:55], v[128:131], v[20:23]
    ds_read_b128 v[128:131], v173 offset:8192
    s_waitcnt lgkmcnt(2)
    v_mfma_f32_16x16x32_bf16 v[16:19], a[56:59], v[132:135], v[16:19]
    v_mfma_f32_16x16x32_bf16 v[20:23], a[60:63], v[132:135], v[20:23]
    ds_read_b128 v[132:135], v174 offset:8192
    s_waitcnt lgkmcnt(2)
    v_mfma_f32_16x16x32_bf16 v[32:35], a[0:3], v[136:139], 0
    v_mfma_f32_16x16x32_bf16 v[36:39], a[4:7], v[136:139], 0
    ds_read_b128 v[136:139], v175 offset:8192
    s_waitcnt lgkmcnt(2)
    v_mfma_f32_16x16x32_bf16 v[32:35], a[8:11], v[128:131], v[32:35]
    v_mfma_f32_16x16x32_bf16 v[36:39], a[12:15], v[128:131], v[36:39]
    ds_read_b128 v[128:131], v172 offset:8448
    s_waitcnt lgkmcnt(2)
    v_mfma_f32_16x16x32_bf16 v[32:35], a[16:19], v[132:135], v[32:35]
    v_mfma_f32_16x16x32_bf16 v[36:39], a[20:23], v[132:135], v[36:39]
    ds_read_b128 v[132:135], v173 offset:8448
    s_waitcnt lgkmcnt(2)
    v_mfma_f32_16x16x32_bf16 v[32:35], a[24:27], v[136:139], v[32:35]
    v_mfma_f32_16x16x32_bf16 v[36:39], a[28:31], v[136:139], v[36:39]
    ds_read_b128 v[136:139], v174 offset:8448
    s_waitcnt lgkmcnt(2)
    v_mfma_f32_16x16x32_bf16 v[32:35], a[32:35], v[128:131], v[32:35]
    v_mfma_f32_16x16x32_bf16 v[36:39], a[36:39], v[128:131], v[36:39]
    ds_read_b128 v[128:131], v175 offset:8448
    s_waitcnt lgkmcnt(2)
    v_mfma_f32_16x16x32_bf16 v[32:35], a[40:43], v[132:135], v[32:35]
    v_mfma_f32_16x16x32_bf16 v[36:39], a[44:47], v[132:135], v[36:39]
    ds_read_b128 v[132:135], v172 offset:16384
    s_waitcnt lgkmcnt(2)
    v_mfma_f32_16x16x32_bf16 v[32:35], a[48:51], v[136:139], v[32:35]
    v_mfma_f32_16x16x32_bf16 v[36:39], a[52:55], v[136:139], v[36:39]
    ds_read_b128 v[136:139], v173 offset:16384
    s_waitcnt lgkmcnt(2)
    v_mfma_f32_16x16x32_bf16 v[32:35], a[56:59], v[128:131], v[32:35]
    v_mfma_f32_16x16x32_bf16 v[36:39], a[60:63], v[128:131], v[36:39]
    ds_read_b128 v[128:131], v174 offset:16384
    s_waitcnt lgkmcnt(2)
    v_mfma_f32_16x16x32_bf16 v[48:51], a[0:3], v[132:135], 0
    v_mfma_f32_16x16x32_bf16 v[52:55], a[4:7], v[132:135], 0
    ds_read_b128 v[132:135], v175 offset:16384
    s_waitcnt lgkmcnt(2)
    v_mfma_f32_16x16x32_bf16 v[48:51], a[8:11], v[136:139], v[48:51]
    v_mfma_f32_16x16x32_bf16 v[52:55], a[12:15], v[136:139], v[52:55]
    ds_read_b128 v[136:139], v172 offset:16640
    s_waitcnt lgkmcnt(2)
    v_mfma_f32_16x16x32_bf16 v[48:51], a[16:19], v[128:131], v[48:51]
    v_mfma_f32_16x16x32_bf16 v[52:55], a[20:23], v[128:131], v[52:55]
    ds_read_b128 v[128:131], v173 offset:16640
    s_waitcnt lgkmcnt(2)
    v_mfma_f32_16x16x32_bf16 v[48:51], a[24:27], v[132:135], v[48:51]
    v_mfma_f32_16x16x32_bf16 v[52:55], a[28:31], v[132:135], v[52:55]
    ds_read_b128 v[132:135], v174 offset:16640
    s_waitcnt lgkmcnt(2)
    v_mfma_f32_16x16x32_bf16 v[48:51], a[32:35], v[136:139], v[48:51]
    v_mfma_f32_16x16x32_bf16 v[52:55], a[36:39], v[136:139], v[52:55]
    ds_read_b128 v[136:139], v175 offset:16640
    s_waitcnt lgkmcnt(2)
    v_mfma_f32_16x16x32_bf16 v[48:51], a[40:43], v[128:131], v[48:51]
    v_mfma_f32_16x16x32_bf16 v[52:55], a[44:47], v[128:131], v[52:55]
    ds_read_b128 v[128:131], v172 offset:24576
    s_waitcnt lgkmcnt(2)
    v_mfma_f32_16x16x32_bf16 v[48:51], a[48:51], v[132:135], v[48:51]
    v_mfma_f32_16x16x32_bf16 v[52:55], a[52:55], v[132:135], v[52:55]
    ds_read_b128 v[132:135], v173 offset:24576
    s_waitcnt lgkmcnt(2)
    v_mfma_f32_16x16x32_bf16 v[48:51], a[56:59], v[136:139], v[48:51]
    v_mfma_f32_16x16x32_bf16 v[52:55], a[60:63], v[136:139], v[52:55]
    ds_read_b128 v[136:139], v174 offset:24576
    s_waitcnt lgkmcnt(2)
    v_mfma_f32_16x16x32_bf16 v[64:67], a[0:3], v[128:131], 0
    v_mfma_f32_16x16x32_bf16 v[68:71], a[4:7], v[128:131], 0
    ds_read_b128 v[128:131], v175 offset:24576
    s_waitcnt lgkmcnt(2)
    v_mfma_f32_16x16x32_bf16 v[64:67], a[8:11], v[132:135], v[64:67]
    v_mfma_f32_16x16x32_bf16 v[68:71], a[12:15], v[132:135], v[68:71]
    ds_read_b128 v[132:135], v172 offset:24832
    s_waitcnt lgkmcnt(2)
    v_mfma_f32_16x16x32_bf16 v[64:67], a[16:19], v[136:139], v[64:67]
    v_mfma_f32_16x16x32_bf16 v[68:71], a[20:23], v[136:139], v[68:71]
    ds_read_b128 v[136:139], v173 offset:24832
    s_waitcnt lgkmcnt(2)
    v_mfma_f32_16x16x32_bf16 v[64:67], a[24:27], v[128:131], v[64:67]
    v_mfma_f32_16x16x32_bf16 v[68:71], a[28:31], v[128:131], v[68:71]
    ds_read_b128 v[128:131], v174 offset:24832
    s_waitcnt lgkmcnt(2)
    v_mfma_f32_16x16x32_bf16 v[64:67], a[32:35], v[132:135], v[64:67]
    v_mfma_f32_16x16x32_bf16 v[68:71], a[36:39], v[132:135], v[68:71]
    ds_read_b128 v[132:135], v175 offset:24832
    s_waitcnt lgkmcnt(2)
    v_mfma_f32_16x16x32_bf16 v[64:67], a[40:43], v[136:139], v[64:67]
    v_mfma_f32_16x16x32_bf16 v[68:71], a[44:47], v[136:139], v[68:71]
    ds_read_b128 v[136:139], v172 offset:32768
    s_waitcnt lgkmcnt(2)
    v_mfma_f32_16x16x32_bf16 v[64:67], a[48:51], v[128:131], v[64:67]
    v_mfma_f32_16x16x32_bf16 v[68:71], a[52:55], v[128:131], v[68:71]
    ds_read_b128 v[128:131], v173 offset:32768
    s_waitcnt lgkmcnt(2)
    v_mfma_f32_16x16x32_bf16 v[64:67], a[56:59], v[132:135], v[64:67]
    v_mfma_f32_16x16x32_bf16 v[68:71], a[60:63], v[132:135], v[68:71]
    ds_read_b128 v[132:135], v174 offset:32768
    s_waitcnt lgkmcnt(2)
    v_mfma_f32_16x16x32_bf16 v[80:83], a[0:3], v[136:139], 0
    v_mfma_f32_16x16x32_bf16 v[84:87], a[4:7], v[136:139], 0
    ds_read_b128 v[136:139], v175 offset:32768
    s_waitcnt lgkmcnt(2)
    v_mfma_f32_16x16x32_bf16 v[80:83], a[8:11], v[128:131], v[80:83]
    v_mfma_f32_16x16x32_bf16 v[84:87], a[12:15], v[128:131], v[84:87]
    ds_read_b128 v[128:131], v172 offset:33024
    s_waitcnt lgkmcnt(2)
    v_mfma_f32_16x16x32_bf16 v[80:83], a[16:19], v[132:135], v[80:83]
    v_mfma_f32_16x16x32_bf16 v[84:87], a[20:23], v[132:135], v[84:87]
    ds_read_b128 v[132:135], v173 offset:33024
    s_waitcnt lgkmcnt(2)
    v_mfma_f32_16x16x32_bf16 v[80:83], a[24:27], v[136:139], v[80:83]
    v_mfma_f32_16x16x32_bf16 v[84:87], a[28:31], v[136:139], v[84:87]
    ds_read_b128 v[136:139], v174 offset:33024
    s_waitcnt lgkmcnt(2)
    v_mfma_f32_16x16x32_bf16 v[80:83], a[32:35], v[128:131], v[80:83]
    v_mfma_f32_16x16x32_bf16 v[84:87], a[36:39], v[128:131], v[84:87]
    ds_read_b128 v[128:131], v175 offset:33024
    s_waitcnt lgkmcnt(2)
    v_mfma_f32_16x16x32_bf16 v[80:83], a[40:43], v[132:135], v[80:83]
    v_mfma_f32_16x16x32_bf16 v[84:87], a[44:47], v[132:135], v[84:87]
    ds_read_b128 v[132:135], v172 offset:40960
    s_waitcnt lgkmcnt(2)
    v_mfma_f32_16x16x32_bf16 v[80:83], a[48:51], v[136:139], v[80:83]
    v_mfma_f32_16x16x32_bf16 v[84:87], a[52:55], v[136:139], v[84:87]
    ds_read_b128 v[136:139], v173 offset:40960
    s_waitcnt lgkmcnt(2)
    v_mfma_f32_16x16x32_bf16 v[80:83], a[56:59], v[128:131], v[80:83]
    v_mfma_f32_16x16x32_bf16 v[84:87], a[60:63], v[128:131], v[84:87]
    ds_read_b128 v[128:131], v174 offset:40960
    s_waitcnt lgkmcnt(2)
    v_mfma_f32_16x16x32_bf16 v[96:99], a[0:3], v[132:135], 0
    v_mfma_f32_16x16x32_bf16 v[100:103], a[4:7], v[132:135], 0
    ds_read_b128 v[132:135], v175 offset:40960
    s_waitcnt lgkmcnt(2)
    v_mfma_f32_16x16x32_bf16 v[96:99], a[8:11], v[136:139], v[96:99]
    v_mfma_f32_16x16x32_bf16 v[100:103], a[12:15], v[136:139], v[100:103]
    ds_read_b128 v[136:139], v172 offset:41216
    s_waitcnt lgkmcnt(2)
    v_mfma_f32_16x16x32_bf16 v[96:99], a[16:19], v[128:131], v[96:99]
    v_mfma_f32_16x16x32_bf16 v[100:103], a[20:23], v[128:131], v[100:103]
    ds_read_b128 v[128:131], v173 offset:41216
    s_waitcnt lgkmcnt(2)
    v_mfma_f32_16x16x32_bf16 v[96:99], a[24:27], v[132:135], v[96:99]
    v_mfma_f32_16x16x32_bf16 v[100:103], a[28:31], v[132:135], v[100:103]
    ds_read_b128 v[132:135], v174 offset:41216
    s_waitcnt lgkmcnt(2)
    v_mfma_f32_16x16x32_bf16 v[96:99], a[32:35], v[136:139], v[96:99]
    v_mfma_f32_16x16x32_bf16 v[100:103], a[36:39], v[136:139], v[100:103]
    ds_read_b128 v[136:139], v175 offset:41216
    s_waitcnt lgkmcnt(2)
    v_mfma_f32_16x16x32_bf16 v[96:99], a[40:43], v[128:131], v[96:99]
    v_mfma_f32_16x16x32_bf16 v[100:103], a[44:47], v[128:131], v[100:103]
    ds_read_b128 v[128:131], v172 offset:49152
    s_waitcnt lgkmcnt(2)
    v_mfma_f32_16x16x32_bf16 v[96:99], a[48:51], v[132:135], v[96:99]
    v_mfma_f32_16x16x32_bf16 v[100:103], a[52:55], v[132:135], v[100:103]
    ds_read_b128 v[132:135], v173 offset:49152
    s_waitcnt lgkmcnt(2)
    v_mfma_f32_16x16x32_bf16 v[96:99], a[56:59], v[136:139], v[96:99]
    v_mfma_f32_16x16x32_bf16 v[100:103], a[60:63], v[136:139], v[100:103]
    ds_read_b128 v[136:139], v174 offset:49152
    s_waitcnt lgkmcnt(2)
    v_mfma_f32_16x16x32_bf16 v[112:115], a[0:3], v[128:131], 0
    v_mfma_f32_16x16x32_bf16 v[116:119], a[4:7], v[128:131], 0
    ds_read_b128 v[128:131], v175 offset:49152
    s_waitcnt lgkmcnt(2)
    v_mfma_f32_16x16x32_bf16 v[112:115], a[8:11], v[132:135], v[112:115]
    v_mfma_f32_16x16x32_bf16 v[116:119], a[12:15], v[132:135], v[116:119]
    ds_read_b128 v[132:135], v172 offset:49408
    s_waitcnt lgkmcnt(2)
    v_mfma_f32_16x16x32_bf16 v[112:115], a[16:19], v[136:139], v[112:115]
    v_mfma_f32_16x16x32_bf16 v[116:119], a[20:23], v[136:139], v[116:119]
    ds_read_b128 v[136:139], v173 offset:49408
    s_waitcnt lgkmcnt(2)
    v_mfma_f32_16x16x32_bf16 v[112:115], a[24:27], v[128:131], v[112:115]
    v_mfma_f32_16x16x32_bf16 v[116:119], a[28:31], v[128:131], v[116:119]
    ds_read_b128 v[128:131], v174 offset:49408
    s_waitcnt lgkmcnt(2)
    v_mfma_f32_16x16x32_bf16 v[112:115], a[32:35], v[132:135], v[112:115]
    v_mfma_f32_16x16x32_bf16 v[116:119], a[36:39], v[132:135], v[116:119]
    ds_read_b128 v[132:135], v175 offset:49408
    s_waitcnt lgkmcnt(2)
    v_mfma_f32_16x16x32_bf16 v[112:115], a[40:43], v[136:139], v[112:115]
    v_mfma_f32_16x16x32_bf16 v[116:119], a[44:47], v[136:139], v[116:119]
    s_waitcnt lgkmcnt(1)
    v_mfma_f32_16x16x32_bf16 v[112:115], a[48:51], v[128:131], v[112:115]
    v_mfma_f32_16x16x32_bf16 v[116:119], a[52:55], v[128:131], v[116:119]
    s_waitcnt lgkmcnt(0)
    v_mfma_f32_16x16x32_bf16 v[112:115], a[56:59], v[132:135], v[112:115]
    v_mfma_f32_16x16x32_bf16 v[116:119], a[60:63], v[132:135], v[116:119]
    s_waitcnt vmcnt(0)
    ds_read_b128 a[64:67], v168 offset:0
    ds_read_b128 a[68:71], v168 offset:8192
    ds_read_b128 a[72:75], v169 offset:0
    ds_read_b128 a[76:79], v169 offset:8192
    ds_read_b128 a[80:83], v170 offset:0
    ds_read_b128 a[84:87], v170 offset:8192
    ds_read_b128 a[88:91], v171 offset:0
    ds_read_b128 a[92:95], v171 offset:8192
    ds_read_b128 a[96:99], v168 offset:256
    ds_read_b128 a[100:103], v168 offset:8448
    ds_read_b128 a[104:107], v169 offset:256
    ds_read_b128 a[108:111], v169 offset:8448
    ds_read_b128 a[112:115], v170 offset:256
    ds_read_b128 a[116:119], v170 offset:8448
    ds_read_b128 a[120:123], v171 offset:256
    ds_read_b128 a[124:127], v171 offset:8448
    s_waitcnt lgkmcnt(0)
    ds_read_b128 v[128:131], v172 offset:0
    ds_read_b128 v[132:135], v173 offset:0
    ds_read_b128 v[136:139], v174 offset:0
    s_waitcnt lgkmcnt(2)
    v_mfma_f32_16x16x32_bf16 v[24:27], a[64:67], v[128:131], 0
    v_mfma_f32_16x16x32_bf16 v[28:31], a[68:71], v[128:131], 0
    ds_read_b128 v[128:131], v175 offset:0
    s_waitcnt lgkmcnt(2)
    v_mfma_f32_16x16x32_bf16 v[24:27], a[72:75], v[132:135], v[24:27]
    v_mfma_f32_16x16x32_bf16 v[28:31], a[76:79], v[132:135], v[28:31]
    ds_read_b128 v[132:135], v172 offset:256
    s_waitcnt lgkmcnt(2)
    v_mfma_f32_16x16x32_bf16 v[24:27], a[80:83], v[136:139], v[24:27]
    v_mfma_f32_16x16x32_bf16 v[28:31], a[84:87], v[136:139], v[28:31]
    ds_read_b128 v[136:139], v173 offset:256
    s_waitcnt lgkmcnt(2)
    v_mfma_f32_16x16x32_bf16 v[24:27], a[88:91], v[128:131], v[24:27]
    v_mul_f32 v16, s34, v16
    v_mul_f32 v17, s34, v17
    v_mfma_f32_16x16x32_bf16 v[28:31], a[92:95], v[128:131], v[28:31]
    v_mul_f32 v18, s34, v18
    v_mul_f32 v19, s34, v19
    ds_read_b128 v[128:131], v174 offset:256
    s_waitcnt lgkmcnt(2)
    v_mfma_f32_16x16x32_bf16 v[24:27], a[96:99], v[132:135], v[24:27]
    v_mul_f32 v20, s34, v20
    v_mul_f32 v21, s34, v21
    v_mfma_f32_16x16x32_bf16 v[28:31], a[100:103], v[132:135], v[28:31]
    v_mul_f32 v22, s34, v22
    v_mul_f32 v23, s34, v23
    ds_read_b128 v[132:135], v175 offset:256
    s_waitcnt lgkmcnt(2)
    v_mfma_f32_16x16x32_bf16 v[24:27], a[104:107], v[136:139], v[24:27]
    v_cvt_pk_bf16_f32 v16, v16, v17
    v_cvt_pk_bf16_f32 v17, v18, v19
    v_mfma_f32_16x16x32_bf16 v[28:31], a[108:111], v[136:139], v[28:31]
    v_cvt_pk_bf16_f32 v18, v20, v21
    v_cvt_pk_bf16_f32 v19, v22, v23
    ds_read_b128 v[136:139], v172 offset:8192
    s_waitcnt lgkmcnt(2)
    v_mfma_f32_16x16x32_bf16 v[24:27], a[112:115], v[128:131], v[24:27]
    buffer_store_dwordx4 v[16:19], v145, s[8:11], s40 offen offset:0 sc1
    v_mfma_f32_16x16x32_bf16 v[28:31], a[116:119], v[128:131], v[28:31]
    ds_read_b128 v[128:131], v173 offset:8192
    s_waitcnt lgkmcnt(2)
    v_mfma_f32_16x16x32_bf16 v[24:27], a[120:123], v[132:135], v[24:27]
    v_mfma_f32_16x16x32_bf16 v[28:31], a[124:127], v[132:135], v[28:31]
    ds_read_b128 v[132:135], v174 offset:8192
    s_waitcnt lgkmcnt(2)
    v_mfma_f32_16x16x32_bf16 v[40:43], a[64:67], v[136:139], 0
    v_mfma_f32_16x16x32_bf16 v[44:47], a[68:71], v[136:139], 0
    ds_read_b128 v[136:139], v175 offset:8192
    s_waitcnt lgkmcnt(2)
    v_mfma_f32_16x16x32_bf16 v[40:43], a[72:75], v[128:131], v[40:43]
    v_mfma_f32_16x16x32_bf16 v[44:47], a[76:79], v[128:131], v[44:47]
    ds_read_b128 v[128:131], v172 offset:8448
    s_waitcnt lgkmcnt(2)
    v_mfma_f32_16x16x32_bf16 v[40:43], a[80:83], v[132:135], v[40:43]
    v_mfma_f32_16x16x32_bf16 v[44:47], a[84:87], v[132:135], v[44:47]
    ds_read_b128 v[132:135], v173 offset:8448
    s_waitcnt lgkmcnt(2)
    v_mfma_f32_16x16x32_bf16 v[40:43], a[88:91], v[136:139], v[40:43]
    v_mul_f32 v32, s34, v32
    v_mul_f32 v33, s34, v33
    v_mfma_f32_16x16x32_bf16 v[44:47], a[92:95], v[136:139], v[44:47]
    v_mul_f32 v34, s34, v34
    v_mul_f32 v35, s34, v35
    ds_read_b128 v[136:139], v174 offset:8448
    s_waitcnt lgkmcnt(2)
    v_mfma_f32_16x16x32_bf16 v[40:43], a[96:99], v[128:131], v[40:43]
    v_mul_f32 v36, s34, v36
    v_mul_f32 v37, s34, v37
    v_mfma_f32_16x16x32_bf16 v[44:47], a[100:103], v[128:131], v[44:47]
    v_mul_f32 v38, s34, v38
    v_mul_f32 v39, s34, v39
    ds_read_b128 v[128:131], v175 offset:8448
    s_waitcnt lgkmcnt(2)
    v_mfma_f32_16x16x32_bf16 v[40:43], a[104:107], v[132:135], v[40:43]
    v_cvt_pk_bf16_f32 v32, v32, v33
    v_cvt_pk_bf16_f32 v33, v34, v35
    v_mfma_f32_16x16x32_bf16 v[44:47], a[108:111], v[132:135], v[44:47]
    v_cvt_pk_bf16_f32 v34, v36, v37
    v_cvt_pk_bf16_f32 v35, v38, v39
    ds_read_b128 v[132:135], v172 offset:16384
    s_waitcnt lgkmcnt(2)
    v_mfma_f32_16x16x32_bf16 v[40:43], a[112:115], v[136:139], v[40:43]
    buffer_store_dwordx4 v[32:35], v145, s[8:11], s41 offen offset:0 sc1
    v_mul_f32 v24, s34, v24
    v_mfma_f32_16x16x32_bf16 v[44:47], a[116:119], v[136:139], v[44:47]
    v_mul_f32 v25, s34, v25
    v_mul_f32 v26, s34, v26
    ds_read_b128 v[136:139], v173 offset:16384
    s_waitcnt lgkmcnt(2)
    v_mfma_f32_16x16x32_bf16 v[40:43], a[120:123], v[128:131], v[40:43]
    v_mul_f32 v27, s34, v27
    v_mul_f32 v28, s34, v28
    v_mfma_f32_16x16x32_bf16 v[44:47], a[124:127], v[128:131], v[44:47]
    v_mul_f32 v29, s34, v29
    v_mul_f32 v30, s34, v30
    ds_read_b128 v[128:131], v174 offset:16384
    s_waitcnt lgkmcnt(2)
    v_mfma_f32_16x16x32_bf16 v[56:59], a[64:67], v[132:135], 0
    v_mul_f32 v31, s34, v31
    v_cvt_pk_bf16_f32 v24, v24, v25
    v_mfma_f32_16x16x32_bf16 v[60:63], a[68:71], v[132:135], 0
    v_cvt_pk_bf16_f32 v25, v26, v27
    v_cvt_pk_bf16_f32 v26, v28, v29
    ds_read_b128 v[132:135], v175 offset:16384
    s_waitcnt lgkmcnt(2)
    v_mfma_f32_16x16x32_bf16 v[56:59], a[72:75], v[136:139], v[56:59]
    v_cvt_pk_bf16_f32 v27, v30, v31
    buffer_store_dwordx4 v[24:27], v146, s[8:11], s40 offen offset:1024 sc1
    v_mfma_f32_16x16x32_bf16 v[60:63], a[76:79], v[136:139], v[60:63]
    ds_read_b128 v[136:139], v172 offset:16640
    s_waitcnt lgkmcnt(2)
    v_mfma_f32_16x16x32_bf16 v[56:59], a[80:83], v[128:131], v[56:59]
    v_mfma_f32_16x16x32_bf16 v[60:63], a[84:87], v[128:131], v[60:63]
    ds_read_b128 v[128:131], v173 offset:16640
    s_waitcnt lgkmcnt(2)
    v_mfma_f32_16x16x32_bf16 v[56:59], a[88:91], v[132:135], v[56:59]
    v_mul_f32 v48, s34, v48
    v_mul_f32 v49, s34, v49
    v_mfma_f32_16x16x32_bf16 v[60:63], a[92:95], v[132:135], v[60:63]
    v_mul_f32 v50, s34, v50
    v_mul_f32 v51, s34, v51
    ds_read_b128 v[132:135], v174 offset:16640
    s_waitcnt lgkmcnt(2)
    v_mfma_f32_16x16x32_bf16 v[56:59], a[96:99], v[136:139], v[56:59]
    v_mul_f32 v52, s34, v52
    v_mul_f32 v53, s34, v53
    v_mfma_f32_16x16x32_bf16 v[60:63], a[100:103], v[136:139], v[60:63]
    v_mul_f32 v54, s34, v54
    v_mul_f32 v55, s34, v55
    ds_read_b128 v[136:139], v175 offset:16640
    s_waitcnt lgkmcnt(2)
    v_mfma_f32_16x16x32_bf16 v[56:59], a[104:107], v[128:131], v[56:59]
    v_cvt_pk_bf16_f32 v48, v48, v49
    v_cvt_pk_bf16_f32 v49, v50, v51
    v_mfma_f32_16x16x32_bf16 v[60:63], a[108:111], v[128:131], v[60:63]
    v_cvt_pk_bf16_f32 v50, v52, v53
    v_cvt_pk_bf16_f32 v51, v54, v55
    ds_read_b128 v[128:131], v172 offset:24576
    s_waitcnt lgkmcnt(2)
    v_mfma_f32_16x16x32_bf16 v[56:59], a[112:115], v[132:135], v[56:59]
    buffer_store_dwordx4 v[48:51], v145, s[8:11], s42 offen offset:0 sc1
    v_mul_f32 v40, s34, v40
    v_mfma_f32_16x16x32_bf16 v[60:63], a[116:119], v[132:135], v[60:63]
    v_mul_f32 v41, s34, v41
    v_mul_f32 v42, s34, v42
    ds_read_b128 v[132:135], v173 offset:24576
    s_waitcnt lgkmcnt(2)
    v_mfma_f32_16x16x32_bf16 v[56:59], a[120:123], v[136:139], v[56:59]
    v_mul_f32 v43, s34, v43
    v_mul_f32 v44, s34, v44
    v_mfma_f32_16x16x32_bf16 v[60:63], a[124:127], v[136:139], v[60:63]
    v_mul_f32 v45, s34, v45
    v_mul_f32 v46, s34, v46
    ds_read_b128 v[136:139], v174 offset:24576
    s_waitcnt lgkmcnt(2)
    v_mfma_f32_16x16x32_bf16 v[72:75], a[64:67], v[128:131], 0
    v_mul_f32 v47, s34, v47
    v_cvt_pk_bf16_f32 v40, v40, v41
    v_mfma_f32_16x16x32_bf16 v[76:79], a[68:71], v[128:131], 0
    v_cvt_pk_bf16_f32 v41, v42, v43
    v_cvt_pk_bf16_f32 v42, v44, v45
    ds_read_b128 v[128:131], v175 offset:24576
    s_waitcnt lgkmcnt(2)
    v_mfma_f32_16x16x32_bf16 v[72:75], a[72:75], v[132:135], v[72:75]
    v_cvt_pk_bf16_f32 v43, v46, v47
    buffer_store_dwordx4 v[40:43], v146, s[8:11], s41 offen offset:1024 sc1
    v_mfma_f32_16x16x32_bf16 v[76:79], a[76:79], v[132:135], v[76:79]
    ds_read_b128 v[132:135], v172 offset:24832
    s_waitcnt lgkmcnt(2)
    v_mfma_f32_16x16x32_bf16 v[72:75], a[80:83], v[136:139], v[72:75]
    v_mfma_f32_16x16x32_bf16 v[76:79], a[84:87], v[136:139], v[76:79]
    ds_read_b128 v[136:139], v173 offset:24832
    s_waitcnt lgkmcnt(2)
    v_mfma_f32_16x16x32_bf16 v[72:75], a[88:91], v[128:131], v[72:75]
    v_mul_f32 v64, s34, v64
    v_mul_f32 v65, s34, v65
    v_mfma_f32_16x16x32_bf16 v[76:79], a[92:95], v[128:131], v[76:79]
    v_mul_f32 v66, s34, v66
    v_mul_f32 v67, s34, v67
    ds_read_b128 v[128:131], v174 offset:24832
    s_waitcnt lgkmcnt(2)
    v_mfma_f32_16x16x32_bf16 v[72:75], a[96:99], v[132:135], v[72:75]
    v_mul_f32 v68, s34, v68
    v_mul_f32 v69, s34, v69
    v_mfma_f32_16x16x32_bf16 v[76:79], a[100:103], v[132:135], v[76:79]
    v_mul_f32 v70, s34, v70
    v_mul_f32 v71, s34, v71
    ds_read_b128 v[132:135], v175 offset:24832
    s_waitcnt lgkmcnt(2)
    v_mfma_f32_16x16x32_bf16 v[72:75], a[104:107], v[136:139], v[72:75]
    v_cvt_pk_bf16_f32 v64, v64, v65
    v_cvt_pk_bf16_f32 v65, v66, v67
    v_mfma_f32_16x16x32_bf16 v[76:79], a[108:111], v[136:139], v[76:79]
    v_cvt_pk_bf16_f32 v66, v68, v69
    v_cvt_pk_bf16_f32 v67, v70, v71
    ds_read_b128 v[136:139], v172 offset:32768
    s_waitcnt lgkmcnt(2)
    v_mfma_f32_16x16x32_bf16 v[72:75], a[112:115], v[128:131], v[72:75]
    buffer_store_dwordx4 v[64:67], v145, s[8:11], s43 offen offset:0 sc1
    v_mul_f32 v56, s34, v56
    v_mfma_f32_16x16x32_bf16 v[76:79], a[116:119], v[128:131], v[76:79]
    v_mul_f32 v57, s34, v57
    v_mul_f32 v58, s34, v58
    ds_read_b128 v[128:131], v173 offset:32768
    s_waitcnt lgkmcnt(2)
    v_mfma_f32_16x16x32_bf16 v[72:75], a[120:123], v[132:135], v[72:75]
    v_mul_f32 v59, s34, v59
    v_mul_f32 v60, s34, v60
    v_mfma_f32_16x16x32_bf16 v[76:79], a[124:127], v[132:135], v[76:79]
    v_mul_f32 v61, s34, v61
    v_mul_f32 v62, s34, v62
    ds_read_b128 v[132:135], v174 offset:32768
    s_waitcnt lgkmcnt(2)
    v_mfma_f32_16x16x32_bf16 v[88:91], a[64:67], v[136:139], 0
    v_mul_f32 v63, s34, v63
    v_cvt_pk_bf16_f32 v56, v56, v57
    v_mfma_f32_16x16x32_bf16 v[92:95], a[68:71], v[136:139], 0
    v_cvt_pk_bf16_f32 v57, v58, v59
    v_cvt_pk_bf16_f32 v58, v60, v61
    ds_read_b128 v[136:139], v175 offset:32768
    s_waitcnt lgkmcnt(2)
    v_mfma_f32_16x16x32_bf16 v[88:91], a[72:75], v[128:131], v[88:91]
    v_cvt_pk_bf16_f32 v59, v62, v63
    buffer_store_dwordx4 v[56:59], v146, s[8:11], s42 offen offset:1024 sc1
    v_mfma_f32_16x16x32_bf16 v[92:95], a[76:79], v[128:131], v[92:95]
    ds_read_b128 v[128:131], v172 offset:33024
    s_waitcnt lgkmcnt(2)
    v_mfma_f32_16x16x32_bf16 v[88:91], a[80:83], v[132:135], v[88:91]
    v_mfma_f32_16x16x32_bf16 v[92:95], a[84:87], v[132:135], v[92:95]
    ds_read_b128 v[132:135], v173 offset:33024
    s_waitcnt lgkmcnt(2)
    v_mfma_f32_16x16x32_bf16 v[88:91], a[88:91], v[136:139], v[88:91]
    v_mul_f32 v80, s34, v80
    v_mul_f32 v81, s34, v81
    v_mfma_f32_16x16x32_bf16 v[92:95], a[92:95], v[136:139], v[92:95]
    v_mul_f32 v82, s34, v82
    v_mul_f32 v83, s34, v83
    ds_read_b128 v[136:139], v174 offset:33024
    s_waitcnt lgkmcnt(2)
    v_mfma_f32_16x16x32_bf16 v[88:91], a[96:99], v[128:131], v[88:91]
    v_mul_f32 v84, s34, v84
    v_mul_f32 v85, s34, v85
    v_mfma_f32_16x16x32_bf16 v[92:95], a[100:103], v[128:131], v[92:95]
    v_mul_f32 v86, s34, v86
    v_mul_f32 v87, s34, v87
    ds_read_b128 v[128:131], v175 offset:33024
    s_waitcnt lgkmcnt(2)
    v_mfma_f32_16x16x32_bf16 v[88:91], a[104:107], v[132:135], v[88:91]
    v_cvt_pk_bf16_f32 v80, v80, v81
    v_cvt_pk_bf16_f32 v81, v82, v83
    v_mfma_f32_16x16x32_bf16 v[92:95], a[108:111], v[132:135], v[92:95]
    v_cvt_pk_bf16_f32 v82, v84, v85
    v_cvt_pk_bf16_f32 v83, v86, v87
    ds_read_b128 v[132:135], v172 offset:40960
    s_waitcnt lgkmcnt(2)
    v_mfma_f32_16x16x32_bf16 v[88:91], a[112:115], v[136:139], v[88:91]
    buffer_store_dwordx4 v[80:83], v145, s[8:11], s44 offen offset:0 sc1
    v_mul_f32 v72, s34, v72
    v_mfma_f32_16x16x32_bf16 v[92:95], a[116:119], v[136:139], v[92:95]
    v_mul_f32 v73, s34, v73
    v_mul_f32 v74, s34, v74
    ds_read_b128 v[136:139], v173 offset:40960
    s_waitcnt lgkmcnt(2)
    v_mfma_f32_16x16x32_bf16 v[88:91], a[120:123], v[128:131], v[88:91]
    v_mul_f32 v75, s34, v75
    v_mul_f32 v76, s34, v76
    v_mfma_f32_16x16x32_bf16 v[92:95], a[124:127], v[128:131], v[92:95]
    v_mul_f32 v77, s34, v77
    v_mul_f32 v78, s34, v78
    ds_read_b128 v[128:131], v174 offset:40960
    s_waitcnt lgkmcnt(2)
    v_mfma_f32_16x16x32_bf16 v[104:107], a[64:67], v[132:135], 0
    v_mul_f32 v79, s34, v79
    v_cvt_pk_bf16_f32 v72, v72, v73
    v_mfma_f32_16x16x32_bf16 v[108:111], a[68:71], v[132:135], 0
    v_cvt_pk_bf16_f32 v73, v74, v75
    v_cvt_pk_bf16_f32 v74, v76, v77
    ds_read_b128 v[132:135], v175 offset:40960
    s_waitcnt lgkmcnt(2)
    v_mfma_f32_16x16x32_bf16 v[104:107], a[72:75], v[136:139], v[104:107]
    v_cvt_pk_bf16_f32 v75, v78, v79
    buffer_store_dwordx4 v[72:75], v146, s[8:11], s43 offen offset:1024 sc1
    v_mfma_f32_16x16x32_bf16 v[108:111], a[76:79], v[136:139], v[108:111]
    ds_read_b128 v[136:139], v172 offset:41216
    s_waitcnt lgkmcnt(2)
    v_mfma_f32_16x16x32_bf16 v[104:107], a[80:83], v[128:131], v[104:107]
    v_mfma_f32_16x16x32_bf16 v[108:111], a[84:87], v[128:131], v[108:111]
    ds_read_b128 v[128:131], v173 offset:41216
    s_waitcnt lgkmcnt(2)
    v_mfma_f32_16x16x32_bf16 v[104:107], a[88:91], v[132:135], v[104:107]
    v_mul_f32 v96, s34, v96
    v_mul_f32 v97, s34, v97
    v_mfma_f32_16x16x32_bf16 v[108:111], a[92:95], v[132:135], v[108:111]
    v_mul_f32 v98, s34, v98
    v_mul_f32 v99, s34, v99
    ds_read_b128 v[132:135], v174 offset:41216
    s_waitcnt lgkmcnt(2)
    v_mfma_f32_16x16x32_bf16 v[104:107], a[96:99], v[136:139], v[104:107]
    v_mul_f32 v100, s34, v100
    v_mul_f32 v101, s34, v101
    v_mfma_f32_16x16x32_bf16 v[108:111], a[100:103], v[136:139], v[108:111]
    v_mul_f32 v102, s34, v102
    v_mul_f32 v103, s34, v103
    ds_read_b128 v[136:139], v175 offset:41216
    s_waitcnt lgkmcnt(2)
    v_mfma_f32_16x16x32_bf16 v[104:107], a[104:107], v[128:131], v[104:107]
    v_cvt_pk_bf16_f32 v96, v96, v97
    v_cvt_pk_bf16_f32 v97, v98, v99
    v_mfma_f32_16x16x32_bf16 v[108:111], a[108:111], v[128:131], v[108:111]
    v_cvt_pk_bf16_f32 v98, v100, v101
    v_cvt_pk_bf16_f32 v99, v102, v103
    ds_read_b128 v[128:131], v172 offset:49152
    s_waitcnt lgkmcnt(2)
    v_mfma_f32_16x16x32_bf16 v[104:107], a[112:115], v[132:135], v[104:107]
    buffer_store_dwordx4 v[96:99], v145, s[8:11], s45 offen offset:0 sc1
    v_mul_f32 v88, s34, v88
    v_mfma_f32_16x16x32_bf16 v[108:111], a[116:119], v[132:135], v[108:111]
    v_mul_f32 v89, s34, v89
    v_mul_f32 v90, s34, v90
    ds_read_b128 v[132:135], v173 offset:49152
    s_waitcnt lgkmcnt(2)
    v_mfma_f32_16x16x32_bf16 v[104:107], a[120:123], v[136:139], v[104:107]
    v_mul_f32 v91, s34, v91
    v_mul_f32 v92, s34, v92
    v_mfma_f32_16x16x32_bf16 v[108:111], a[124:127], v[136:139], v[108:111]
    v_mul_f32 v93, s34, v93
    v_mul_f32 v94, s34, v94
    ds_read_b128 v[136:139], v174 offset:49152
    s_waitcnt lgkmcnt(2)
    v_mfma_f32_16x16x32_bf16 v[120:123], a[64:67], v[128:131], 0
    v_mul_f32 v95, s34, v95
    v_cvt_pk_bf16_f32 v88, v88, v89
    v_mfma_f32_16x16x32_bf16 v[124:127], a[68:71], v[128:131], 0
    v_cvt_pk_bf16_f32 v89, v90, v91
    v_cvt_pk_bf16_f32 v90, v92, v93
    ds_read_b128 v[128:131], v175 offset:49152
    s_waitcnt lgkmcnt(2)
    v_mfma_f32_16x16x32_bf16 v[120:123], a[72:75], v[132:135], v[120:123]
    v_cvt_pk_bf16_f32 v91, v94, v95
    buffer_store_dwordx4 v[88:91], v146, s[8:11], s44 offen offset:1024 sc1
    v_mfma_f32_16x16x32_bf16 v[124:127], a[76:79], v[132:135], v[124:127]
    ds_read_b128 v[132:135], v172 offset:49408
    s_waitcnt lgkmcnt(2)
    v_mfma_f32_16x16x32_bf16 v[120:123], a[80:83], v[136:139], v[120:123]
    v_mfma_f32_16x16x32_bf16 v[124:127], a[84:87], v[136:139], v[124:127]
    ds_read_b128 v[136:139], v173 offset:49408
    s_waitcnt lgkmcnt(2)
    v_mfma_f32_16x16x32_bf16 v[120:123], a[88:91], v[128:131], v[120:123]
    v_mul_f32 v112, s34, v112
    v_mul_f32 v113, s34, v113
    v_mfma_f32_16x16x32_bf16 v[124:127], a[92:95], v[128:131], v[124:127]
    v_mul_f32 v114, s34, v114
    v_mul_f32 v115, s34, v115
    ds_read_b128 v[128:131], v174 offset:49408
    s_waitcnt lgkmcnt(2)
    v_mfma_f32_16x16x32_bf16 v[120:123], a[96:99], v[132:135], v[120:123]
    v_mul_f32 v116, s34, v116
    v_mul_f32 v117, s34, v117
    v_mfma_f32_16x16x32_bf16 v[124:127], a[100:103], v[132:135], v[124:127]
    v_mul_f32 v118, s34, v118
    v_mul_f32 v119, s34, v119
    ds_read_b128 v[132:135], v175 offset:49408
    s_waitcnt lgkmcnt(2)
    v_mfma_f32_16x16x32_bf16 v[120:123], a[104:107], v[136:139], v[120:123]
    v_cvt_pk_bf16_f32 v112, v112, v113
    v_cvt_pk_bf16_f32 v113, v114, v115
    v_mfma_f32_16x16x32_bf16 v[124:127], a[108:111], v[136:139], v[124:127]
    v_cvt_pk_bf16_f32 v114, v116, v117
    v_cvt_pk_bf16_f32 v115, v118, v119
    s_waitcnt lgkmcnt(1)
    v_mfma_f32_16x16x32_bf16 v[120:123], a[112:115], v[128:131], v[120:123]
    buffer_store_dwordx4 v[112:115], v145, s[8:11], s46 offen offset:0 sc1
    v_mul_f32 v104, s34, v104
    v_mfma_f32_16x16x32_bf16 v[124:127], a[116:119], v[128:131], v[124:127]
    v_mul_f32 v105, s34, v105
    v_mul_f32 v106, s34, v106
    s_waitcnt lgkmcnt(0)
    v_mfma_f32_16x16x32_bf16 v[120:123], a[120:123], v[132:135], v[120:123]
    v_mul_f32 v107, s34, v107
    v_mul_f32 v108, s34, v108
    v_mfma_f32_16x16x32_bf16 v[124:127], a[124:127], v[132:135], v[124:127]
    v_mul_f32 v109, s34, v109
    v_mul_f32 v110, s34, v110
    v_mul_f32 v111, s34, v111
    v_cvt_pk_bf16_f32 v104, v104, v105
    v_cvt_pk_bf16_f32 v105, v106, v107
    v_cvt_pk_bf16_f32 v106, v108, v109
    v_cvt_pk_bf16_f32 v107, v110, v111
    buffer_store_dwordx4 v[104:107], v146, s[8:11], s45 offen offset:1024 sc1
    s_nop 7
    v_mul_f32 v120, s34, v120
    v_mul_f32 v121, s34, v121
    v_mul_f32 v122, s34, v122
    v_mul_f32 v123, s34, v123
    v_mul_f32 v124, s34, v124
    v_mul_f32 v125, s34, v125
    v_mul_f32 v126, s34, v126
    v_mul_f32 v127, s34, v127
    v_cvt_pk_bf16_f32 v120, v120, v121
    v_cvt_pk_bf16_f32 v121, v122, v123
    v_cvt_pk_bf16_f32 v122, v124, v125
    v_cvt_pk_bf16_f32 v123, v126, v127
    buffer_store_dwordx4 v[120:123], v146, s[8:11], s46 offen offset:1024 sc1
    s_branch L0_tail
L0_B:
    s_mov_b32 s56, s44
    s_mov_b32 s57, s45
    s_mov_b32 s58, 3670016
    s_mov_b32 s59, 0x00020000
    s_mov_b32 s60, s46
    s_mov_b32 s61, s47
    s_mov_b32 s62, 3670016
    s_mov_b32 s63, 0x00020000
    v_lshlrev_b32 v145, 4, v2
    s_lshl_b32 s21, s12, 1
    s_mul_i32 s20, s20, 7
    s_add_u32 s21, s21, s20
    s_lshl_b32 s23, s19, 9
    s_lshl_b32 s24, s21, 18
    s_add_u32 s24, s24, s23
    s_cmp_eq_u32 s12, 3
    s_cselect_b32 s25, 1073741824, 0
    v_add_u32 v146, s25, v145
    s_add_u32 s25, s25, s24
    s_lshl_b32 s38, s12, 14
    v_lshrrev_b32 v11, 5, v2
    v_and_b32 v12, 31, v2
    v_add_u32 v9, 0, v11
    v_xor_b32 v9, v9, v12
    v_lshlrev_b32 v9, 4, v9
    v_lshl_add_u32 v160, v11, 13, v9
    v_add_u32 v9, 2, v11
    v_xor_b32 v9, v9, v12
    v_lshlrev_b32 v9, 4, v9
    v_lshl_add_u32 v161, v11, 13, v9
    v_add_u32 v9, 4, v11
    v_xor_b32 v9, v9, v12
    v_lshlrev_b32 v9, 4, v9
    v_lshl_add_u32 v162, v11, 13, v9
    v_add_u32 v9, 6, v11
    v_xor_b32 v9, v9, v12
    v_lshlrev_b32 v9, 4, v9
    v_lshl_add_u32 v163, v11, 13, v9
    v_add_u32 v9, 8, v11
    v_xor_b32 v9, v9, v12
    v_lshlrev_b32 v9, 4, v9
    v_lshl_add_u32 v164, v11, 13, v9
    v_add_u32 v9, 10, v11
    v_xor_b32 v9, v9, v12
    v_lshlrev_b32 v9, 4, v9
    v_lshl_add_u32 v165, v11, 13, v9
    v_add_u32 v9, 12, v11
    v_xor_b32 v9, v9, v12
    v_lshlrev_b32 v9, 4, v9
    v_lshl_add_u32 v166, v11, 13, v9
    v_add_u32 v9, 14, v11
    v_xor_b32 v9, v9, v12
    v_lshlrev_b32 v9, 4, v9
    v_lshl_add_u32 v167, v11, 13, v9
    s_add_u32 m0, s38, 0
    s_add_u32 s30, s24, 0
    buffer_load_dwordx4 v160, s[56:59], s30 offen nt lds
    s_add_u32 m0, s38, 1024
    s_add_u32 s30, s24, 16384
    buffer_load_dwordx4 v161, s[56:59], s30 offen nt lds
    s_add_u32 m0, s38, 2048
    s_add_u32 s30, s24, 32768
    buffer_load_dwordx4 v162, s[56:59], s30 offen nt lds
    s_add_u32 m0, s38, 3072
    s_add_u32 s30, s24, 49152
    buffer_load_dwordx4 v163, s[56:59], s30 offen nt lds
    s_add_u32 m0, s38, 4096
    s_add_u32 s30, s24, 65536
    buffer_load_dwordx4 v164, s[56:59], s30 offen nt lds
    s_add_u32 m0, s38, 5120
    s_add_u32 s30, s24, 81920
    buffer_load_dwordx4 v165, s[56:59], s30 offen nt lds
    s_add_u32 m0, s38, 6144
    s_add_u32 s30, s24, 98304
    buffer_load_dwordx4 v166, s[56:59], s30 offen nt lds
    s_add_u32 m0, s38, 7168
    s_add_u32 s30, s24, 114688
    buffer_load_dwordx4 v167, s[56:59], s30 offen nt lds
    s_add_u32 m0, s38, 8192
    s_add_u32 s30, s24, 131072
    buffer_load_dwordx4 v160, s[56:59], s30 offen nt lds
    s_add_u32 m0, s38, 9216
    s_add_u32 s30, s24, 147456
    buffer_load_dwordx4 v161, s[56:59], s30 offen nt lds
    s_add_u32 m0, s38, 10240
    s_add_u32 s30, s24, 163840
    buffer_load_dwordx4 v162, s[56:59], s30 offen nt lds
    s_add_u32 m0, s38, 11264
    s_add_u32 s30, s24, 180224
    buffer_load_dwordx4 v163, s[56:59], s30 offen nt lds
    s_add_u32 m0, s38, 12288
    s_add_u32 s30, s24, 196608
    buffer_load_dwordx4 v164, s[56:59], s30 offen nt lds
    s_add_u32 m0, s38, 13312
    s_add_u32 s30, s24, 212992
    buffer_load_dwordx4 v165, s[56:59], s30 offen nt lds
    s_add_u32 m0, s38, 14336
    s_add_u32 s30, s24, 229376
    buffer_load_dwordx4 v166, s[56:59], s30 offen nt lds
    s_add_u32 m0, s38, 15360
    s_add_u32 s30, s24, 245760
    buffer_load_dwordx4 v167, s[56:59], s30 offen nt lds
    v_lshlrev_b32 v9, 1, v3
    v_xor_b32 v9, v9, v4
    v_cmp_gt_u32 vcc, 14, v9
    v_lshlrev_b32 v9, 4, v9
    v_mul_u32_u24 v10, 896, v3
    v_add_u32 v9, v9, v10
    v_mov_b32 v10, 1073741824
    v_cndmask_b32 v148, v10, v9, vcc
    v_lshlrev_b32 v9, 1, v3
    v_xor_b32 v9, v9, v4
    v_xor_b32 v9, 8, v9
    v_cmp_gt_u32 vcc, 14, v9
    v_lshlrev_b32 v9, 4, v9
    v_mul_u32_u24 v10, 896, v3
    v_add_u32 v9, v9, v10
    v_mov_b32 v10, 1073741824
    v_cndmask_b32 v149, v10, v9, vcc
    s_mul_i32 s36, s19, 229376
    s_mul_i32 s37, s22, 224
    s_add_u32 s36, s36, s37
    s_mul_i32 s37, s12, 57344
    s_add_u32 s36, s36, s37
    s_lshl_b32 s31, s12, 14
    s_add_u32 m0, s31, 65536
    s_add_u32 s30, s36, 0
    buffer_load_dwordx4 v148, s[60:63], s30 offen nt lds
    s_add_u32 m0, s31, 66560
    s_add_u32 s30, s36, 3584
    buffer_load_dwordx4 v148, s[60:63], s30 offen nt lds
    s_add_u32 m0, s31, 67584
    s_add_u32 s30, s36, 7168
    buffer_load_dwordx4 v149, s[60:63], s30 offen nt lds
    s_add_u32 m0, s31, 68608
    s_add_u32 s30, s36, 10752
    buffer_load_dwordx4 v149, s[60:63], s30 offen nt lds
    s_add_u32 m0, s31, 69632
    s_add_u32 s30, s36, 14336
    buffer_load_dwordx4 v148, s[60:63], s30 offen nt lds
    s_add_u32 m0, s31, 70656
    s_add_u32 s30, s36, 17920
    buffer_load_dwordx4 v148, s[60:63], s30 offen nt lds
    s_add_u32 m0, s31, 71680
    s_add_u32 s30, s36, 21504
    buffer_load_dwordx4 v149, s[60:63], s30 offen nt lds
    s_add_u32 m0, s31, 72704
    s_add_u32 s30, s36, 25088
    buffer_load_dwordx4 v149, s[60:63], s30 offen nt lds
    s_add_u32 m0, s31, 73728
    s_add_u32 s30, s36, 28672
    buffer_load_dwordx4 v148, s[60:63], s30 offen nt lds
    s_add_u32 m0, s31, 74752
    s_add_u32 s30, s36, 32256
    buffer_load_dwordx4 v148, s[60:63], s30 offen nt lds
    s_add_u32 m0, s31, 75776
    s_add_u32 s30, s36, 35840
    buffer_load_dwordx4 v149, s[60:63], s30 offen nt lds
    s_add_u32 m0, s31, 76800
    s_add_u32 s30, s36, 39424
    buffer_load_dwordx4 v149, s[60:63], s30 offen nt lds
    s_add_u32 m0, s31, 77824
    s_add_u32 s30, s36, 43008
    buffer_load_dwordx4 v148, s[60:63], s30 offen nt lds
    s_add_u32 m0, s31, 78848
    s_add_u32 s30, s36, 46592
    buffer_load_dwordx4 v148, s[60:63], s30 offen nt lds
    s_add_u32 m0, s31, 79872
    s_add_u32 s30, s36, 50176
    buffer_load_dwordx4 v149, s[60:63], s30 offen nt lds
    s_add_u32 m0, s31, 80896
    s_add_u32 s30, s36, 53760
    buffer_load_dwordx4 v149, s[60:63], s30 offen nt lds
    v_bfe_u32 v9, v2, 2, 2
    v_lshl_add_u32 v10, v3, 3, v9
    v_lshlrev_b32 v10, 8, v10
    v_and_b32 v13, 1, v2
    v_lshl_add_u32 v10, v13, 3, v10
    v_add_u32 v10, 65536, v10
    v_lshlrev_b32 v9, 1, v9
    v_and_b32 v13, 1, v3
    v_lshl_add_u32 v9, v13, 3, v9
    v_bfe_u32 v13, v2, 1, 1
    v_xor_b32 v9, v9, v13
    v_xor_b32 v13, 0, v9
    v_lshl_add_u32 v150, v13, 4, v10
    v_xor_b32 v13, 2, v9
    v_lshl_add_u32 v151, v13, 4, v10
    v_xor_b32 v13, 4, v9
    v_lshl_add_u32 v152, v13, 4, v10
    v_xor_b32 v13, 6, v9
    v_lshl_add_u32 v153, v13, 4, v10
    v_xor_b32 v13, 8, v9
    v_lshl_add_u32 v154, v13, 4, v10
    v_xor_b32 v13, 10, v9
    v_lshl_add_u32 v155, v13, 4, v10
    v_xor_b32 v13, 12, v9
    v_lshl_add_u32 v156, v13, 4, v10
    s_lshr_b32 s30, s19, 2
    s_mul_i32 s30, s30, 114688
    s_and_b32 s31, s19, 3
    s_mul_i32 s31, s31, 28672
    s_add_u32 s30, s30, s31
    s_lshl_b32 s31, s21, 10
    s_add_u32 s30, s30, s31
    s_add_u32 s30, s30, 6422528
    s_mul_i32 s31, s22, 7
    s_add_u32 s32, s31, 0
    s_lshr_b32 s33, s32, 1
    s_mul_i32 s33, s33, 458752
    s_and_b32 s32, s32, 1
    s_mul_i32 s32, s32, 14336
    s_add_u32 s32, s32, s33
    s_add_u32 s40, s32, s30
    s_add_u32 s32, s31, 1
    s_lshr_b32 s33, s32, 1
    s_mul_i32 s33, s33, 458752
    s_and_b32 s32, s32, 1
    s_mul_i32 s32, s32, 14336
    s_add_u32 s32, s32, s33
    s_add_u32 s41, s32, s30
    s_add_u32 s32, s31, 2
    s_lshr_b32 s33, s32, 1
    s_mul_i32 s33, s33, 458752
    s_and_b32 s32, s32, 1
    s_mul_i32 s32, s32, 14336
    s_add_u32 s32, s32, s33
    s_add_u32 s42, s32, s30
    s_add_u32 s32, s31, 3
    s_lshr_b32 s33, s32, 1
    s_mul_i32 s33, s33, 458752
    s_and_b32 s32, s32, 1
    s_mul_i32 s32, s32, 14336
    s_add_u32 s32, s32, s33
    s_add_u32 s43, s32, s30
    s_add_u32 s32, s31, 4
    s_lshr_b32 s33, s32, 1
    s_mul_i32 s33, s33, 458752
    s_and_b32 s32, s32, 1
    s_mul_i32 s32, s32, 14336
    s_add_u32 s32, s32, s33
    s_add_u32 s44, s32, s30
    s_add_u32 s32, s31, 5
    s_lshr_b32 s33, s32, 1
    s_mul_i32 s33, s33, 458752
    s_and_b32 s32, s32, 1
    s_mul_i32 s32, s32, 14336
    s_add_u32 s32, s32, s33
    s_add_u32 s45, s32, s30
    s_add_u32 s32, s31, 6
    s_lshr_b32 s33, s32, 1
    s_mul_i32 s33, s33, 458752
    s_and_b32 s32, s32, 1
    s_mul_i32 s32, s32, 14336
    s_add_u32 s32, s32, s33
    s_add_u32 s46, s32, s30
    v_add_u32 v9, 0, v3
    v_xor_b32 v9, v9, v4
    v_lshlrev_b32 v9, 4, v9
    v_lshl_add_u32 v9, v4, 9, v9
    v_add_u32 v168, s38, v9
    v_add_u32 v172, 65536, v9
    v_add_u32 v9, 4, v3
    v_xor_b32 v9, v9, v4
    v_lshlrev_b32 v9, 4, v9
    v_lshl_add_u32 v9, v4, 9, v9
    v_add_u32 v169, s38, v9
    v_add_u32 v173, 65536, v9
    v_add_u32 v9, 8, v3
    v_xor_b32 v9, v9, v4
    v_lshlrev_b32 v9, 4, v9
    v_lshl_add_u32 v9, v4, 9, v9
    v_add_u32 v170, s38, v9
    v_add_u32 v174, 65536, v9
    v_add_u32 v9, 12, v3
    v_xor_b32 v9, v9, v4
    v_lshlrev_b32 v9, 4, v9
    v_lshl_add_u32 v9, v4, 9, v9
    v_add_u32 v171, s38, v9
    v_add_u32 v175, 65536, v9
    v_mov_b32 v128, -1
    v_mov_b32 v132, 0
    v_mov_b32 v129, -1
    v_mov_b32 v133, 0
    v_mov_b32 v130, -1
    v_mov_b32 v134, 0
    v_mov_b32 v131, -1
    v_mov_b32 v135, 0
    s_mul_i32 s30, s2, 148
    v_add_u32 v9, s30, v0
    v_lshlrev_b32 v9, 4, v9
    v_add_u32 v10, 8192, v9
    v_cmp_le_u32 vcc, 516096, v9
    v_mov_b32 v11, 1073741824
    s_nop 0
    v_cndmask_b32 v9, v9, v10, vcc
    v_cmp_gt_u32 vcc, 148, v0
    s_nop 1
    v_cndmask_b32 v9, v11, v9, vcc
    s_mov_b32 s30, 44048384
    buffer_store_dwordx4 v[128:131], v9, s[8:11], s30 offen sc1
    v_lshlrev_b32 v9, 4, v0
    v_cmp_gt_u32 vcc, 32, v0
    s_lshl_b32 s30, s2, 9
    s_add_u32 s30, s30, 44662784
    v_cndmask_b32 v9, v11, v9, vcc
    buffer_store_dwordx4 v[132:135], v9, s[8:11], s30 offen sc1
    s_cmp_eq_u32 s12, 0
    s_cselect_b32 s30, s16, 1073741824
    v_mov_b32 v190, 1
    s_mov_b64 exec, 1
    buffer_atomic_add v190, off, s[84:87], s30 sc0
    s_mov_b64 exec, -1
    s_waitcnt vmcnt(35)
    s_mov_b32 s30, 3216550459
    v_mov_b32 v12, 0
    v_mov_b32 v13, 0
    v_mov_b32 v14, 0
    v_mov_b32 v15, 0
    v_lshlrev_b32 v206, 16, v206
    v_mul_f32 v9, s30, v206
    v_exp_f32 v9, v9
    s_nop 0
    v_add_f32 v9, 1.0, v9
    v_rcp_f32 v9, v9
    s_nop 0
    v_mul_f32 v206, v206, v9
    v_lshlrev_b32 v10, 16, v192
    v_and_b32 v11, 0xffff0000, v192
    v_fmac_f32 v12, v10, v206
    v_fmac_f32 v13, v11, v206
    v_lshlrev_b32 v10, 16, v193
    v_and_b32 v11, 0xffff0000, v193
    v_fmac_f32 v14, v10, v206
    v_fmac_f32 v15, v11, v206
    v_lshlrev_b32 v207, 16, v207
    v_mul_f32 v9, s30, v207
    v_exp_f32 v9, v9
    s_nop 0
    v_add_f32 v9, 1.0, v9
    v_rcp_f32 v9, v9
    s_nop 0
    v_mul_f32 v207, v207, v9
    v_lshlrev_b32 v10, 16, v194
    v_and_b32 v11, 0xffff0000, v194
    v_fmac_f32 v12, v10, v207
    v_fmac_f32 v13, v11, v207
    v_lshlrev_b32 v10, 16, v195
    v_and_b32 v11, 0xffff0000, v195
    v_fmac_f32 v14, v10, v207
    v_fmac_f32 v15, v11, v207
    v_lshlrev_b32 v208, 16, v208
    v_mul_f32 v9, s30, v208
    v_exp_f32 v9, v9
    s_nop 0
    v_add_f32 v9, 1.0, v9
    v_rcp_f32 v9, v9
    s_nop 0
    v_mul_f32 v208, v208, v9
    v_lshlrev_b32 v10, 16, v196
    v_and_b32 v11, 0xffff0000, v196
    v_fmac_f32 v12, v10, v208
    v_fmac_f32 v13, v11, v208
    v_lshlrev_b32 v10, 16, v197
    v_and_b32 v11, 0xffff0000, v197
    v_fmac_f32 v14, v10, v208
    v_fmac_f32 v15, v11, v208
    v_lshlrev_b32 v209, 16, v209
    v_mul_f32 v9, s30, v209
    v_exp_f32 v9, v9
    s_nop 0
    v_add_f32 v9, 1.0, v9
    v_rcp_f32 v9, v9
    s_nop 0
    v_mul_f32 v209, v209, v9
    v_lshlrev_b32 v10, 16, v198
    v_and_b32 v11, 0xffff0000, v198
    v_fmac_f32 v12, v10, v209
    v_fmac_f32 v13, v11, v209
    v_lshlrev_b32 v10, 16, v199
    v_and_b32 v11, 0xffff0000, v199
    v_fmac_f32 v14, v10, v209
    v_fmac_f32 v15, v11, v209
    v_lshlrev_b32 v210, 16, v210
    v_mul_f32 v9, s30, v210
    v_exp_f32 v9, v9
    s_nop 0
    v_add_f32 v9, 1.0, v9
    v_rcp_f32 v9, v9
    s_nop 0
    v_mul_f32 v210, v210, v9
    v_lshlrev_b32 v10, 16, v200
    v_and_b32 v11, 0xffff0000, v200
    v_fmac_f32 v12, v10, v210
    v_fmac_f32 v13, v11, v210
    v_lshlrev_b32 v10, 16, v201
    v_and_b32 v11, 0xffff0000, v201
    v_fmac_f32 v14, v10, v210
    v_fmac_f32 v15, v11, v210
    v_lshlrev_b32 v211, 16, v211
    v_mul_f32 v9, s30, v211
    v_exp_f32 v9, v9
    s_nop 0
    v_add_f32 v9, 1.0, v9
    v_rcp_f32 v9, v9
    s_nop 0
    v_mul_f32 v211, v211, v9
    v_lshlrev_b32 v10, 16, v202
    v_and_b32 v11, 0xffff0000, v202
    v_fmac_f32 v12, v10, v211
    v_fmac_f32 v13, v11, v211
    v_lshlrev_b32 v10, 16, v203
    v_and_b32 v11, 0xffff0000, v203
    v_fmac_f32 v14, v10, v211
    v_fmac_f32 v15, v11, v211
    v_lshlrev_b32 v212, 16, v212
    v_mul_f32 v9, s30, v212
    v_exp_f32 v9, v9
    s_nop 0
    v_add_f32 v9, 1.0, v9
    v_rcp_f32 v9, v9
    s_nop 0
    v_mul_f32 v212, v212, v9
    v_lshlrev_b32 v10, 16, v204
    v_and_b32 v11, 0xffff0000, v204
    v_fmac_f32 v12, v10, v212
    v_fmac_f32 v13, v11, v212
    v_lshlrev_b32 v10, 16, v205
    v_and_b32 v11, 0xffff0000, v205
    v_fmac_f32 v14, v10, v212
    v_fmac_f32 v15, v11, v212
    s_nop 1
    v_add_f32_dpp v12, v12, v12 row_ror:4 row_mask:0xf bank_mask:0xf
    v_add_f32_dpp v13, v13, v13 row_ror:4 row_mask:0xf bank_mask:0xf
    v_add_f32_dpp v14, v14, v14 row_ror:4 row_mask:0xf bank_mask:0xf
    v_add_f32_dpp v15, v15, v15 row_ror:4 row_mask:0xf bank_mask:0xf
    s_nop 1
    v_add_f32_dpp v12, v12, v12 row_ror:8 row_mask:0xf bank_mask:0xf
    v_add_f32_dpp v13, v13, v13 row_ror:8 row_mask:0xf bank_mask:0xf
    v_add_f32_dpp v14, v14, v14 row_ror:8 row_mask:0xf bank_mask:0xf
    v_add_f32_dpp v15, v15, v15 row_ror:8 row_mask:0xf bank_mask:0xf
    v_lshrrev_b32 v9, 4, v0
    v_lshlrev_b32 v9, 6, v9
    v_lshl_add_u32 v9, v6, 4, v9
    v_add_u32 v9, 131072, v9
    ds_write_b128 v9, v[12:15]
    s_waitcnt vmcnt(19)
    ds_read_b128 a[0:3], v168 offset:0
    ds_read_b128 a[4:7], v168 offset:8192
    ds_read_b128 a[8:11], v169 offset:0
    ds_read_b128 a[12:15], v169 offset:8192
    ds_read_b128 a[16:19], v170 offset:0
    ds_read_b128 a[20:23], v170 offset:8192
    ds_read_b128 a[24:27], v171 offset:0
    ds_read_b128 a[28:31], v171 offset:8192
    ds_read_b128 a[32:35], v168 offset:256
    ds_read_b128 a[36:39], v168 offset:8448
    ds_read_b128 a[40:43], v169 offset:256
    ds_read_b128 a[44:47], v169 offset:8448
    ds_read_b128 a[48:51], v170 offset:256
    ds_read_b128 a[52:55], v170 offset:8448
    ds_read_b128 a[56:59], v171 offset:256
    ds_read_b128 a[60:63], v171 offset:8448
    s_waitcnt lgkmcnt(0)
    s_add_u32 m0, s38, 0
    s_add_u32 s30, s25, 262144
    buffer_load_dwordx4 v160, s[56:59], s30 offen nt lds
    s_add_u32 m0, s38, 1024
    s_add_u32 s30, s25, 278528
    buffer_load_dwordx4 v161, s[56:59], s30 offen nt lds
    s_add_u32 m0, s38, 2048
    s_add_u32 s30, s25, 294912
    buffer_load_dwordx4 v162, s[56:59], s30 offen nt lds
    s_add_u32 m0, s38, 3072
    s_add_u32 s30, s25, 311296
    buffer_load_dwordx4 v163, s[56:59], s30 offen nt lds
    s_add_u32 m0, s38, 4096
    s_add_u32 s30, s25, 327680
    buffer_load_dwordx4 v164, s[56:59], s30 offen nt lds
    s_add_u32 m0, s38, 5120
    s_add_u32 s30, s25, 344064
    buffer_load_dwordx4 v165, s[56:59], s30 offen nt lds
    s_add_u32 m0, s38, 6144
    s_add_u32 s30, s25, 360448
    buffer_load_dwordx4 v166, s[56:59], s30 offen nt lds
    s_add_u32 m0, s38, 7168
    s_add_u32 s30, s25, 376832
    buffer_load_dwordx4 v167, s[56:59], s30 offen nt lds
    s_add_u32 m0, s38, 8192
    s_add_u32 s30, s25, 393216
    buffer_load_dwordx4 v160, s[56:59], s30 offen nt lds
    s_add_u32 m0, s38, 9216
    s_add_u32 s30, s25, 409600
    buffer_load_dwordx4 v161, s[56:59], s30 offen nt lds
    s_add_u32 m0, s38, 10240
    s_add_u32 s30, s25, 425984
    buffer_load_dwordx4 v162, s[56:59], s30 offen nt lds
    s_add_u32 m0, s38, 11264
    s_add_u32 s30, s25, 442368
    buffer_load_dwordx4 v163, s[56:59], s30 offen nt lds
    s_add_u32 m0, s38, 12288
    s_add_u32 s30, s25, 458752
    buffer_load_dwordx4 v164, s[56:59], s30 offen nt lds
    s_add_u32 m0, s38, 13312
    s_add_u32 s30, s25, 475136
    buffer_load_dwordx4 v165, s[56:59], s30 offen nt lds
    s_add_u32 m0, s38, 14336
    s_add_u32 s30, s25, 491520
    buffer_load_dwordx4 v166, s[56:59], s30 offen nt lds
    s_add_u32 m0, s38, 15360
    s_add_u32 s30, s25, 507904
    buffer_load_dwordx4 v167, s[56:59], s30 offen nt lds
    s_waitcnt vmcnt(16)
    s_barrier
    v_lshlrev_b32 v9, 2, v2
    v_add_u32 v9, 131072, v9
    ds_read_b32 v12, v9 offset:0
    ds_read_b32 v13, v9 offset:256
    ds_read_b32 v14, v9 offset:512
    ds_read_b32 v15, v9 offset:768
    s_waitcnt lgkmcnt(0)
    v_add_f32 v12, v12, v13
    v_add_f32 v14, v14, v15
    v_add_f32 v12, v12, v14
    v_mov_b32 v13, v12
    s_nop 1
    v_permlane16_swap_b32 v12, v13
    v_add_f32 v12, v12, v13
    v_mov_b32 v13, v12
    s_nop 1
    v_permlane32_swap_b32 v12, v13
    v_add_f32 v12, v12, v13
    v_lshlrev_b32 v9, 2, v4
    s_lshl_b32 s30, s39, 6
    s_add_u32 s30, s30, 44859392
    s_cmp_lt_u32 s2, 168
    s_cselect_b32 s30, s30, 1073741824
    s_cmp_eq_u32 s12, 0
    s_cselect_b32 s30, s30, 1073741824
    buffer_store_dword v12, v9, s[8:11], s30 offen sc1
    v_min_u32 v213, 0xfffe, v213
    v_lshlrev_b32 v9, 1, v0
    s_lshl_b32 s30, s2, 9
    s_cmp_lt_u32 s2, 14
    s_cselect_b32 s30, s30, 1073741824
    s_add_u32 s31, s30, 44564480
    s_add_u32 s30, s30, 44040192
    buffer_store_short v213, v9, s[8:11], s30 offen sc1
    buffer_store_short v213, v9, s[8:11], s31 offen sc1
    ds_read_b64_tr_b16 v[128:129], v150 offset:0
    ds_read_b64_tr_b16 v[130:131], v150 offset:1024
    ds_read_b64_tr_b16 v[132:133], v150 offset:8192
    ds_read_b64_tr_b16 v[134:135], v150 offset:9216
    ds_read_b64_tr_b16 v[136:137], v150 offset:16384
    ds_read_b64_tr_b16 v[138:139], v150 offset:17408
    s_waitcnt lgkmcnt(4)
    v_mfma_f32_16x16x32_bf16 v[16:19], a[0:3], v[128:131], 0
    v_mfma_f32_16x16x32_bf16 v[20:23], a[4:7], v[128:131], 0
    ds_read_b64_tr_b16 v[128:129], v150 offset:24576
    ds_read_b64_tr_b16 v[130:131], v150 offset:25600
    s_waitcnt lgkmcnt(4)
    v_mfma_f32_16x16x32_bf16 v[16:19], a[8:11], v[132:135], v[16:19]
    v_mfma_f32_16x16x32_bf16 v[20:23], a[12:15], v[132:135], v[20:23]
    ds_read_b64_tr_b16 v[132:133], v150 offset:32768
    ds_read_b64_tr_b16 v[134:135], v150 offset:33792
    s_waitcnt lgkmcnt(4)
    v_mfma_f32_16x16x32_bf16 v[16:19], a[16:19], v[136:139], v[16:19]
    v_mfma_f32_16x16x32_bf16 v[20:23], a[20:23], v[136:139], v[20:23]
    ds_read_b64_tr_b16 v[136:137], v150 offset:40960
    ds_read_b64_tr_b16 v[138:139], v150 offset:41984
    s_waitcnt lgkmcnt(4)
    v_mfma_f32_16x16x32_bf16 v[16:19], a[24:27], v[128:131], v[16:19]
    v_mfma_f32_16x16x32_bf16 v[20:23], a[28:31], v[128:131], v[20:23]
    ds_read_b64_tr_b16 v[128:129], v150 offset:49152
    ds_read_b64_tr_b16 v[130:131], v150 offset:50176
    s_waitcnt lgkmcnt(4)
    v_mfma_f32_16x16x32_bf16 v[16:19], a[32:35], v[132:135], v[16:19]
    v_mfma_f32_16x16x32_bf16 v[20:23], a[36:39], v[132:135], v[20:23]
    ds_read_b64_tr_b16 v[132:133], v150 offset:57344
    ds_read_b64_tr_b16 v[134:135], v150 offset:58368
    s_waitcnt lgkmcnt(4)
    v_mfma_f32_16x16x32_bf16 v[16:19], a[40:43], v[136:139], v[16:19]
    v_mfma_f32_16x16x32_bf16 v[20:23], a[44:47], v[136:139], v[20:23]
    ds_read_b64_tr_b16 v[136:137], v151 offset:0
    ds_read_b64_tr_b16 v[138:139], v151 offset:1024
    s_waitcnt lgkmcnt(4)
    v_mfma_f32_16x16x32_bf16 v[16:19], a[48:51], v[128:131], v[16:19]
    v_mfma_f32_16x16x32_bf16 v[20:23], a[52:55], v[128:131], v[20:23]
    ds_read_b64_tr_b16 v[128:129], v151 offset:8192
    ds_read_b64_tr_b16 v[130:131], v151 offset:9216
    s_waitcnt lgkmcnt(4)
    v_mfma_f32_16x16x32_bf16 v[16:19], a[56:59], v[132:135], v[16:19]
    v_mfma_f32_16x16x32_bf16 v[20:23], a[60:63], v[132:135], v[20:23]
    ds_read_b64_tr_b16 v[132:133], v151 offset:16384
    ds_read_b64_tr_b16 v[134:135], v151 offset:17408
    s_waitcnt lgkmcnt(4)
    v_mfma_f32_16x16x32_bf16 v[32:35], a[0:3], v[136:139], 0
    v_mfma_f32_16x16x32_bf16 v[36:39], a[4:7], v[136:139], 0
    ds_read_b64_tr_b16 v[136:137], v151 offset:24576
    ds_read_b64_tr_b16 v[138:139], v151 offset:25600
    s_waitcnt lgkmcnt(4)
    v_mfma_f32_16x16x32_bf16 v[32:35], a[8:11], v[128:131], v[32:35]
    v_mfma_f32_16x16x32_bf16 v[36:39], a[12:15], v[128:131], v[36:39]
    ds_read_b64_tr_b16 v[128:129], v151 offset:32768
    ds_read_b64_tr_b16 v[130:131], v151 offset:33792
    s_waitcnt lgkmcnt(4)
    v_mfma_f32_16x16x32_bf16 v[32:35], a[16:19], v[132:135], v[32:35]
    v_mfma_f32_16x16x32_bf16 v[36:39], a[20:23], v[132:135], v[36:39]
    ds_read_b64_tr_b16 v[132:133], v151 offset:40960
    ds_read_b64_tr_b16 v[134:135], v151 offset:41984
    s_waitcnt lgkmcnt(4)
    v_mfma_f32_16x16x32_bf16 v[32:35], a[24:27], v[136:139], v[32:35]
    v_mfma_f32_16x16x32_bf16 v[36:39], a[28:31], v[136:139], v[36:39]
    ds_read_b64_tr_b16 v[136:137], v151 offset:49152
    ds_read_b64_tr_b16 v[138:139], v151 offset:50176
    s_waitcnt lgkmcnt(4)
    v_mfma_f32_16x16x32_bf16 v[32:35], a[32:35], v[128:131], v[32:35]
    v_mfma_f32_16x16x32_bf16 v[36:39], a[36:39], v[128:131], v[36:39]
    ds_read_b64_tr_b16 v[128:129], v151 offset:57344
    ds_read_b64_tr_b16 v[130:131], v151 offset:58368
    s_waitcnt lgkmcnt(4)
    v_mfma_f32_16x16x32_bf16 v[32:35], a[40:43], v[132:135], v[32:35]
    v_mfma_f32_16x16x32_bf16 v[36:39], a[44:47], v[132:135], v[36:39]
    ds_read_b64_tr_b16 v[132:133], v152 offset:0
    ds_read_b64_tr_b16 v[134:135], v152 offset:1024
    s_waitcnt lgkmcnt(4)
    v_mfma_f32_16x16x32_bf16 v[32:35], a[48:51], v[136:139], v[32:35]
    v_mfma_f32_16x16x32_bf16 v[36:39], a[52:55], v[136:139], v[36:39]
    ds_read_b64_tr_b16 v[136:137], v152 offset:8192
    ds_read_b64_tr_b16 v[138:139], v152 offset:9216
    s_waitcnt lgkmcnt(4)
    v_mfma_f32_16x16x32_bf16 v[32:35], a[56:59], v[128:131], v[32:35]
    v_mfma_f32_16x16x32_bf16 v[36:39], a[60:63], v[128:131], v[36:39]
    ds_read_b64_tr_b16 v[128:129], v152 offset:16384
    ds_read_b64_tr_b16 v[130:131], v152 offset:17408
    s_waitcnt lgkmcnt(4)
    v_mfma_f32_16x16x32_bf16 v[48:51], a[0:3], v[132:135], 0
    v_mfma_f32_16x16x32_bf16 v[52:55], a[4:7], v[132:135], 0
    ds_read_b64_tr_b16 v[132:133], v152 offset:24576
    ds_read_b64_tr_b16 v[134:135], v152 offset:25600
    s_waitcnt lgkmcnt(4)
    v_mfma_f32_16x16x32_bf16 v[48:51], a[8:11], v[136:139], v[48:51]
    v_mfma_f32_16x16x32_bf16 v[52:55], a[12:15], v[136:139], v[52:55]
    ds_read_b64_tr_b16 v[136:137], v152 offset:32768
    ds_read_b64_tr_b16 v[138:139], v152 offset:33792
    s_waitcnt lgkmcnt(4)
    v_mfma_f32_16x16x32_bf16 v[48:51], a[16:19], v[128:131], v[48:51]
    v_mfma_f32_16x16x32_bf16 v[52:55], a[20:23], v[128:131], v[52:55]
    ds_read_b64_tr_b16 v[128:129], v152 offset:40960
    ds_read_b64_tr_b16 v[130:131], v152 offset:41984
    s_waitcnt lgkmcnt(4)
    v_mfma_f32_16x16x32_bf16 v[48:51], a[24:27], v[132:135], v[48:51]
    v_mfma_f32_16x16x32_bf16 v[52:55], a[28:31], v[132:135], v[52:55]
    ds_read_b64_tr_b16 v[132:133], v152 offset:49152
    ds_read_b64_tr_b16 v[134:135], v152 offset:50176
    s_waitcnt lgkmcnt(4)
    v_mfma_f32_16x16x32_bf16 v[48:51], a[32:35], v[136:139], v[48:51]
    v_mfma_f32_16x16x32_bf16 v[52:55], a[36:39], v[136:139], v[52:55]
    ds_read_b64_tr_b16 v[136:137], v152 offset:57344
    ds_read_b64_tr_b16 v[138:139], v152 offset:58368
    s_waitcnt lgkmcnt(4)
    v_mfma_f32_16x16x32_bf16 v[48:51], a[40:43], v[128:131], v[48:51]
    v_mfma_f32_16x16x32_bf16 v[52:55], a[44:47], v[128:131], v[52:55]
    ds_read_b64_tr_b16 v[128:129], v153 offset:0
    ds_read_b64_tr_b16 v[130:131], v153 offset:1024
    s_waitcnt lgkmcnt(4)
    v_mfma_f32_16x16x32_bf16 v[48:51], a[48:51], v[132:135], v[48:51]
    v_mfma_f32_16x16x32_bf16 v[52:55], a[52:55], v[132:135], v[52:55]
    ds_read_b64_tr_b16 v[132:133], v153 offset:8192
    ds_read_b64_tr_b16 v[134:135], v153 offset:9216
    s_waitcnt lgkmcnt(4)
    v_mfma_f32_16x16x32_bf16 v[48:51], a[56:59], v[136:139], v[48:51]
    v_mfma_f32_16x16x32_bf16 v[52:55], a[60:63], v[136:139], v[52:55]
    ds_read_b64_tr_b16 v[136:137], v153 offset:16384
    ds_read_b64_tr_b16 v[138:139], v153 offset:17408
    s_waitcnt lgkmcnt(4)
    v_mfma_f32_16x16x32_bf16 v[64:67], a[0:3], v[128:131], 0
    v_mfma_f32_16x16x32_bf16 v[68:71], a[4:7], v[128:131], 0
    ds_read_b64_tr_b16 v[128:129], v153 offset:24576
    ds_read_b64_tr_b16 v[130:131], v153 offset:25600
    s_waitcnt lgkmcnt(4)
    v_mfma_f32_16x16x32_bf16 v[64:67], a[8:11], v[132:135], v[64:67]
    v_mfma_f32_16x16x32_bf16 v[68:71], a[12:15], v[132:135], v[68:71]
    ds_read_b64_tr_b16 v[132:133], v153 offset:32768
    ds_read_b64_tr_b16 v[134:135], v153 offset:33792
    s_waitcnt lgkmcnt(4)
    v_mfma_f32_16x16x32_bf16 v[64:67], a[16:19], v[136:139], v[64:67]
    v_mfma_f32_16x16x32_bf16 v[68:71], a[20:23], v[136:139], v[68:71]
    ds_read_b64_tr_b16 v[136:137], v153 offset:40960
    ds_read_b64_tr_b16 v[138:139], v153 offset:41984
    s_waitcnt lgkmcnt(4)
    v_mfma_f32_16x16x32_bf16 v[64:67], a[24:27], v[128:131], v[64:67]
    v_mfma_f32_16x16x32_bf16 v[68:71], a[28:31], v[128:131], v[68:71]
    ds_read_b64_tr_b16 v[128:129], v153 offset:49152
    ds_read_b64_tr_b16 v[130:131], v153 offset:50176
    s_waitcnt lgkmcnt(4)
    v_mfma_f32_16x16x32_bf16 v[64:67], a[32:35], v[132:135], v[64:67]
    v_mfma_f32_16x16x32_bf16 v[68:71], a[36:39], v[132:135], v[68:71]
    ds_read_b64_tr_b16 v[132:133], v153 offset:57344
    ds_read_b64_tr_b16 v[134:135], v153 offset:58368
    s_waitcnt lgkmcnt(4)
    v_mfma_f32_16x16x32_bf16 v[64:67], a[40:43], v[136:139], v[64:67]
    v_mfma_f32_16x16x32_bf16 v[68:71], a[44:47], v[136:139], v[68:71]
    ds_read_b64_tr_b16 v[136:137], v154 offset:0
    ds_read_b64_tr_b16 v[138:139], v154 offset:1024
    s_waitcnt lgkmcnt(4)
    v_mfma_f32_16x16x32_bf16 v[64:67], a[48:51], v[128:131], v[64:67]
    v_mfma_f32_16x16x32_bf16 v[68:71], a[52:55], v[128:131], v[68:71]
    ds_read_b64_tr_b16 v[128:129], v154 offset:8192
    ds_read_b64_tr_b16 v[130:131], v154 offset:9216
    s_waitcnt lgkmcnt(4)
    v_mfma_f32_16x16x32_bf16 v[64:67], a[56:59], v[132:135], v[64:67]
    v_mfma_f32_16x16x32_bf16 v[68:71], a[60:63], v[132:135], v[68:71]
    ds_read_b64_tr_b16 v[132:133], v154 offset:16384
    ds_read_b64_tr_b16 v[134:135], v154 offset:17408
    s_waitcnt lgkmcnt(4)
    v_mfma_f32_16x16x32_bf16 v[80:83], a[0:3], v[136:139], 0
    v_mfma_f32_16x16x32_bf16 v[84:87], a[4:7], v[136:139], 0
    ds_read_b64_tr_b16 v[136:137], v154 offset:24576
    ds_read_b64_tr_b16 v[138:139], v154 offset:25600
    s_waitcnt lgkmcnt(4)
    v_mfma_f32_16x16x32_bf16 v[80:83], a[8:11], v[128:131], v[80:83]
    v_mfma_f32_16x16x32_bf16 v[84:87], a[12:15], v[128:131], v[84:87]
    ds_read_b64_tr_b16 v[128:129], v154 offset:32768
    ds_read_b64_tr_b16 v[130:131], v154 offset:33792
    s_waitcnt lgkmcnt(4)
    v_mfma_f32_16x16x32_bf16 v[80:83], a[16:19], v[132:135], v[80:83]
    v_mfma_f32_16x16x32_bf16 v[84:87], a[20:23], v[132:135], v[84:87]
    ds_read_b64_tr_b16 v[132:133], v154 offset:40960
    ds_read_b64_tr_b16 v[134:135], v154 offset:41984
    s_waitcnt lgkmcnt(4)
    v_mfma_f32_16x16x32_bf16 v[80:83], a[24:27], v[136:139], v[80:83]
    v_mfma_f32_16x16x32_bf16 v[84:87], a[28:31], v[136:139], v[84:87]
    ds_read_b64_tr_b16 v[136:137], v154 offset:49152
    ds_read_b64_tr_b16 v[138:139], v154 offset:50176
    s_waitcnt lgkmcnt(4)
    v_mfma_f32_16x16x32_bf16 v[80:83], a[32:35], v[128:131], v[80:83]
    v_mfma_f32_16x16x32_bf16 v[84:87], a[36:39], v[128:131], v[84:87]
    ds_read_b64_tr_b16 v[128:129], v154 offset:57344
    ds_read_b64_tr_b16 v[130:131], v154 offset:58368
    s_waitcnt lgkmcnt(4)
    v_mfma_f32_16x16x32_bf16 v[80:83], a[40:43], v[132:135], v[80:83]
    v_mfma_f32_16x16x32_bf16 v[84:87], a[44:47], v[132:135], v[84:87]
    ds_read_b64_tr_b16 v[132:133], v155 offset:0
    ds_read_b64_tr_b16 v[134:135], v155 offset:1024
    s_waitcnt lgkmcnt(4)
    v_mfma_f32_16x16x32_bf16 v[80:83], a[48:51], v[136:139], v[80:83]
    v_mfma_f32_16x16x32_bf16 v[84:87], a[52:55], v[136:139], v[84:87]
    ds_read_b64_tr_b16 v[136:137], v155 offset:8192
    ds_read_b64_tr_b16 v[138:139], v155 offset:9216
    s_waitcnt lgkmcnt(4)
    v_mfma_f32_16x16x32_bf16 v[80:83], a[56:59], v[128:131], v[80:83]
    v_mfma_f32_16x16x32_bf16 v[84:87], a[60:63], v[128:131], v[84:87]
    ds_read_b64_tr_b16 v[128:129], v155 offset:16384
    ds_read_b64_tr_b16 v[130:131], v155 offset:17408
    s_waitcnt lgkmcnt(4)
    v_mfma_f32_16x16x32_bf16 v[96:99], a[0:3], v[132:135], 0
    v_mfma_f32_16x16x32_bf16 v[100:103], a[4:7], v[132:135], 0
    ds_read_b64_tr_b16 v[132:133], v155 offset:24576
    ds_read_b64_tr_b16 v[134:135], v155 offset:25600
    s_waitcnt lgkmcnt(4)
    v_mfma_f32_16x16x32_bf16 v[96:99], a[8:11], v[136:139], v[96:99]
    v_mfma_f32_16x16x32_bf16 v[100:103], a[12:15], v[136:139], v[100:103]
    ds_read_b64_tr_b16 v[136:137], v155 offset:32768
    ds_read_b64_tr_b16 v[138:139], v155 offset:33792
    s_waitcnt lgkmcnt(4)
    v_mfma_f32_16x16x32_bf16 v[96:99], a[16:19], v[128:131], v[96:99]
    v_mfma_f32_16x16x32_bf16 v[100:103], a[20:23], v[128:131], v[100:103]
    ds_read_b64_tr_b16 v[128:129], v155 offset:40960
    ds_read_b64_tr_b16 v[130:131], v155 offset:41984
    s_waitcnt lgkmcnt(4)
    v_mfma_f32_16x16x32_bf16 v[96:99], a[24:27], v[132:135], v[96:99]
    v_mfma_f32_16x16x32_bf16 v[100:103], a[28:31], v[132:135], v[100:103]
    ds_read_b64_tr_b16 v[132:133], v155 offset:49152
    ds_read_b64_tr_b16 v[134:135], v155 offset:50176
    s_waitcnt lgkmcnt(4)
    v_mfma_f32_16x16x32_bf16 v[96:99], a[32:35], v[136:139], v[96:99]
    v_mfma_f32_16x16x32_bf16 v[100:103], a[36:39], v[136:139], v[100:103]
    ds_read_b64_tr_b16 v[136:137], v155 offset:57344
    ds_read_b64_tr_b16 v[138:139], v155 offset:58368
    s_waitcnt lgkmcnt(4)
    v_mfma_f32_16x16x32_bf16 v[96:99], a[40:43], v[128:131], v[96:99]
    v_mfma_f32_16x16x32_bf16 v[100:103], a[44:47], v[128:131], v[100:103]
    ds_read_b64_tr_b16 v[128:129], v156 offset:0
    ds_read_b64_tr_b16 v[130:131], v156 offset:1024
    s_waitcnt lgkmcnt(4)
    v_mfma_f32_16x16x32_bf16 v[96:99], a[48:51], v[132:135], v[96:99]
    v_mfma_f32_16x16x32_bf16 v[100:103], a[52:55], v[132:135], v[100:103]
    ds_read_b64_tr_b16 v[132:133], v156 offset:8192
    ds_read_b64_tr_b16 v[134:135], v156 offset:9216
    s_waitcnt lgkmcnt(4)
    v_mfma_f32_16x16x32_bf16 v[96:99], a[56:59], v[136:139], v[96:99]
    v_mfma_f32_16x16x32_bf16 v[100:103], a[60:63], v[136:139], v[100:103]
    ds_read_b64_tr_b16 v[136:137], v156 offset:16384
    ds_read_b64_tr_b16 v[138:139], v156 offset:17408
    s_waitcnt lgkmcnt(4)
    v_mfma_f32_16x16x32_bf16 v[112:115], a[0:3], v[128:131], 0
    v_mfma_f32_16x16x32_bf16 v[116:119], a[4:7], v[128:131], 0
    ds_read_b64_tr_b16 v[128:129], v156 offset:24576
    ds_read_b64_tr_b16 v[130:131], v156 offset:25600
    s_waitcnt lgkmcnt(4)
    v_mfma_f32_16x16x32_bf16 v[112:115], a[8:11], v[132:135], v[112:115]
    v_mfma_f32_16x16x32_bf16 v[116:119], a[12:15], v[132:135], v[116:119]
    ds_read_b64_tr_b16 v[132:133], v156 offset:32768
    ds_read_b64_tr_b16 v[134:135], v156 offset:33792
    s_waitcnt lgkmcnt(4)
    v_mfma_f32_16x16x32_bf16 v[112:115], a[16:19], v[136:139], v[112:115]
    v_mfma_f32_16x16x32_bf16 v[116:119], a[20:23], v[136:139], v[116:119]
    ds_read_b64_tr_b16 v[136:137], v156 offset:40960
    ds_read_b64_tr_b16 v[138:139], v156 offset:41984
    s_waitcnt lgkmcnt(4)
    v_mfma_f32_16x16x32_bf16 v[112:115], a[24:27], v[128:131], v[112:115]
    v_mfma_f32_16x16x32_bf16 v[116:119], a[28:31], v[128:131], v[116:119]
    ds_read_b64_tr_b16 v[128:129], v156 offset:49152
    ds_read_b64_tr_b16 v[130:131], v156 offset:50176
    s_waitcnt lgkmcnt(4)
    v_mfma_f32_16x16x32_bf16 v[112:115], a[32:35], v[132:135], v[112:115]
    v_mfma_f32_16x16x32_bf16 v[116:119], a[36:39], v[132:135], v[116:119]
    ds_read_b64_tr_b16 v[132:133], v156 offset:57344
    ds_read_b64_tr_b16 v[134:135], v156 offset:58368
    s_waitcnt lgkmcnt(4)
    v_mfma_f32_16x16x32_bf16 v[112:115], a[40:43], v[136:139], v[112:115]
    v_mfma_f32_16x16x32_bf16 v[116:119], a[44:47], v[136:139], v[116:119]
    s_waitcnt lgkmcnt(2)
    v_mfma_f32_16x16x32_bf16 v[112:115], a[48:51], v[128:131], v[112:115]
    v_mfma_f32_16x16x32_bf16 v[116:119], a[52:55], v[128:131], v[116:119]
    s_waitcnt lgkmcnt(0)
    v_mfma_f32_16x16x32_bf16 v[112:115], a[56:59], v[132:135], v[112:115]
    v_mfma_f32_16x16x32_bf16 v[116:119], a[60:63], v[132:135], v[116:119]
    s_waitcnt vmcnt(0)
    ds_read_b128 a[64:67], v168 offset:0
    ds_read_b128 a[68:71], v168 offset:8192
    ds_read_b128 a[72:75], v169 offset:0
    ds_read_b128 a[76:79], v169 offset:8192
    ds_read_b128 a[80:83], v170 offset:0
    ds_read_b128 a[84:87], v170 offset:8192
    ds_read_b128 a[88:91], v171 offset:0
    ds_read_b128 a[92:95], v171 offset:8192
    ds_read_b128 a[96:99], v168 offset:256
    ds_read_b128 a[100:103], v168 offset:8448
    ds_read_b128 a[104:107], v169 offset:256
    ds_read_b128 a[108:111], v169 offset:8448
    ds_read_b128 a[112:115], v170 offset:256
    ds_read_b128 a[116:119], v170 offset:8448
    ds_read_b128 a[120:123], v171 offset:256
    ds_read_b128 a[124:127], v171 offset:8448
    s_waitcnt lgkmcnt(0)
    ds_read_b64_tr_b16 v[128:129], v150 offset:0
    ds_read_b64_tr_b16 v[130:131], v150 offset:1024
    ds_read_b64_tr_b16 v[132:133], v150 offset:8192
    ds_read_b64_tr_b16 v[134:135], v150 offset:9216
    ds_read_b64_tr_b16 v[136:137], v150 offset:16384
    ds_read_b64_tr_b16 v[138:139], v150 offset:17408
    s_waitcnt lgkmcnt(4)
    v_mfma_f32_16x16x32_bf16 v[24:27], a[64:67], v[128:131], 0
    v_mfma_f32_16x16x32_bf16 v[28:31], a[68:71], v[128:131], 0
    ds_read_b64_tr_b16 v[128:129], v150 offset:24576
    ds_read_b64_tr_b16 v[130:131], v150 offset:25600
    s_waitcnt lgkmcnt(4)
    v_mfma_f32_16x16x32_bf16 v[24:27], a[72:75], v[132:135], v[24:27]
    v_mfma_f32_16x16x32_bf16 v[28:31], a[76:79], v[132:135], v[28:31]
    ds_read_b64_tr_b16 v[132:133], v150 offset:32768
    ds_read_b64_tr_b16 v[134:135], v150 offset:33792
    s_waitcnt lgkmcnt(4)
    v_mfma_f32_16x16x32_bf16 v[24:27], a[80:83], v[136:139], v[24:27]
    v_mfma_f32_16x16x32_bf16 v[28:31], a[84:87], v[136:139], v[28:31]
    ds_read_b64_tr_b16 v[136:137], v150 offset:40960
    ds_read_b64_tr_b16 v[138:139], v150 offset:41984
    s_waitcnt lgkmcnt(4)
    v_mfma_f32_16x16x32_bf16 v[24:27], a[88:91], v[128:131], v[24:27]
    v_cvt_pk_bf16_f32 v16, v16, v17
    v_cvt_pk_bf16_f32 v17, v18, v19
    v_mfma_f32_16x16x32_bf16 v[28:31], a[92:95], v[128:131], v[28:31]
    v_cvt_pk_bf16_f32 v18, v20, v21
    v_cvt_pk_bf16_f32 v19, v22, v23
    ds_read_b64_tr_b16 v[128:129], v150 offset:49152
    ds_read_b64_tr_b16 v[130:131], v150 offset:50176
    s_waitcnt lgkmcnt(4)
    v_mfma_f32_16x16x32_bf16 v[24:27], a[96:99], v[132:135], v[24:27]
    buffer_store_dwordx4 v[16:19], v145, s[8:11], s40 offen offset:0 sc1
    v_mfma_f32_16x16x32_bf16 v[28:31], a[100:103], v[132:135], v[28:31]
    ds_read_b64_tr_b16 v[132:133], v150 offset:57344
    ds_read_b64_tr_b16 v[134:135], v150 offset:58368
    s_waitcnt lgkmcnt(4)
    v_mfma_f32_16x16x32_bf16 v[24:27], a[104:107], v[136:139], v[24:27]
    v_mfma_f32_16x16x32_bf16 v[28:31], a[108:111], v[136:139], v[28:31]
    ds_read_b64_tr_b16 v[136:137], v151 offset:0
    ds_read_b64_tr_b16 v[138:139], v151 offset:1024
    s_waitcnt lgkmcnt(4)
    v_mfma_f32_16x16x32_bf16 v[24:27], a[112:115], v[128:131], v[24:27]
    v_mfma_f32_16x16x32_bf16 v[28:31], a[116:119], v[128:131], v[28:31]
    ds_read_b64_tr_b16 v[128:129], v151 offset:8192
    ds_read_b64_tr_b16 v[130:131], v151 offset:9216
    s_waitcnt lgkmcnt(4)
    v_mfma_f32_16x16x32_bf16 v[24:27], a[120:123], v[132:135], v[24:27]
    v_mfma_f32_16x16x32_bf16 v[28:31], a[124:127], v[132:135], v[28:31]
    ds_read_b64_tr_b16 v[132:133], v151 offset:16384
    ds_read_b64_tr_b16 v[134:135], v151 offset:17408
    s_waitcnt lgkmcnt(4)
    v_mfma_f32_16x16x32_bf16 v[40:43], a[64:67], v[136:139], 0
    v_mfma_f32_16x16x32_bf16 v[44:47], a[68:71], v[136:139], 0
    ds_read_b64_tr_b16 v[136:137], v151 offset:24576
    ds_read_b64_tr_b16 v[138:139], v151 offset:25600
    s_waitcnt lgkmcnt(4)
    v_mfma_f32_16x16x32_bf16 v[40:43], a[72:75], v[128:131], v[40:43]
    v_mfma_f32_16x16x32_bf16 v[44:47], a[76:79], v[128:131], v[44:47]
    ds_read_b64_tr_b16 v[128:129], v151 offset:32768
    ds_read_b64_tr_b16 v[130:131], v151 offset:33792
    s_waitcnt lgkmcnt(4)
    v_mfma_f32_16x16x32_bf16 v[40:43], a[80:83], v[132:135], v[40:43]
    v_mfma_f32_16x16x32_bf16 v[44:47], a[84:87], v[132:135], v[44:47]
    ds_read_b64_tr_b16 v[132:133], v151 offset:40960
    ds_read_b64_tr_b16 v[134:135], v151 offset:41984
    s_waitcnt lgkmcnt(4)
    v_mfma_f32_16x16x32_bf16 v[40:43], a[88:91], v[136:139], v[40:43]
    v_cvt_pk_bf16_f32 v32, v32, v33
    v_cvt_pk_bf16_f32 v33, v34, v35
    v_mfma_f32_16x16x32_bf16 v[44:47], a[92:95], v[136:139], v[44:47]
    v_cvt_pk_bf16_f32 v34, v36, v37
    v_cvt_pk_bf16_f32 v35, v38, v39
    ds_read_b64_tr_b16 v[136:137], v151 offset:49152
    ds_read_b64_tr_b16 v[138:139], v151 offset:50176
    s_waitcnt lgkmcnt(4)
    v_mfma_f32_16x16x32_bf16 v[40:43], a[96:99], v[128:131], v[40:43]
    buffer_store_dwordx4 v[32:35], v145, s[8:11], s41 offen offset:0 sc1
    v_cvt_pk_bf16_f32 v24, v24, v25
    v_mfma_f32_16x16x32_bf16 v[44:47], a[100:103], v[128:131], v[44:47]
    v_cvt_pk_bf16_f32 v25, v26, v27
    v_cvt_pk_bf16_f32 v26, v28, v29
    ds_read_b64_tr_b16 v[128:129], v151 offset:57344
    ds_read_b64_tr_b16 v[130:131], v151 offset:58368
    s_waitcnt lgkmcnt(4)
    v_mfma_f32_16x16x32_bf16 v[40:43], a[104:107], v[132:135], v[40:43]
    v_cvt_pk_bf16_f32 v27, v30, v31
    buffer_store_dwordx4 v[24:27], v146, s[8:11], s40 offen offset:1024 sc1
    v_mfma_f32_16x16x32_bf16 v[44:47], a[108:111], v[132:135], v[44:47]
    ds_read_b64_tr_b16 v[132:133], v152 offset:0
    ds_read_b64_tr_b16 v[134:135], v152 offset:1024
    s_waitcnt lgkmcnt(4)
    v_mfma_f32_16x16x32_bf16 v[40:43], a[112:115], v[136:139], v[40:43]
    v_mfma_f32_16x16x32_bf16 v[44:47], a[116:119], v[136:139], v[44:47]
    ds_read_b64_tr_b16 v[136:137], v152 offset:8192
    ds_read_b64_tr_b16 v[138:139], v152 offset:9216
    s_waitcnt lgkmcnt(4)
    v_mfma_f32_16x16x32_bf16 v[40:43], a[120:123], v[128:131], v[40:43]
    v_mfma_f32_16x16x32_bf16 v[44:47], a[124:127], v[128:131], v[44:47]
    ds_read_b64_tr_b16 v[128:129], v152 offset:16384
    ds_read_b64_tr_b16 v[130:131], v152 offset:17408
    s_waitcnt lgkmcnt(4)
    v_mfma_f32_16x16x32_bf16 v[56:59], a[64:67], v[132:135], 0
    v_mfma_f32_16x16x32_bf16 v[60:63], a[68:71], v[132:135], 0
    ds_read_b64_tr_b16 v[132:133], v152 offset:24576
    ds_read_b64_tr_b16 v[134:135], v152 offset:25600
    s_waitcnt lgkmcnt(4)
    v_mfma_f32_16x16x32_bf16 v[56:59], a[72:75], v[136:139], v[56:59]
    v_mfma_f32_16x16x32_bf16 v[60:63], a[76:79], v[136:139], v[60:63]
    ds_read_b64_tr_b16 v[136:137], v152 offset:32768
    ds_read_b64_tr_b16 v[138:139], v152 offset:33792
    s_waitcnt lgkmcnt(4)
    v_mfma_f32_16x16x32_bf16 v[56:59], a[80:83], v[128:131], v[56:59]
    v_mfma_f32_16x16x32_bf16 v[60:63], a[84:87], v[128:131], v[60:63]
    ds_read_b64_tr_b16 v[128:129], v152 offset:40960
    ds_read_b64_tr_b16 v[130:131], v152 offset:41984
    s_waitcnt lgkmcnt(4)
    v_mfma_f32_16x16x32_bf16 v[56:59], a[88:91], v[132:135], v[56:59]
    v_cvt_pk_bf16_f32 v48, v48, v49
    v_cvt_pk_bf16_f32 v49, v50, v51
    v_mfma_f32_16x16x32_bf16 v[60:63], a[92:95], v[132:135], v[60:63]
    v_cvt_pk_bf16_f32 v50, v52, v53
    v_cvt_pk_bf16_f32 v51, v54, v55
    ds_read_b64_tr_b16 v[132:133], v152 offset:49152
    ds_read_b64_tr_b16 v[134:135], v152 offset:50176
    s_waitcnt lgkmcnt(4)
    v_mfma_f32_16x16x32_bf16 v[56:59], a[96:99], v[136:139], v[56:59]
    buffer_store_dwordx4 v[48:51], v145, s[8:11], s42 offen offset:0 sc1
    v_cvt_pk_bf16_f32 v40, v40, v41
    v_mfma_f32_16x16x32_bf16 v[60:63], a[100:103], v[136:139], v[60:63]
    v_cvt_pk_bf16_f32 v41, v42, v43
    v_cvt_pk_bf16_f32 v42, v44, v45
    ds_read_b64_tr_b16 v[136:137], v152 offset:57344
    ds_read_b64_tr_b16 v[138:139], v152 offset:58368
    s_waitcnt lgkmcnt(4)
    v_mfma_f32_16x16x32_bf16 v[56:59], a[104:107], v[128:131], v[56:59]
    v_cvt_pk_bf16_f32 v43, v46, v47
    buffer_store_dwordx4 v[40:43], v146, s[8:11], s41 offen offset:1024 sc1
    v_mfma_f32_16x16x32_bf16 v[60:63], a[108:111], v[128:131], v[60:63]
    ds_read_b64_tr_b16 v[128:129], v153 offset:0
    ds_read_b64_tr_b16 v[130:131], v153 offset:1024
    s_waitcnt lgkmcnt(4)
    v_mfma_f32_16x16x32_bf16 v[56:59], a[112:115], v[132:135], v[56:59]
    v_mfma_f32_16x16x32_bf16 v[60:63], a[116:119], v[132:135], v[60:63]
    ds_read_b64_tr_b16 v[132:133], v153 offset:8192
    ds_read_b64_tr_b16 v[134:135], v153 offset:9216
    s_waitcnt lgkmcnt(4)
    v_mfma_f32_16x16x32_bf16 v[56:59], a[120:123], v[136:139], v[56:59]
    v_mfma_f32_16x16x32_bf16 v[60:63], a[124:127], v[136:139], v[60:63]
    ds_read_b64_tr_b16 v[136:137], v153 offset:16384
    ds_read_b64_tr_b16 v[138:139], v153 offset:17408
    s_waitcnt lgkmcnt(4)
    v_mfma_f32_16x16x32_bf16 v[72:75], a[64:67], v[128:131], 0
    v_mfma_f32_16x16x32_bf16 v[76:79], a[68:71], v[128:131], 0
    ds_read_b64_tr_b16 v[128:129], v153 offset:24576
    ds_read_b64_tr_b16 v[130:131], v153 offset:25600
    s_waitcnt lgkmcnt(4)
    v_mfma_f32_16x16x32_bf16 v[72:75], a[72:75], v[132:135], v[72:75]
    v_mfma_f32_16x16x32_bf16 v[76:79], a[76:79], v[132:135], v[76:79]
    ds_read_b64_tr_b16 v[132:133], v153 offset:32768
    ds_read_b64_tr_b16 v[134:135], v153 offset:33792
    s_waitcnt lgkmcnt(4)
    v_mfma_f32_16x16x32_bf16 v[72:75], a[80:83], v[136:139], v[72:75]
    v_mfma_f32_16x16x32_bf16 v[76:79], a[84:87], v[136:139], v[76:79]
    ds_read_b64_tr_b16 v[136:137], v153 offset:40960
    ds_read_b64_tr_b16 v[138:139], v153 offset:41984
    s_waitcnt lgkmcnt(4)
    v_mfma_f32_16x16x32_bf16 v[72:75], a[88:91], v[128:131], v[72:75]
    v_cvt_pk_bf16_f32 v64, v64, v65
    v_cvt_pk_bf16_f32 v65, v66, v67
    v_mfma_f32_16x16x32_bf16 v[76:79], a[92:95], v[128:131], v[76:79]
    v_cvt_pk_bf16_f32 v66, v68, v69
    v_cvt_pk_bf16_f32 v67, v70, v71
    ds_read_b64_tr_b16 v[128:129], v153 offset:49152
    ds_read_b64_tr_b16 v[130:131], v153 offset:50176
    s_waitcnt lgkmcnt(4)
    v_mfma_f32_16x16x32_bf16 v[72:75], a[96:99], v[132:135], v[72:75]
    buffer_store_dwordx4 v[64:67], v145, s[8:11], s43 offen offset:0 sc1
    v_cvt_pk_bf16_f32 v56, v56, v57
    v_mfma_f32_16x16x32_bf16 v[76:79], a[100:103], v[132:135], v[76:79]
    v_cvt_pk_bf16_f32 v57, v58, v59
    v_cvt_pk_bf16_f32 v58, v60, v61
    ds_read_b64_tr_b16 v[132:133], v153 offset:57344
    ds_read_b64_tr_b16 v[134:135], v153 offset:58368
    s_waitcnt lgkmcnt(4)
    v_mfma_f32_16x16x32_bf16 v[72:75], a[104:107], v[136:139], v[72:75]
    v_cvt_pk_bf16_f32 v59, v62, v63
    buffer_store_dwordx4 v[56:59], v146, s[8:11], s42 offen offset:1024 sc1
    v_mfma_f32_16x16x32_bf16 v[76:79], a[108:111], v[136:139], v[76:79]
    ds_read_b64_tr_b16 v[136:137], v154 offset:0
    ds_read_b64_tr_b16 v[138:139], v154 offset:1024
    s_waitcnt lgkmcnt(4)
    v_mfma_f32_16x16x32_bf16 v[72:75], a[112:115], v[128:131], v[72:75]
    v_mfma_f32_16x16x32_bf16 v[76:79], a[116:119], v[128:131], v[76:79]
    ds_read_b64_tr_b16 v[128:129], v154 offset:8192
    ds_read_b64_tr_b16 v[130:131], v154 offset:9216
    s_waitcnt lgkmcnt(4)
    v_mfma_f32_16x16x32_bf16 v[72:75], a[120:123], v[132:135], v[72:75]
    v_mfma_f32_16x16x32_bf16 v[76:79], a[124:127], v[132:135], v[76:79]
    ds_read_b64_tr_b16 v[132:133], v154 offset:16384
    ds_read_b64_tr_b16 v[134:135], v154 offset:17408
    s_waitcnt lgkmcnt(4)
    v_mfma_f32_16x16x32_bf16 v[88:91], a[64:67], v[136:139], 0
    v_mfma_f32_16x16x32_bf16 v[92:95], a[68:71], v[136:139], 0
    ds_read_b64_tr_b16 v[136:137], v154 offset:24576
    ds_read_b64_tr_b16 v[138:139], v154 offset:25600
    s_waitcnt lgkmcnt(4)
    v_mfma_f32_16x16x32_bf16 v[88:91], a[72:75], v[128:131], v[88:91]
    v_mfma_f32_16x16x32_bf16 v[92:95], a[76:79], v[128:131], v[92:95]
    ds_read_b64_tr_b16 v[128:129], v154 offset:32768
    ds_read_b64_tr_b16 v[130:131], v154 offset:33792
    s_waitcnt lgkmcnt(4)
    v_mfma_f32_16x16x32_bf16 v[88:91], a[80:83], v[132:135], v[88:91]
    v_mfma_f32_16x16x32_bf16 v[92:95], a[84:87], v[132:135], v[92:95]
    ds_read_b64_tr_b16 v[132:133], v154 offset:40960
    ds_read_b64_tr_b16 v[134:135], v154 offset:41984
    s_waitcnt lgkmcnt(4)
    v_mfma_f32_16x16x32_bf16 v[88:91], a[88:91], v[136:139], v[88:91]
    v_cvt_pk_bf16_f32 v80, v80, v81
    v_cvt_pk_bf16_f32 v81, v82, v83
    v_mfma_f32_16x16x32_bf16 v[92:95], a[92:95], v[136:139], v[92:95]
    v_cvt_pk_bf16_f32 v82, v84, v85
    v_cvt_pk_bf16_f32 v83, v86, v87
    ds_read_b64_tr_b16 v[136:137], v154 offset:49152
    ds_read_b64_tr_b16 v[138:139], v154 offset:50176
    s_waitcnt lgkmcnt(4)
    v_mfma_f32_16x16x32_bf16 v[88:91], a[96:99], v[128:131], v[88:91]
    buffer_store_dwordx4 v[80:83], v145, s[8:11], s44 offen offset:0 sc1
    v_cvt_pk_bf16_f32 v72, v72, v73
    v_mfma_f32_16x16x32_bf16 v[92:95], a[100:103], v[128:131], v[92:95]
    v_cvt_pk_bf16_f32 v73, v74, v75
    v_cvt_pk_bf16_f32 v74, v76, v77
    ds_read_b64_tr_b16 v[128:129], v154 offset:57344
    ds_read_b64_tr_b16 v[130:131], v154 offset:58368
    s_waitcnt lgkmcnt(4)
    v_mfma_f32_16x16x32_bf16 v[88:91], a[104:107], v[132:135], v[88:91]
    v_cvt_pk_bf16_f32 v75, v78, v79
    buffer_store_dwordx4 v[72:75], v146, s[8:11], s43 offen offset:1024 sc1
    v_mfma_f32_16x16x32_bf16 v[92:95], a[108:111], v[132:135], v[92:95]
    ds_read_b64_tr_b16 v[132:133], v155 offset:0
    ds_read_b64_tr_b16 v[134:135], v155 offset:1024
    s_waitcnt lgkmcnt(4)
    v_mfma_f32_16x16x32_bf16 v[88:91], a[112:115], v[136:139], v[88:91]
    v_mfma_f32_16x16x32_bf16 v[92:95], a[116:119], v[136:139], v[92:95]
    ds_read_b64_tr_b16 v[136:137], v155 offset:8192
    ds_read_b64_tr_b16 v[138:139], v155 offset:9216
    s_waitcnt lgkmcnt(4)
    v_mfma_f32_16x16x32_bf16 v[88:91], a[120:123], v[128:131], v[88:91]
    v_mfma_f32_16x16x32_bf16 v[92:95], a[124:127], v[128:131], v[92:95]
    ds_read_b64_tr_b16 v[128:129], v155 offset:16384
    ds_read_b64_tr_b16 v[130:131], v155 offset:17408
    s_waitcnt lgkmcnt(4)
    v_mfma_f32_16x16x32_bf16 v[104:107], a[64:67], v[132:135], 0
    v_mfma_f32_16x16x32_bf16 v[108:111], a[68:71], v[132:135], 0
    ds_read_b64_tr_b16 v[132:133], v155 offset:24576
    ds_read_b64_tr_b16 v[134:135], v155 offset:25600
    s_waitcnt lgkmcnt(4)
    v_mfma_f32_16x16x32_bf16 v[104:107], a[72:75], v[136:139], v[104:107]
    v_mfma_f32_16x16x32_bf16 v[108:111], a[76:79], v[136:139], v[108:111]
    ds_read_b64_tr_b16 v[136:137], v155 offset:32768
    ds_read_b64_tr_b16 v[138:139], v155 offset:33792
    s_waitcnt lgkmcnt(4)
    v_mfma_f32_16x16x32_bf16 v[104:107], a[80:83], v[128:131], v[104:107]
    v_mfma_f32_16x16x32_bf16 v[108:111], a[84:87], v[128:131], v[108:111]
    ds_read_b64_tr_b16 v[128:129], v155 offset:40960
    ds_read_b64_tr_b16 v[130:131], v155 offset:41984
    s_waitcnt lgkmcnt(4)
    v_mfma_f32_16x16x32_bf16 v[104:107], a[88:91], v[132:135], v[104:107]
    v_cvt_pk_bf16_f32 v96, v96, v97
    v_cvt_pk_bf16_f32 v97, v98, v99
    v_mfma_f32_16x16x32_bf16 v[108:111], a[92:95], v[132:135], v[108:111]
    v_cvt_pk_bf16_f32 v98, v100, v101
    v_cvt_pk_bf16_f32 v99, v102, v103
    ds_read_b64_tr_b16 v[132:133], v155 offset:49152
    ds_read_b64_tr_b16 v[134:135], v155 offset:50176
    s_waitcnt lgkmcnt(4)
    v_mfma_f32_16x16x32_bf16 v[104:107], a[96:99], v[136:139], v[104:107]
    buffer_store_dwordx4 v[96:99], v145, s[8:11], s45 offen offset:0 sc1
    v_cvt_pk_bf16_f32 v88, v88, v89
    v_mfma_f32_16x16x32_bf16 v[108:111], a[100:103], v[136:139], v[108:111]
    v_cvt_pk_bf16_f32 v89, v90, v91
    v_cvt_pk_bf16_f32 v90, v92, v93
    ds_read_b64_tr_b16 v[136:137], v155 offset:57344
    ds_read_b64_tr_b16 v[138:139], v155 offset:58368
    s_waitcnt lgkmcnt(4)
    v_mfma_f32_16x16x32_bf16 v[104:107], a[104:107], v[128:131], v[104:107]
    v_cvt_pk_bf16_f32 v91, v94, v95
    buffer_store_dwordx4 v[88:91], v146, s[8:11], s44 offen offset:1024 sc1
    v_mfma_f32_16x16x32_bf16 v[108:111], a[108:111], v[128:131], v[108:111]
    ds_read_b64_tr_b16 v[128:129], v156 offset:0
    ds_read_b64_tr_b16 v[130:131], v156 offset:1024
    s_waitcnt lgkmcnt(4)
    v_mfma_f32_16x16x32_bf16 v[104:107], a[112:115], v[132:135], v[104:107]
    v_mfma_f32_16x16x32_bf16 v[108:111], a[116:119], v[132:135], v[108:111]
    ds_read_b64_tr_b16 v[132:133], v156 offset:8192
    ds_read_b64_tr_b16 v[134:135], v156 offset:9216
    s_waitcnt lgkmcnt(4)
    v_mfma_f32_16x16x32_bf16 v[104:107], a[120:123], v[136:139], v[104:107]
    v_mfma_f32_16x16x32_bf16 v[108:111], a[124:127], v[136:139], v[108:111]
    ds_read_b64_tr_b16 v[136:137], v156 offset:16384
    ds_read_b64_tr_b16 v[138:139], v156 offset:17408
    s_waitcnt lgkmcnt(4)
    v_mfma_f32_16x16x32_bf16 v[120:123], a[64:67], v[128:131], 0
    v_mfma_f32_16x16x32_bf16 v[124:127], a[68:71], v[128:131], 0
    ds_read_b64_tr_b16 v[128:129], v156 offset:24576
    ds_read_b64_tr_b16 v[130:131], v156 offset:25600
    s_waitcnt lgkmcnt(4)
    v_mfma_f32_16x16x32_bf16 v[120:123], a[72:75], v[132:135], v[120:123]
    v_mfma_f32_16x16x32_bf16 v[124:127], a[76:79], v[132:135], v[124:127]
    ds_read_b64_tr_b16 v[132:133], v156 offset:32768
    ds_read_b64_tr_b16 v[134:135], v156 offset:33792
    s_waitcnt lgkmcnt(4)
    v_mfma_f32_16x16x32_bf16 v[120:123], a[80:83], v[136:139], v[120:123]
    v_mfma_f32_16x16x32_bf16 v[124:127], a[84:87], v[136:139], v[124:127]
    ds_read_b64_tr_b16 v[136:137], v156 offset:40960
    ds_read_b64_tr_b16 v[138:139], v156 offset:41984
    s_waitcnt lgkmcnt(4)
    v_mfma_f32_16x16x32_bf16 v[120:123], a[88:91], v[128:131], v[120:123]
    v_cvt_pk_bf16_f32 v112, v112, v113
    v_cvt_pk_bf16_f32 v113, v114, v115
    v_mfma_f32_16x16x32_bf16 v[124:127], a[92:95], v[128:131], v[124:127]
    v_cvt_pk_bf16_f32 v114, v116, v117
    v_cvt_pk_bf16_f32 v115, v118, v119
    ds_read_b64_tr_b16 v[128:129], v156 offset:49152
    ds_read_b64_tr_b16 v[130:131], v156 offset:50176
    s_waitcnt lgkmcnt(4)
    v_mfma_f32_16x16x32_bf16 v[120:123], a[96:99], v[132:135], v[120:123]
    buffer_store_dwordx4 v[112:115], v145, s[8:11], s46 offen offset:0 sc1
    v_cvt_pk_bf16_f32 v104, v104, v105
    v_mfma_f32_16x16x32_bf16 v[124:127], a[100:103], v[132:135], v[124:127]
    v_cvt_pk_bf16_f32 v105, v106, v107
    v_cvt_pk_bf16_f32 v106, v108, v109
    ds_read_b64_tr_b16 v[132:133], v156 offset:57344
    ds_read_b64_tr_b16 v[134:135], v156 offset:58368
    s_waitcnt lgkmcnt(4)
    v_mfma_f32_16x16x32_bf16 v[120:123], a[104:107], v[136:139], v[120:123]
    v_cvt_pk_bf16_f32 v107, v110, v111
    buffer_store_dwordx4 v[104:107], v146, s[8:11], s45 offen offset:1024 sc1
    v_mfma_f32_16x16x32_bf16 v[124:127], a[108:111], v[136:139], v[124:127]
    s_waitcnt lgkmcnt(2)
    v_mfma_f32_16x16x32_bf16 v[120:123], a[112:115], v[128:131], v[120:123]
    v_mfma_f32_16x16x32_bf16 v[124:127], a[116:119], v[128:131], v[124:127]
    s_waitcnt lgkmcnt(0)
    v_mfma_f32_16x16x32_bf16 v[120:123], a[120:123], v[132:135], v[120:123]
    v_mfma_f32_16x16x32_bf16 v[124:127], a[124:127], v[132:135], v[124:127]
    s_nop 7
    v_cvt_pk_bf16_f32 v120, v120, v121
    v_cvt_pk_bf16_f32 v121, v122, v123
    v_cvt_pk_bf16_f32 v122, v124, v125
    v_cvt_pk_bf16_f32 v123, v126, v127
    buffer_store_dwordx4 v[120:123], v146, s[8:11], s46 offen offset:1024 sc1
L0_tail:
    v_mov_b32 v9, 0
    s_cmp_lg_u32 s12, 0
    s_cbranch_scc1 L0_nr
    s_mov_b64 exec, 1
    ds_write_b32 v9, v190
    s_mov_b64 exec, -1
    s_waitcnt lgkmcnt(0)
L0_nr:
    s_waitcnt vmcnt(0)
    s_barrier
    v_mov_b32 v10, s17
    s_lshl_b32 s30, s2, 2
    s_add_u32 s30, s30, 44793856
    s_cmp_eq_u32 s12, 0
    s_cselect_b32 s30, s30, 1073741824
    buffer_store_dword v10, off, s[8:11], s30 sc1
    ds_read_b32 v5, v9
    s_waitcnt lgkmcnt(0)
    v_readfirstlane_b32 s13, v5
    s_barrier
    s_load_dwordx2 s[88:89], s[0:1], 0
    s_load_dwordx2 s[90:91], s[0:1], 104
    s_load_dwordx4 s[40:43], s[0:1], 64
    s_load_dwordx2 s[92:93], s[0:1], 80
    s_mov_b32 s26, 1048576
    s_waitcnt lgkmcnt(0)
    s_mov_b32 s64, s88
    s_mov_b32 s65, s89
    s_mov_b32 s66, 1835008
    s_mov_b32 s67, 0x00020000
    s_mov_b32 s68, s90
    s_mov_b32 s69, s91
    s_mov_b32 s70, 1835008
    s_mov_b32 s71, 0x00020000
    s_mov_b32 s72, s40
    s_mov_b32 s73, s41
    s_mov_b32 s74, 1605632
    s_mov_b32 s75, 0x00020000
    s_mov_b32 s76, s92
    s_mov_b32 s77, s93
    s_mov_b32 s78, 1605632
    s_mov_b32 s79, 0x00020000
    s_mov_b32 s80, s42
    s_mov_b32 s81, s43
    s_mov_b32 s82, 3584
    s_mov_b32 s83, 0x00020000
    s_cmp_ge_u32 s13, 32
    s_cbranch_scc1 L_irregular
    s_cmp_ge_u32 s14, 8
    s_cbranch_scc1 L_irregular
L_dispatch:
    s_cmp_lg_u32 s15, 0
    s_cbranch_scc1 L_ver_1_ok
    v_and_b32 v4, 15, v0
    v_and_b32 v5, 7, v4
    v_lshlrev_b32 v5, 5, v5
    v_lshrrev_b32 v6, 3, v4
    v_cmp_gt_u32 vcc, 8, v4
    v_lshl_add_u32 v5, v6, 2, v5
    s_nop 0
    v_cndmask_b32 v4, 0, 32, vcc
L_ver_1:
    buffer_load_dword v6, v5, s[84:87], 0 offen sc1
    s_sub_u32 s26, s26, 1
    s_cbranch_scc1 L_fail
    s_waitcnt vmcnt(0)
    v_cmp_gt_u32 vcc, v6, v4
    s_cbranch_vccnz L_irregular
    v_cmp_ne_u32 vcc, v6, v4
    s_cbranch_vccnz L_ver_1
L_ver_1_ok:
    s_cmp_eq_u32 s14, 0
    s_cbranch_scc1 L_team0
    s_cmp_eq_u32 s14, 7
    s_cbranch_scc1 L_to7
    s_cmp_eq_u32 s14, 6
    s_cbranch_scc1 L_toLN
L_roles:
    s_cmp_lg_u32 s15, 0
    s_cbranch_scc1 L_ver_2_ok
    v_and_b32 v4, 15, v0
    v_and_b32 v5, 7, v4
    v_lshlrev_b32 v5, 5, v5
    v_lshrrev_b32 v6, 3, v4
    v_cmp_gt_u32 vcc, 8, v4
    v_lshl_add_u32 v5, v6, 2, v5
    s_nop 0
    v_cndmask_b32 v4, 0, 32, vcc
L_ver_2:
    buffer_load_dword v6, v5, s[84:87], 0 offen sc1
    s_sub_u32 s26, s26, 1
    s_cbranch_scc1 L_fail
    s_waitcnt vmcnt(0)
    v_cmp_gt_u32 vcc, v6, v4
    s_cbranch_vccnz L_irregular
    v_cmp_ne_u32 vcc, v6, v4
    s_cbranch_vccnz L_ver_2
L_ver_2_ok:
    s_cmp_lt_u32 s14, 4
    s_cbranch_scc1 L_teamX
    s_cmp_lt_u32 s13, 28
    s_cbranch_scc1 L_toF
L_idle:
L_fail:
L_exit:
    s_endpgm
L_irregular:
    s_waitcnt vmcnt(0) lgkmcnt(0)
    s_barrier
    s_lshr_b32 s14, s2, 5
    s_and_b32 s13, s2, 31
    s_mov_b32 s15, 1
    s_branch L_dispatch
L_toF:
    s_branch L_F
L_toLN:
    s_branch L_LN
L_to7:
    s_branch L_team7
L_toRAs:
    s_branch L_RAs
L_teamX:
    s_cmp_ge_u32 s13, 30
    s_cbranch_scc1 L_idle
    s_cmp_ge_u32 s13, 16
    s_cbranch_scc1 L_toXB
    s_cmp_eq_u32 s15, 0
    s_cbranch_scc1 L_XAf
    s_branch L_XAs
L_toXB:
    s_branch L_XB
L_toRBs:
    s_branch L_RBs
L_team0:
    s_cmp_lt_u32 s13, 30
    s_cbranch_scc1 L_notspare
    s_cmp_lg_u32 s15, 0
    s_cbranch_scc1 L_ver_3_ok
    v_and_b32 v4, 15, v0
    v_and_b32 v5, 7, v4
    v_lshlrev_b32 v5, 5, v5
    v_lshrrev_b32 v6, 3, v4
    v_cmp_gt_u32 vcc, 8, v4
    v_lshl_add_u32 v5, v6, 2, v5
    s_nop 0
    v_cndmask_b32 v4, 0, 32, vcc
L_ver_3:
    buffer_load_dword v6, v5, s[84:87], 0 offen sc1
    s_sub_u32 s26, s26, 1
    s_cbranch_scc1 L_fail
    s_waitcnt vmcnt(0)
    v_cmp_gt_u32 vcc, v6, v4
    s_cbranch_vccnz L_irregular
    v_cmp_ne_u32 vcc, v6, v4
    s_cbranch_vccnz L_ver_3
L_ver_3_ok:
    s_sub_u32 s18, s13, 30
    s_lshl_b32 s18, s18, 8
    v_add_u32 v1, s18, v0
    v_min_u32 v1, 448, v1
    v_lshlrev_b32 v1, 16, v1
    s_mov_b32 s18, 14680064
    buffer_load_dword v2, v1, s[8:11], s18 offen sc1
    s_endpgm
L_notspare:
    s_cmp_ge_u32 s13, 30
    s_cbranch_scc1 L_exit
    s_cmp_lt_u32 s13, 16
    s_cbranch_scc1 L_headowner
    s_cmp_eq_u32 s15, 0
    s_cbranch_scc1 L_RBf
    s_branch L_toRBs
L_headowner:
    s_cmp_eq_u32 s15, 0
    s_cbranch_scc0 L_toRAs
L_RAf:
    s_lshr_b32 s30, s13, 2
    s_lshl_b32 s30, s30, 1
    s_and_b32 s31, s13, 3
    s_lshl_b32 s31, s31, 6
    s_add_u32 s30, s30, s31
    s_lshl_b32 s31, s12, 3
    s_add_u32 s30, s30, s31
    v_and_b32 v9, 1, v0
    v_lshlrev_b32 v9, 7, v9
    s_lshl_b32 s30, s30, 2
    s_add_u32 s30, s30, 44793856
L_wf_4:
    buffer_load_dword v8, v9, s[8:11], s30 offen offset:0 sc1
    s_sub_u32 s26, s26, 1
    s_cbranch_scc1 L_fail
    s_waitcnt vmcnt(0)
    v_cmp_ne_u32 vcc, s17, v8
    s_cbranch_vccz L_wfd_5
    s_sleep 4
    s_branch L_wf_4
L_wfd_5:
    v_and_b32 v8, 63, v0
    v_lshrrev_b32 v9, 4, v8
    v_and_b32 v10, 15, v8
    v_lshlrev_b32 v108, 4, v8
    s_mul_i32 s28, s13, 401408
    s_mul_i32 s29, s12, 100352
    s_add_u32 s28, s28, s29
    s_lshl_b32 s30, s12, 2
    s_lshr_b32 s44, 21536, s30
    s_and_b32 s44, s44, 15
    s_lshl_b32 s44, s44, 11
    s_lshr_b32 s45, 25905, s30
    s_and_b32 s45, s45, 15
    s_lshl_b32 s45, s45, 11
    s_lshr_b32 s46, 2, s30
    s_and_b32 s46, s46, 15
    s_lshl_b32 s46, s46, 11
    s_lshr_b32 s47, 4371, s30
    s_and_b32 s47, s47, 15
    s_lshl_b32 s47, s47, 11
    s_lshr_b32 s48, 8772, s30
    s_and_b32 s48, s48, 15
    s_lshl_b32 s48, s48, 11
    s_lshr_b32 s49, 13141, s30
    s_and_b32 s49, s49, 15
    s_lshl_b32 s49, s49, 11
    s_lshr_b32 s50, 18022, s30
    s_and_b32 s50, s50, 15
    s_lshl_b32 s50, s50, 11
    s_lshr_b32 s29, s46, 1
    v_add_u32 v109, s29, v108
    s_lshr_b32 s29, s48, 1
    v_add_u32 v110, s29, v108
    s_lshr_b32 s29, s50, 1
    v_add_u32 v111, s29, v108
    s_mul_i32 s24, s12, 7168
    s_add_u32 s25, s24, 24576
    s_add_u32 s24, s24, 12845056
    s_add_u32 s29, s28, s44
    buffer_load_dwordx4 a[0:3], v108, s[8:11], s29 offen offset:0
    buffer_load_dwordx4 a[4:7], v108, s[8:11], s29 offen offset:1024
    s_add_u32 s29, s28, s45
    buffer_load_dwordx4 a[8:11], v108, s[8:11], s29 offen offset:0
    buffer_load_dwordx4 a[12:15], v108, s[8:11], s29 offen offset:1024
    s_add_u32 s29, s28, s46
    buffer_load_dwordx4 a[16:19], v108, s[8:11], s29 offen offset:0
    buffer_load_dwordx4 a[20:23], v108, s[8:11], s29 offen offset:1024
    s_add_u32 s29, s28, s47
    buffer_load_dwordx4 a[24:27], v108, s[8:11], s29 offen offset:0
    buffer_load_dwordx4 a[28:31], v108, s[8:11], s29 offen offset:1024
    s_add_u32 s29, s28, s48
    buffer_load_dwordx4 a[32:35], v108, s[8:11], s29 offen offset:0
    buffer_load_dwordx4 a[36:39], v108, s[8:11], s29 offen offset:1024
    s_add_u32 s29, s28, s49
    buffer_load_dwordx4 a[40:43], v108, s[8:11], s29 offen offset:0
    buffer_load_dwordx4 a[44:47], v108, s[8:11], s29 offen offset:1024
    s_add_u32 s29, s28, s50
    buffer_load_dwordx4 a[48:51], v108, s[8:11], s29 offen offset:0
    buffer_load_dwordx4 a[52:55], v108, s[8:11], s29 offen offset:1024
    s_add_u32 s28, s28, 14336
    s_add_u32 s29, s28, s44
    buffer_load_dwordx4 a[56:59], v108, s[8:11], s29 offen offset:0
    buffer_load_dwordx4 a[60:63], v108, s[8:11], s29 offen offset:1024
    s_add_u32 s29, s28, s45
    buffer_load_dwordx4 a[64:67], v108, s[8:11], s29 offen offset:0
    buffer_load_dwordx4 a[68:71], v108, s[8:11], s29 offen offset:1024
    s_add_u32 s29, s28, s46
    buffer_load_dwordx4 a[72:75], v108, s[8:11], s29 offen offset:0
    buffer_load_dwordx4 a[76:79], v108, s[8:11], s29 offen offset:1024
    s_add_u32 s29, s28, s47
    buffer_load_dwordx4 a[80:83], v108, s[8:11], s29 offen offset:0
    buffer_load_dwordx4 a[84:87], v108, s[8:11], s29 offen offset:1024
    s_add_u32 s29, s28, s48
    buffer_load_dwordx4 a[88:91], v108, s[8:11], s29 offen offset:0
    buffer_load_dwordx4 a[92:95], v108, s[8:11], s29 offen offset:1024
    s_add_u32 s29, s28, s49
    buffer_load_dwordx4 a[96:99], v108, s[8:11], s29 offen offset:0
    buffer_load_dwordx4 a[100:103], v108, s[8:11], s29 offen offset:1024
    s_add_u32 s29, s28, s50
    buffer_load_dwordx4 a[104:107], v108, s[8:11], s29 offen offset:0
    buffer_load_dwordx4 a[108:111], v108, s[8:11], s29 offen offset:1024
    s_add_u32 s28, s28, 14336
    s_add_u32 s29, s28, s44
    buffer_load_dwordx4 a[112:115], v108, s[8:11], s29 offen offset:0
    buffer_load_dwordx4 a[116:119], v108, s[8:11], s29 offen offset:1024
    s_add_u32 s29, s28, s45
    buffer_load_dwordx4 a[120:123], v108, s[8:11], s29 offen offset:0
    buffer_load_dwordx4 a[124:127], v108, s[8:11], s29 offen offset:1024
    s_add_u32 s29, s28, s46
    buffer_load_dwordx4 a[128:131], v108, s[8:11], s29 offen offset:0
    buffer_load_dwordx4 a[132:135], v108, s[8:11], s29 offen offset:1024
    s_add_u32 s29, s28, s47
    buffer_load_dwordx4 a[136:139], v108, s[8:11], s29 offen offset:0
    buffer_load_dwordx4 a[140:143], v108, s[8:11], s29 offen offset:1024
    s_add_u32 s29, s28, s48
    buffer_load_dwordx4 a[144:147], v108, s[8:11], s29 offen offset:0
    buffer_load_dwordx4 a[148:151], v108, s[8:11], s29 offen offset:1024
    s_add_u32 s29, s28, s49
    buffer_load_dwordx4 a[152:155], v108, s[8:11], s29 offen offset:0
    buffer_load_dwordx4 a[156:159], v108, s[8:11], s29 offen offset:1024
    s_add_u32 s29, s28, s50
    buffer_load_dwordx4 a[160:163], v108, s[8:11], s29 offen offset:0
    buffer_load_dwordx4 a[164:167], v108, s[8:11], s29 offen offset:1024
    s_add_u32 s28, s28, 14336
    s_waitcnt vmcnt(40)
    s_add_u32 s29, s28, s44
    buffer_load_dwordx4 a[168:171], v108, s[8:11], s29 offen offset:0
    buffer_load_dwordx4 a[172:175], v108, s[8:11], s29 offen offset:1024
    s_waitcnt vmcnt(40)
    s_add_u32 s29, s28, s45
    buffer_load_dwordx4 a[176:179], v108, s[8:11], s29 offen offset:0
    buffer_load_dwordx4 a[180:183], v108, s[8:11], s29 offen offset:1024
    s_waitcnt vmcnt(40)
    s_add_u32 s29, s28, s46
    buffer_load_dwordx4 a[184:187], v108, s[8:11], s29 offen offset:0
    buffer_load_dwordx4 a[188:191], v108, s[8:11], s29 offen offset:1024
    s_waitcnt vmcnt(40)
    s_add_u32 s29, s28, s47
    buffer_load_dwordx4 a[192:195], v108, s[8:11], s29 offen offset:0
    buffer_load_dwordx4 a[196:199], v108, s[8:11], s29 offen offset:1024
    s_waitcnt vmcnt(40)
    s_add_u32 s29, s28, s48
    buffer_load_dwordx4 a[200:203], v108, s[8:11], s29 offen offset:0
    buffer_load_dwordx4 a[204:207], v108, s[8:11], s29 offen offset:1024
    s_waitcnt vmcnt(40)
    s_add_u32 s29, s28, s49
    buffer_load_dwordx4 a[208:211], v108, s[8:11], s29 offen offset:0
    buffer_load_dwordx4 a[212:215], v108, s[8:11], s29 offen offset:1024
    s_waitcnt vmcnt(40)
    s_add_u32 s29, s28, s50
    buffer_load_dwordx4 a[216:219], v108, s[8:11], s29 offen offset:0
    buffer_load_dwordx4 a[220:223], v108, s[8:11], s29 offen offset:1024
    s_add_u32 s28, s28, 14336
    s_waitcnt vmcnt(40)
    s_add_u32 s29, s28, s44
    buffer_load_dwordx4 a[224:227], v108, s[8:11], s29 offen offset:0
    buffer_load_dwordx4 a[228:231], v108, s[8:11], s29 offen offset:1024
    s_waitcnt vmcnt(40)
    v_and_b32 v88, 15, v0
    v_and_b32 v89, 7, v88
    v_lshlrev_b32 v89, 5, v89
    v_lshrrev_b32 v90, 3, v88
    v_cmp_gt_u32 vcc, 8, v88
    v_lshl_add_u32 v89, v90, 2, v89
    v_and_b32 v90, 63, v0
    v_cndmask_b32 v88, 0, 32, vcc
    v_lshlrev_b32 v91, 3, v90
    v_lshlrev_b32 v90, 4, v90
    buffer_load_dword v86, v89, s[84:87], 0 offen sc1
    s_mov_b32 s18, 44793856
    buffer_load_dwordx4 v[80:83], v90, s[8:11], s18 offen sc1
    s_mov_b32 s18, 44796416
    buffer_load_dwordx2 v[84:85], v91, s[8:11], s18 offen sc1
    s_add_u32 s29, s28, s45
    buffer_load_dwordx4 a[232:235], v108, s[8:11], s29 offen offset:0
    buffer_load_dwordx4 a[236:239], v108, s[8:11], s29 offen offset:1024
    s_waitcnt vmcnt(40)
    s_add_u32 s29, s28, s46
    buffer_load_dwordx4 a[240:243], v108, s[8:11], s29 offen offset:0
    buffer_load_dwordx4 a[244:247], v108, s[8:11], s29 offen offset:1024
    s_waitcnt vmcnt(40)
    s_add_u32 s29, s28, s47
    buffer_load_dwordx4 a[248:251], v108, s[8:11], s29 offen offset:0
    buffer_load_dwordx4 a[252:255], v108, s[8:11], s29 offen offset:1024
    s_waitcnt vmcnt(40)
    s_add_u32 s29, s28, s48
    buffer_load_dwordx4 v[120:123], v108, s[8:11], s29 offen offset:0
    buffer_load_dwordx4 v[124:127], v108, s[8:11], s29 offen offset:1024
    s_waitcnt vmcnt(40)
    s_add_u32 s29, s28, s49
    buffer_load_dwordx4 v[128:131], v108, s[8:11], s29 offen offset:0
    buffer_load_dwordx4 v[132:135], v108, s[8:11], s29 offen offset:1024
    s_waitcnt vmcnt(40)
    s_add_u32 s29, s28, s50
    buffer_load_dwordx4 v[136:139], v108, s[8:11], s29 offen offset:0
    buffer_load_dwordx4 v[140:143], v108, s[8:11], s29 offen offset:1024
    s_add_u32 s28, s28, 14336
    s_waitcnt vmcnt(40)
    s_waitcnt vmcnt(12)
    v_xor_b32 v80, s17, v80
    v_xor_b32 v81, s17, v81
    v_xor_b32 v82, s17, v82
    v_xor_b32 v83, s17, v83
    v_xor_b32 v84, s17, v84
    v_xor_b32 v85, s17, v85
    v_xor_b32 v86, v86, v88
    s_cmp_eq_u32 s15, 0
    s_cselect_b32 s18, -1, 0
    v_and_b32 v86, s18, v86
    v_or3_b32 v80, v80, v81, v82
    v_or3_b32 v80, v80, v83, v86
    v_or3_b32 v80, v80, v84, v85
    v_cmp_ne_u32 vcc, 0, v80
    s_cmp_eq_u64 vcc, 0
    s_cselect_b32 s18, 1, 0
    s_cmp_eq_u32 s18, 0
    s_cbranch_scc1 L_RAf_nodma
    s_mov_b32 m0, s25
    s_nop 0
    buffer_load_dwordx4 v108, s[8:11], s24 offen offset:0 lds
    buffer_load_dwordx4 v108, s[8:11], s24 offen offset:1024 lds
    buffer_load_dwordx4 v108, s[8:11], s24 offen offset:2048 lds
    buffer_load_dwordx4 v108, s[8:11], s24 offen offset:3072 lds
    s_add_u32 m0, s25, 4096
    s_add_u32 s19, s24, 4096
    buffer_load_dwordx4 v108, s[8:11], s19 offen offset:0 lds
    buffer_load_dwordx4 v108, s[8:11], s19 offen offset:1024 lds
    buffer_load_dwordx4 v108, s[8:11], s19 offen offset:2048 lds
L_RAf_nodma:
    s_add_u32 s29, s28, s44
    buffer_load_dwordx4 v[144:147], v108, s[8:11], s29 offen offset:0
    buffer_load_dwordx4 v[148:151], v108, s[8:11], s29 offen offset:1024
    s_waitcnt vmcnt(40)
    s_add_u32 s29, s28, s45
    buffer_load_dwordx4 v[152:155], v108, s[8:11], s29 offen offset:0
    buffer_load_dwordx4 v[156:159], v108, s[8:11], s29 offen offset:1024
    s_waitcnt vmcnt(40)
    s_add_u32 s29, s28, s46
    buffer_load_dwordx4 v[160:163], v108, s[8:11], s29 offen offset:0
    buffer_load_dwordx4 v[164:167], v108, s[8:11], s29 offen offset:1024
    s_waitcnt vmcnt(40)
    s_add_u32 s29, s28, s47
    buffer_load_dwordx4 v[168:171], v108, s[8:11], s29 offen offset:0
    buffer_load_dwordx4 v[172:175], v108, s[8:11], s29 offen offset:1024
    s_waitcnt vmcnt(40)
    s_add_u32 s29, s28, s48
    buffer_load_dwordx4 v[176:179], v108, s[8:11], s29 offen offset:0
    buffer_load_dwordx4 v[180:183], v108, s[8:11], s29 offen offset:1024
    s_waitcnt vmcnt(40)
    s_add_u32 s29, s28, s49
    buffer_load_dwordx4 v[184:187], v108, s[8:11], s29 offen offset:0
    buffer_load_dwordx4 v[188:191], v108, s[8:11], s29 offen offset:1024
    s_waitcnt vmcnt(40)
    s_add_u32 s29, s28, s50
    buffer_load_dwordx4 v[192:195], v108, s[8:11], s29 offen offset:0
    buffer_load_dwordx4 v[196:199], v108, s[8:11], s29 offen offset:1024
    s_add_u32 s28, s28, 14336
    s_waitcnt vmcnt(40)
    s_add_u32 s29, s28, s44
    buffer_load_dwordx4 v[200:203], v108, s[8:11], s29 offen offset:0
    buffer_load_dwordx4 v[204:207], v108, s[8:11], s29 offen offset:1024
    s_waitcnt vmcnt(40)
    s_add_u32 s29, s28, s45
    buffer_load_dwordx4 v[208:211], v108, s[8:11], s29 offen offset:0
    buffer_load_dwordx4 v[212:215], v108, s[8:11], s29 offen offset:1024
    s_waitcnt vmcnt(40)
    s_add_u32 s29, s28, s46
    buffer_load_dwordx4 v[216:219], v108, s[8:11], s29 offen offset:0
    buffer_load_dwordx4 v[220:223], v108, s[8:11], s29 offen offset:1024
    s_waitcnt vmcnt(40)
    s_add_u32 s29, s28, s47
    buffer_load_dwordx4 v[224:227], v108, s[8:11], s29 offen offset:0
    buffer_load_dwordx4 v[228:231], v108, s[8:11], s29 offen offset:1024
    s_waitcnt vmcnt(40)
    s_add_u32 s29, s28, s48
    buffer_load_dwordx4 v[232:235], v108, s[8:11], s29 offen offset:0
    buffer_load_dwordx4 v[236:239], v108, s[8:11], s29 offen offset:1024
    s_waitcnt vmcnt(40)
    s_add_u32 s29, s28, s49
    buffer_load_dwordx4 v[240:243], v108, s[8:11], s29 offen offset:0
    buffer_load_dwordx4 v[244:247], v108, s[8:11], s29 offen offset:1024
    s_waitcnt vmcnt(40)
    s_add_u32 s29, s28, s50
    buffer_load_dwordx4 v[248:251], v108, s[8:11], s29 offen offset:0
    buffer_load_dwordx4 v[252:255], v108, s[8:11], s29 offen offset:1024
    s_add_u32 s28, s28, 14336
    s_waitcnt vmcnt(40)
    v_mov_b32 v1, 0x4444
    v_mov_b32 v11, 0xeeee
    v_cmp_lt_u32 vcc, 7, v10
    s_nop 1
    v_cndmask_b32 v1, v1, v11, vcc
    v_mov_b32 v106, 0x4444
    v_mov_b32 v11, 0xeeee
    v_and_b32 v12, 2, v10
    v_cmp_ne_u32 vcc, 0, v12
    s_nop 1
    v_cndmask_b32 v106, v106, v11, vcc
    v_and_b32 v11, 1, v10
    v_lshlrev_b32 v11, 4, v11
    v_mov_b32 v12, 0x3f80
    v_lshlrev_b32 v12, v11, v12
    v_lshrrev_b32 v11, 3, v10
    v_and_b32 v13, 1, v9
    v_cmp_eq_u32 vcc, v11, v13
    s_nop 1
    v_cndmask_b32 v12, 0, v12, vcc
    v_bfe_u32 v11, v10, 2, 1
    v_bfe_u32 v13, v10, 1, 1
    v_lshl_add_u32 v11, v13, 1, v11
    v_cmp_eq_u32 vcc, 0, v11
    s_nop 1
    v_cndmask_b32 v4, 0, v12, vcc
    v_cmp_eq_u32 vcc, 1, v11
    s_nop 1
    v_cndmask_b32 v5, 0, v12, vcc
    v_cmp_eq_u32 vcc, 2, v11
    s_nop 1
    v_cndmask_b32 v6, 0, v12, vcc
    v_cmp_eq_u32 vcc, 3, v11
    s_nop 1
    v_cndmask_b32 v7, 0, v12, vcc
    s_and_b32 s28, s12, 1
    s_cmp_eq_u32 s28, 0
    s_cselect_b64 vcc, -1, 0
    s_nop 1
    v_cndmask_b32 v2, v6, v4, vcc
    v_cndmask_b32 v3, v7, v5, vcc
    s_lshl_b32 s28, s12, 11
    s_min_u32 s28, s28, 5120
    v_add_u32 v107, s28, v108
    s_lshl_b32 s30, s12, 3
    s_lshr_b32 s28, 185009152, s30
    s_and_b32 s28, s28, 255
    s_lshr_b32 s29, 201852161, s30
    s_and_b32 s29, s29, 255
    v_and_b32 v11, 1, v9
    v_cmp_eq_u32 vcc, 1, v11
    v_mov_b32 v12, s28
    v_mov_b32 v13, s29
    v_cndmask_b32 v12, v12, v13, vcc
    v_lshrrev_b32 v13, 1, v9
    v_and_b32 v11, 7, v10
    v_lshlrev_b32 v11, 4, v11
    v_lshl_add_u32 v11, v13, 3, v11
    v_lshl_add_u32 v112, v12, 9, v11
    v_lshlrev_b32 v11, 4, v10
    v_lshl_add_u32 v11, v13, 8, v11
    v_lshl_add_u32 v11, v12, 10, v11
    v_add_u32 v114, 24576, v11
    s_lshl_b32 s30, s12, 3
    s_lshr_b32 s28, 218695170, s30
    s_and_b32 s28, s28, 255
    s_lshr_b32 s29, 168428291, s30
    s_and_b32 s29, s29, 255
    v_and_b32 v11, 1, v9
    v_cmp_eq_u32 vcc, 1, v11
    v_mov_b32 v12, s28
    v_mov_b32 v13, s29
    v_cndmask_b32 v12, v12, v13, vcc
    v_lshrrev_b32 v13, 1, v9
    v_and_b32 v11, 7, v10
    v_lshlrev_b32 v11, 4, v11
    v_lshl_add_u32 v11, v13, 3, v11
    v_lshl_add_u32 v113, v12, 9, v11
    v_lshlrev_b32 v11, 4, v10
    v_lshl_add_u32 v11, v13, 8, v11
    v_lshl_add_u32 v11, v12, 10, v11
    v_add_u32 v115, 24576, v11
    v_and_b32 v11, 31, v8
    v_min_u32 v11, 19, v11
    v_lshlrev_b32 v11, 3, v11
    v_lshrrev_b32 v12, 5, v8
    v_lshl_add_u32 v11, v12, 8, v11
    s_lshl_b32 s28, s12, 9
    s_add_u32 s28, s28, 8192
    v_add_u32 v116, s28, v11
    s_lshl_b32 s28, s12, 11
    s_add_u32 s28, s28, 8192
    v_lshlrev_b32 v11, 9, v9
    v_add_u32 v11, s28, v11
    v_lshl_add_u32 v118, v10, 2, v11
    v_add_u32 v118, 128, v118
    v_bfe_u32 v12, v10, 3, 1
    v_lshl_add_u32 v11, v12, 6, v11
    v_bfe_u32 v12, v10, 1, 1
    v_lshl_add_u32 v11, v12, 5, v11
    v_bfe_u32 v12, v10, 2, 1
    v_lshl_add_u32 v11, v12, 4, v11
    v_bfe_u32 v12, v10, 0, 1
    v_lshl_add_u32 v11, v12, 2, v11
    v_mov_b32 v117, v11
    s_mov_b32 vcc_lo, 0x000fffff
    s_mov_b32 vcc_hi, 0x000fffff
    v_mov_b32 v11, 0xff800000
    v_cndmask_b32 v104, v11, 0, vcc
    v_bfe_u32 v12, v8, 3, 1
    v_lshlrev_b32 v119, 8, v12
    v_bfe_u32 v12, v8, 2, 1
    v_lshl_add_u32 v119, v12, 5, v119
    s_lshl_b32 s28, s13, 9
    v_add_u32 v119, s28, v119
    s_lshr_b32 s28, s13, 1
    s_lshl_b32 s28, s28, 8
    s_and_b32 s29, s13, 1
    s_lshl_b32 s29, s29, 5
    s_add_u32 s28, s28, s29
    s_add_u32 s31, s28, 8192
    v_mov_b32 v12, s31
    v_and_b32 v13, 16, v8
    v_cmp_ne_u32 s[36:37], 0, v13
    s_nop 1
    v_cndmask_b32 v119, v119, v12, s[36:37]
    v_and_b32 v12, 3, v8
    v_lshl_add_u32 v119, v12, 2, v119
    v_lshrrev_b32 v12, 5, v8
    v_lshl_add_u32 v119, v12, 4, v119
    s_lshl_b32 s28, s12, 6
    v_add_u32 v119, s28, v119
    v_mov_b32 v11, 1073741824
    v_cndmask_b32 v119, v11, v119, vcc
    s_lshl_b32 s28, s13, 8
    s_lshl_b32 s29, s12, 6
    s_add_u32 s28, s28, s29
    s_add_u32 s28, s28, 44746496
    v_lshlrev_b32 v12, 2, v10
    v_add_u32 v105, s28, v12
    s_lshl_b32 s28, s13, 2
    s_add_u32 s28, s28, 44744704
    v_lshlrev_b32 v12, 7, v8
    v_add_u32 v12, s28, v12
    v_cmp_gt_u32 vcc, 14, v8
    s_cmp_eq_u32 s12, 0
    s_cselect_b64 vcc, vcc, 0
    s_nop 1
    v_cndmask_b32 v68, v11, v12, vcc
    s_mov_b32 s20, 0
    s_mov_b32 s21, 44564480
    s_mov_b32 s22, 44597248
    s_mov_b32 s26, 1048576
    s_mov_b32 s40, 0xfffefffe
    s_mov_b32 s41, 28672
    s_mov_b32 s36, 20
    s_cmp_eq_u32 s18, 1
    s_cbranch_scc1 L_RAf_ready
    s_cmp_lg_u32 s15, 0
    s_cbranch_scc1 L_ver_6_ok
    v_and_b32 v8, 15, v0
    v_and_b32 v9, 7, v8
    v_lshlrev_b32 v9, 5, v9
    v_lshrrev_b32 v10, 3, v8
    v_cmp_gt_u32 vcc, 8, v8
    v_lshl_add_u32 v9, v10, 2, v9
    s_nop 0
    v_cndmask_b32 v8, 0, 32, vcc
L_ver_6:
    buffer_load_dword v10, v9, s[84:87], 0 offen sc1
    s_sub_u32 s26, s26, 1
    s_cbranch_scc1 L_fail
    s_waitcnt vmcnt(0)
    v_cmp_gt_u32 vcc, v10, v8
    s_cbranch_vccnz L_irregular
    v_cmp_ne_u32 vcc, v10, v8
    s_cbranch_vccnz L_ver_6
L_ver_6_ok:
    v_and_b32 v12, 63, v0
    v_lshlrev_b32 v12, 4, v12
    s_mov_b32 s30, 44793856
L_qs_7:
    buffer_load_dwordx4 v[8:11], v12, s[8:11], s30 offen sc1
    s_sub_u32 s26, s26, 1
    s_cbranch_scc1 L_fail
    s_waitcnt vmcnt(0)
    v_xor_b32 v8, s17, v8
    v_xor_b32 v9, s17, v9
    v_xor_b32 v10, s17, v10
    v_xor_b32 v11, s17, v11
    v_or3_b32 v8, v8, v9, v10
    v_or_b32 v8, v8, v11
    v_cmp_ne_u32 vcc, 0, v8
    s_cbranch_vccnz L_qs_7
    v_and_b32 v10, 63, v0
    v_lshlrev_b32 v10, 3, v10
    s_mov_b32 s30, 44796416
L_wf_8:
    buffer_load_dwordx2 v[8:9], v10, s[8:11], s30 offen offset:0 sc1
    s_sub_u32 s26, s26, 1
    s_cbranch_scc1 L_fail
    s_waitcnt vmcnt(0)
    v_xor_b32 v9, s17, v9
    v_xor_b32 v8, s17, v8
    v_or_b32 v8, v8, v9
    v_cmp_ne_u32 vcc, 0, v8
    s_cbranch_vccz L_wfd_9
    s_sleep 4
    s_branch L_wf_8
L_wfd_9:
    s_mov_b32 m0, s25
    s_nop 0
    buffer_load_dwordx4 v108, s[8:11], s24 offen offset:0 lds
    buffer_load_dwordx4 v108, s[8:11], s24 offen offset:1024 lds
    buffer_load_dwordx4 v108, s[8:11], s24 offen offset:2048 lds
    buffer_load_dwordx4 v108, s[8:11], s24 offen offset:3072 lds
    s_add_u32 m0, s25, 4096
    s_add_u32 s19, s24, 4096
    buffer_load_dwordx4 v108, s[8:11], s19 offen offset:0 lds
    buffer_load_dwordx4 v108, s[8:11], s19 offen offset:1024 lds
    buffer_load_dwordx4 v108, s[8:11], s19 offen offset:2048 lds
L_RAf_ready:
    v_mov_b32 v0, v68
    s_add_u32 s24, s24, 28672
    v_mov_b64 v[28:29], 0
    v_mov_b64 v[30:31], 0
    v_mov_b64 v[32:33], 0
    v_mov_b64 v[34:35], 0
    v_mov_b64 v[36:37], 0
    v_mov_b64 v[38:39], 0
    v_mov_b64 v[40:41], 0
    v_mov_b64 v[42:43], 0
    v_mov_b64 v[44:45], 0
    v_mov_b64 v[46:47], 0
    v_mov_b64 v[48:49], 0
    v_mov_b64 v[50:51], 0
    v_mov_b64 v[52:53], 0
    v_mov_b64 v[54:55], 0
    v_mov_b64 v[56:57], 0
    v_mov_b64 v[58:59], 0
    v_mov_b64 v[60:61], 0
    v_mov_b64 v[62:63], 0
    v_mov_b64 v[64:65], 0
    v_mov_b64 v[66:67], 0
    s_waitcnt vmcnt(0)
.p2align 6
    s_nop 0
    s_nop 0
L_RAf_step:
    buffer_load_dwordx4 v[80:83], v107, s[8:11], s21 offen offset:0 sc1
    buffer_load_dwordx4 v[84:87], v107, s[8:11], s21 offen offset:1024 sc1
    s_sleep 1
    s_sleep 1
L_RAf_pm_loop:
    buffer_load_dwordx4 v[88:91], v107, s[8:11], s21 offen offset:0 sc1
    buffer_load_dwordx4 v[92:95], v107, s[8:11], s21 offen offset:1024 sc1
    s_sub_u32 s26, s26, 1
    s_cbranch_scc1 L_fail
    s_nop 5
    v_mov_b64 v[28:29], 0
    v_mov_b64 v[30:31], 0
    v_mov_b64 v[32:33], 0
    v_mov_b64 v[34:35], 0
    v_mov_b64 v[36:37], 0
    v_mov_b64 v[38:39], 0
    s_nop 0
    s_waitcnt vmcnt(2)
    v_smfmac_f32_16x16x64_bf16 v[28:31], v[80:83], a[0:7], v1
    v_max_u32 v76, v83, v87
    v_smfmac_f32_16x16x64_bf16 v[32:35], v[80:83], a[56:63], v1
    v_cmp_eq_u32 vcc, -1, v76
    v_smfmac_f32_16x16x64_bf16 v[36:39], v[80:83], a[112:119], v1
    s_cbranch_vccz L_RAf_pm_ok0
    buffer_load_dwordx4 v[80:83], v107, s[8:11], s21 offen offset:0 sc1
    buffer_load_dwordx4 v[84:87], v107, s[8:11], s21 offen offset:1024 sc1
    s_nop 5
    v_mov_b64 v[28:29], 0
    v_mov_b64 v[30:31], 0
    v_mov_b64 v[32:33], 0
    v_mov_b64 v[34:35], 0
    v_mov_b64 v[36:37], 0
    v_mov_b64 v[38:39], 0
    s_nop 0
    s_waitcnt vmcnt(2)
    v_smfmac_f32_16x16x64_bf16 v[28:31], v[88:91], a[0:7], v1
    v_max_u32 v76, v91, v95
    v_smfmac_f32_16x16x64_bf16 v[32:35], v[88:91], a[56:63], v1
    v_cmp_eq_u32 vcc, -1, v76
    v_smfmac_f32_16x16x64_bf16 v[36:39], v[88:91], a[112:119], v1
    s_cbranch_vccnz L_RAf_pm_loop
L_RAf_pm_ok1:
    ds_write_b128 v107, v[88:91] offset:0
    v_smfmac_f32_16x16x64_bf16 v[40:43], v[88:91], a[168:175], v1
    ds_write_b128 v107, v[92:95] offset:1024
    v_smfmac_f32_16x16x64_bf16 v[44:47], v[88:91], a[224:231], v1
    v_smfmac_f32_16x16x64_bf16 v[48:51], v[88:91], v[144:151], v1
    v_smfmac_f32_16x16x64_bf16 v[52:55], v[88:91], v[200:207], v1
    v_smfmac_f32_16x16x64_bf16 v[28:31], v[92:95], a[8:15], v1
    v_smfmac_f32_16x16x64_bf16 v[32:35], v[92:95], a[64:71], v1
    s_waitcnt lgkmcnt(0)
    v_smfmac_f32_16x16x64_bf16 v[36:39], v[92:95], a[120:127], v1
    s_barrier
    v_smfmac_f32_16x16x64_bf16 v[40:43], v[92:95], a[176:183], v1
    ds_read_b128 v[8:11], v109 offset:0
    v_smfmac_f32_16x16x64_bf16 v[44:47], v[92:95], a[232:239], v1
    ds_read_b128 v[12:15], v109 offset:1024
    v_smfmac_f32_16x16x64_bf16 v[48:51], v[92:95], v[152:159], v1
    ds_read_b128 v[16:19], v110 offset:0
    v_smfmac_f32_16x16x64_bf16 v[52:55], v[92:95], v[208:215], v1
    ds_read_b128 v[20:23], v110 offset:1024
    s_branch L_RAf_pm_done
L_RAf_pm_ok0:
    ds_write_b128 v107, v[80:83] offset:0
    v_smfmac_f32_16x16x64_bf16 v[40:43], v[80:83], a[168:175], v1
    ds_write_b128 v107, v[84:87] offset:1024
    v_smfmac_f32_16x16x64_bf16 v[44:47], v[80:83], a[224:231], v1
    v_smfmac_f32_16x16x64_bf16 v[48:51], v[80:83], v[144:151], v1
    v_smfmac_f32_16x16x64_bf16 v[52:55], v[80:83], v[200:207], v1
    v_smfmac_f32_16x16x64_bf16 v[28:31], v[84:87], a[8:15], v1
    v_smfmac_f32_16x16x64_bf16 v[32:35], v[84:87], a[64:71], v1
    s_waitcnt lgkmcnt(0)
    v_smfmac_f32_16x16x64_bf16 v[36:39], v[84:87], a[120:127], v1
    s_barrier
    v_smfmac_f32_16x16x64_bf16 v[40:43], v[84:87], a[176:183], v1
    ds_read_b128 v[8:11], v109 offset:0
    v_smfmac_f32_16x16x64_bf16 v[44:47], v[84:87], a[232:239], v1
    ds_read_b128 v[12:15], v109 offset:1024
    v_smfmac_f32_16x16x64_bf16 v[48:51], v[84:87], v[152:159], v1
    ds_read_b128 v[16:19], v110 offset:0
    v_smfmac_f32_16x16x64_bf16 v[52:55], v[84:87], v[208:215], v1
    ds_read_b128 v[20:23], v110 offset:1024
L_RAf_pm_done:
    ds_read_b128 v[24:27], v111 offset:0
    s_waitcnt lgkmcnt(4)
    v_smfmac_f32_16x16x64_bf16 v[28:31], v[8:11], a[16:23], v1
    s_waitcnt lgkmcnt(3)
    v_smfmac_f32_16x16x64_bf16 v[28:31], v[12:15], a[24:31], v1
    s_waitcnt lgkmcnt(2)
    v_smfmac_f32_16x16x64_bf16 v[28:31], v[16:19], a[32:39], v1
    s_waitcnt lgkmcnt(1)
    v_smfmac_f32_16x16x64_bf16 v[28:31], v[20:23], a[40:47], v1
    s_waitcnt lgkmcnt(0)
    v_smfmac_f32_16x16x64_bf16 v[28:31], v[24:27], a[48:55], v1
    s_waitcnt vmcnt(0)
    v_smfmac_f32_16x16x64_bf16 v[32:35], v[8:11], a[72:79], v1
    ds_read2_b32 v[80:81], v112 offset0:0 offset1:32
    v_smfmac_f32_16x16x64_bf16 v[32:35], v[12:15], a[80:87], v1
    ds_read2_b32 v[82:83], v112 offset0:1 offset1:33
    v_smfmac_f32_16x16x64_bf16 v[32:35], v[16:19], a[88:95], v1
    ds_read2_b32 v[84:85], v112 offset0:64 offset1:96
    v_smfmac_f32_16x16x64_bf16 v[32:35], v[20:23], a[96:103], v1
    ds_read2_b32 v[86:87], v112 offset0:65 offset1:97
    v_smfmac_f32_16x16x64_bf16 v[32:35], v[24:27], a[104:111], v1
    v_cvt_pk_bf16_f32 v68, v28, v29
    v_smfmac_f32_16x16x64_bf16 v[36:39], v[8:11], a[128:135], v1
    v_cvt_pk_bf16_f32 v69, v30, v31
    v_smfmac_f32_16x16x64_bf16 v[36:39], v[12:15], a[136:143], v1
    ds_read_b128 v[88:91], v114 offset:0
    v_smfmac_f32_16x16x64_bf16 v[36:39], v[16:19], a[144:151], v1
    ds_read_b128 v[92:95], v114 offset:512
    v_smfmac_f32_16x16x64_bf16 v[36:39], v[20:23], a[152:159], v1
    v_cvt_pk_bf16_f32 v70, v32, v33
    v_smfmac_f32_16x16x64_bf16 v[36:39], v[24:27], a[160:167], v1
    v_cvt_pk_bf16_f32 v71, v34, v35
    v_smfmac_f32_16x16x64_bf16 v[40:43], v[8:11], a[184:191], v1
    ds_read2_b32 v[28:29], v113 offset0:0 offset1:32
    v_smfmac_f32_16x16x64_bf16 v[40:43], v[12:15], a[192:199], v1
    v_mfma_f32_16x16x32_bf16 v[72:75], v[68:71], v[4:7], 0
    ds_read2_b32 v[30:31], v113 offset0:1 offset1:33
    ds_read2_b32 v[32:33], v113 offset0:64 offset1:96
    v_smfmac_f32_16x16x64_bf16 v[40:43], v[16:19], a[200:207], v1
    ds_read2_b32 v[34:35], v113 offset0:65 offset1:97
    v_smfmac_f32_16x16x64_bf16 v[40:43], v[20:23], a[208:215], v1
    v_cvt_pk_bf16_f32 v68, v36, v37
    v_smfmac_f32_16x16x64_bf16 v[40:43], v[24:27], a[216:223], v1
    v_cvt_pk_bf16_f32 v69, v38, v39
    v_smfmac_f32_16x16x64_bf16 v[44:47], v[8:11], a[240:247], v1
    v_cvt_pk_bf16_f32 v76, v72, v73
    v_smfmac_f32_16x16x64_bf16 v[44:47], v[12:15], a[248:255], v1
    v_cvt_pk_bf16_f32 v77, v74, v75
    v_smfmac_f32_16x16x64_bf16 v[44:47], v[16:19], v[120:127], v1
    ds_read_b128 v[36:39], v115 offset:0
    v_smfmac_f32_16x16x64_bf16 v[44:47], v[20:23], v[128:135], v1
    v_cvt_pk_bf16_f32 v70, v40, v41
    v_smfmac_f32_16x16x64_bf16 v[44:47], v[24:27], v[136:143], v1
    v_cvt_pk_bf16_f32 v71, v42, v43
    v_smfmac_f32_16x16x64_bf16 v[48:51], v[8:11], v[160:167], v1
    ds_read_b128 v[40:43], v115 offset:512
    v_smfmac_f32_16x16x64_bf16 v[48:51], v[12:15], v[168:175], v1
    v_mfma_f32_16x16x32_bf16 v[72:75], v[68:71], v[4:7], 0
    v_smfmac_f32_16x16x64_bf16 v[48:51], v[16:19], v[176:183], v1
    ds_read_b128 v[96:99], v114 offset:14336
    v_smfmac_f32_16x16x64_bf16 v[48:51], v[20:23], v[184:191], v1
    v_cvt_pk_bf16_f32 v68, v44, v45
    v_smfmac_f32_16x16x64_bf16 v[48:51], v[24:27], v[192:199], v1
    v_cvt_pk_bf16_f32 v69, v46, v47
    v_smfmac_f32_16x16x64_bf16 v[52:55], v[8:11], v[216:223], v1
    ds_read_b128 v[100:103], v114 offset:14848
    v_smfmac_f32_16x16x64_bf16 v[52:55], v[12:15], v[224:231], v1
    v_cvt_pk_bf16_f32 v78, v72, v73
    v_smfmac_f32_16x16x64_bf16 v[52:55], v[16:19], v[232:239], v1
    v_cvt_pk_bf16_f32 v79, v74, v75
    v_smfmac_f32_16x16x64_bf16 v[52:55], v[20:23], v[240:247], v1
    v_cvt_pk_bf16_f32 v70, v48, v49
    v_smfmac_f32_16x16x64_bf16 v[52:55], v[24:27], v[248:255], v1
    v_cvt_pk_bf16_f32 v71, v50, v51
    s_waitcnt lgkmcnt(0)
    v_smfmac_f32_16x16x64_bf16 v[56:59], v[76:79], v[80:87], v106
    v_mfma_f32_16x16x32_bf16 v[72:75], v[68:71], v[4:7], 0
    ds_read_b128 v[8:11], v115 offset:14336
    ds_read_b128 v[12:15], v115 offset:14848
    v_smfmac_f32_16x16x64_bf16 v[60:63], v[76:79], v[88:95], v106
    v_smfmac_f32_16x16x64_bf16 v[64:67], v[76:79], v[96:103], v106
    v_cvt_pk_bf16_f32 v68, v52, v53
    v_cvt_pk_bf16_f32 v69, v54, v55
    s_nop 1
    v_mfma_f32_16x16x16_bf16 v[44:47], v[68:69], v[2:3], 0
    v_cvt_pk_bf16_f32 v24, v72, v73
    v_cvt_pk_bf16_f32 v25, v74, v75
    s_nop 4
    s_waitcnt lgkmcnt(0)
    v_cvt_pk_bf16_f32 v26, v44, v45
    v_cvt_pk_bf16_f32 v27, v46, v47
    s_nop 1
    v_smfmac_f32_16x16x64_bf16 v[56:59], v[24:27], v[28:35], v106
    v_smfmac_f32_16x16x64_bf16 v[60:63], v[24:27], v[36:43], v106
    v_smfmac_f32_16x16x64_bf16 v[64:67], v[24:27], v[8:15], v106
    s_nop 5
    v_pk_add_f32 v[56:57], v[56:57], v[58:59]
    ds_write2_b32 v118, v56, v57 offset0:0 offset1:64
    v_pk_add_f32 v[60:61], v[60:61], v[62:63]
    ds_write2_b32 v117, v60, v61 offset0:0 offset1:64
    v_pk_add_f32 v[64:65], v[64:65], v[66:67]
    ds_write2_b32 v117, v64, v65 offset0:2 offset1:66
    s_waitcnt lgkmcnt(0)
    s_barrier
    ds_read_b64 v[8:9], v116 offset:0
    ds_read_b64 v[10:11], v116 offset:2048
    ds_read_b64 v[12:13], v116 offset:4096
    ds_read_b64 v[14:15], v116 offset:6144
    s_waitcnt lgkmcnt(3)
    v_pk_add_f32 v[8:9], v[8:9], v[104:105] op_sel_hi:[1,0]
    s_waitcnt lgkmcnt(2)
    v_pk_add_f32 v[8:9], v[8:9], v[10:11]
    s_waitcnt lgkmcnt(0)
    v_pk_add_f32 v[12:13], v[12:13], v[14:15]
    v_pk_add_f32 v[8:9], v[8:9], v[12:13]
    v_exp_f32 v12, v8
    v_exp_f32 v13, v9
    s_nop 0
    v_add_f32 v10, v12, v13
    s_nop 1
    v_add_f32_dpp v10, v10, v10 quad_perm:[1,0,3,2] row_mask:0xf bank_mask:0xf
    s_nop 1
    v_add_f32_dpp v10, v10, v10 quad_perm:[2,3,0,1] row_mask:0xf bank_mask:0xf
    s_nop 1
    v_add_f32_dpp v10, v10, v10 row_half_mirror row_mask:0xf bank_mask:0xf
    s_nop 1
    v_add_f32_dpp v11, v10, v10 row_mirror row_mask:0xf bank_mask:0xf
    v_add_f32_dpp v10, v10, v10 row_mirror row_mask:0xf bank_mask:0xf
    s_nop 1
    v_permlane16_swap_b32 v10, v11
    v_add_f32 v10, v10, v11
    v_rcp_f32 v14, v10
    v_subrev_u32 v10, 0x1f800000, v10
    v_pk_mul_f32 v[12:13], v[12:13], v[14:15] op_sel_hi:[1,0]
    v_cmp_le_u32 vcc, 2.0, v10
    v_cvt_pk_bf16_f32 v12, v12, v13
    s_cbranch_vccnz L_RAf_slow
L_RAf_pub:
    buffer_store_dword v12, v119, s[8:11], s22 offen
    s_add_u32 s20, s20, 1
    s_cmp_ge_u32 s20, 63
    s_cbranch_scc1 L_RAf_end
    v_mov_b32 v16, -1
    s_add_u32 s28, s20, 1
    s_and_b32 s28, s28, 3
    s_lshl_b32 s28, s28, 14
    s_add_u32 s28, s28, 44597248
    buffer_store_dword v16, v119, s[8:11], s28 offen
    s_add_u32 s25, s25, s41
    v_add_u32 v114, s41, v114
    v_add_u32 v115, s41, v115
    s_sub_u32 s41, 0, s41
    s_mov_b32 m0, s25
    s_nop 0
    buffer_load_dwordx4 v108, s[8:11], s24 offen offset:0 lds
    buffer_load_dwordx4 v108, s[8:11], s24 offen offset:1024 lds
    buffer_load_dwordx4 v108, s[8:11], s24 offen offset:2048 lds
    buffer_load_dwordx4 v108, s[8:11], s24 offen offset:3072 lds
    s_add_u32 m0, s25, 4096
    s_add_u32 s19, s24, 4096
    buffer_load_dwordx4 v108, s[8:11], s19 offen offset:0 lds
    buffer_load_dwordx4 v108, s[8:11], s19 offen offset:1024 lds
    buffer_load_dwordx4 v108, s[8:11], s19 offen offset:2048 lds
    s_add_u32 s24, s24, 28672
    v_mov_b64 v[28:29], 0
    v_mov_b64 v[30:31], 0
    v_mov_b64 v[32:33], 0
    v_mov_b64 v[34:35], 0
    v_mov_b64 v[36:37], 0
    v_mov_b64 v[38:39], 0
    v_mov_b64 v[40:41], 0
    v_mov_b64 v[42:43], 0
    v_mov_b64 v[44:45], 0
    v_mov_b64 v[46:47], 0
    v_mov_b64 v[48:49], 0
    v_mov_b64 v[50:51], 0
    v_mov_b64 v[52:53], 0
    v_mov_b64 v[54:55], 0
    v_mov_b64 v[56:57], 0
    v_mov_b64 v[58:59], 0
    v_mov_b64 v[60:61], 0
    v_mov_b64 v[62:63], 0
    v_mov_b64 v[64:65], 0
    v_mov_b64 v[66:67], 0
    s_and_b32 s28, s20, 3
    s_lshl_b32 s29, s28, 13
    s_add_u32 s21, s29, 44564480
    s_lshl_b32 s29, s28, 14
    s_add_u32 s22, s29, 44597248
    s_sleep 1
    s_sleep 1
    s_sleep 1
    s_sleep 1
    s_sleep 1
    s_sleep 1
    s_sleep 1
    s_sleep 1
    s_sleep 1
    s_nop 7
    s_branch L_RAf_step
L_RAf_end:
    s_or_b32 s28, s13, s12
    s_cmp_lg_u32 s28, 0
    s_cbranch_scc1 L_exit
    v_mov_b32 v8, s17
    s_mov_b32 s28, 44797952
    buffer_store_dword v8, off, s[8:11], s28
    s_branch L_exit
L_RAf_slow:
    v_max_f32 v10, v8, v9
    s_nop 1
    v_max_f32_dpp v10, v10, v10 quad_perm:[1,0,3,2] row_mask:0xf bank_mask:0xf
    s_nop 1
    v_max_f32_dpp v10, v10, v10 quad_perm:[2,3,0,1] row_mask:0xf bank_mask:0xf
    s_nop 1
    v_max_f32_dpp v10, v10, v10 row_half_mirror row_mask:0xf bank_mask:0xf
    s_nop 1
    v_max_f32_dpp v11, v10, v10 row_mirror row_mask:0xf bank_mask:0xf
    v_max_f32_dpp v10, v10, v10 row_mirror row_mask:0xf bank_mask:0xf
    s_nop 1
    v_permlane16_swap_b32 v10, v11
    v_max_f32 v10, v10, v11
    v_sub_f32 v8, v8, v10
    v_sub_f32 v9, v9, v10
    v_exp_f32 v12, v8
    v_exp_f32 v13, v9
    s_nop 0
    v_add_f32 v10, v12, v13
    s_nop 1
    v_add_f32_dpp v10, v10, v10 quad_perm:[1,0,3,2] row_mask:0xf bank_mask:0xf
    s_nop 1
    v_add_f32_dpp v10, v10, v10 quad_perm:[2,3,0,1] row_mask:0xf bank_mask:0xf
    s_nop 1
    v_add_f32_dpp v10, v10, v10 row_half_mirror row_mask:0xf bank_mask:0xf
    s_nop 1
    v_add_f32_dpp v11, v10, v10 row_mirror row_mask:0xf bank_mask:0xf
    v_add_f32_dpp v10, v10, v10 row_mirror row_mask:0xf bank_mask:0xf
    s_nop 1
    v_permlane16_swap_b32 v10, v11
    v_add_f32 v10, v10, v11
    v_rcp_f32 v14, v10
    s_nop 0
    v_pk_mul_f32 v[12:13], v[12:13], v[14:15] op_sel_hi:[1,0]
    v_cvt_pk_bf16_f32 v12, v12, v13
    v_pk_min_u16 v12, v12, s40
    s_branch L_RAf_pub
L_RBf:
    s_lshl_b32 s30, s12, 1
    s_add_u32 s30, s30, 1
    v_and_b32 v5, 31, v0
    v_lshlrev_b32 v5, 5, v5
    s_lshl_b32 s30, s30, 2
    s_add_u32 s30, s30, 44793856
L_wf_10:
    buffer_load_dword v4, v5, s[8:11], s30 offen offset:0 sc1
    s_sub_u32 s26, s26, 1
    s_cbranch_scc1 L_fail
    s_waitcnt vmcnt(0)
    v_cmp_ne_u32 vcc, s17, v4
    s_cbranch_vccz L_wfd_11
    s_sleep 4
    s_branch L_wf_10
L_wfd_11:
    v_and_b32 v4, 63, v0
    v_lshrrev_b32 v5, 4, v4
    v_and_b32 v6, 15, v4
    s_sub_u32 s27, s13, 16
    v_lshlrev_b32 v154, 4, v4
    s_lshl_b32 s30, s12, 2
    s_lshr_b32 s44, 21536, s30
    s_and_b32 s44, s44, 15
    s_lshl_b32 s44, s44, 11
    s_lshr_b32 s45, 25905, s30
    s_and_b32 s45, s45, 15
    s_lshl_b32 s45, s45, 11
    s_lshr_b32 s46, 2, s30
    s_and_b32 s46, s46, 15
    s_lshl_b32 s46, s46, 11
    s_lshr_b32 s47, 4371, s30
    s_and_b32 s47, s47, 15
    s_lshl_b32 s47, s47, 11
    s_lshr_b32 s48, 8772, s30
    s_and_b32 s48, s48, 15
    s_lshl_b32 s48, s48, 11
    s_lshr_b32 s49, 13141, s30
    s_and_b32 s49, s49, 15
    s_lshl_b32 s49, s49, 11
    s_lshr_b32 s50, 18022, s30
    s_and_b32 s50, s50, 15
    s_lshl_b32 s50, s50, 11
    s_lshr_b32 s29, s46, 1
    v_add_u32 v164, s29, v154
    s_lshr_b32 s29, s48, 1
    v_add_u32 v165, s29, v154
    s_lshr_b32 s29, s50, 1
    v_add_u32 v166, s29, v154
    s_mul_i32 s28, s27, 458752
    s_mul_i32 s29, s12, 114688
    s_add_u32 s28, s28, s29
    s_add_u32 s28, s28, 6422528
    s_mul_i32 s30, s12, 28672
    s_add_u32 s30, s30, 16384
    v_add_u32 v162, s30, v154
    s_add_u32 s29, s28, s44
    buffer_load_dwordx4 a[0:3], v154, s[8:11], s29 offen offset:0
    buffer_load_dwordx4 a[4:7], v154, s[8:11], s29 offen offset:1024
    s_add_u32 s29, s28, s45
    buffer_load_dwordx4 a[8:11], v154, s[8:11], s29 offen offset:0
    buffer_load_dwordx4 a[12:15], v154, s[8:11], s29 offen offset:1024
    s_add_u32 s29, s28, s46
    buffer_load_dwordx4 a[16:19], v154, s[8:11], s29 offen offset:0
    buffer_load_dwordx4 a[20:23], v154, s[8:11], s29 offen offset:1024
    s_add_u32 s29, s28, s47
    buffer_load_dwordx4 a[24:27], v154, s[8:11], s29 offen offset:0
    buffer_load_dwordx4 a[28:31], v154, s[8:11], s29 offen offset:1024
    s_add_u32 s29, s28, s48
    buffer_load_dwordx4 a[32:35], v154, s[8:11], s29 offen offset:0
    buffer_load_dwordx4 a[36:39], v154, s[8:11], s29 offen offset:1024
    s_add_u32 s29, s28, s49
    buffer_load_dwordx4 v[240:243], v154, s[8:11], s29 offen offset:0
    buffer_load_dwordx4 v[244:247], v154, s[8:11], s29 offen offset:1024
    s_add_u32 s29, s28, s50
    s_add_u32 m0, s30, 0
    s_nop 0
    buffer_load_dwordx4 v154, s[8:11], s29 offen offset:0  lds
    buffer_load_dwordx4 v154, s[8:11], s29 offen offset:1024  lds
    s_add_u32 s28, s28, 14336
    s_add_u32 s29, s28, s44
    buffer_load_dwordx4 a[40:43], v154, s[8:11], s29 offen offset:0
    buffer_load_dwordx4 a[44:47], v154, s[8:11], s29 offen offset:1024
    s_add_u32 s29, s28, s45
    buffer_load_dwordx4 a[48:51], v154, s[8:11], s29 offen offset:0
    buffer_load_dwordx4 a[52:55], v154, s[8:11], s29 offen offset:1024
    s_add_u32 s29, s28, s46
    buffer_load_dwordx4 a[56:59], v154, s[8:11], s29 offen offset:0
    buffer_load_dwordx4 a[60:63], v154, s[8:11], s29 offen offset:1024
    s_add_u32 s29, s28, s47
    buffer_load_dwordx4 a[64:67], v154, s[8:11], s29 offen offset:0
    buffer_load_dwordx4 a[68:71], v154, s[8:11], s29 offen offset:1024
    s_add_u32 s29, s28, s48
    buffer_load_dwordx4 a[72:75], v154, s[8:11], s29 offen offset:0
    buffer_load_dwordx4 a[76:79], v154, s[8:11], s29 offen offset:1024
    s_add_u32 s29, s28, s49
    buffer_load_dwordx4 v[248:251], v154, s[8:11], s29 offen offset:0
    buffer_load_dwordx4 v[252:255], v154, s[8:11], s29 offen offset:1024
    s_add_u32 s29, s28, s50
    s_add_u32 m0, s30, 2048
    s_nop 0
    buffer_load_dwordx4 v154, s[8:11], s29 offen offset:0  lds
    buffer_load_dwordx4 v154, s[8:11], s29 offen offset:1024  lds
    s_add_u32 s28, s28, 14336
    s_add_u32 s29, s28, s44
    buffer_load_dwordx4 a[80:83], v154, s[8:11], s29 offen offset:0
    buffer_load_dwordx4 a[84:87], v154, s[8:11], s29 offen offset:1024
    s_add_u32 s29, s28, s45
    buffer_load_dwordx4 a[88:91], v154, s[8:11], s29 offen offset:0
    buffer_load_dwordx4 a[92:95], v154, s[8:11], s29 offen offset:1024
    s_add_u32 s29, s28, s46
    buffer_load_dwordx4 a[96:99], v154, s[8:11], s29 offen offset:0
    buffer_load_dwordx4 a[100:103], v154, s[8:11], s29 offen offset:1024
    s_add_u32 s29, s28, s47
    buffer_load_dwordx4 a[104:107], v154, s[8:11], s29 offen offset:0
    buffer_load_dwordx4 a[108:111], v154, s[8:11], s29 offen offset:1024
    s_add_u32 s29, s28, s48
    buffer_load_dwordx4 a[112:115], v154, s[8:11], s29 offen offset:0
    buffer_load_dwordx4 a[116:119], v154, s[8:11], s29 offen offset:1024
    s_add_u32 s29, s28, s49
    s_add_u32 m0, s30, 4096
    s_nop 0
    buffer_load_dwordx4 v154, s[8:11], s29 offen offset:0  lds
    buffer_load_dwordx4 v154, s[8:11], s29 offen offset:1024  lds
    s_add_u32 s29, s28, s50
    s_add_u32 m0, s30, 6144
    s_nop 0
    buffer_load_dwordx4 v154, s[8:11], s29 offen offset:0  lds
    buffer_load_dwordx4 v154, s[8:11], s29 offen offset:1024  lds
    s_add_u32 s28, s28, 14336
    s_waitcnt vmcnt(32)
    s_add_u32 s29, s28, s44
    buffer_load_dwordx4 a[120:123], v154, s[8:11], s29 offen offset:0
    buffer_load_dwordx4 a[124:127], v154, s[8:11], s29 offen offset:1024
    s_add_u32 s29, s28, s45
    buffer_load_dwordx4 a[128:131], v154, s[8:11], s29 offen offset:0
    buffer_load_dwordx4 a[132:135], v154, s[8:11], s29 offen offset:1024
    s_add_u32 s29, s28, s46
    buffer_load_dwordx4 a[136:139], v154, s[8:11], s29 offen offset:0
    buffer_load_dwordx4 a[140:143], v154, s[8:11], s29 offen offset:1024
    s_add_u32 s29, s28, s47
    buffer_load_dwordx4 a[144:147], v154, s[8:11], s29 offen offset:0
    buffer_load_dwordx4 a[148:151], v154, s[8:11], s29 offen offset:1024
    s_add_u32 s29, s28, s48
    buffer_load_dwordx4 a[152:155], v154, s[8:11], s29 offen offset:0
    buffer_load_dwordx4 a[156:159], v154, s[8:11], s29 offen offset:1024
    s_add_u32 s29, s28, s49
    s_add_u32 m0, s30, 8192
    s_nop 0
    buffer_load_dwordx4 v154, s[8:11], s29 offen offset:0  lds
    buffer_load_dwordx4 v154, s[8:11], s29 offen offset:1024  lds
    s_add_u32 s29, s28, s50
    s_add_u32 m0, s30, 10240
    s_nop 0
    buffer_load_dwordx4 v154, s[8:11], s29 offen offset:0  lds
    buffer_load_dwordx4 v154, s[8:11], s29 offen offset:1024  lds
    s_add_u32 s28, s28, 14336
    s_waitcnt vmcnt(32)
    s_add_u32 s29, s28, s44
    buffer_load_dwordx4 a[160:163], v154, s[8:11], s29 offen offset:0
    buffer_load_dwordx4 a[164:167], v154, s[8:11], s29 offen offset:1024
    s_add_u32 s29, s28, s45
    buffer_load_dwordx4 a[168:171], v154, s[8:11], s29 offen offset:0
    buffer_load_dwordx4 a[172:175], v154, s[8:11], s29 offen offset:1024
    s_add_u32 s29, s28, s46
    buffer_load_dwordx4 a[176:179], v154, s[8:11], s29 offen offset:0
    buffer_load_dwordx4 a[180:183], v154, s[8:11], s29 offen offset:1024
    s_add_u32 s29, s28, s47
    buffer_load_dwordx4 a[184:187], v154, s[8:11], s29 offen offset:0
    buffer_load_dwordx4 a[188:191], v154, s[8:11], s29 offen offset:1024
    s_add_u32 s29, s28, s48
    buffer_load_dwordx4 a[192:195], v154, s[8:11], s29 offen offset:0
    buffer_load_dwordx4 a[196:199], v154, s[8:11], s29 offen offset:1024
    s_add_u32 s29, s28, s49
    s_add_u32 m0, s30, 12288
    s_nop 0
    buffer_load_dwordx4 v154, s[8:11], s29 offen offset:0  lds
    buffer_load_dwordx4 v154, s[8:11], s29 offen offset:1024  lds
    s_add_u32 s29, s28, s50
    s_add_u32 m0, s30, 14336
    s_nop 0
    buffer_load_dwordx4 v154, s[8:11], s29 offen offset:0  lds
    buffer_load_dwordx4 v154, s[8:11], s29 offen offset:1024  lds
    s_add_u32 s28, s28, 14336
    s_waitcnt vmcnt(32)
    v_and_b32 v120, 15, v0
    v_and_b32 v121, 7, v120
    v_lshlrev_b32 v121, 5, v121
    v_lshrrev_b32 v122, 3, v120
    v_cmp_gt_u32 vcc, 8, v120
    v_lshl_add_u32 v121, v122, 2, v121
    v_and_b32 v122, 63, v0
    v_cndmask_b32 v120, 0, 32, vcc
    v_lshlrev_b32 v123, 3, v122
    v_lshlrev_b32 v122, 4, v122
    buffer_load_dword v118, v121, s[84:87], 0 offen sc1
    s_mov_b32 s18, 44793856
    buffer_load_dwordx4 v[112:115], v122, s[8:11], s18 offen sc1
    s_mov_b32 s18, 44796416
    buffer_load_dwordx2 v[116:117], v123, s[8:11], s18 offen sc1
    s_add_u32 s29, s28, s44
    buffer_load_dwordx4 a[200:203], v154, s[8:11], s29 offen offset:0
    buffer_load_dwordx4 a[204:207], v154, s[8:11], s29 offen offset:1024
    s_add_u32 s29, s28, s45
    buffer_load_dwordx4 a[208:211], v154, s[8:11], s29 offen offset:0
    buffer_load_dwordx4 a[212:215], v154, s[8:11], s29 offen offset:1024
    s_add_u32 s29, s28, s46
    buffer_load_dwordx4 a[216:219], v154, s[8:11], s29 offen offset:0
    buffer_load_dwordx4 a[220:223], v154, s[8:11], s29 offen offset:1024
    s_add_u32 s29, s28, s47
    buffer_load_dwordx4 a[224:227], v154, s[8:11], s29 offen offset:0
    buffer_load_dwordx4 a[228:231], v154, s[8:11], s29 offen offset:1024
    s_add_u32 s29, s28, s48
    buffer_load_dwordx4 a[232:235], v154, s[8:11], s29 offen offset:0
    buffer_load_dwordx4 a[236:239], v154, s[8:11], s29 offen offset:1024
    s_add_u32 s29, s28, s49
    s_add_u32 m0, s30, 16384
    s_nop 0
    buffer_load_dwordx4 v154, s[8:11], s29 offen offset:0  lds
    buffer_load_dwordx4 v154, s[8:11], s29 offen offset:1024  lds
    s_add_u32 s29, s28, s50
    s_add_u32 m0, s30, 18432
    s_nop 0
    buffer_load_dwordx4 v154, s[8:11], s29 offen offset:0  lds
    buffer_load_dwordx4 v154, s[8:11], s29 offen offset:1024  lds
    s_add_u32 s28, s28, 14336
    s_waitcnt vmcnt(32)
    s_waitcnt vmcnt(14)
    v_xor_b32 v112, s17, v112
    v_xor_b32 v113, s17, v113
    v_xor_b32 v114, s17, v114
    v_xor_b32 v115, s17, v115
    v_xor_b32 v118, v118, v120
    s_cmp_eq_u32 s15, 0
    s_cselect_b32 s18, -1, 0
    v_and_b32 v118, s18, v118
    v_or3_b32 v112, v112, v113, v114
    v_or3_b32 v112, v112, v115, v118
    v_cmp_ne_u32 vcc, 0, v112
    s_cmp_eq_u64 vcc, 0
    s_cselect_b32 s18, 1, 0
    s_add_u32 s29, s28, s44
    buffer_load_dwordx4 a[240:243], v154, s[8:11], s29 offen offset:0
    buffer_load_dwordx4 a[244:247], v154, s[8:11], s29 offen offset:1024
    s_add_u32 s29, s28, s45
    buffer_load_dwordx4 a[248:251], v154, s[8:11], s29 offen offset:0
    buffer_load_dwordx4 a[252:255], v154, s[8:11], s29 offen offset:1024
    s_add_u32 s29, s28, s46
    buffer_load_dwordx4 v[176:179], v154, s[8:11], s29 offen offset:0
    buffer_load_dwordx4 v[180:183], v154, s[8:11], s29 offen offset:1024
    s_add_u32 s29, s28, s47
    buffer_load_dwordx4 v[184:187], v154, s[8:11], s29 offen offset:0
    buffer_load_dwordx4 v[188:191], v154, s[8:11], s29 offen offset:1024
    s_add_u32 s29, s28, s48
    buffer_load_dwordx4 v[192:195], v154, s[8:11], s29 offen offset:0
    buffer_load_dwordx4 v[196:199], v154, s[8:11], s29 offen offset:1024
    s_add_u32 s29, s28, s49
    s_add_u32 m0, s30, 20480
    s_nop 0
    buffer_load_dwordx4 v154, s[8:11], s29 offen offset:0  lds
    buffer_load_dwordx4 v154, s[8:11], s29 offen offset:1024  lds
    s_add_u32 s29, s28, s50
    s_add_u32 m0, s30, 22528
    s_nop 0
    buffer_load_dwordx4 v154, s[8:11], s29 offen offset:0  lds
    buffer_load_dwordx4 v154, s[8:11], s29 offen offset:1024  lds
    s_add_u32 s28, s28, 14336
    s_waitcnt vmcnt(32)
    s_add_u32 s29, s28, s44
    buffer_load_dwordx4 v[200:203], v154, s[8:11], s29 offen offset:0
    buffer_load_dwordx4 v[204:207], v154, s[8:11], s29 offen offset:1024
    s_add_u32 s29, s28, s45
    buffer_load_dwordx4 v[208:211], v154, s[8:11], s29 offen offset:0
    buffer_load_dwordx4 v[212:215], v154, s[8:11], s29 offen offset:1024
    s_add_u32 s29, s28, s46
    buffer_load_dwordx4 v[216:219], v154, s[8:11], s29 offen offset:0
    buffer_load_dwordx4 v[220:223], v154, s[8:11], s29 offen offset:1024
    s_add_u32 s29, s28, s47
    buffer_load_dwordx4 v[224:227], v154, s[8:11], s29 offen offset:0
    buffer_load_dwordx4 v[228:231], v154, s[8:11], s29 offen offset:1024
    s_add_u32 s29, s28, s48
    buffer_load_dwordx4 v[232:235], v154, s[8:11], s29 offen offset:0
    buffer_load_dwordx4 v[236:239], v154, s[8:11], s29 offen offset:1024
    s_add_u32 s29, s28, s49
    s_add_u32 m0, s30, 24576
    s_nop 0
    buffer_load_dwordx4 v154, s[8:11], s29 offen offset:0  lds
    buffer_load_dwordx4 v154, s[8:11], s29 offen offset:1024  lds
    s_add_u32 s29, s28, s50
    s_add_u32 m0, s30, 26624
    s_nop 0
    buffer_load_dwordx4 v154, s[8:11], s29 offen offset:0  lds
    buffer_load_dwordx4 v154, s[8:11], s29 offen offset:1024  lds
    s_add_u32 s28, s28, 14336
    s_waitcnt vmcnt(32)
    s_lshl_b32 s28, s27, 7
    s_lshl_b32 s29, s12, 4
    s_add_u32 s28, s28, s29
    s_add_u32 s28, s28, 44744704
    v_and_b32 v7, 3, v4
    v_lshlrev_b32 v7, 2, v7
    v_add_u32 v168, s28, v7
    s_lshr_b32 s28, s27, 2
    s_lshl_b32 s29, s28, 2
    s_min_u32 s29, s29, 10
    s_sub_u32 s29, s27, s29
    s_lshl_b32 s29, s29, 4
    s_lshl_b32 s28, s28, 6
    s_add_u32 s28, s28, s29
    s_sub_u32 s29, s27, 10
    s_lshl_b32 s30, s29, 4
    s_add_u32 s30, s30, 192
    s_cmp_lt_u32 s29, 2
    s_cselect_b32 s30, s30, 1073741824
    v_mov_b32 v7, s28
    v_mov_b32 v8, s30
    v_mov_b32 v9, 1073741824
    v_cmp_eq_u32 vcc, 1, v5
    s_nop 1
    v_cndmask_b32 v7, v7, v8, vcc
    v_cmp_lt_u32 vcc, 1, v5
    s_nop 1
    v_cndmask_b32 v7, v7, v9, vcc
    v_lshl_add_u32 v7, v6, 8, v7
    s_lshl_b32 s28, s12, 2
    s_add_u32 s28, s28, 44746496
    v_add_u32 v169, s28, v7
    v_mov_b32 v1, 0x4444
    v_mov_b32 v7, 0xeeee
    v_cmp_lt_u32 vcc, 7, v6
    s_nop 1
    v_cndmask_b32 v1, v1, v7, vcc
    v_mov_b32 v167, 0x4444
    v_and_b32 v8, 2, v6
    v_cmp_ne_u32 vcc, 0, v8
    s_nop 1
    v_cndmask_b32 v167, v167, v7, vcc
    s_lshl_b32 s28, s12, 11
    v_add_u32 v156, s28, v154
    s_min_u32 s28, s28, 5120
    v_add_u32 v155, s28, v154
    v_lshrrev_b32 v7, 1, v5
    v_lshlrev_b32 v7, 8, v7
    v_lshl_add_u32 v7, v6, 4, v7
    s_lshl_b32 s28, s12, 9
    s_add_u32 s28, s28, 8192
    v_add_u32 v157, s28, v7
    s_mul_i32 s28, s12, 1792
    s_add_u32 s28, s28, 8192
    v_mul_u32_u24 v158, 192, v5
    v_lshl_add_u32 v163, v6, 3, v158
    v_add_u32 v163, s28, v163
    v_bfe_u32 v8, v4, 3, 1
    v_lshl_add_u32 v158, v8, 2, v158
    v_bfe_u32 v8, v4, 2, 1
    v_lshl_add_u32 v158, v8, 5, v158
    v_bfe_u32 v8, v4, 0, 1
    v_lshl_add_u32 v158, v8, 3, v158
    v_bfe_u32 v8, v4, 1, 1
    v_mul_u32_u24 v8, 784, v8
    v_add_u32 v158, v8, v158
    s_lshr_b32 s28, s12, 1
    s_lshl_b32 s28, s28, 6
    s_and_b32 s29, s12, 1
    s_lshl_b32 s29, s29, 4
    s_add_u32 s28, s28, s29
    s_add_u32 s28, s28, 8192
    v_add_u32 v158, s28, v158
    s_lshl_b32 s28, s12, 7
    s_lshl_b32 s29, s27, 9
    s_add_u32 s28, s28, s29
    v_lshlrev_b32 v159, 1, v4
    v_add_u32 v159, s28, v159
    v_add_u32 v160, s29, v154
    v_mov_b32 v7, 1073741824
    v_cmp_gt_u32 vcc, 32, v4
    s_cmp_eq_u32 s12, 0
    s_cselect_b64 vcc, vcc, 0
    s_nop 1
    v_cndmask_b32 v160, v7, v160, vcc
    s_lshl_b32 s28, s27, 2
    s_add_u32 s28, s28, s12
    s_lshl_b32 s29, s28, 3
    v_and_b32 v161, 1, v4
    v_lshlrev_b32 v161, 2, v161
    v_add_u32 v161, s29, v161
    s_lshl_b32 s23, s28, 13
    s_add_u32 s23, s23, 14680064
    s_mov_b32 s24, 44662784
    s_mov_b32 s25, 44040192
    s_mov_b32 s20, 0
    s_mov_b32 s21, 44564480
    s_mov_b32 s22, 44597248
    s_mov_b32 s26, 1048576
    s_mov_b32 s40, 0xfffefffe
    s_mov_b32 s36, 16
    v_mov_b32 v153, 0
    s_add_u32 s32, s23, 4096
    s_mov_b32 s33, 44580864
    v_mov_b32 v148, -1
    v_mov_b32 v149, -1
    v_mov_b32 v150, -1
    v_mov_b32 v151, -1
    v_mov_b64 v[24:25], 0
    v_mov_b64 v[26:27], 0
    v_mov_b64 v[28:29], 0
    v_mov_b64 v[30:31], 0
    v_mov_b64 v[32:33], 0
    v_mov_b64 v[34:35], 0
    v_mov_b64 v[36:37], 0
    v_mov_b64 v[38:39], 0
    v_mov_b64 v[40:41], 0
    v_mov_b64 v[42:43], 0
    v_mov_b64 v[44:45], 0
    v_mov_b64 v[46:47], 0
    v_mov_b64 v[48:49], 0
    v_mov_b64 v[50:51], 0
    v_mov_b64 v[52:53], 0
    v_mov_b64 v[54:55], 0
    v_mov_b64 v[104:105], 0
    v_mov_b64 v[106:107], 0
    v_mov_b64 v[108:109], 0
    v_mov_b64 v[110:111], 0
    s_cmp_eq_u32 s18, 1
    s_cbranch_scc1 L_RBf_ready
    s_cmp_lg_u32 s15, 0
    s_cbranch_scc1 L_ver_12_ok
    v_and_b32 v4, 15, v0
    v_and_b32 v5, 7, v4
    v_lshlrev_b32 v5, 5, v5
    v_lshrrev_b32 v6, 3, v4
    v_cmp_gt_u32 vcc, 8, v4
    v_lshl_add_u32 v5, v6, 2, v5
    s_nop 0
    v_cndmask_b32 v4, 0, 32, vcc
L_ver_12:
    buffer_load_dword v6, v5, s[84:87], 0 offen sc1
    s_sub_u32 s26, s26, 1
    s_cbranch_scc1 L_fail
    s_waitcnt vmcnt(0)
    v_cmp_gt_u32 vcc, v6, v4
    s_cbranch_vccnz L_irregular
    v_cmp_ne_u32 vcc, v6, v4
    s_cbranch_vccnz L_ver_12
L_ver_12_ok:
    v_and_b32 v8, 63, v0
    v_lshlrev_b32 v8, 4, v8
    s_mov_b32 s30, 44793856
L_qs_13:
    buffer_load_dwordx4 v[4:7], v8, s[8:11], s30 offen sc1
    s_sub_u32 s26, s26, 1
    s_cbranch_scc1 L_fail
    s_waitcnt vmcnt(0)
    v_xor_b32 v4, s17, v4
    v_xor_b32 v5, s17, v5
    v_xor_b32 v6, s17, v6
    v_xor_b32 v7, s17, v7
    v_or3_b32 v4, v4, v5, v6
    v_or_b32 v4, v4, v7
    v_cmp_ne_u32 vcc, 0, v4
    s_cbranch_vccnz L_qs_13
L_RBf_ready:
    s_waitcnt vmcnt(0)
    ds_read_b128 v[112:115], v162 offset:0
    ds_read_b128 v[116:119], v162 offset:1024
    ds_read_b128 v[120:123], v162 offset:2048
    ds_read_b128 v[124:127], v162 offset:3072
    ds_read_b128 v[128:131], v162 offset:4096
    ds_read_b128 v[132:135], v162 offset:5120
    ds_read_b128 v[136:139], v162 offset:6144
    ds_read_b128 v[140:143], v162 offset:7168
.p2align 6
    s_nop 0
    s_nop 0
L_RBf_step:
    v_cmp_eq_u32 vcc, 0, v153
    s_cbranch_vccz L_RBf_vok
L_RBf_vspin:
    buffer_load_dword v153, v161, s[8:11], s24 offen sc1
    s_sub_u32 s26, s26, 1
    s_cbranch_scc1 L_fail
    s_waitcnt vmcnt(0)
    v_cmp_eq_u32 vcc, 0, v153
    s_cbranch_vccnz L_RBf_vspin
L_RBf_vok:
    s_sleep 1
L_RBf_pm_loop:
    buffer_load_dwordx4 v[56:59], v155, s[8:11], s21 offen offset:0 sc1
    buffer_load_dwordx4 v[60:63], v155, s[8:11], s21 offen offset:1024 sc1
    s_sub_u32 s26, s26, 1
    s_cbranch_scc1 L_fail
    s_waitcnt vmcnt(0)
    v_max_u32 v4, v59, v63
    v_cmp_eq_u32 vcc, -1, v4
    s_cbranch_vccnz L_RBf_pm_loop
L_RBf_pm_ok0:
    s_cmp_lg_u32 s27, 0
    s_cbranch_scc1 L_nopub_14
    buffer_store_dwordx4 v[56:59], v155, s[8:11], s25 offen sc1
    buffer_store_dwordx4 v[60:63], v155, s[8:11], s25 offen offset:1024 sc1
    s_cmp_lg_u32 s20, 0
    s_cbranch_scc1 L_nopub_14
    v_mov_b32 v152, s17
    s_mov_b32 s30, 44797440
    buffer_store_dword v152, off, s[8:11], s30 sc1
L_nopub_14:
    v_smfmac_f32_16x16x64_bf16 v[24:27], v[56:59], a[0:7], v1
    ds_write_b128 v155, v[56:59] offset:0
    v_smfmac_f32_16x16x64_bf16 v[28:31], v[56:59], a[40:47], v1
    ds_write_b128 v155, v[60:63] offset:1024
    v_smfmac_f32_16x16x64_bf16 v[32:35], v[56:59], a[80:87], v1
    buffer_load_dwordx4 v[72:75], v154, s[8:11], s23 offen offset:0 sc1
    v_smfmac_f32_16x16x64_bf16 v[36:39], v[56:59], a[120:127], v1
    v_smfmac_f32_16x16x64_bf16 v[40:43], v[56:59], a[160:167], v1
    buffer_load_dwordx4 v[80:83], v154, s[8:11], s23 offen offset:1024 sc1
    v_smfmac_f32_16x16x64_bf16 v[44:47], v[56:59], a[200:207], v1
    v_smfmac_f32_16x16x64_bf16 v[48:51], v[56:59], a[240:247], v1
    buffer_load_dwordx4 v[76:79], v154, s[8:11], s23 offen offset:2048 sc1
    v_smfmac_f32_16x16x64_bf16 v[52:55], v[56:59], v[200:207], v1
    v_smfmac_f32_16x16x64_bf16 v[24:27], v[60:63], a[8:15], v1
    buffer_load_dwordx4 v[84:87], v154, s[8:11], s23 offen offset:3072 sc1
    v_smfmac_f32_16x16x64_bf16 v[28:31], v[60:63], a[48:55], v1
    s_waitcnt lgkmcnt(0)
    v_smfmac_f32_16x16x64_bf16 v[32:35], v[60:63], a[88:95], v1
    s_barrier
    v_smfmac_f32_16x16x64_bf16 v[36:39], v[60:63], a[128:135], v1
    ds_read_b128 v[4:7], v164 offset:0
    v_smfmac_f32_16x16x64_bf16 v[40:43], v[60:63], a[168:175], v1
    ds_read_b128 v[8:11], v164 offset:1024
    v_smfmac_f32_16x16x64_bf16 v[44:47], v[60:63], a[208:215], v1
    ds_read_b128 v[12:15], v165 offset:0
    v_smfmac_f32_16x16x64_bf16 v[48:51], v[60:63], a[248:255], v1
    ds_read_b128 v[16:19], v165 offset:1024
    v_smfmac_f32_16x16x64_bf16 v[52:55], v[60:63], v[208:215], v1
    ds_read_b128 v[20:23], v166 offset:0
L_RBf_pm_done:
    s_waitcnt lgkmcnt(4)
    v_smfmac_f32_16x16x64_bf16 v[24:27], v[4:7], a[16:23], v1
    s_waitcnt lgkmcnt(3)
    v_smfmac_f32_16x16x64_bf16 v[24:27], v[8:11], a[24:31], v1
    buffer_load_dwordx4 v[88:91], v154, s[8:11], s32 offen offset:0 sc1
    s_waitcnt lgkmcnt(2)
    v_smfmac_f32_16x16x64_bf16 v[24:27], v[12:15], a[32:39], v1
    s_waitcnt lgkmcnt(1)
    v_smfmac_f32_16x16x64_bf16 v[24:27], v[16:19], v[240:247], v1
    buffer_load_dwordx4 v[96:99], v154, s[8:11], s32 offen offset:1024 sc1
    s_waitcnt lgkmcnt(0)
    v_smfmac_f32_16x16x64_bf16 v[24:27], v[20:23], v[112:119], v1
    ds_read_b128 v[112:115], v162 offset:8192
    v_smfmac_f32_16x16x64_bf16 v[28:31], v[4:7], a[56:63], v1
    ds_read_b128 v[116:119], v162 offset:9216
    v_smfmac_f32_16x16x64_bf16 v[28:31], v[8:11], a[64:71], v1
    buffer_load_dwordx4 v[92:95], v154, s[8:11], s32 offen offset:2048 sc1
    v_smfmac_f32_16x16x64_bf16 v[28:31], v[12:15], a[72:79], v1
    v_smfmac_f32_16x16x64_bf16 v[28:31], v[16:19], v[248:255], v1
    buffer_load_dwordx4 v[100:103], v154, s[8:11], s32 offen offset:3072 sc1
    v_smfmac_f32_16x16x64_bf16 v[28:31], v[20:23], v[120:127], v1
    ds_read_b128 v[120:123], v162 offset:10240
    v_smfmac_f32_16x16x64_bf16 v[32:35], v[4:7], a[96:103], v1
    ds_read_b128 v[124:127], v162 offset:11264
    v_cvt_pk_bf16_f32 v56, v24, v25
    v_smfmac_f32_16x16x64_bf16 v[32:35], v[8:11], a[104:111], v1
    v_cvt_pk_bf16_f32 v58, v26, v27
    v_smfmac_f32_16x16x64_bf16 v[32:35], v[12:15], a[112:119], v1
    buffer_load_dword v153, v161, s[8:11], s24 offen offset:512 sc1
    v_smfmac_f32_16x16x64_bf16 v[32:35], v[16:19], v[128:135], v1
    ds_read_b128 v[128:131], v162 offset:12288
    v_smfmac_f32_16x16x64_bf16 v[32:35], v[20:23], v[136:143], v1
    ds_read_b128 v[132:135], v162 offset:13312
    ds_read_b128 v[136:139], v162 offset:14336
    v_smfmac_f32_16x16x64_bf16 v[36:39], v[4:7], a[136:143], v1
    ds_read_b128 v[140:143], v162 offset:15360
    buffer_store_dwordx4 v[148:151], v160, s[8:11], s33 offen
    v_smfmac_f32_16x16x64_bf16 v[36:39], v[8:11], a[144:151], v1
    v_cvt_pk_bf16_f32 v64, v28, v29
    v_smfmac_f32_16x16x64_bf16 v[36:39], v[12:15], a[152:159], v1
    v_cvt_pk_bf16_f32 v66, v30, v31
    s_waitcnt lgkmcnt(6)
    v_smfmac_f32_16x16x64_bf16 v[36:39], v[16:19], v[112:119], v1
    ds_read_b128 v[112:115], v162 offset:16384
    s_waitcnt lgkmcnt(5)
    v_smfmac_f32_16x16x64_bf16 v[36:39], v[20:23], v[120:127], v1
    ds_read_b128 v[116:119], v162 offset:17408
    ds_read_b128 v[120:123], v162 offset:18432
    v_smfmac_f32_16x16x64_bf16 v[40:43], v[4:7], a[176:183], v1
    ds_read_b128 v[124:127], v162 offset:19456
    v_smfmac_f32_16x16x64_bf16 v[40:43], v[8:11], a[184:191], v1
    v_cvt_pk_bf16_f32 v57, v32, v33
    v_smfmac_f32_16x16x64_bf16 v[40:43], v[12:15], a[192:199], v1
    v_cvt_pk_bf16_f32 v59, v34, v35
    s_waitcnt lgkmcnt(6)
    v_smfmac_f32_16x16x64_bf16 v[40:43], v[16:19], v[128:135], v1
    ds_read_b128 v[128:131], v162 offset:20480
    s_waitcnt lgkmcnt(5)
    v_smfmac_f32_16x16x64_bf16 v[40:43], v[20:23], v[136:143], v1
    ds_read_b128 v[132:135], v162 offset:21504
    ds_read_b128 v[136:139], v162 offset:22528
    v_smfmac_f32_16x16x64_bf16 v[44:47], v[4:7], a[216:223], v1
    ds_read_b128 v[140:143], v162 offset:23552
    v_smfmac_f32_16x16x64_bf16 v[44:47], v[8:11], a[224:231], v1
    v_cvt_pk_bf16_f32 v65, v36, v37
    v_smfmac_f32_16x16x64_bf16 v[44:47], v[12:15], a[232:239], v1
    v_cvt_pk_bf16_f32 v67, v38, v39
    s_waitcnt lgkmcnt(6)
    v_smfmac_f32_16x16x64_bf16 v[44:47], v[16:19], v[112:119], v1
    ds_read_b128 v[112:115], v162 offset:24576
    s_waitcnt lgkmcnt(5)
    v_smfmac_f32_16x16x64_bf16 v[44:47], v[20:23], v[120:127], v1
    ds_read_b128 v[116:119], v162 offset:25600
    ds_read_b128 v[120:123], v162 offset:26624
    v_smfmac_f32_16x16x64_bf16 v[48:51], v[4:7], v[176:183], v1
    ds_read_b128 v[124:127], v162 offset:27648
    v_smfmac_f32_16x16x64_bf16 v[48:51], v[8:11], v[184:191], v1
    v_cvt_pk_bf16_f32 v60, v40, v41
    v_smfmac_f32_16x16x64_bf16 v[48:51], v[12:15], v[192:199], v1
    v_cvt_pk_bf16_f32 v62, v42, v43
    s_waitcnt lgkmcnt(6)
    v_smfmac_f32_16x16x64_bf16 v[48:51], v[16:19], v[128:135], v1
    s_waitcnt lgkmcnt(4)
    v_smfmac_f32_16x16x64_bf16 v[48:51], v[20:23], v[136:143], v1
    v_smfmac_f32_16x16x64_bf16 v[52:55], v[4:7], v[216:223], v1
    v_smfmac_f32_16x16x64_bf16 v[52:55], v[8:11], v[224:231], v1
    v_cvt_pk_bf16_f32 v68, v44, v45
    v_smfmac_f32_16x16x64_bf16 v[52:55], v[12:15], v[232:239], v1
    v_cvt_pk_bf16_f32 v70, v46, v47
    s_waitcnt lgkmcnt(2)
    v_smfmac_f32_16x16x64_bf16 v[52:55], v[16:19], v[112:119], v1
    s_waitcnt lgkmcnt(0)
    v_smfmac_f32_16x16x64_bf16 v[52:55], v[20:23], v[120:127], v1
    v_cvt_pk_bf16_f32 v61, v48, v49
    v_cvt_pk_bf16_f32 v63, v50, v51
    s_add_u32 s20, s20, 1
    s_and_b32 s28, s20, 3
    s_lshl_b32 s29, s28, 13
    s_add_u32 s21, s29, 44564480
    s_nop 1
    v_cvt_pk_bf16_f32 v69, v52, v53
    v_cvt_pk_bf16_f32 v71, v54, v55
    v_mov_b32 v170, s20
    s_sleep 1
    s_sleep 1
    s_sleep 1
    s_nop 11
    buffer_load_dwordx4 v[112:115], v156, s[8:11], s22 offen offset:0 sc1
    buffer_load_dwordx4 v[116:119], v156, s[8:11], s22 offen offset:1024 sc1
    buffer_load_dwordx4 v[120:123], v157, s[8:11], s22 offen offset:0 sc1
    s_sleep 1
    s_sleep 1
L_RBf_pp_loop:
    buffer_load_dwordx4 v[124:127], v156, s[8:11], s22 offen offset:0 sc1
    buffer_load_dwordx4 v[128:131], v156, s[8:11], s22 offen offset:1024 sc1
    buffer_load_dwordx4 v[132:135], v157, s[8:11], s22 offen offset:0 sc1
    s_sub_u32 s26, s26, 1
    s_cbranch_scc1 L_fail
    s_nop 4
    v_mov_b64 v[104:105], 0
    v_mov_b64 v[106:107], 0
    s_nop 0
    s_waitcnt vmcnt(3)
    v_smfmac_f32_16x16x64_bf16 v[104:107], v[112:115], v[72:79], v167
    v_max3_u32 v12, v115, v119, v123
    v_smfmac_f32_16x16x64_bf16 v[104:107], v[116:119], v[88:95], v167
    v_cmp_eq_u32 vcc, -1, v12
    v_smfmac_f32_16x16x64_bf16 v[104:107], v[120:123], v[56:63], v167
    s_cbranch_vccz L_RBf_pp_ok0
    buffer_load_dwordx4 v[112:115], v156, s[8:11], s22 offen offset:0 sc1
    buffer_load_dwordx4 v[116:119], v156, s[8:11], s22 offen offset:1024 sc1
    buffer_load_dwordx4 v[120:123], v157, s[8:11], s22 offen offset:0 sc1
    s_nop 4
    v_mov_b64 v[104:105], 0
    v_mov_b64 v[106:107], 0
    s_nop 0
    s_waitcnt vmcnt(3)
    v_smfmac_f32_16x16x64_bf16 v[104:107], v[124:127], v[72:79], v167
    v_max3_u32 v12, v127, v131, v135
    v_smfmac_f32_16x16x64_bf16 v[104:107], v[128:131], v[88:95], v167
    v_cmp_eq_u32 vcc, -1, v12
    v_smfmac_f32_16x16x64_bf16 v[104:107], v[132:135], v[56:63], v167
    s_cbranch_vccnz L_RBf_pp_loop
L_RBf_pp_ok1:
    v_smfmac_f32_16x16x64_bf16 v[108:111], v[124:127], v[80:87], v167
    v_smfmac_f32_16x16x64_bf16 v[108:111], v[128:131], v[96:103], v167
    v_smfmac_f32_16x16x64_bf16 v[108:111], v[132:135], v[64:71], v167
    s_branch L_RBf_pp_done
L_RBf_pp_ok0:
    v_smfmac_f32_16x16x64_bf16 v[108:111], v[112:115], v[80:87], v167
    v_smfmac_f32_16x16x64_bf16 v[108:111], v[116:119], v[96:103], v167
    v_smfmac_f32_16x16x64_bf16 v[108:111], v[120:123], v[64:71], v167
L_RBf_pp_done:
    s_nop 3
    v_pk_add_f32 v[104:105], v[104:105], v[106:107]
    ds_write_b64 v163, v[104:105]
    s_nop 1
    v_pk_add_f32 v[108:109], v[108:109], v[110:111]
    ds_write_b64 v163, v[108:109] offset:784
    s_waitcnt lgkmcnt(0)
    s_barrier
    ds_read2st64_b32 v[104:105], v158 offset0:0 offset1:7
    ds_read2st64_b32 v[106:107], v158 offset0:14 offset1:21
    s_waitcnt lgkmcnt(1)
    v_add_f32 v104, v104, v105
    s_waitcnt lgkmcnt(0)
    v_add_f32 v106, v106, v107
    v_add_f32 v104, v104, v106
    v_cvt_pk_bf16_f32 v104, v104, v104
    v_pk_min_u16 v104, v104, s40
    buffer_store_short v104, v159, s[8:11], s21 offen
    s_cmp_lt_u32 s20, 63
    s_cbranch_scc1 L_RBf_more
    s_lshl_b32 s28, s12, 7
    s_add_u32 s29, s28, 15360
    v_lshrrev_b32 v4, 3, v154
    v_add_u32 v4, s29, v4
    v_add_u32 v5, s29, v154
    ds_write_b16 v4, v104
    s_waitcnt lgkmcnt(0)
    s_mov_b64 exec, 0xff
    ds_read_b128 v[8:11], v5
    s_lshl_b32 s29, s27, 9
    s_add_u32 s28, s28, s29
    s_add_u32 s28, s28, 44556288
    s_waitcnt lgkmcnt(0)
    buffer_store_dwordx4 v[8:11], v154, s[8:11], s28 offen sc1
    s_mov_b64 exec, -1
    s_branch L_RBf_end
L_RBf_more:
    s_lshl_b32 s29, s28, 14
    s_add_u32 s22, s29, 44597248
    s_add_u32 s25, s25, 8192
    s_lshl_b32 s29, s28, 13
    s_xor_b32 s29, s29, 16384
    s_add_u32 s33, s29, 44564480
    s_add_u32 s23, s23, 458752
    s_add_u32 s32, s23, 4096
    s_add_u32 s24, s24, 512
    v_mov_b64 v[24:25], 0
    v_mov_b64 v[26:27], 0
    v_mov_b64 v[28:29], 0
    v_mov_b64 v[30:31], 0
    v_mov_b64 v[32:33], 0
    v_mov_b64 v[34:35], 0
    v_mov_b64 v[36:37], 0
    v_mov_b64 v[38:39], 0
    v_mov_b64 v[40:41], 0
    v_mov_b64 v[42:43], 0
    v_mov_b64 v[44:45], 0
    v_mov_b64 v[46:47], 0
    v_mov_b64 v[48:49], 0
    v_mov_b64 v[50:51], 0
    v_mov_b64 v[52:53], 0
    v_mov_b64 v[54:55], 0
    v_mov_b64 v[104:105], 0
    v_mov_b64 v[106:107], 0
    v_mov_b64 v[108:109], 0
    v_mov_b64 v[110:111], 0
    s_waitcnt vmcnt(1)
    ds_read_b128 v[112:115], v162 offset:0
    ds_read_b128 v[116:119], v162 offset:1024
    ds_read_b128 v[120:123], v162 offset:2048
    ds_read_b128 v[124:127], v162 offset:3072
    ds_read_b128 v[128:131], v162 offset:4096
    ds_read_b128 v[132:135], v162 offset:5120
    ds_read_b128 v[136:139], v162 offset:6144
    ds_read_b128 v[140:143], v162 offset:7168
    s_branch L_RBf_step
L_RBf_end:
    s_branch L_exit
L_XAf:
    v_and_b32 v4, 63, v0
    v_lshrrev_b32 v5, 4, v4
    v_and_b32 v6, 15, v4
    s_mov_b32 s26, 1048576
    v_lshlrev_b32 v104, 4, v4
    v_mov_b32 v62, 0
    s_mov_b32 s30, 44797440
L_wf_15:
    buffer_load_dword v60, v62, s[8:11], s30 offen offset:0 sc1
    s_sub_u32 s26, s26, 1
    s_cbranch_scc1 L_fail
    s_waitcnt vmcnt(0)
    v_cmp_ne_u32 vcc, s17, v60
    s_cbranch_vccz L_wfd_16
    s_sleep 24
    s_branch L_wf_15
L_wfd_16:
    s_mul_i32 s32, s13, 401408
    s_mul_i32 s33, s12, 100352
    s_add_u32 s32, s32, s33
    buffer_load_dwordx4 a[0:3], v104, s[8:11], s32 offen offset:0
    buffer_load_dwordx4 a[4:7], v104, s[8:11], s32 offen offset:1024
    s_waitcnt vmcnt(1)
    buffer_load_dwordx4 a[8:11], v104, s[8:11], s32 offen offset:2048
    s_waitcnt vmcnt(1)
    buffer_load_dwordx4 a[12:15], v104, s[8:11], s32 offen offset:3072
    s_add_u32 s32, s32, 4096
    s_waitcnt vmcnt(1)
    buffer_load_dwordx4 a[16:19], v104, s[8:11], s32 offen offset:0
    s_waitcnt vmcnt(1)
    buffer_load_dwordx4 a[20:23], v104, s[8:11], s32 offen offset:1024
    s_waitcnt vmcnt(1)
    buffer_load_dwordx4 a[24:27], v104, s[8:11], s32 offen offset:2048
    s_waitcnt vmcnt(1)
    buffer_load_dwordx4 a[28:31], v104, s[8:11], s32 offen offset:3072
    s_add_u32 s32, s32, 4096
    s_waitcnt vmcnt(1)
    buffer_load_dwordx4 a[32:35], v104, s[8:11], s32 offen offset:0
    s_waitcnt vmcnt(1)
    buffer_load_dwordx4 a[36:39], v104, s[8:11], s32 offen offset:1024
    s_waitcnt vmcnt(1)
    buffer_load_dwordx4 a[40:43], v104, s[8:11], s32 offen offset:2048
    s_waitcnt vmcnt(1)
    buffer_load_dwordx4 a[44:47], v104, s[8:11], s32 offen offset:3072
    s_add_u32 s32, s32, 4096
    s_waitcnt vmcnt(1)
    buffer_load_dwordx4 a[48:51], v104, s[8:11], s32 offen offset:0
    s_waitcnt vmcnt(1)
    buffer_load_dwordx4 a[52:55], v104, s[8:11], s32 offen offset:1024
    s_waitcnt vmcnt(1)
    buffer_load_dwordx4 a[56:59], v104, s[8:11], s32 offen offset:2048
    s_waitcnt vmcnt(1)
    buffer_load_dwordx4 a[60:63], v104, s[8:11], s32 offen offset:3072
    s_add_u32 s32, s32, 4096
    s_waitcnt vmcnt(1)
    buffer_load_dwordx4 a[64:67], v104, s[8:11], s32 offen offset:0
    s_waitcnt vmcnt(1)
    buffer_load_dwordx4 a[68:71], v104, s[8:11], s32 offen offset:1024
    s_waitcnt vmcnt(1)
    buffer_load_dwordx4 a[72:75], v104, s[8:11], s32 offen offset:2048
    s_waitcnt vmcnt(1)
    buffer_load_dwordx4 a[76:79], v104, s[8:11], s32 offen offset:3072
    s_add_u32 s32, s32, 4096
    s_waitcnt vmcnt(1)
    buffer_load_dwordx4 a[80:83], v104, s[8:11], s32 offen offset:0
    s_waitcnt vmcnt(1)
    buffer_load_dwordx4 a[84:87], v104, s[8:11], s32 offen offset:1024
    s_waitcnt vmcnt(1)
    buffer_load_dwordx4 a[88:91], v104, s[8:11], s32 offen offset:2048
    s_waitcnt vmcnt(1)
    buffer_load_dwordx4 a[92:95], v104, s[8:11], s32 offen offset:3072
    s_add_u32 s32, s32, 4096
    s_waitcnt vmcnt(1)
    buffer_load_dwordx4 a[96:99], v104, s[8:11], s32 offen offset:0
    s_waitcnt vmcnt(1)
    buffer_load_dwordx4 a[100:103], v104, s[8:11], s32 offen offset:1024
    s_waitcnt vmcnt(1)
    buffer_load_dwordx4 a[104:107], v104, s[8:11], s32 offen offset:2048
    s_waitcnt vmcnt(1)
    buffer_load_dwordx4 a[108:111], v104, s[8:11], s32 offen offset:3072
    s_add_u32 s32, s32, 4096
    s_waitcnt vmcnt(1)
    buffer_load_dwordx4 a[112:115], v104, s[8:11], s32 offen offset:0
    s_waitcnt vmcnt(1)
    buffer_load_dwordx4 a[116:119], v104, s[8:11], s32 offen offset:1024
    s_waitcnt vmcnt(1)
    buffer_load_dwordx4 a[120:123], v104, s[8:11], s32 offen offset:2048
    s_waitcnt vmcnt(1)
    buffer_load_dwordx4 a[124:127], v104, s[8:11], s32 offen offset:3072
    s_add_u32 s32, s32, 4096
    s_waitcnt vmcnt(1)
    buffer_load_dwordx4 a[128:131], v104, s[8:11], s32 offen offset:0
    s_waitcnt vmcnt(1)
    buffer_load_dwordx4 a[132:135], v104, s[8:11], s32 offen offset:1024
    s_waitcnt vmcnt(1)
    buffer_load_dwordx4 a[136:139], v104, s[8:11], s32 offen offset:2048
    s_waitcnt vmcnt(1)
    buffer_load_dwordx4 a[140:143], v104, s[8:11], s32 offen offset:3072
    s_add_u32 s32, s32, 4096
    s_waitcnt vmcnt(1)
    buffer_load_dwordx4 a[144:147], v104, s[8:11], s32 offen offset:0
    s_waitcnt vmcnt(1)
    buffer_load_dwordx4 a[148:151], v104, s[8:11], s32 offen offset:1024
    s_waitcnt vmcnt(1)
    buffer_load_dwordx4 a[152:155], v104, s[8:11], s32 offen offset:2048
    s_waitcnt vmcnt(1)
    buffer_load_dwordx4 a[156:159], v104, s[8:11], s32 offen offset:3072
    s_add_u32 s32, s32, 4096
    s_waitcnt vmcnt(1)
    buffer_load_dwordx4 a[160:163], v104, s[8:11], s32 offen offset:0
    s_waitcnt vmcnt(1)
    buffer_load_dwordx4 a[164:167], v104, s[8:11], s32 offen offset:1024
    s_waitcnt vmcnt(1)
    buffer_load_dwordx4 a[168:171], v104, s[8:11], s32 offen offset:2048
    s_waitcnt vmcnt(1)
    buffer_load_dwordx4 a[172:175], v104, s[8:11], s32 offen offset:3072
    s_add_u32 s32, s32, 4096
    s_waitcnt vmcnt(1)
    buffer_load_dwordx4 a[176:179], v104, s[8:11], s32 offen offset:0
    s_waitcnt vmcnt(1)
    buffer_load_dwordx4 a[180:183], v104, s[8:11], s32 offen offset:1024
    s_waitcnt vmcnt(1)
    buffer_load_dwordx4 a[184:187], v104, s[8:11], s32 offen offset:2048
    s_waitcnt vmcnt(1)
    buffer_load_dwordx4 a[188:191], v104, s[8:11], s32 offen offset:3072
    s_add_u32 s32, s32, 4096
    s_waitcnt vmcnt(1)
    buffer_load_dwordx4 a[192:195], v104, s[8:11], s32 offen offset:0
    s_waitcnt vmcnt(1)
    buffer_load_dwordx4 a[196:199], v104, s[8:11], s32 offen offset:1024
    s_waitcnt vmcnt(1)
    buffer_load_dwordx4 a[200:203], v104, s[8:11], s32 offen offset:2048
    s_waitcnt vmcnt(1)
    buffer_load_dwordx4 a[204:207], v104, s[8:11], s32 offen offset:3072
    s_add_u32 s32, s32, 4096
    s_waitcnt vmcnt(1)
    buffer_load_dwordx4 a[208:211], v104, s[8:11], s32 offen offset:0
    s_waitcnt vmcnt(1)
    buffer_load_dwordx4 a[212:215], v104, s[8:11], s32 offen offset:1024
    s_waitcnt vmcnt(1)
    buffer_load_dwordx4 a[216:219], v104, s[8:11], s32 offen offset:2048
    s_waitcnt vmcnt(1)
    buffer_load_dwordx4 a[220:223], v104, s[8:11], s32 offen offset:3072
    s_add_u32 s32, s32, 4096
    s_waitcnt vmcnt(1)
    buffer_load_dwordx4 a[224:227], v104, s[8:11], s32 offen offset:0
    s_waitcnt vmcnt(1)
    buffer_load_dwordx4 a[228:231], v104, s[8:11], s32 offen offset:1024
    s_waitcnt vmcnt(1)
    buffer_load_dwordx4 a[232:235], v104, s[8:11], s32 offen offset:2048
    s_waitcnt vmcnt(1)
    buffer_load_dwordx4 a[236:239], v104, s[8:11], s32 offen offset:3072
    s_add_u32 s32, s32, 4096
    s_waitcnt vmcnt(1)
    buffer_load_dwordx4 a[240:243], v104, s[8:11], s32 offen offset:0
    s_waitcnt vmcnt(1)
    buffer_load_dwordx4 a[244:247], v104, s[8:11], s32 offen offset:1024
    s_waitcnt vmcnt(1)
    buffer_load_dwordx4 a[248:251], v104, s[8:11], s32 offen offset:2048
    s_waitcnt vmcnt(1)
    buffer_load_dwordx4 a[252:255], v104, s[8:11], s32 offen offset:3072
    s_add_u32 s32, s32, 4096
    s_waitcnt vmcnt(1)
    buffer_load_dwordx4 v[120:123], v104, s[8:11], s32 offen offset:0
    s_waitcnt vmcnt(1)
    buffer_load_dwordx4 v[124:127], v104, s[8:11], s32 offen offset:1024
    s_waitcnt vmcnt(1)
    buffer_load_dwordx4 v[128:131], v104, s[8:11], s32 offen offset:2048
    s_waitcnt vmcnt(1)
    buffer_load_dwordx4 v[132:135], v104, s[8:11], s32 offen offset:3072
    s_add_u32 s32, s32, 4096
    s_waitcnt vmcnt(1)
    buffer_load_dwordx4 v[136:139], v104, s[8:11], s32 offen offset:0
    s_waitcnt vmcnt(1)
    buffer_load_dwordx4 v[140:143], v104, s[8:11], s32 offen offset:1024
    s_waitcnt vmcnt(1)
    buffer_load_dwordx4 v[144:147], v104, s[8:11], s32 offen offset:2048
    s_waitcnt vmcnt(1)
    buffer_load_dwordx4 v[148:151], v104, s[8:11], s32 offen offset:3072
    s_add_u32 s32, s32, 4096
    s_waitcnt vmcnt(1)
    buffer_load_dwordx4 v[152:155], v104, s[8:11], s32 offen offset:0
    s_waitcnt vmcnt(1)
    buffer_load_dwordx4 v[156:159], v104, s[8:11], s32 offen offset:1024
    s_waitcnt vmcnt(1)
    buffer_load_dwordx4 v[160:163], v104, s[8:11], s32 offen offset:2048
    s_waitcnt vmcnt(1)
    buffer_load_dwordx4 v[164:167], v104, s[8:11], s32 offen offset:3072
    s_add_u32 s32, s32, 4096
    s_waitcnt vmcnt(1)
    buffer_load_dwordx4 v[168:171], v104, s[8:11], s32 offen offset:0
    s_waitcnt vmcnt(1)
    buffer_load_dwordx4 v[172:175], v104, s[8:11], s32 offen offset:1024
    s_waitcnt vmcnt(1)
    buffer_load_dwordx4 v[176:179], v104, s[8:11], s32 offen offset:2048
    s_waitcnt vmcnt(1)
    buffer_load_dwordx4 v[180:183], v104, s[8:11], s32 offen offset:3072
    s_add_u32 s32, s32, 4096
    s_waitcnt vmcnt(1)
    buffer_load_dwordx4 v[184:187], v104, s[8:11], s32 offen offset:0
    s_waitcnt vmcnt(1)
    buffer_load_dwordx4 v[188:191], v104, s[8:11], s32 offen offset:1024
    s_waitcnt vmcnt(1)
    buffer_load_dwordx4 v[192:195], v104, s[8:11], s32 offen offset:2048
    s_waitcnt vmcnt(1)
    buffer_load_dwordx4 v[196:199], v104, s[8:11], s32 offen offset:3072
    s_add_u32 s32, s32, 4096
    s_waitcnt vmcnt(1)
    buffer_load_dwordx4 v[200:203], v104, s[8:11], s32 offen offset:0
    s_waitcnt vmcnt(1)
    buffer_load_dwordx4 v[204:207], v104, s[8:11], s32 offen offset:1024
    s_waitcnt vmcnt(1)
    buffer_load_dwordx4 v[208:211], v104, s[8:11], s32 offen offset:2048
    s_waitcnt vmcnt(1)
    buffer_load_dwordx4 v[212:215], v104, s[8:11], s32 offen offset:3072
    s_add_u32 s32, s32, 4096
    s_waitcnt vmcnt(1)
    buffer_load_dwordx4 v[216:219], v104, s[8:11], s32 offen offset:0
    s_waitcnt vmcnt(1)
    buffer_load_dwordx4 v[220:223], v104, s[8:11], s32 offen offset:1024
    s_waitcnt vmcnt(1)
    buffer_load_dwordx4 v[224:227], v104, s[8:11], s32 offen offset:2048
    s_waitcnt vmcnt(1)
    buffer_load_dwordx4 v[228:231], v104, s[8:11], s32 offen offset:3072
    s_add_u32 s32, s32, 4096
    s_waitcnt vmcnt(1)
    buffer_load_dwordx4 v[232:235], v104, s[8:11], s32 offen offset:0
    s_waitcnt vmcnt(1)
    buffer_load_dwordx4 v[236:239], v104, s[8:11], s32 offen offset:1024
    s_waitcnt vmcnt(1)
    buffer_load_dwordx4 v[240:243], v104, s[8:11], s32 offen offset:2048
    s_waitcnt vmcnt(1)
    buffer_load_dwordx4 v[244:247], v104, s[8:11], s32 offen offset:3072
    s_add_u32 s32, s32, 4096
    s_waitcnt vmcnt(1)
    buffer_load_dwordx4 v[248:251], v104, s[8:11], s32 offen offset:0
    s_waitcnt vmcnt(1)
    buffer_load_dwordx4 v[252:255], v104, s[8:11], s32 offen offset:1024
    s_waitcnt vmcnt(1)
    s_lshl_b32 s34, s12, 3
    s_lshr_b32 s32, 185009152, s34
    s_and_b32 s32, s32, 255
    s_lshr_b32 s33, 168428291, s34
    s_and_b32 s33, s33, 255
    v_add_u32 v105, 32768, v104
    s_lshl_b32 s34, s32, 10
    v_add_u32 v106, s34, v105
    s_lshl_b32 s34, s33, 10
    v_add_u32 v107, s34, v105
    v_lshrrev_b32 v7, 1, v5
    v_lshlrev_b32 v7, 8, v7
    v_and_b32 v8, 7, v6
    v_lshl_add_u32 v7, v8, 4, v7
    v_and_b32 v8, 1, v5
    v_lshl_add_u32 v7, v8, 3, v7
    s_lshl_b32 s34, s32, 9
    v_add_u32 v108, s34, v7
    v_add_u32 v109, 1024, v108
    s_lshl_b32 s34, s33, 9
    v_add_u32 v110, s34, v7
    s_lshl_b32 s32, s12, 11
    s_min_u32 s32, s32, 5120
    v_add_u32 v111, s32, v104
    v_mov_b32 v112, 7164
    s_and_b32 s36, s12, 1
    s_lshl_b32 s32, s12, 10
    v_add_u32 v113, s32, v104
    s_lshl_b32 s32, s36, 12
    v_add_u32 v114, s32, v104
    s_lshl_b32 s32, s36, 4
    v_add_u32 v7, s32, v6
    v_lshlrev_b32 v8, 2, v5
    v_sub_u32 v7, v7, v8
    v_mov_b32 v8, 0xff800000
    v_cmp_le_i32 vcc, 0, v7
    s_nop 1
    v_cndmask_b32 v96, v8, 0, vcc
    v_cmp_le_i32 vcc, 1, v7
    s_nop 1
    v_cndmask_b32 v97, v8, 0, vcc
    v_cmp_le_i32 vcc, 2, v7
    s_nop 1
    v_cndmask_b32 v98, v8, 0, vcc
    v_cmp_le_i32 vcc, 3, v7
    s_nop 1
    v_cndmask_b32 v99, v8, 0, vcc
    v_cmp_le_i32 vcc, 16, v7
    s_nop 1
    v_cndmask_b32 v100, v8, 0, vcc
    v_cmp_le_i32 vcc, 17, v7
    s_nop 1
    v_cndmask_b32 v101, v8, 0, vcc
    v_cmp_le_i32 vcc, 18, v7
    s_nop 1
    v_cndmask_b32 v102, v8, 0, vcc
    v_cmp_le_i32 vcc, 19, v7
    s_nop 1
    v_cndmask_b32 v103, v8, 0, vcc
    s_mul_i32 s32, s13, 3328
    s_mul_i32 s33, s36, 1664
    s_add_u32 s32, s32, s33
    s_lshl_b32 s33, s13, 1
    s_add_u32 s33, s33, s36
    s_lshl_b32 s33, s33, 2
    s_cmp_lt_u32 s12, 2
    s_cselect_b32 s32, s32, 1073741824
    s_cselect_b32 s33, s33, 1073741824
    v_add_u32 v115, s32, v104
    v_lshlrev_b32 v7, 3, v4
    v_add_u32 v116, s32, v7
    v_mov_b32 v2, s33
    v_lshlrev_b32 v7, 2, v6
    v_add_u32 v117, s32, v7
    v_mov_b32 v1, 1
    s_sub_u32 s20, s14, 1
    s_lshl_b32 s21, s20, 13
    s_add_u32 s21, s21, 44040192
    s_mul_i32 s22, s20, 28672
    s_mul_i32 s23, s12, 7168
    s_add_u32 s22, s22, s23
    s_add_u32 s23, s23, 32768
    s_mul_i32 s24, s20, 53248
    s_add_u32 s24, s24, 44875776
    s_lshl_b32 s25, s20, 7
    s_add_u32 s25, s25, 44695552
    s_mov_b32 s41, 28672
    s_bitcmp1_b32 s12, 0
    s_cselect_b64 s[38:39], -1, 0
    s_waitcnt vmcnt(0)
    v_and_b32 v62, 63, v0
    v_lshlrev_b32 v62, 3, v62
    s_mov_b32 s30, 44796416
L_wf_17:
    buffer_load_dwordx2 v[60:61], v62, s[8:11], s30 offen offset:0 sc1
    s_sub_u32 s26, s26, 1
    s_cbranch_scc1 L_fail
    s_waitcnt vmcnt(0)
    v_xor_b32 v61, s17, v61
    v_xor_b32 v60, s17, v60
    v_or_b32 v60, v60, v61
    v_cmp_ne_u32 vcc, 0, v60
    s_cbranch_vccz L_wfd_18
    s_sleep 4
    s_branch L_wf_17
L_wfd_18:
    s_mov_b32 m0, s23
    s_add_u32 s30, s22, 12845056
    buffer_load_dwordx4 v104, s[8:11], s30 offen offset:0 lds
    buffer_load_dwordx4 v104, s[8:11], s30 offen offset:1024 lds
    buffer_load_dwordx4 v104, s[8:11], s30 offen offset:2048 lds
    buffer_load_dwordx4 v104, s[8:11], s30 offen offset:3072 lds
    s_add_u32 m0, s23, 4096
    s_add_u32 s30, s30, 4096
    buffer_load_dwordx4 v104, s[8:11], s30 offen offset:0 lds
    buffer_load_dwordx4 v104, s[8:11], s30 offen offset:1024 lds
    buffer_load_dwordx4 v104, s[8:11], s30 offen offset:2048 lds
L_XAf_seg:
    s_waitcnt vmcnt(0)
    s_barrier
    s_add_u32 s22, s22, 86016
    s_add_u32 s23, s23, s41
    s_mov_b32 m0, s23
    s_add_u32 s30, s22, 12845056
    s_add_u32 s31, s30, 4096
    buffer_load_dwordx4 v[76:79], v115, s[8:11], s24 offen
    buffer_load_dwordx2 v[80:81], v116, s[8:11], s24 offen offset:1024
    buffer_load_dword v82, v117, s[8:11], s24 offen offset:1536
    ds_read_b128 v[60:63], v105 offset:0
    ds_read_b128 v[64:67], v105 offset:14336
    s_waitcnt lgkmcnt(0)
    v_mfma_f32_16x16x32_bf16 v[4:7], a[0:3], v[60:63], 0
    v_mfma_f32_16x16x32_bf16 v[8:11], a[0:3], v[64:67], 0
    ds_read_b128 v[68:71], v105 offset:1024
    v_mfma_f32_16x16x32_bf16 v[12:15], a[56:59], v[60:63], 0
    ds_read_b128 v[72:75], v105 offset:15360
    v_mfma_f32_16x16x32_bf16 v[16:19], a[56:59], v[64:67], 0
    v_mfma_f32_16x16x32_bf16 v[20:23], a[112:115], v[60:63], 0
    v_mfma_f32_16x16x32_bf16 v[24:27], a[112:115], v[64:67], 0
    buffer_load_dwordx4 v104, s[8:11], s30 offen offset:0 lds
    v_mfma_f32_16x16x32_bf16 v[28:31], a[168:171], v[60:63], 0
    v_mfma_f32_16x16x32_bf16 v[32:35], a[168:171], v[64:67], 0
    v_mfma_f32_16x16x32_bf16 v[36:39], a[224:227], v[60:63], 0
    v_mfma_f32_16x16x32_bf16 v[40:43], a[224:227], v[64:67], 0
    v_mfma_f32_16x16x32_bf16 v[44:47], v[144:147], v[60:63], 0
    v_mfma_f32_16x16x32_bf16 v[48:51], v[144:147], v[64:67], 0
    v_mfma_f32_16x16x32_bf16 v[52:55], v[200:203], v[60:63], 0
    v_mfma_f32_16x16x32_bf16 v[56:59], v[200:203], v[64:67], 0
    s_waitcnt lgkmcnt(0)
    v_mfma_f32_16x16x32_bf16 v[4:7], a[4:7], v[68:71], v[4:7]
    v_mfma_f32_16x16x32_bf16 v[8:11], a[4:7], v[72:75], v[8:11]
    ds_read_b128 v[60:63], v105 offset:2048
    v_mfma_f32_16x16x32_bf16 v[12:15], a[60:63], v[68:71], v[12:15]
    ds_read_b128 v[64:67], v105 offset:16384
    v_mfma_f32_16x16x32_bf16 v[16:19], a[60:63], v[72:75], v[16:19]
    v_mfma_f32_16x16x32_bf16 v[20:23], a[116:119], v[68:71], v[20:23]
    v_mfma_f32_16x16x32_bf16 v[24:27], a[116:119], v[72:75], v[24:27]
    buffer_load_dwordx4 v104, s[8:11], s30 offen offset:1024 lds
    v_mfma_f32_16x16x32_bf16 v[28:31], a[172:175], v[68:71], v[28:31]
    v_mfma_f32_16x16x32_bf16 v[32:35], a[172:175], v[72:75], v[32:35]
    v_mfma_f32_16x16x32_bf16 v[36:39], a[228:231], v[68:71], v[36:39]
    v_mfma_f32_16x16x32_bf16 v[40:43], a[228:231], v[72:75], v[40:43]
    v_mfma_f32_16x16x32_bf16 v[44:47], v[148:151], v[68:71], v[44:47]
    v_mfma_f32_16x16x32_bf16 v[48:51], v[148:151], v[72:75], v[48:51]
    v_mfma_f32_16x16x32_bf16 v[52:55], v[204:207], v[68:71], v[52:55]
    v_mfma_f32_16x16x32_bf16 v[56:59], v[204:207], v[72:75], v[56:59]
    s_waitcnt lgkmcnt(0)
    v_mfma_f32_16x16x32_bf16 v[4:7], a[8:11], v[60:63], v[4:7]
    v_mfma_f32_16x16x32_bf16 v[8:11], a[8:11], v[64:67], v[8:11]
    ds_read_b128 v[68:71], v105 offset:3072
    v_mfma_f32_16x16x32_bf16 v[12:15], a[64:67], v[60:63], v[12:15]
    ds_read_b128 v[72:75], v105 offset:17408
    v_mfma_f32_16x16x32_bf16 v[16:19], a[64:67], v[64:67], v[16:19]
    v_mfma_f32_16x16x32_bf16 v[20:23], a[120:123], v[60:63], v[20:23]
    v_mfma_f32_16x16x32_bf16 v[24:27], a[120:123], v[64:67], v[24:27]
    buffer_load_dwordx4 v104, s[8:11], s30 offen offset:2048 lds
    v_mfma_f32_16x16x32_bf16 v[28:31], a[176:179], v[60:63], v[28:31]
    v_mfma_f32_16x16x32_bf16 v[32:35], a[176:179], v[64:67], v[32:35]
    v_mfma_f32_16x16x32_bf16 v[36:39], a[232:235], v[60:63], v[36:39]
    v_mfma_f32_16x16x32_bf16 v[40:43], a[232:235], v[64:67], v[40:43]
    v_mfma_f32_16x16x32_bf16 v[44:47], v[152:155], v[60:63], v[44:47]
    v_mfma_f32_16x16x32_bf16 v[48:51], v[152:155], v[64:67], v[48:51]
    v_mfma_f32_16x16x32_bf16 v[52:55], v[208:211], v[60:63], v[52:55]
    v_mfma_f32_16x16x32_bf16 v[56:59], v[208:211], v[64:67], v[56:59]
    s_waitcnt lgkmcnt(0)
    v_mfma_f32_16x16x32_bf16 v[4:7], a[12:15], v[68:71], v[4:7]
    v_mfma_f32_16x16x32_bf16 v[8:11], a[12:15], v[72:75], v[8:11]
    ds_read_b128 v[60:63], v105 offset:4096
    v_mfma_f32_16x16x32_bf16 v[12:15], a[68:71], v[68:71], v[12:15]
    ds_read_b128 v[64:67], v105 offset:18432
    v_mfma_f32_16x16x32_bf16 v[16:19], a[68:71], v[72:75], v[16:19]
    v_mfma_f32_16x16x32_bf16 v[20:23], a[124:127], v[68:71], v[20:23]
    v_mfma_f32_16x16x32_bf16 v[24:27], a[124:127], v[72:75], v[24:27]
    buffer_load_dwordx4 v104, s[8:11], s30 offen offset:3072 lds
    v_mfma_f32_16x16x32_bf16 v[28:31], a[180:183], v[68:71], v[28:31]
    v_mfma_f32_16x16x32_bf16 v[32:35], a[180:183], v[72:75], v[32:35]
    v_mfma_f32_16x16x32_bf16 v[36:39], a[236:239], v[68:71], v[36:39]
    s_add_u32 m0, s23, 4096
    v_mfma_f32_16x16x32_bf16 v[40:43], a[236:239], v[72:75], v[40:43]
    v_mfma_f32_16x16x32_bf16 v[44:47], v[156:159], v[68:71], v[44:47]
    v_mfma_f32_16x16x32_bf16 v[48:51], v[156:159], v[72:75], v[48:51]
    v_mfma_f32_16x16x32_bf16 v[52:55], v[212:215], v[68:71], v[52:55]
    v_mfma_f32_16x16x32_bf16 v[56:59], v[212:215], v[72:75], v[56:59]
    s_waitcnt lgkmcnt(0)
    v_mfma_f32_16x16x32_bf16 v[4:7], a[16:19], v[60:63], v[4:7]
    v_mfma_f32_16x16x32_bf16 v[8:11], a[16:19], v[64:67], v[8:11]
    ds_read_b128 v[68:71], v105 offset:5120
    v_mfma_f32_16x16x32_bf16 v[12:15], a[72:75], v[60:63], v[12:15]
    ds_read_b128 v[72:75], v105 offset:19456
    v_mfma_f32_16x16x32_bf16 v[16:19], a[72:75], v[64:67], v[16:19]
    v_mfma_f32_16x16x32_bf16 v[20:23], a[128:131], v[60:63], v[20:23]
    v_mfma_f32_16x16x32_bf16 v[24:27], a[128:131], v[64:67], v[24:27]
    buffer_load_dwordx4 v104, s[8:11], s31 offen offset:0 lds
    v_mfma_f32_16x16x32_bf16 v[28:31], a[184:187], v[60:63], v[28:31]
    v_mfma_f32_16x16x32_bf16 v[32:35], a[184:187], v[64:67], v[32:35]
    v_mfma_f32_16x16x32_bf16 v[36:39], a[240:243], v[60:63], v[36:39]
    v_mfma_f32_16x16x32_bf16 v[40:43], a[240:243], v[64:67], v[40:43]
    v_mfma_f32_16x16x32_bf16 v[44:47], v[160:163], v[60:63], v[44:47]
    v_mfma_f32_16x16x32_bf16 v[48:51], v[160:163], v[64:67], v[48:51]
    v_mfma_f32_16x16x32_bf16 v[52:55], v[216:219], v[60:63], v[52:55]
    v_mfma_f32_16x16x32_bf16 v[56:59], v[216:219], v[64:67], v[56:59]
    s_waitcnt lgkmcnt(0)
    v_mfma_f32_16x16x32_bf16 v[4:7], a[20:23], v[68:71], v[4:7]
    v_mfma_f32_16x16x32_bf16 v[8:11], a[20:23], v[72:75], v[8:11]
    ds_read_b128 v[60:63], v105 offset:6144
    v_mfma_f32_16x16x32_bf16 v[12:15], a[76:79], v[68:71], v[12:15]
    ds_read_b128 v[64:67], v105 offset:20480
    v_mfma_f32_16x16x32_bf16 v[16:19], a[76:79], v[72:75], v[16:19]
    v_mfma_f32_16x16x32_bf16 v[20:23], a[132:135], v[68:71], v[20:23]
    v_mfma_f32_16x16x32_bf16 v[24:27], a[132:135], v[72:75], v[24:27]
    buffer_load_dwordx4 v104, s[8:11], s31 offen offset:1024 lds
    v_mfma_f32_16x16x32_bf16 v[28:31], a[188:191], v[68:71], v[28:31]
    v_mfma_f32_16x16x32_bf16 v[32:35], a[188:191], v[72:75], v[32:35]
    v_mfma_f32_16x16x32_bf16 v[36:39], a[244:247], v[68:71], v[36:39]
    v_mfma_f32_16x16x32_bf16 v[40:43], a[244:247], v[72:75], v[40:43]
    v_mfma_f32_16x16x32_bf16 v[44:47], v[164:167], v[68:71], v[44:47]
    v_mfma_f32_16x16x32_bf16 v[48:51], v[164:167], v[72:75], v[48:51]
    v_mfma_f32_16x16x32_bf16 v[52:55], v[220:223], v[68:71], v[52:55]
    v_mfma_f32_16x16x32_bf16 v[56:59], v[220:223], v[72:75], v[56:59]
    s_waitcnt lgkmcnt(0)
    v_mfma_f32_16x16x32_bf16 v[4:7], a[24:27], v[60:63], v[4:7]
    v_mfma_f32_16x16x32_bf16 v[8:11], a[24:27], v[64:67], v[8:11]
    ds_read_b128 v[68:71], v105 offset:7168
    v_mfma_f32_16x16x32_bf16 v[12:15], a[80:83], v[60:63], v[12:15]
    ds_read_b128 v[72:75], v105 offset:21504
    v_mfma_f32_16x16x32_bf16 v[16:19], a[80:83], v[64:67], v[16:19]
    v_mfma_f32_16x16x32_bf16 v[20:23], a[136:139], v[60:63], v[20:23]
    v_mfma_f32_16x16x32_bf16 v[24:27], a[136:139], v[64:67], v[24:27]
    buffer_load_dwordx4 v104, s[8:11], s31 offen offset:2048 lds
    v_mfma_f32_16x16x32_bf16 v[28:31], a[192:195], v[60:63], v[28:31]
    v_mfma_f32_16x16x32_bf16 v[32:35], a[192:195], v[64:67], v[32:35]
    v_mfma_f32_16x16x32_bf16 v[36:39], a[248:251], v[60:63], v[36:39]
    v_mfma_f32_16x16x32_bf16 v[40:43], a[248:251], v[64:67], v[40:43]
    v_mfma_f32_16x16x32_bf16 v[44:47], v[168:171], v[60:63], v[44:47]
    v_mfma_f32_16x16x32_bf16 v[48:51], v[168:171], v[64:67], v[48:51]
    v_mfma_f32_16x16x32_bf16 v[52:55], v[224:227], v[60:63], v[52:55]
    v_mfma_f32_16x16x32_bf16 v[56:59], v[224:227], v[64:67], v[56:59]
    s_waitcnt lgkmcnt(0)
    v_mfma_f32_16x16x32_bf16 v[4:7], a[28:31], v[68:71], v[4:7]
    v_mfma_f32_16x16x32_bf16 v[8:11], a[28:31], v[72:75], v[8:11]
    ds_read_b128 v[60:63], v105 offset:8192
    v_mfma_f32_16x16x32_bf16 v[12:15], a[84:87], v[68:71], v[12:15]
    ds_read_b128 v[64:67], v105 offset:22528
    v_mfma_f32_16x16x32_bf16 v[16:19], a[84:87], v[72:75], v[16:19]
    v_mfma_f32_16x16x32_bf16 v[20:23], a[140:143], v[68:71], v[20:23]
    v_mfma_f32_16x16x32_bf16 v[24:27], a[140:143], v[72:75], v[24:27]
    v_mfma_f32_16x16x32_bf16 v[28:31], a[196:199], v[68:71], v[28:31]
    v_mfma_f32_16x16x32_bf16 v[32:35], a[196:199], v[72:75], v[32:35]
    v_mfma_f32_16x16x32_bf16 v[36:39], a[252:255], v[68:71], v[36:39]
    v_mfma_f32_16x16x32_bf16 v[40:43], a[252:255], v[72:75], v[40:43]
    v_mfma_f32_16x16x32_bf16 v[44:47], v[172:175], v[68:71], v[44:47]
    v_mfma_f32_16x16x32_bf16 v[48:51], v[172:175], v[72:75], v[48:51]
    v_mfma_f32_16x16x32_bf16 v[52:55], v[228:231], v[68:71], v[52:55]
    v_mfma_f32_16x16x32_bf16 v[56:59], v[228:231], v[72:75], v[56:59]
    s_waitcnt lgkmcnt(0)
    v_mfma_f32_16x16x32_bf16 v[4:7], a[32:35], v[60:63], v[4:7]
    v_mfma_f32_16x16x32_bf16 v[8:11], a[32:35], v[64:67], v[8:11]
    ds_read_b128 v[68:71], v105 offset:9216
    v_mfma_f32_16x16x32_bf16 v[12:15], a[88:91], v[60:63], v[12:15]
    ds_read_b128 v[72:75], v105 offset:23552
    v_mfma_f32_16x16x32_bf16 v[16:19], a[88:91], v[64:67], v[16:19]
    v_mfma_f32_16x16x32_bf16 v[20:23], a[144:147], v[60:63], v[20:23]
    v_mfma_f32_16x16x32_bf16 v[24:27], a[144:147], v[64:67], v[24:27]
    v_mfma_f32_16x16x32_bf16 v[28:31], a[200:203], v[60:63], v[28:31]
    v_mfma_f32_16x16x32_bf16 v[32:35], a[200:203], v[64:67], v[32:35]
    v_mfma_f32_16x16x32_bf16 v[36:39], v[120:123], v[60:63], v[36:39]
    v_mfma_f32_16x16x32_bf16 v[40:43], v[120:123], v[64:67], v[40:43]
    v_mfma_f32_16x16x32_bf16 v[44:47], v[176:179], v[60:63], v[44:47]
    v_mfma_f32_16x16x32_bf16 v[48:51], v[176:179], v[64:67], v[48:51]
    v_mfma_f32_16x16x32_bf16 v[52:55], v[232:235], v[60:63], v[52:55]
    v_mfma_f32_16x16x32_bf16 v[56:59], v[232:235], v[64:67], v[56:59]
    s_waitcnt lgkmcnt(0)
    v_mfma_f32_16x16x32_bf16 v[4:7], a[36:39], v[68:71], v[4:7]
    v_mfma_f32_16x16x32_bf16 v[8:11], a[36:39], v[72:75], v[8:11]
    ds_read_b128 v[60:63], v105 offset:10240
    v_mfma_f32_16x16x32_bf16 v[12:15], a[92:95], v[68:71], v[12:15]
    ds_read_b128 v[64:67], v105 offset:24576
    v_mfma_f32_16x16x32_bf16 v[16:19], a[92:95], v[72:75], v[16:19]
    v_mfma_f32_16x16x32_bf16 v[20:23], a[148:151], v[68:71], v[20:23]
    v_mfma_f32_16x16x32_bf16 v[24:27], a[148:151], v[72:75], v[24:27]
    v_mfma_f32_16x16x32_bf16 v[28:31], a[204:207], v[68:71], v[28:31]
    v_mfma_f32_16x16x32_bf16 v[32:35], a[204:207], v[72:75], v[32:35]
    v_mfma_f32_16x16x32_bf16 v[36:39], v[124:127], v[68:71], v[36:39]
    v_mfma_f32_16x16x32_bf16 v[40:43], v[124:127], v[72:75], v[40:43]
    v_mfma_f32_16x16x32_bf16 v[44:47], v[180:183], v[68:71], v[44:47]
    v_mfma_f32_16x16x32_bf16 v[48:51], v[180:183], v[72:75], v[48:51]
    v_mfma_f32_16x16x32_bf16 v[52:55], v[236:239], v[68:71], v[52:55]
    v_mfma_f32_16x16x32_bf16 v[56:59], v[236:239], v[72:75], v[56:59]
    s_waitcnt lgkmcnt(0)
    v_mfma_f32_16x16x32_bf16 v[4:7], a[40:43], v[60:63], v[4:7]
    v_mfma_f32_16x16x32_bf16 v[8:11], a[40:43], v[64:67], v[8:11]
    ds_read_b128 v[68:71], v105 offset:11264
    v_mfma_f32_16x16x32_bf16 v[12:15], a[96:99], v[60:63], v[12:15]
    ds_read_b128 v[72:75], v105 offset:25600
    v_mfma_f32_16x16x32_bf16 v[16:19], a[96:99], v[64:67], v[16:19]
    v_mfma_f32_16x16x32_bf16 v[20:23], a[152:155], v[60:63], v[20:23]
    v_mfma_f32_16x16x32_bf16 v[24:27], a[152:155], v[64:67], v[24:27]
    v_mfma_f32_16x16x32_bf16 v[28:31], a[208:211], v[60:63], v[28:31]
    v_mfma_f32_16x16x32_bf16 v[32:35], a[208:211], v[64:67], v[32:35]
    v_mfma_f32_16x16x32_bf16 v[36:39], v[128:131], v[60:63], v[36:39]
    v_mfma_f32_16x16x32_bf16 v[40:43], v[128:131], v[64:67], v[40:43]
    v_mfma_f32_16x16x32_bf16 v[44:47], v[184:187], v[60:63], v[44:47]
    v_mfma_f32_16x16x32_bf16 v[48:51], v[184:187], v[64:67], v[48:51]
    v_mfma_f32_16x16x32_bf16 v[52:55], v[240:243], v[60:63], v[52:55]
    v_mfma_f32_16x16x32_bf16 v[56:59], v[240:243], v[64:67], v[56:59]
    s_waitcnt lgkmcnt(0)
    v_mfma_f32_16x16x32_bf16 v[4:7], a[44:47], v[68:71], v[4:7]
    v_mfma_f32_16x16x32_bf16 v[8:11], a[44:47], v[72:75], v[8:11]
    ds_read_b128 v[60:63], v105 offset:12288
    v_mfma_f32_16x16x32_bf16 v[12:15], a[100:103], v[68:71], v[12:15]
    ds_read_b128 v[64:67], v105 offset:26624
    v_mfma_f32_16x16x32_bf16 v[16:19], a[100:103], v[72:75], v[16:19]
    v_mfma_f32_16x16x32_bf16 v[20:23], a[156:159], v[68:71], v[20:23]
    v_mfma_f32_16x16x32_bf16 v[24:27], a[156:159], v[72:75], v[24:27]
    v_mfma_f32_16x16x32_bf16 v[28:31], a[212:215], v[68:71], v[28:31]
    v_mfma_f32_16x16x32_bf16 v[32:35], a[212:215], v[72:75], v[32:35]
    v_mfma_f32_16x16x32_bf16 v[36:39], v[132:135], v[68:71], v[36:39]
    v_mfma_f32_16x16x32_bf16 v[40:43], v[132:135], v[72:75], v[40:43]
    v_mfma_f32_16x16x32_bf16 v[44:47], v[188:191], v[68:71], v[44:47]
    v_mfma_f32_16x16x32_bf16 v[48:51], v[188:191], v[72:75], v[48:51]
    v_mfma_f32_16x16x32_bf16 v[52:55], v[244:247], v[68:71], v[52:55]
    v_mfma_f32_16x16x32_bf16 v[56:59], v[244:247], v[72:75], v[56:59]
    s_waitcnt lgkmcnt(0)
    v_mfma_f32_16x16x32_bf16 v[4:7], a[48:51], v[60:63], v[4:7]
    v_mfma_f32_16x16x32_bf16 v[8:11], a[48:51], v[64:67], v[8:11]
    ds_read_b128 v[68:71], v105 offset:13312
    v_mfma_f32_16x16x32_bf16 v[12:15], a[104:107], v[60:63], v[12:15]
    ds_read_b128 v[72:75], v105 offset:27648
    v_mfma_f32_16x16x32_bf16 v[16:19], a[104:107], v[64:67], v[16:19]
    v_mfma_f32_16x16x32_bf16 v[20:23], a[160:163], v[60:63], v[20:23]
    v_mfma_f32_16x16x32_bf16 v[24:27], a[160:163], v[64:67], v[24:27]
    v_mfma_f32_16x16x32_bf16 v[28:31], a[216:219], v[60:63], v[28:31]
    v_mfma_f32_16x16x32_bf16 v[32:35], a[216:219], v[64:67], v[32:35]
    v_mfma_f32_16x16x32_bf16 v[36:39], v[136:139], v[60:63], v[36:39]
    v_mfma_f32_16x16x32_bf16 v[40:43], v[136:139], v[64:67], v[40:43]
    v_mfma_f32_16x16x32_bf16 v[44:47], v[192:195], v[60:63], v[44:47]
    v_mfma_f32_16x16x32_bf16 v[48:51], v[192:195], v[64:67], v[48:51]
    v_mfma_f32_16x16x32_bf16 v[52:55], v[248:251], v[60:63], v[52:55]
    v_mfma_f32_16x16x32_bf16 v[56:59], v[248:251], v[64:67], v[56:59]
    s_waitcnt lgkmcnt(0)
    v_mfma_f32_16x16x32_bf16 v[4:7], a[52:55], v[68:71], v[4:7]
    v_mfma_f32_16x16x32_bf16 v[8:11], a[52:55], v[72:75], v[8:11]
    v_mfma_f32_16x16x32_bf16 v[12:15], a[108:111], v[68:71], v[12:15]
    v_mfma_f32_16x16x32_bf16 v[16:19], a[108:111], v[72:75], v[16:19]
    v_mfma_f32_16x16x32_bf16 v[20:23], a[164:167], v[68:71], v[20:23]
    v_mfma_f32_16x16x32_bf16 v[24:27], a[164:167], v[72:75], v[24:27]
    v_mfma_f32_16x16x32_bf16 v[28:31], a[220:223], v[68:71], v[28:31]
    v_mfma_f32_16x16x32_bf16 v[32:35], a[220:223], v[72:75], v[32:35]
    v_mfma_f32_16x16x32_bf16 v[36:39], v[140:143], v[68:71], v[36:39]
    v_mfma_f32_16x16x32_bf16 v[40:43], v[140:143], v[72:75], v[40:43]
    v_mfma_f32_16x16x32_bf16 v[44:47], v[196:199], v[68:71], v[44:47]
    v_mfma_f32_16x16x32_bf16 v[48:51], v[196:199], v[72:75], v[48:51]
    v_mfma_f32_16x16x32_bf16 v[52:55], v[252:255], v[68:71], v[52:55]
    v_mfma_f32_16x16x32_bf16 v[56:59], v[252:255], v[72:75], v[56:59]
    ds_read_b128 v[60:63], v106 offset:0
    ds_read_b128 v[64:67], v106 offset:14336
    ds_read_b128 v[68:71], v106 offset:1024
    ds_read_b128 v[72:75], v106 offset:15360
    v_cvt_pk_bf16_f32 v4, v4, v5
    v_cvt_pk_bf16_f32 v5, v12, v13
    v_cvt_pk_bf16_f32 v6, v6, v7
    v_cvt_pk_bf16_f32 v7, v14, v15
    v_cvt_pk_bf16_f32 v8, v8, v9
    v_cvt_pk_bf16_f32 v9, v16, v17
    v_cvt_pk_bf16_f32 v10, v10, v11
    v_cvt_pk_bf16_f32 v11, v18, v19
    v_cvt_pk_bf16_f32 v20, v20, v21
    v_cvt_pk_bf16_f32 v21, v28, v29
    v_cvt_pk_bf16_f32 v22, v22, v23
    v_cvt_pk_bf16_f32 v23, v30, v31
    v_cvt_pk_bf16_f32 v24, v24, v25
    v_cvt_pk_bf16_f32 v25, v32, v33
    v_cvt_pk_bf16_f32 v26, v26, v27
    v_cvt_pk_bf16_f32 v27, v34, v35
    v_cvt_pk_bf16_f32 v36, v36, v37
    v_cvt_pk_bf16_f32 v37, v44, v45
    v_cvt_pk_bf16_f32 v38, v38, v39
    v_cvt_pk_bf16_f32 v39, v46, v47
    v_cvt_pk_bf16_f32 v40, v40, v41
    v_cvt_pk_bf16_f32 v41, v48, v49
    v_cvt_pk_bf16_f32 v42, v42, v43
    v_cvt_pk_bf16_f32 v43, v50, v51
    v_cvt_pk_bf16_f32 v12, v52, v53
    v_cvt_pk_bf16_f32 v13, v54, v55
    v_cndmask_b32 v52, v12, 0, s[38:39]
    v_cndmask_b32 v53, 0, v12, s[38:39]
    v_cndmask_b32 v54, v13, 0, s[38:39]
    v_cndmask_b32 v55, 0, v13, s[38:39]
    v_cvt_pk_bf16_f32 v12, v56, v57
    v_cvt_pk_bf16_f32 v13, v58, v59
    v_cndmask_b32 v56, v12, 0, s[38:39]
    v_cndmask_b32 v57, 0, v12, s[38:39]
    v_cndmask_b32 v58, v13, 0, s[38:39]
    v_cndmask_b32 v59, 0, v13, s[38:39]
    s_waitcnt vmcnt(7)
    s_waitcnt lgkmcnt(2)
    v_mfma_f32_16x16x32_bf16 v[76:79], v[60:63], v[4:7], 0
    v_mfma_f32_16x16x32_bf16 v[80:83], v[60:63], v[8:11], 0
    v_mfma_f32_16x16x32_bf16 v[84:87], v[64:67], v[8:11], 0
    ds_read_b128 v[60:63], v106 offset:2048
    ds_read_b128 v[64:67], v106 offset:16384
    s_waitcnt lgkmcnt(2)
    v_mfma_f32_16x16x32_bf16 v[76:79], v[68:71], v[20:23], v[76:79]
    v_mfma_f32_16x16x32_bf16 v[80:83], v[68:71], v[24:27], v[80:83]
    v_mfma_f32_16x16x32_bf16 v[84:87], v[72:75], v[24:27], v[84:87]
    ds_read_b128 v[68:71], v107 offset:0
    ds_read_b128 v[72:75], v107 offset:14336
    s_waitcnt lgkmcnt(2)
    v_mfma_f32_16x16x32_bf16 v[76:79], v[60:63], v[36:39], v[76:79]
    v_mfma_f32_16x16x32_bf16 v[80:83], v[60:63], v[40:43], v[80:83]
    v_mfma_f32_16x16x32_bf16 v[84:87], v[64:67], v[40:43], v[84:87]
    s_waitcnt lgkmcnt(0)
    v_mfma_f32_16x16x32_bf16 v[76:79], v[68:71], v[52:55], v[76:79]
    v_mfma_f32_16x16x32_bf16 v[80:83], v[68:71], v[56:59], v[80:83]
    v_mfma_f32_16x16x32_bf16 v[84:87], v[72:75], v[56:59], v[84:87]
    s_nop 5
    ds_write_b128 v113, v[76:79] offset:8192
    ds_write_b128 v113, v[80:83] offset:12288
    ds_write_b128 v113, v[84:87] offset:16384
    s_waitcnt lgkmcnt(0)
    s_barrier
    ds_read_b128 v[12:15], v114 offset:8192
    ds_read_b128 v[16:19], v114 offset:9216
    ds_read_b128 v[28:31], v114 offset:10240
    ds_read_b128 v[32:35], v114 offset:11264
    s_waitcnt lgkmcnt(3)
    v_pk_add_f32 v[88:89], v[12:13], v[96:97]
    v_pk_add_f32 v[90:91], v[14:15], v[98:99]
    s_waitcnt lgkmcnt(2)
    v_pk_add_f32 v[88:89], v[16:17], v[88:89]
    v_pk_add_f32 v[90:91], v[18:19], v[90:91]
    s_waitcnt lgkmcnt(1)
    v_pk_add_f32 v[88:89], v[28:29], v[88:89]
    v_pk_add_f32 v[90:91], v[30:31], v[90:91]
    s_waitcnt lgkmcnt(0)
    v_pk_add_f32 v[88:89], v[32:33], v[88:89]
    v_pk_add_f32 v[90:91], v[34:35], v[90:91]
    ds_read_b128 v[12:15], v104 offset:16384
    ds_read_b128 v[16:19], v104 offset:17408
    ds_read_b128 v[28:31], v104 offset:18432
    ds_read_b128 v[32:35], v104 offset:19456
    s_waitcnt lgkmcnt(3)
    v_pk_add_f32 v[92:93], v[12:13], v[100:101]
    v_pk_add_f32 v[94:95], v[14:15], v[102:103]
    s_waitcnt lgkmcnt(2)
    v_pk_add_f32 v[92:93], v[16:17], v[92:93]
    v_pk_add_f32 v[94:95], v[18:19], v[94:95]
    s_waitcnt lgkmcnt(1)
    v_pk_add_f32 v[92:93], v[28:29], v[92:93]
    v_pk_add_f32 v[94:95], v[30:31], v[94:95]
    s_waitcnt lgkmcnt(0)
    v_pk_add_f32 v[92:93], v[32:33], v[92:93]
    v_pk_add_f32 v[94:95], v[34:35], v[94:95]
    s_sub_u32 s29, s21, 8192
    buffer_load_dword v62, v112, s[8:11], s29 offen sc1
    buffer_load_dwordx4 v[44:47], v111, s[8:11], s21 offen sc1
    buffer_load_dwordx4 v[48:51], v111, s[8:11], s21 offen offset:1024 sc1
    v_max3_f32 v84, v88, v89, v90
    v_max3_f32 v84, v84, v91, v92
    v_max3_f32 v84, v84, v93, v94
    v_max_f32 v84, v84, v95
    v_mov_b32 v85, v84
    s_nop 1
    v_permlane16_swap_b32 v84, v85
    v_max_f32 v84, v84, v85
    v_mov_b32 v85, v84
    s_nop 1
    v_permlane32_swap_b32 v84, v85
    v_max_f32 v84, v84, v85
    v_pk_add_f32 v[88:89], v[88:89], v[84:85] op_sel_hi:[1,0] neg_lo:[0,1] neg_hi:[0,1]
    v_pk_add_f32 v[90:91], v[90:91], v[84:85] op_sel_hi:[1,0] neg_lo:[0,1] neg_hi:[0,1]
    v_pk_add_f32 v[92:93], v[92:93], v[84:85] op_sel_hi:[1,0] neg_lo:[0,1] neg_hi:[0,1]
    v_pk_add_f32 v[94:95], v[94:95], v[84:85] op_sel_hi:[1,0] neg_lo:[0,1] neg_hi:[0,1]
    v_exp_f32 v88, v88
    v_exp_f32 v89, v89
    v_exp_f32 v90, v90
    v_exp_f32 v91, v91
    v_exp_f32 v92, v92
    v_exp_f32 v93, v93
    v_exp_f32 v94, v94
    v_exp_f32 v95, v95
    v_pk_add_f32 v[12:13], v[88:89], v[90:91]
    v_pk_add_f32 v[14:15], v[92:93], v[94:95]
    v_pk_add_f32 v[12:13], v[12:13], v[14:15]
    v_add_f32 v86, v12, v13
    v_cvt_pk_bf16_f32 v88, v88, v89
    v_cvt_pk_bf16_f32 v89, v90, v91
    v_cvt_pk_bf16_f32 v90, v92, v93
    v_cvt_pk_bf16_f32 v91, v94, v95
    buffer_store_dwordx4 v[88:91], v115, s[8:11], s24 offen
    v_mov_b32 v87, v86
    s_nop 1
    v_permlane16_swap_b32 v86, v87
    v_add_f32 v86, v86, v87
    v_mov_b32 v87, v86
    s_nop 1
    v_permlane32_swap_b32 v86, v87
    v_add_f32 v86, v86, v87
    s_add_u32 s32, s25, 8192
    s_waitcnt vmcnt(0)
    buffer_store_dword v1, v2, s[8:11], s32 offen
    v_add_u32 v105, s41, v105
    v_add_u32 v106, s41, v106
    v_add_u32 v107, s41, v107
    s_sub_u32 s41, 0, s41
    s_waitcnt vmcnt(0)
    v_pk_max_u16 v60, v44, v45
    v_pk_max_u16 v60, v60, v46
    v_pk_max_u16 v60, v60, v47
    v_pk_max_u16 v60, v60, v48
    v_pk_max_u16 v60, v60, v49
    v_pk_max_u16 v60, v60, v50
    v_pk_max_u16 v60, v60, v51
    v_lshlrev_b32 v61, 16, v60
    v_max_u32 v60, v60, v61
    v_cmp_le_u32 vcc, 0xffff0000, v60
    s_cbranch_vccz L_XAf_m_p_ok0
    v_cmp_eq_u32 vcc, -1, v62
    s_cbranch_vccz L_XAf_m_go
L_XAf_m_tr:
    s_sleep 4
    buffer_load_dword v60, v112, s[8:11], s29 offen sc1
    s_sub_u32 s26, s26, 1
    s_cbranch_scc1 L_fail
    s_waitcnt vmcnt(0)
    v_cmp_eq_u32 vcc, -1, v60
    s_cbranch_vccnz L_XAf_m_tr
    s_sleep 24
L_XAf_m_go:
L_XAf_m_p_loop:
    buffer_load_dwordx4 v[44:47], v111, s[8:11], s21 offen offset:0 sc1
    buffer_load_dwordx4 v[48:51], v111, s[8:11], s21 offen offset:1024 sc1
    s_sub_u32 s26, s26, 1
    s_cbranch_scc1 L_fail
    s_waitcnt vmcnt(0)
    v_pk_max_u16 v60, v44, v45
    v_pk_max_u16 v60, v60, v46
    v_pk_max_u16 v60, v60, v47
    v_pk_max_u16 v60, v60, v48
    v_pk_max_u16 v60, v60, v49
    v_pk_max_u16 v60, v60, v50
    v_pk_max_u16 v60, v60, v51
    v_lshlrev_b32 v61, 16, v60
    v_max_u32 v60, v60, v61
    v_cmp_le_u32 vcc, 0xffff0000, v60
    s_cbranch_vccnz L_XAf_m_p_loop
L_XAf_m_p_ok0:
    ds_write_b128 v111, v[44:47]
    ds_write_b128 v111, v[48:51] offset:1024
L_XAf_m_p_done:
    s_waitcnt lgkmcnt(0)
    s_barrier
    ds_read2_b32 v[60:61], v108 offset0:0 offset1:32
    ds_read2_b32 v[62:63], v108 offset0:1 offset1:33
    ds_read2_b32 v[64:65], v108 offset0:128 offset1:160
    ds_read2_b32 v[66:67], v108 offset0:129 offset1:161
    ds_read2_b32 v[68:69], v109 offset0:0 offset1:32
    ds_read2_b32 v[70:71], v109 offset0:1 offset1:33
    ds_read2_b32 v[72:73], v110 offset0:0 offset1:32
    ds_read2_b32 v[74:75], v110 offset0:1 offset1:33
    s_waitcnt lgkmcnt(6)
    v_mfma_f32_16x16x32_bf16 v[76:79], v[60:63], v[4:7], 0
    v_mfma_f32_16x16x32_bf16 v[80:83], v[60:63], v[8:11], 0
    s_waitcnt lgkmcnt(4)
    v_mfma_f32_16x16x32_bf16 v[76:79], v[64:67], v[20:23], v[76:79]
    v_mfma_f32_16x16x32_bf16 v[80:83], v[64:67], v[24:27], v[80:83]
    s_waitcnt lgkmcnt(2)
    v_mfma_f32_16x16x32_bf16 v[76:79], v[68:71], v[36:39], v[76:79]
    v_mfma_f32_16x16x32_bf16 v[80:83], v[68:71], v[40:43], v[80:83]
    s_waitcnt lgkmcnt(0)
    v_mfma_f32_16x16x32_bf16 v[76:79], v[72:75], v[52:55], v[76:79]
    v_mfma_f32_16x16x32_bf16 v[80:83], v[72:75], v[56:59], v[80:83]
    s_nop 6
    ds_write_b128 v113, v[76:79] offset:20480
    ds_write_b128 v113, v[80:83] offset:24576
    s_waitcnt lgkmcnt(0)
    s_barrier
    s_waitcnt vmcnt(0)
    ds_read_b128 v[12:15], v114 offset:20480
    ds_read_b128 v[16:19], v114 offset:21504
    ds_read_b128 v[28:31], v114 offset:22528
    ds_read_b128 v[32:35], v114 offset:23552
    s_waitcnt lgkmcnt(2)
    v_pk_add_f32 v[76:77], v[12:13], v[16:17]
    v_pk_add_f32 v[78:79], v[14:15], v[18:19]
    s_waitcnt lgkmcnt(0)
    v_pk_add_f32 v[28:29], v[28:29], v[32:33]
    v_pk_add_f32 v[30:31], v[30:31], v[34:35]
    v_pk_add_f32 v[76:77], v[76:77], v[28:29]
    v_pk_add_f32 v[78:79], v[78:79], v[30:31]
    v_max3_f32 v92, v84, v76, v77
    v_max3_f32 v92, v92, v78, v79
    v_mov_b32 v93, v92
    s_nop 1
    v_permlane16_swap_b32 v92, v93
    v_max_f32 v92, v92, v93
    v_pk_add_f32 v[76:77], v[76:77], v[92:93] op_sel_hi:[1,0] neg_lo:[0,1] neg_hi:[0,1]
    v_pk_add_f32 v[78:79], v[78:79], v[92:93] op_sel_hi:[1,0] neg_lo:[0,1] neg_hi:[0,1]
    v_sub_f32 v94, v84, v92
    v_exp_f32 v76, v76
    v_exp_f32 v77, v77
    v_exp_f32 v78, v78
    v_exp_f32 v79, v79
    v_exp_f32 v94, v94
    v_pk_add_f32 v[12:13], v[76:77], v[78:79]
    v_add_f32 v12, v12, v13
    v_mov_b32 v13, v12
    s_nop 1
    v_permlane16_swap_b32 v12, v13
    v_add_f32 v12, v12, v13
    v_fmac_f32 v12, v94, v86
    v_rcp_f32 v12, v12
    s_nop 0
    v_pk_mul_f32 v[76:77], v[76:77], v[12:13] op_sel_hi:[1,0]
    v_pk_mul_f32 v[78:79], v[78:79], v[12:13] op_sel_hi:[1,0]
    v_mul_f32 v94, v94, v12
    v_cvt_pk_bf16_f32 v76, v76, v77
    v_cvt_pk_bf16_f32 v77, v78, v79
    buffer_store_dwordx2 v[76:77], v116, s[8:11], s24 offen offset:1024
    buffer_store_dword v94, v117, s[8:11], s24 offen offset:1536
    s_waitcnt vmcnt(0)
    buffer_store_dword v1, v2, s[8:11], s25 offen
    s_add_u32 s20, s20, 3
    s_add_u32 s21, s21, 24576
    s_add_u32 s24, s24, 159744
    s_add_u32 s25, s25, 384
    s_cmp_lt_u32 s20, 64
    s_cbranch_scc1 L_XAf_seg
    s_branch L_exit
L_XB:
    v_and_b32 v4, 63, v0
    v_lshrrev_b32 v5, 4, v4
    v_and_b32 v6, 15, v4
    s_mov_b32 s26, 1048576
    s_sub_u32 s27, s13, 16
    v_lshlrev_b32 v154, 4, v4
    v_mov_b32 v118, 0
    s_mov_b32 s30, 44797440
L_wf_19:
    buffer_load_dword v116, v118, s[8:11], s30 offen offset:0 sc1
    s_sub_u32 s26, s26, 1
    s_cbranch_scc1 L_fail
    s_waitcnt vmcnt(0)
    v_cmp_ne_u32 vcc, s17, v116
    s_cbranch_vccz L_wfd_20
    s_sleep 24
    s_branch L_wf_19
L_wfd_20:
    s_mul_i32 s32, s27, 458752
    s_mul_i32 s33, s12, 114688
    s_add_u32 s32, s32, s33
    s_add_u32 s32, s32, 6422528
    s_mul_i32 s33, s12, 28672
    s_add_u32 s33, s33, 45056
    v_add_u32 v155, s33, v154
    buffer_load_dwordx4 a[0:3], v154, s[8:11], s32 offen offset:0
    buffer_load_dwordx4 a[4:7], v154, s[8:11], s32 offen offset:1024
    s_waitcnt vmcnt(1)
    buffer_load_dwordx4 a[8:11], v154, s[8:11], s32 offen offset:2048
    s_waitcnt vmcnt(1)
    buffer_load_dwordx4 a[12:15], v154, s[8:11], s32 offen offset:3072
    s_add_u32 s32, s32, 4096
    s_waitcnt vmcnt(1)
    buffer_load_dwordx4 a[16:19], v154, s[8:11], s32 offen offset:0
    s_waitcnt vmcnt(1)
    buffer_load_dwordx4 a[20:23], v154, s[8:11], s32 offen offset:1024
    s_waitcnt vmcnt(1)
    buffer_load_dwordx4 a[24:27], v154, s[8:11], s32 offen offset:2048
    s_waitcnt vmcnt(1)
    buffer_load_dwordx4 a[28:31], v154, s[8:11], s32 offen offset:3072
    s_add_u32 s32, s32, 4096
    s_waitcnt vmcnt(1)
    buffer_load_dwordx4 a[32:35], v154, s[8:11], s32 offen offset:0
    s_waitcnt vmcnt(1)
    buffer_load_dwordx4 a[36:39], v154, s[8:11], s32 offen offset:1024
    s_waitcnt vmcnt(1)
    buffer_load_dwordx4 a[40:43], v154, s[8:11], s32 offen offset:2048
    s_waitcnt vmcnt(1)
    buffer_load_dwordx4 a[44:47], v154, s[8:11], s32 offen offset:3072
    s_add_u32 s32, s32, 4096
    s_waitcnt vmcnt(1)
    buffer_load_dwordx4 a[48:51], v154, s[8:11], s32 offen offset:0
    s_waitcnt vmcnt(1)
    buffer_load_dwordx4 a[52:55], v154, s[8:11], s32 offen offset:1024
    s_waitcnt vmcnt(1)
    buffer_load_dwordx4 a[56:59], v154, s[8:11], s32 offen offset:2048
    s_waitcnt vmcnt(1)
    buffer_load_dwordx4 a[60:63], v154, s[8:11], s32 offen offset:3072
    s_add_u32 s32, s32, 4096
    s_waitcnt vmcnt(1)
    buffer_load_dwordx4 a[64:67], v154, s[8:11], s32 offen offset:0
    s_waitcnt vmcnt(1)
    buffer_load_dwordx4 a[68:71], v154, s[8:11], s32 offen offset:1024
    s_waitcnt vmcnt(1)
    buffer_load_dwordx4 a[72:75], v154, s[8:11], s32 offen offset:2048
    s_waitcnt vmcnt(1)
    buffer_load_dwordx4 a[76:79], v154, s[8:11], s32 offen offset:3072
    s_add_u32 s32, s32, 4096
    s_waitcnt vmcnt(1)
    buffer_load_dwordx4 a[80:83], v154, s[8:11], s32 offen offset:0
    s_waitcnt vmcnt(1)
    buffer_load_dwordx4 a[84:87], v154, s[8:11], s32 offen offset:1024
    s_waitcnt vmcnt(1)
    buffer_load_dwordx4 a[88:91], v154, s[8:11], s32 offen offset:2048
    s_waitcnt vmcnt(1)
    buffer_load_dwordx4 a[92:95], v154, s[8:11], s32 offen offset:3072
    s_add_u32 s32, s32, 4096
    s_waitcnt vmcnt(1)
    buffer_load_dwordx4 a[96:99], v154, s[8:11], s32 offen offset:0
    s_waitcnt vmcnt(1)
    buffer_load_dwordx4 a[100:103], v154, s[8:11], s32 offen offset:1024
    s_waitcnt vmcnt(1)
    buffer_load_dwordx4 a[104:107], v154, s[8:11], s32 offen offset:2048
    s_waitcnt vmcnt(1)
    buffer_load_dwordx4 a[108:111], v154, s[8:11], s32 offen offset:3072
    s_add_u32 s32, s32, 4096
    s_waitcnt vmcnt(1)
    buffer_load_dwordx4 a[112:115], v154, s[8:11], s32 offen offset:0
    s_waitcnt vmcnt(1)
    buffer_load_dwordx4 a[116:119], v154, s[8:11], s32 offen offset:1024
    s_waitcnt vmcnt(1)
    buffer_load_dwordx4 a[120:123], v154, s[8:11], s32 offen offset:2048
    s_waitcnt vmcnt(1)
    buffer_load_dwordx4 a[124:127], v154, s[8:11], s32 offen offset:3072
    s_add_u32 s32, s32, 4096
    s_waitcnt vmcnt(1)
    buffer_load_dwordx4 a[128:131], v154, s[8:11], s32 offen offset:0
    s_waitcnt vmcnt(1)
    buffer_load_dwordx4 a[132:135], v154, s[8:11], s32 offen offset:1024
    s_waitcnt vmcnt(1)
    buffer_load_dwordx4 a[136:139], v154, s[8:11], s32 offen offset:2048
    s_waitcnt vmcnt(1)
    buffer_load_dwordx4 a[140:143], v154, s[8:11], s32 offen offset:3072
    s_add_u32 s32, s32, 4096
    s_waitcnt vmcnt(1)
    buffer_load_dwordx4 a[144:147], v154, s[8:11], s32 offen offset:0
    s_waitcnt vmcnt(1)
    buffer_load_dwordx4 a[148:151], v154, s[8:11], s32 offen offset:1024
    s_waitcnt vmcnt(1)
    buffer_load_dwordx4 a[152:155], v154, s[8:11], s32 offen offset:2048
    s_waitcnt vmcnt(1)
    buffer_load_dwordx4 a[156:159], v154, s[8:11], s32 offen offset:3072
    s_add_u32 s32, s32, 4096
    s_waitcnt vmcnt(1)
    buffer_load_dwordx4 a[160:163], v154, s[8:11], s32 offen offset:0
    s_waitcnt vmcnt(1)
    buffer_load_dwordx4 a[164:167], v154, s[8:11], s32 offen offset:1024
    s_waitcnt vmcnt(1)
    buffer_load_dwordx4 a[168:171], v154, s[8:11], s32 offen offset:2048
    s_waitcnt vmcnt(1)
    buffer_load_dwordx4 a[172:175], v154, s[8:11], s32 offen offset:3072
    s_add_u32 s32, s32, 4096
    s_waitcnt vmcnt(1)
    buffer_load_dwordx4 a[176:179], v154, s[8:11], s32 offen offset:0
    s_waitcnt vmcnt(1)
    buffer_load_dwordx4 a[180:183], v154, s[8:11], s32 offen offset:1024
    s_waitcnt vmcnt(1)
    buffer_load_dwordx4 a[184:187], v154, s[8:11], s32 offen offset:2048
    s_waitcnt vmcnt(1)
    buffer_load_dwordx4 a[188:191], v154, s[8:11], s32 offen offset:3072
    s_add_u32 s32, s32, 4096
    s_waitcnt vmcnt(1)
    buffer_load_dwordx4 a[192:195], v154, s[8:11], s32 offen offset:0
    s_waitcnt vmcnt(1)
    buffer_load_dwordx4 a[196:199], v154, s[8:11], s32 offen offset:1024
    s_waitcnt vmcnt(1)
    buffer_load_dwordx4 a[200:203], v154, s[8:11], s32 offen offset:2048
    s_waitcnt vmcnt(1)
    buffer_load_dwordx4 a[204:207], v154, s[8:11], s32 offen offset:3072
    s_add_u32 s32, s32, 4096
    s_waitcnt vmcnt(1)
    buffer_load_dwordx4 a[208:211], v154, s[8:11], s32 offen offset:0
    s_waitcnt vmcnt(1)
    buffer_load_dwordx4 a[212:215], v154, s[8:11], s32 offen offset:1024
    s_waitcnt vmcnt(1)
    buffer_load_dwordx4 a[216:219], v154, s[8:11], s32 offen offset:2048
    s_waitcnt vmcnt(1)
    buffer_load_dwordx4 a[220:223], v154, s[8:11], s32 offen offset:3072
    s_add_u32 s32, s32, 4096
    s_waitcnt vmcnt(1)
    buffer_load_dwordx4 a[224:227], v154, s[8:11], s32 offen offset:0
    s_waitcnt vmcnt(1)
    buffer_load_dwordx4 a[228:231], v154, s[8:11], s32 offen offset:1024
    s_waitcnt vmcnt(1)
    buffer_load_dwordx4 a[232:235], v154, s[8:11], s32 offen offset:2048
    s_waitcnt vmcnt(1)
    buffer_load_dwordx4 a[236:239], v154, s[8:11], s32 offen offset:3072
    s_add_u32 s32, s32, 4096
    s_waitcnt vmcnt(1)
    buffer_load_dwordx4 a[240:243], v154, s[8:11], s32 offen offset:0
    s_waitcnt vmcnt(1)
    buffer_load_dwordx4 a[244:247], v154, s[8:11], s32 offen offset:1024
    s_waitcnt vmcnt(1)
    buffer_load_dwordx4 a[248:251], v154, s[8:11], s32 offen offset:2048
    s_waitcnt vmcnt(1)
    buffer_load_dwordx4 a[252:255], v154, s[8:11], s32 offen offset:3072
    s_add_u32 s32, s32, 4096
    s_waitcnt vmcnt(1)
    buffer_load_dwordx4 v[176:179], v154, s[8:11], s32 offen offset:0
    s_waitcnt vmcnt(1)
    buffer_load_dwordx4 v[180:183], v154, s[8:11], s32 offen offset:1024
    s_waitcnt vmcnt(1)
    buffer_load_dwordx4 v[184:187], v154, s[8:11], s32 offen offset:2048
    s_waitcnt vmcnt(1)
    buffer_load_dwordx4 v[188:191], v154, s[8:11], s32 offen offset:3072
    s_add_u32 s32, s32, 4096
    s_waitcnt vmcnt(1)
    buffer_load_dwordx4 v[192:195], v154, s[8:11], s32 offen offset:0
    s_waitcnt vmcnt(1)
    buffer_load_dwordx4 v[196:199], v154, s[8:11], s32 offen offset:1024
    s_waitcnt vmcnt(1)
    buffer_load_dwordx4 v[200:203], v154, s[8:11], s32 offen offset:2048
    s_waitcnt vmcnt(1)
    buffer_load_dwordx4 v[204:207], v154, s[8:11], s32 offen offset:3072
    s_add_u32 s32, s32, 4096
    s_waitcnt vmcnt(1)
    buffer_load_dwordx4 v[208:211], v154, s[8:11], s32 offen offset:0
    s_waitcnt vmcnt(1)
    buffer_load_dwordx4 v[212:215], v154, s[8:11], s32 offen offset:1024
    s_waitcnt vmcnt(1)
    buffer_load_dwordx4 v[216:219], v154, s[8:11], s32 offen offset:2048
    s_waitcnt vmcnt(1)
    buffer_load_dwordx4 v[220:223], v154, s[8:11], s32 offen offset:3072
    s_add_u32 s32, s32, 4096
    s_waitcnt vmcnt(1)
    buffer_load_dwordx4 v[224:227], v154, s[8:11], s32 offen offset:0
    s_waitcnt vmcnt(1)
    buffer_load_dwordx4 v[228:231], v154, s[8:11], s32 offen offset:1024
    s_waitcnt vmcnt(1)
    buffer_load_dwordx4 v[232:235], v154, s[8:11], s32 offen offset:2048
    s_waitcnt vmcnt(1)
    buffer_load_dwordx4 v[236:239], v154, s[8:11], s32 offen offset:3072
    s_add_u32 s32, s32, 4096
    s_waitcnt vmcnt(1)
    buffer_load_dwordx4 v[240:243], v154, s[8:11], s32 offen offset:0
    s_waitcnt vmcnt(1)
    buffer_load_dwordx4 v[244:247], v154, s[8:11], s32 offen offset:1024
    s_waitcnt vmcnt(1)
    buffer_load_dwordx4 v[248:251], v154, s[8:11], s32 offen offset:2048
    s_waitcnt vmcnt(1)
    buffer_load_dwordx4 v[252:255], v154, s[8:11], s32 offen offset:3072
    s_add_u32 s32, s32, 4096
    s_waitcnt vmcnt(1)
    s_add_u32 m0, s33, 0
    s_nop 0
    buffer_load_dwordx4 v154, s[8:11], s32 offen offset:0 lds
    s_waitcnt vmcnt(1)
    buffer_load_dwordx4 v154, s[8:11], s32 offen offset:1024 lds
    s_waitcnt vmcnt(1)
    buffer_load_dwordx4 v154, s[8:11], s32 offen offset:2048 lds
    s_waitcnt vmcnt(1)
    buffer_load_dwordx4 v154, s[8:11], s32 offen offset:3072 lds
    s_add_u32 s32, s32, 4096
    s_waitcnt vmcnt(1)
    s_add_u32 m0, s33, 4096
    s_nop 0
    buffer_load_dwordx4 v154, s[8:11], s32 offen offset:0 lds
    s_waitcnt vmcnt(1)
    buffer_load_dwordx4 v154, s[8:11], s32 offen offset:1024 lds
    s_waitcnt vmcnt(1)
    buffer_load_dwordx4 v154, s[8:11], s32 offen offset:2048 lds
    s_waitcnt vmcnt(1)
    buffer_load_dwordx4 v154, s[8:11], s32 offen offset:3072 lds
    s_add_u32 s32, s32, 4096
    s_waitcnt vmcnt(1)
    s_add_u32 m0, s33, 8192
    s_nop 0
    buffer_load_dwordx4 v154, s[8:11], s32 offen offset:0 lds
    s_waitcnt vmcnt(1)
    buffer_load_dwordx4 v154, s[8:11], s32 offen offset:1024 lds
    s_waitcnt vmcnt(1)
    buffer_load_dwordx4 v154, s[8:11], s32 offen offset:2048 lds
    s_waitcnt vmcnt(1)
    buffer_load_dwordx4 v154, s[8:11], s32 offen offset:3072 lds
    s_add_u32 s32, s32, 4096
    s_waitcnt vmcnt(1)
    s_add_u32 m0, s33, 12288
    s_nop 0
    buffer_load_dwordx4 v154, s[8:11], s32 offen offset:0 lds
    s_waitcnt vmcnt(1)
    buffer_load_dwordx4 v154, s[8:11], s32 offen offset:1024 lds
    s_waitcnt vmcnt(1)
    buffer_load_dwordx4 v154, s[8:11], s32 offen offset:2048 lds
    s_waitcnt vmcnt(1)
    buffer_load_dwordx4 v154, s[8:11], s32 offen offset:3072 lds
    s_add_u32 s32, s32, 4096
    s_waitcnt vmcnt(1)
    s_add_u32 m0, s33, 16384
    s_nop 0
    buffer_load_dwordx4 v154, s[8:11], s32 offen offset:0 lds
    s_waitcnt vmcnt(1)
    buffer_load_dwordx4 v154, s[8:11], s32 offen offset:1024 lds
    s_waitcnt vmcnt(1)
    buffer_load_dwordx4 v154, s[8:11], s32 offen offset:2048 lds
    s_waitcnt vmcnt(1)
    buffer_load_dwordx4 v154, s[8:11], s32 offen offset:3072 lds
    s_add_u32 s32, s32, 4096
    s_waitcnt vmcnt(1)
    s_add_u32 m0, s33, 20480
    s_nop 0
    buffer_load_dwordx4 v154, s[8:11], s32 offen offset:0 lds
    s_waitcnt vmcnt(1)
    buffer_load_dwordx4 v154, s[8:11], s32 offen offset:1024 lds
    s_waitcnt vmcnt(1)
    buffer_load_dwordx4 v154, s[8:11], s32 offen offset:2048 lds
    s_waitcnt vmcnt(1)
    buffer_load_dwordx4 v154, s[8:11], s32 offen offset:3072 lds
    s_add_u32 s32, s32, 4096
    s_waitcnt vmcnt(1)
    s_add_u32 m0, s33, 24576
    s_nop 0
    buffer_load_dwordx4 v154, s[8:11], s32 offen offset:0 lds
    s_waitcnt vmcnt(1)
    buffer_load_dwordx4 v154, s[8:11], s32 offen offset:1024 lds
    s_waitcnt vmcnt(1)
    buffer_load_dwordx4 v154, s[8:11], s32 offen offset:2048 lds
    s_waitcnt vmcnt(1)
    buffer_load_dwordx4 v154, s[8:11], s32 offen offset:3072 lds
    s_add_u32 s32, s32, 4096
    s_waitcnt vmcnt(1)
    v_mov_b32 v1, 0x4444
    v_mov_b32 v7, 0xeeee
    v_cmp_lt_u32 vcc, 7, v6
    s_nop 1
    v_cndmask_b32 v1, v1, v7, vcc
    v_mov_b32 v2, 1
    v_add_u32 v156, 16384, v154
    s_lshl_b32 s32, s12, 11
    s_min_u32 s32, s32, 5120
    v_add_u32 v157, s32, v154
    v_mov_b32 v158, 7164
    s_lshl_b32 s32, s27, 2
    s_add_u32 s32, s32, s12
    s_lshl_b32 s33, s32, 2
    v_mov_b32 v159, s33
    s_lshl_b32 s42, s32, 13
    s_lshl_b32 s33, s32, 3
    v_and_b32 v169, 1, v4
    v_lshlrev_b32 v169, 2, v169
    v_add_u32 v169, s33, v169
    v_and_b32 v7, 7, v4
    v_lshlrev_b32 v7, 2, v7
    s_lshl_b32 s32, s12, 5
    v_add_u32 v160, s32, v7
    v_lshlrev_b32 v161, 3, v4
    v_lshlrev_b32 v168, 2, v6
    s_lshl_b32 s32, s12, 10
    v_add_u32 v162, s32, v154
    s_lshl_b32 s32, s12, 12
    v_add_u32 v163, s32, v154
    s_lshr_b32 s36, s12, 1
    s_and_b32 s37, s12, 1
    v_mul_u32_u24 v164, 896, v6
    v_lshl_add_u32 v164, v5, 3, v164
    s_mul_i32 s32, s37, 14336
    s_lshl_b32 s33, s27, 6
    s_add_u32 s32, s32, s33
    s_lshl_b32 s33, s36, 5
    s_add_u32 s32, s32, s33
    v_add_u32 v164, s32, v164
    s_mul_i32 s32, s37, 14336
    s_lshl_b32 s33, s27, 10
    s_add_u32 s32, s32, s33
    s_lshl_b32 s33, s36, 3
    s_add_u32 s32, s32, s33
    v_add_u32 v165, s32, v154
    s_mul_i32 s32, s37, 3584
    s_lshl_b32 s33, s27, 8
    s_add_u32 s32, s32, s33
    s_lshl_b32 s33, s36, 7
    s_add_u32 s32, s32, s33
    v_add_u32 v166, s32, v161
    v_mov_b32 v7, 1073741824
    v_cmp_gt_u32 vcc, 16, v4
    s_nop 1
    v_cndmask_b32 v166, v7, v166, vcc
    s_lshl_b32 s32, s27, 7
    s_lshl_b32 s33, s36, 6
    s_add_u32 s32, s32, s33
    s_add_u32 s32, s32, 44862976
    v_lshlrev_b32 v7, 4, v5
    buffer_load_dwordx4 v[150:153], v7, s[8:11], s32 offen
    s_sub_u32 s20, s14, 1
    s_mov_b32 s48, s20
    s_lshl_b32 s21, s20, 13
    s_add_u32 s21, s21, 44040192
    s_mul_i32 s22, s20, 28672
    s_add_u32 s45, s22, 48283648
    s_mul_i32 s23, s12, 7168
    s_add_u32 s22, s22, s23
    s_add_u32 s23, s23, 16384
    s_mul_i32 s32, s20, 458752
    s_add_u32 s42, s42, s32
    s_add_u32 s42, s42, 14680064
    s_lshl_b32 s32, s20, 8
    s_add_u32 s47, s32, 44711936
    s_lshl_b32 s32, s20, 9
    s_add_u32 s43, s32, 44662784
    s_mul_i32 s24, s20, 53248
    s_mul_i32 s32, s12, 13312
    s_add_u32 s24, s24, s32
    s_add_u32 s24, s24, 44875776
    s_lshl_b32 s25, s20, 7
    s_add_u32 s25, s25, 44695552
    s_mul_i32 s44, s20, 28672
    s_lshl_b32 s46, s20, 13
    s_add_u32 s46, s46, 50118656
    s_waitcnt vmcnt(0)
L_wf_21:
    buffer_load_dword v3, v169, s[8:11], s43 offen offset:0 sc1
    s_sub_u32 s26, s26, 1
    s_cbranch_scc1 L_fail
    s_waitcnt vmcnt(0)
    v_cmp_eq_u32 vcc, 0, v3
    s_cbranch_vccz L_wfd_22
    s_sleep 4
    s_branch L_wf_21
L_wfd_22:
    s_add_u32 s32, s42, 4096
    buffer_load_dwordx4 v[68:71], v154, s[8:11], s42 offen offset:0 sc1
    buffer_load_dwordx4 v[72:75], v154, s[8:11], s42 offen offset:1024 sc1
    buffer_load_dwordx4 v[76:79], v154, s[8:11], s42 offen offset:2048 sc1
    buffer_load_dwordx4 v[80:83], v154, s[8:11], s42 offen offset:3072 sc1
    buffer_load_dwordx4 v[84:87], v154, s[8:11], s32 offen offset:0 sc1
    buffer_load_dwordx4 v[88:91], v154, s[8:11], s32 offen offset:1024 sc1
    buffer_load_dwordx4 v[92:95], v154, s[8:11], s32 offen offset:2048 sc1
    buffer_load_dwordx4 v[96:99], v154, s[8:11], s32 offen offset:3072 sc1
    buffer_load_dwordx2 v[148:149], v164, s[64:67], s44 offen
L_XB_seg:
    s_barrier
    buffer_load_dword v167, v169, s[8:11], s43 offen offset:1536 sc1
    s_sub_u32 s29, s21, 8192
    buffer_load_dword v110, v158, s[8:11], s29 offen sc1
    buffer_load_dwordx4 v[100:103], v157, s[8:11], s21 offen sc1
    buffer_load_dwordx4 v[104:107], v157, s[8:11], s21 offen offset:1024 sc1
    s_add_u32 s33, s25, 8192
L_wf_23:
    buffer_load_dword v3, v160, s[8:11], s33 offen offset:0 sc1
    s_sub_u32 s26, s26, 1
    s_cbranch_scc1 L_fail
    s_waitcnt vmcnt(0)
    v_cmp_eq_u32 vcc, 0, v3
    s_cbranch_vccz L_wfd_24
    s_sleep 2
    s_branch L_wf_23
L_wfd_24:
    s_add_u32 s32, s24, 0
    buffer_load_dwordx4 v[116:119], v154, s[8:11], s32 offen offset:0
    buffer_load_dwordx4 v[120:123], v154, s[8:11], s32 offen offset:1664
    s_add_u32 s32, s24, 3328
    buffer_load_dwordx4 v[124:127], v154, s[8:11], s32 offen offset:0
    buffer_load_dwordx4 v[128:131], v154, s[8:11], s32 offen offset:1664
    s_add_u32 s32, s24, 6656
    buffer_load_dwordx4 v[132:135], v154, s[8:11], s32 offen offset:0
    buffer_load_dwordx4 v[136:139], v154, s[8:11], s32 offen offset:1664
    s_add_u32 s32, s24, 9984
    buffer_load_dwordx4 v[140:143], v154, s[8:11], s32 offen offset:0
    buffer_load_dwordx4 v[144:147], v154, s[8:11], s32 offen offset:1664
    s_waitcnt vmcnt(6)
    v_mfma_f32_16x16x32_bf16 v[4:7], v[68:71], v[116:119], 0
    v_mfma_f32_16x16x32_bf16 v[8:11], v[68:71], v[120:123], 0
    v_mfma_f32_16x16x32_bf16 v[12:15], v[72:75], v[116:119], 0
    v_mfma_f32_16x16x32_bf16 v[16:19], v[72:75], v[120:123], 0
    s_waitcnt vmcnt(4)
    v_mfma_f32_16x16x32_bf16 v[20:23], v[76:79], v[124:127], 0
    v_mfma_f32_16x16x32_bf16 v[24:27], v[76:79], v[128:131], 0
    v_mfma_f32_16x16x32_bf16 v[28:31], v[80:83], v[124:127], 0
    v_mfma_f32_16x16x32_bf16 v[32:35], v[80:83], v[128:131], 0
    s_waitcnt vmcnt(2)
    v_mfma_f32_16x16x32_bf16 v[36:39], v[84:87], v[132:135], 0
    v_mfma_f32_16x16x32_bf16 v[40:43], v[84:87], v[136:139], 0
    v_mfma_f32_16x16x32_bf16 v[44:47], v[88:91], v[132:135], 0
    v_mfma_f32_16x16x32_bf16 v[48:51], v[88:91], v[136:139], 0
    s_waitcnt vmcnt(0)
    v_mfma_f32_16x16x32_bf16 v[52:55], v[92:95], v[140:143], 0
    v_mfma_f32_16x16x32_bf16 v[56:59], v[92:95], v[144:147], 0
    v_mfma_f32_16x16x32_bf16 v[60:63], v[96:99], v[140:143], 0
    v_mfma_f32_16x16x32_bf16 v[64:67], v[96:99], v[144:147], 0
    v_mov_b64 v[68:69], 0
    v_mov_b64 v[70:71], 0
    v_mov_b64 v[72:73], 0
    v_mov_b64 v[74:75], 0
    v_mov_b64 v[76:77], 0
    v_mov_b64 v[78:79], 0
    v_mov_b64 v[80:81], 0
    v_mov_b64 v[82:83], 0
    v_mov_b64 v[84:85], 0
    v_mov_b64 v[86:87], 0
    v_mov_b64 v[88:89], 0
    v_mov_b64 v[90:91], 0
    v_mov_b64 v[92:93], 0
    v_mov_b64 v[94:95], 0
    v_mov_b64 v[96:97], 0
    v_mov_b64 v[98:99], 0
    s_waitcnt vmcnt(0)
    v_pk_max_u16 v108, v100, v101
    v_pk_max_u16 v108, v108, v102
    v_pk_max_u16 v108, v108, v103
    v_pk_max_u16 v108, v108, v104
    v_pk_max_u16 v108, v108, v105
    v_pk_max_u16 v108, v108, v106
    v_pk_max_u16 v108, v108, v107
    v_lshlrev_b32 v109, 16, v108
    v_max_u32 v108, v108, v109
    v_cmp_le_u32 vcc, 0xffff0000, v108
    s_cbranch_vccz L_XB_m_p_ok0
    v_cmp_eq_u32 vcc, -1, v110
    s_cbranch_vccz L_XB_m_go
L_XB_m_tr:
    s_sleep 4
    buffer_load_dword v108, v158, s[8:11], s29 offen sc1
    s_sub_u32 s26, s26, 1
    s_cbranch_scc1 L_fail
    s_waitcnt vmcnt(0)
    v_cmp_eq_u32 vcc, -1, v108
    s_cbranch_vccnz L_XB_m_tr
    s_sleep 24
L_XB_m_go:
L_XB_m_p_loop:
    buffer_load_dwordx4 v[100:103], v157, s[8:11], s21 offen offset:0 sc1
    buffer_load_dwordx4 v[104:107], v157, s[8:11], s21 offen offset:1024 sc1
    s_sub_u32 s26, s26, 1
    s_cbranch_scc1 L_fail
    s_waitcnt vmcnt(0)
    v_pk_max_u16 v108, v100, v101
    v_pk_max_u16 v108, v108, v102
    v_pk_max_u16 v108, v108, v103
    v_pk_max_u16 v108, v108, v104
    v_pk_max_u16 v108, v108, v105
    v_pk_max_u16 v108, v108, v106
    v_pk_max_u16 v108, v108, v107
    v_lshlrev_b32 v109, 16, v108
    v_max_u32 v108, v108, v109
    v_cmp_le_u32 vcc, 0xffff0000, v108
    s_cbranch_vccnz L_XB_m_p_loop
L_XB_m_p_ok0:
    ds_write_b128 v157, v[100:103]
    ds_write_b128 v157, v[104:107] offset:1024
L_XB_m_p_done:
    s_waitcnt lgkmcnt(0)
    s_barrier
    ds_read_b128 v[100:103], v154 offset:0
    ds_read_b128 v[132:135], v155 offset:0
    ds_read_b128 v[136:139], v155 offset:1024
    ds_read_b128 v[140:143], v155 offset:14336
    ds_read_b128 v[144:147], v155 offset:15360
    ds_read_b128 v[104:107], v154 offset:1024
    ds_read_b128 v[116:119], v155 offset:2048
    ds_read_b128 v[120:123], v155 offset:3072
    ds_read_b128 v[124:127], v155 offset:16384
    ds_read_b128 v[128:131], v155 offset:17408
    s_waitcnt lgkmcnt(5)
    v_smfmac_f32_16x16x64_bf16 v[92:95], v[100:103], v[132:139], v1
    v_smfmac_f32_16x16x64_bf16 v[96:99], v[100:103], v[140:147], v1
    v_smfmac_f32_16x16x64_bf16 v[68:71], v[100:103], a[0:7], v1
    ds_read_b128 v[108:111], v154 offset:2048
    v_smfmac_f32_16x16x64_bf16 v[72:75], v[100:103], a[56:63], v1
    ds_read_b128 v[132:135], v155 offset:4096
    v_smfmac_f32_16x16x64_bf16 v[76:79], v[100:103], a[112:119], v1
    ds_read_b128 v[136:139], v155 offset:5120
    v_smfmac_f32_16x16x64_bf16 v[80:83], v[100:103], a[168:175], v1
    ds_read_b128 v[140:143], v155 offset:18432
    v_smfmac_f32_16x16x64_bf16 v[84:87], v[100:103], a[224:231], v1
    ds_read_b128 v[144:147], v155 offset:19456
    v_smfmac_f32_16x16x64_bf16 v[88:91], v[100:103], v[200:207], v1
    s_waitcnt lgkmcnt(5)
    v_smfmac_f32_16x16x64_bf16 v[92:95], v[104:107], v[116:123], v1
    v_smfmac_f32_16x16x64_bf16 v[96:99], v[104:107], v[124:131], v1
    v_smfmac_f32_16x16x64_bf16 v[68:71], v[104:107], a[8:15], v1
    ds_read_b128 v[100:103], v154 offset:3072
    v_smfmac_f32_16x16x64_bf16 v[72:75], v[104:107], a[64:71], v1
    ds_read_b128 v[116:119], v155 offset:6144
    v_smfmac_f32_16x16x64_bf16 v[76:79], v[104:107], a[120:127], v1
    ds_read_b128 v[120:123], v155 offset:7168
    v_smfmac_f32_16x16x64_bf16 v[80:83], v[104:107], a[176:183], v1
    ds_read_b128 v[124:127], v155 offset:20480
    v_smfmac_f32_16x16x64_bf16 v[84:87], v[104:107], a[232:239], v1
    ds_read_b128 v[128:131], v155 offset:21504
    v_smfmac_f32_16x16x64_bf16 v[88:91], v[104:107], v[208:215], v1
    s_waitcnt lgkmcnt(5)
    v_smfmac_f32_16x16x64_bf16 v[92:95], v[108:111], v[132:139], v1
    v_smfmac_f32_16x16x64_bf16 v[96:99], v[108:111], v[140:147], v1
    v_smfmac_f32_16x16x64_bf16 v[68:71], v[108:111], a[16:23], v1
    ds_read_b128 v[104:107], v154 offset:4096
    v_smfmac_f32_16x16x64_bf16 v[72:75], v[108:111], a[72:79], v1
    ds_read_b128 v[132:135], v155 offset:8192
    v_smfmac_f32_16x16x64_bf16 v[76:79], v[108:111], a[128:135], v1
    ds_read_b128 v[136:139], v155 offset:9216
    v_smfmac_f32_16x16x64_bf16 v[80:83], v[108:111], a[184:191], v1
    ds_read_b128 v[140:143], v155 offset:22528
    v_smfmac_f32_16x16x64_bf16 v[84:87], v[108:111], a[240:247], v1
    ds_read_b128 v[144:147], v155 offset:23552
    v_smfmac_f32_16x16x64_bf16 v[88:91], v[108:111], v[216:223], v1
    s_waitcnt lgkmcnt(5)
    v_smfmac_f32_16x16x64_bf16 v[92:95], v[100:103], v[116:123], v1
    v_smfmac_f32_16x16x64_bf16 v[96:99], v[100:103], v[124:131], v1
    v_smfmac_f32_16x16x64_bf16 v[68:71], v[100:103], a[24:31], v1
    ds_read_b128 v[108:111], v154 offset:5120
    v_smfmac_f32_16x16x64_bf16 v[72:75], v[100:103], a[80:87], v1
    ds_read_b128 v[116:119], v155 offset:10240
    v_smfmac_f32_16x16x64_bf16 v[76:79], v[100:103], a[136:143], v1
    ds_read_b128 v[120:123], v155 offset:11264
    v_smfmac_f32_16x16x64_bf16 v[80:83], v[100:103], a[192:199], v1
    ds_read_b128 v[124:127], v155 offset:24576
    v_smfmac_f32_16x16x64_bf16 v[84:87], v[100:103], a[248:255], v1
    ds_read_b128 v[128:131], v155 offset:25600
    v_smfmac_f32_16x16x64_bf16 v[88:91], v[100:103], v[224:231], v1
    s_waitcnt lgkmcnt(5)
    v_smfmac_f32_16x16x64_bf16 v[92:95], v[104:107], v[132:139], v1
    v_smfmac_f32_16x16x64_bf16 v[96:99], v[104:107], v[140:147], v1
    v_smfmac_f32_16x16x64_bf16 v[68:71], v[104:107], a[32:39], v1
    ds_read_b128 v[100:103], v154 offset:6144
    v_smfmac_f32_16x16x64_bf16 v[72:75], v[104:107], a[88:95], v1
    ds_read_b128 v[132:135], v155 offset:12288
    v_smfmac_f32_16x16x64_bf16 v[76:79], v[104:107], a[144:151], v1
    ds_read_b128 v[136:139], v155 offset:13312
    v_smfmac_f32_16x16x64_bf16 v[80:83], v[104:107], a[200:207], v1
    ds_read_b128 v[140:143], v155 offset:26624
    v_smfmac_f32_16x16x64_bf16 v[84:87], v[104:107], v[176:183], v1
    ds_read_b128 v[144:147], v155 offset:27648
    v_smfmac_f32_16x16x64_bf16 v[88:91], v[104:107], v[232:239], v1
    s_waitcnt lgkmcnt(5)
    v_smfmac_f32_16x16x64_bf16 v[92:95], v[108:111], v[116:123], v1
    v_smfmac_f32_16x16x64_bf16 v[96:99], v[108:111], v[124:131], v1
    v_smfmac_f32_16x16x64_bf16 v[68:71], v[108:111], a[40:47], v1
    v_smfmac_f32_16x16x64_bf16 v[72:75], v[108:111], a[96:103], v1
    v_smfmac_f32_16x16x64_bf16 v[76:79], v[108:111], a[152:159], v1
    v_smfmac_f32_16x16x64_bf16 v[80:83], v[108:111], a[208:215], v1
    v_smfmac_f32_16x16x64_bf16 v[84:87], v[108:111], v[184:191], v1
    v_smfmac_f32_16x16x64_bf16 v[88:91], v[108:111], v[240:247], v1
    s_waitcnt lgkmcnt(0)
    v_smfmac_f32_16x16x64_bf16 v[92:95], v[100:103], v[132:139], v1
    v_smfmac_f32_16x16x64_bf16 v[96:99], v[100:103], v[140:147], v1
    v_smfmac_f32_16x16x64_bf16 v[68:71], v[100:103], a[48:55], v1
    v_smfmac_f32_16x16x64_bf16 v[72:75], v[100:103], a[104:111], v1
    v_smfmac_f32_16x16x64_bf16 v[76:79], v[100:103], a[160:167], v1
    v_smfmac_f32_16x16x64_bf16 v[80:83], v[100:103], a[216:223], v1
    v_smfmac_f32_16x16x64_bf16 v[84:87], v[100:103], v[192:199], v1
    v_smfmac_f32_16x16x64_bf16 v[88:91], v[100:103], v[248:255], v1
    s_nop 3
    s_waitcnt vmcnt(0)
    s_barrier
    v_cvt_pk_bf16_f32 v100, v68, v69
    v_cvt_pk_bf16_f32 v101, v70, v71
    v_cvt_pk_bf16_f32 v104, v72, v73
    v_cvt_pk_bf16_f32 v105, v74, v75
    v_cvt_pk_bf16_f32 v102, v76, v77
    v_cvt_pk_bf16_f32 v103, v78, v79
    v_cvt_pk_bf16_f32 v106, v80, v81
    v_cvt_pk_bf16_f32 v107, v82, v83
    v_cvt_pk_bf16_f32 v108, v84, v85
    v_cvt_pk_bf16_f32 v109, v86, v87
    v_cvt_pk_bf16_f32 v112, v88, v89
    v_cvt_pk_bf16_f32 v113, v90, v91
    v_cvt_pk_bf16_f32 v110, v92, v93
    v_cvt_pk_bf16_f32 v111, v94, v95
    v_cvt_pk_bf16_f32 v114, v96, v97
    v_cvt_pk_bf16_f32 v115, v98, v99
L_wf_25:
    buffer_load_dword v3, v160, s[8:11], s25 offen offset:0 sc1
    s_sub_u32 s26, s26, 1
    s_cbranch_scc1 L_fail
    s_waitcnt vmcnt(0)
    v_cmp_eq_u32 vcc, 0, v3
    s_cbranch_vccz L_wfd_26
    s_sleep 1
    s_branch L_wf_25
L_wfd_26:
    s_add_u32 s32, s24, 0
    buffer_load_dword v116, v168, s[8:11], s32 offen offset:1536
    buffer_load_dwordx2 v[132:133], v161, s[8:11], s32 offen offset:1024
    buffer_load_dword v117, v168, s[8:11], s32 offen offset:3200
    buffer_load_dwordx2 v[136:137], v161, s[8:11], s32 offen offset:2688
    s_add_u32 s32, s24, 3328
    buffer_load_dword v118, v168, s[8:11], s32 offen offset:1536
    buffer_load_dwordx2 v[134:135], v161, s[8:11], s32 offen offset:1024
    buffer_load_dword v119, v168, s[8:11], s32 offen offset:3200
    buffer_load_dwordx2 v[138:139], v161, s[8:11], s32 offen offset:2688
    s_add_u32 s32, s24, 6656
    buffer_load_dword v120, v168, s[8:11], s32 offen offset:1536
    buffer_load_dwordx2 v[140:141], v161, s[8:11], s32 offen offset:1024
    buffer_load_dword v121, v168, s[8:11], s32 offen offset:3200
    buffer_load_dwordx2 v[144:145], v161, s[8:11], s32 offen offset:2688
    s_add_u32 s32, s24, 9984
    buffer_load_dword v122, v168, s[8:11], s32 offen offset:1536
    buffer_load_dwordx2 v[142:143], v161, s[8:11], s32 offen offset:1024
    buffer_load_dword v123, v168, s[8:11], s32 offen offset:3200
    buffer_load_dwordx2 v[146:147], v161, s[8:11], s32 offen offset:2688
    s_waitcnt vmcnt(12)
    v_pk_mul_f32 v[4:5], v[4:5], v[116:117] op_sel:[0,0] op_sel_hi:[1,0]
    v_pk_mul_f32 v[6:7], v[6:7], v[116:117] op_sel:[0,0] op_sel_hi:[1,0]
    v_pk_mul_f32 v[8:9], v[8:9], v[116:117] op_sel:[0,1] op_sel_hi:[1,1]
    v_pk_mul_f32 v[10:11], v[10:11], v[116:117] op_sel:[0,1] op_sel_hi:[1,1]
    v_pk_mul_f32 v[12:13], v[12:13], v[116:117] op_sel:[0,0] op_sel_hi:[1,0]
    v_pk_mul_f32 v[14:15], v[14:15], v[116:117] op_sel:[0,0] op_sel_hi:[1,0]
    v_pk_mul_f32 v[16:17], v[16:17], v[116:117] op_sel:[0,1] op_sel_hi:[1,1]
    v_pk_mul_f32 v[18:19], v[18:19], v[116:117] op_sel:[0,1] op_sel_hi:[1,1]
    s_waitcnt vmcnt(8)
    v_mfma_f32_16x16x32_bf16 v[68:71], v[100:103], v[132:135], 0
    v_mfma_f32_16x16x32_bf16 v[72:75], v[100:103], v[136:139], 0
    v_mfma_f32_16x16x32_bf16 v[76:79], v[104:107], v[132:135], 0
    v_mfma_f32_16x16x32_bf16 v[80:83], v[104:107], v[136:139], 0
    v_pk_fma_f32 v[4:5], v[20:21], v[118:119], v[4:5] op_sel:[0,0,0] op_sel_hi:[1,0,1]
    v_pk_fma_f32 v[6:7], v[22:23], v[118:119], v[6:7] op_sel:[0,0,0] op_sel_hi:[1,0,1]
    v_pk_fma_f32 v[8:9], v[24:25], v[118:119], v[8:9] op_sel:[0,1,0] op_sel_hi:[1,1,1]
    v_pk_fma_f32 v[10:11], v[26:27], v[118:119], v[10:11] op_sel:[0,1,0] op_sel_hi:[1,1,1]
    v_pk_fma_f32 v[12:13], v[28:29], v[118:119], v[12:13] op_sel:[0,0,0] op_sel_hi:[1,0,1]
    v_pk_fma_f32 v[14:15], v[30:31], v[118:119], v[14:15] op_sel:[0,0,0] op_sel_hi:[1,0,1]
    v_pk_fma_f32 v[16:17], v[32:33], v[118:119], v[16:17] op_sel:[0,1,0] op_sel_hi:[1,1,1]
    v_pk_fma_f32 v[18:19], v[34:35], v[118:119], v[18:19] op_sel:[0,1,0] op_sel_hi:[1,1,1]
    s_waitcnt vmcnt(4)
    v_pk_fma_f32 v[4:5], v[36:37], v[120:121], v[4:5] op_sel:[0,0,0] op_sel_hi:[1,0,1]
    v_pk_fma_f32 v[6:7], v[38:39], v[120:121], v[6:7] op_sel:[0,0,0] op_sel_hi:[1,0,1]
    v_pk_fma_f32 v[8:9], v[40:41], v[120:121], v[8:9] op_sel:[0,1,0] op_sel_hi:[1,1,1]
    v_pk_fma_f32 v[10:11], v[42:43], v[120:121], v[10:11] op_sel:[0,1,0] op_sel_hi:[1,1,1]
    v_pk_fma_f32 v[12:13], v[44:45], v[120:121], v[12:13] op_sel:[0,0,0] op_sel_hi:[1,0,1]
    v_pk_fma_f32 v[14:15], v[46:47], v[120:121], v[14:15] op_sel:[0,0,0] op_sel_hi:[1,0,1]
    v_pk_fma_f32 v[16:17], v[48:49], v[120:121], v[16:17] op_sel:[0,1,0] op_sel_hi:[1,1,1]
    v_pk_fma_f32 v[18:19], v[50:51], v[120:121], v[18:19] op_sel:[0,1,0] op_sel_hi:[1,1,1]
    s_waitcnt vmcnt(0)
    v_mfma_f32_16x16x32_bf16 v[68:71], v[108:111], v[140:143], v[68:71]
    v_mfma_f32_16x16x32_bf16 v[72:75], v[108:111], v[144:147], v[72:75]
    v_mfma_f32_16x16x32_bf16 v[76:79], v[112:115], v[140:143], v[76:79]
    v_mfma_f32_16x16x32_bf16 v[80:83], v[112:115], v[144:147], v[80:83]
    v_pk_fma_f32 v[4:5], v[52:53], v[122:123], v[4:5] op_sel:[0,0,0] op_sel_hi:[1,0,1]
    v_pk_fma_f32 v[6:7], v[54:55], v[122:123], v[6:7] op_sel:[0,0,0] op_sel_hi:[1,0,1]
    v_pk_fma_f32 v[8:9], v[56:57], v[122:123], v[8:9] op_sel:[0,1,0] op_sel_hi:[1,1,1]
    v_pk_fma_f32 v[10:11], v[58:59], v[122:123], v[10:11] op_sel:[0,1,0] op_sel_hi:[1,1,1]
    v_pk_fma_f32 v[12:13], v[60:61], v[122:123], v[12:13] op_sel:[0,0,0] op_sel_hi:[1,0,1]
    v_pk_fma_f32 v[14:15], v[62:63], v[122:123], v[14:15] op_sel:[0,0,0] op_sel_hi:[1,0,1]
    v_pk_fma_f32 v[16:17], v[64:65], v[122:123], v[16:17] op_sel:[0,1,0] op_sel_hi:[1,1,1]
    v_pk_fma_f32 v[18:19], v[66:67], v[122:123], v[18:19] op_sel:[0,1,0] op_sel_hi:[1,1,1]
    v_pk_add_f32 v[4:5], v[4:5], v[68:69]
    v_pk_add_f32 v[6:7], v[6:7], v[70:71]
    v_pk_add_f32 v[8:9], v[8:9], v[72:73]
    v_pk_add_f32 v[10:11], v[10:11], v[74:75]
    v_pk_add_f32 v[12:13], v[12:13], v[76:77]
    v_pk_add_f32 v[14:15], v[14:15], v[78:79]
    v_pk_add_f32 v[16:17], v[16:17], v[80:81]
    v_pk_add_f32 v[18:19], v[18:19], v[82:83]
    ds_write_b128 v162, v[4:7] offset:0
    ds_write_b128 v162, v[8:11] offset:4096
    ds_write_b128 v162, v[12:15] offset:8192
    ds_write_b128 v162, v[16:19] offset:12288
    s_waitcnt lgkmcnt(0)
    s_barrier
    ds_read_b128 v[4:7], v163 offset:0
    ds_read_b128 v[8:11], v163 offset:1024
    ds_read_b128 v[12:15], v163 offset:2048
    ds_read_b128 v[16:19], v163 offset:3072
    v_lshlrev_b32 v132, 16, v148
    v_and_b32 v133, 0xffff0000, v148
    v_lshlrev_b32 v134, 16, v149
    v_and_b32 v135, 0xffff0000, v149
    s_waitcnt lgkmcnt(2)
    v_pk_add_f32 v[4:5], v[4:5], v[8:9]
    v_pk_add_f32 v[6:7], v[6:7], v[10:11]
    s_waitcnt lgkmcnt(0)
    v_pk_add_f32 v[12:13], v[12:13], v[16:17]
    v_pk_add_f32 v[14:15], v[14:15], v[18:19]
    v_pk_add_f32 v[4:5], v[4:5], v[12:13]
    v_pk_add_f32 v[6:7], v[6:7], v[14:15]
    v_pk_fma_f32 v[132:133], v[4:5], v[150:151], v[132:133]
    v_pk_fma_f32 v[134:135], v[6:7], v[152:153], v[134:135]
    v_cvt_pk_bf16_f32 v4, v132, v133
    v_cvt_pk_bf16_f32 v5, v134, v135
    buffer_store_dwordx2 v[4:5], v165, s[8:11], s45 offen sc1
    v_lshlrev_b32 v132, 16, v4
    v_and_b32 v133, 0xffff0000, v4
    v_lshlrev_b32 v134, 16, v5
    v_and_b32 v135, 0xffff0000, v5
    v_pk_add_f32 v[8:9], v[132:133], v[134:135]
    v_add_f32 v8, v8, v9
    v_mov_b32 v10, v8
    s_nop 1
    v_permlane16_swap_b32 v8, v10
    v_add_f32 v8, v8, v10
    v_mov_b32 v10, v8
    s_nop 1
    v_permlane32_swap_b32 v8, v10
    v_add_f32 v8, v8, v10
    v_mul_f32 v8, 1031798784, v8
    v_pk_add_f32 v[132:133], v[132:133], v[8:9] op_sel_hi:[1,0] neg_lo:[0,1] neg_hi:[0,1]
    v_pk_add_f32 v[134:135], v[134:135], v[8:9] op_sel_hi:[1,0] neg_lo:[0,1] neg_hi:[0,1]
    v_pk_mul_f32 v[132:133], v[132:133], v[132:133]
    v_pk_fma_f32 v[132:133], v[134:135], v[134:135], v[132:133]
    v_add_f32 v9, v132, v133
    v_mov_b32 v10, v9
    s_nop 1
    v_permlane16_swap_b32 v9, v10
    v_add_f32 v9, v9, v10
    v_mov_b32 v10, v9
    s_nop 1
    v_permlane32_swap_b32 v9, v10
    v_add_f32 v9, v9, v10
    buffer_store_dwordx2 v[8:9], v166, s[8:11], s46 offen sc1
    s_add_u32 s20, s20, 3
    s_cmp_ge_u32 s20, 64
    s_cbranch_scc1 L_XB_last
    s_add_u32 s42, s42, 1376256
    s_add_u32 s43, s43, 1536
    s_add_u32 s44, s44, 86016
    v_cmp_eq_u32 vcc, 0, v167
    s_cbranch_vccz L_XB_vok
L_wf_27:
    buffer_load_dword v3, v169, s[8:11], s43 offen offset:0 sc1
    s_sub_u32 s26, s26, 1
    s_cbranch_scc1 L_fail
    s_waitcnt vmcnt(0)
    v_cmp_eq_u32 vcc, 0, v3
    s_cbranch_vccz L_wfd_28
    s_sleep 4
    s_branch L_wf_27
L_wfd_28:
L_XB_vok:
    s_add_u32 s32, s42, 4096
    buffer_load_dwordx4 v[68:71], v154, s[8:11], s42 offen offset:0 sc1
    buffer_load_dwordx4 v[72:75], v154, s[8:11], s42 offen offset:1024 sc1
    buffer_load_dwordx4 v[76:79], v154, s[8:11], s42 offen offset:2048 sc1
    buffer_load_dwordx4 v[80:83], v154, s[8:11], s42 offen offset:3072 sc1
    buffer_load_dwordx4 v[84:87], v154, s[8:11], s32 offen offset:0 sc1
    buffer_load_dwordx4 v[88:91], v154, s[8:11], s32 offen offset:1024 sc1
    buffer_load_dwordx4 v[92:95], v154, s[8:11], s32 offen offset:2048 sc1
    buffer_load_dwordx4 v[96:99], v154, s[8:11], s32 offen offset:3072 sc1
    buffer_load_dwordx2 v[148:149], v164, s[64:67], s44 offen
    s_waitcnt vmcnt(9)
    buffer_store_dword v2, v159, s[8:11], s47 offen sc1
    s_add_u32 s21, s21, 24576
    s_add_u32 s24, s24, 159744
    s_add_u32 s25, s25, 384
    s_add_u32 s45, s45, 86016
    s_add_u32 s46, s46, 24576
    s_add_u32 s47, s47, 768
    s_branch L_XB_seg
L_XB_last:
    s_waitcnt vmcnt(0)
    buffer_store_dword v2, v159, s[8:11], s47 offen sc1
    s_branch L_exit
L_xflush:
    s_or_b32 s27, s27, s12
    s_cmp_lg_u32 s27, 0
    s_cbranch_scc1 L_exit
    s_waitcnt vmcnt(0)
    buffer_wbl2 sc1
    s_waitcnt vmcnt(0)
    s_endpgm
L_F:
    v_and_b32 v28, 63, v0
    v_lshrrev_b32 v29, 4, v28
    v_and_b32 v30, 15, v28
    s_mov_b32 s26, 1048576
    s_cmp_ge_u32 s13, 14
    s_cselect_b32 s20, 1, 0
    s_cselect_b32 s32, 14, 0
    s_sub_u32 s27, s13, s32
    s_sub_u32 s32, s14, 4
    s_lshl_b32 s32, s32, 1
    s_add_u32 s20, s20, s32
    v_lshlrev_b32 v116, 4, v28
    v_mov_b32 v86, 0
    s_mov_b32 s30, 44797440
L_wf_29:
    buffer_load_dword v84, v86, s[8:11], s30 offen offset:0 sc1
    s_sub_u32 s26, s26, 1
    s_cbranch_scc1 L_fail
    s_waitcnt vmcnt(0)
    v_cmp_ne_u32 vcc, s17, v84
    s_cbranch_vccz L_wfd_30
    s_sleep 24
    s_branch L_wf_29
L_wfd_30:
    s_lshl_b32 s36, s12, 15
    v_lshrrev_b32 v31, 2, v28
    v_mul_u32_u24 v31, 3584, v31
    v_and_b32 v32, 3, v28
    v_lshl_add_u32 v31, v32, 4, v31
    s_lshl_b32 s32, s27, 8
    s_lshl_b32 s33, s12, 6
    s_add_u32 s32, s32, s33
    s_mov_b32 s37, s32
    s_add_u32 m0, s36, 0
    s_nop 0
    buffer_load_dwordx4 v31, s[72:75], s32 offen lds
    s_add_u32 s32, s32, 57344
    s_waitcnt vmcnt(2)
    s_add_u32 m0, s36, 1024
    s_nop 0
    buffer_load_dwordx4 v31, s[72:75], s32 offen lds
    s_add_u32 s32, s32, 57344
    s_waitcnt vmcnt(2)
    s_add_u32 m0, s36, 2048
    s_nop 0
    buffer_load_dwordx4 v31, s[72:75], s32 offen lds
    s_add_u32 s32, s32, 57344
    s_waitcnt vmcnt(2)
    s_add_u32 m0, s36, 3072
    s_nop 0
    buffer_load_dwordx4 v31, s[72:75], s32 offen lds
    s_add_u32 s32, s32, 57344
    s_waitcnt vmcnt(2)
    s_add_u32 m0, s36, 4096
    s_nop 0
    buffer_load_dwordx4 v31, s[72:75], s32 offen lds
    s_add_u32 s32, s32, 57344
    s_waitcnt vmcnt(2)
    s_add_u32 m0, s36, 5120
    s_nop 0
    buffer_load_dwordx4 v31, s[72:75], s32 offen lds
    s_add_u32 s32, s32, 57344
    s_waitcnt vmcnt(2)
    s_add_u32 m0, s36, 6144
    s_nop 0
    buffer_load_dwordx4 v31, s[72:75], s32 offen lds
    s_add_u32 s32, s32, 57344
    s_waitcnt vmcnt(2)
    s_add_u32 m0, s36, 7168
    s_nop 0
    buffer_load_dwordx4 v31, s[72:75], s32 offen lds
    s_add_u32 s32, s32, 57344
    s_waitcnt vmcnt(2)
    s_add_u32 m0, s36, 8192
    s_nop 0
    buffer_load_dwordx4 v31, s[72:75], s32 offen lds
    s_add_u32 s32, s32, 57344
    s_waitcnt vmcnt(2)
    s_add_u32 m0, s36, 9216
    s_nop 0
    buffer_load_dwordx4 v31, s[72:75], s32 offen lds
    s_add_u32 s32, s32, 57344
    s_waitcnt vmcnt(2)
    s_add_u32 m0, s36, 10240
    s_nop 0
    buffer_load_dwordx4 v31, s[72:75], s32 offen lds
    s_add_u32 s32, s32, 57344
    s_waitcnt vmcnt(2)
    s_add_u32 m0, s36, 11264
    s_nop 0
    buffer_load_dwordx4 v31, s[72:75], s32 offen lds
    s_add_u32 s32, s32, 57344
    s_waitcnt vmcnt(2)
    s_add_u32 m0, s36, 12288
    s_nop 0
    buffer_load_dwordx4 v31, s[72:75], s32 offen lds
    s_add_u32 s32, s32, 57344
    s_waitcnt vmcnt(2)
    s_add_u32 m0, s36, 13312
    s_nop 0
    buffer_load_dwordx4 v31, s[72:75], s32 offen lds
    s_add_u32 s32, s32, 57344
    s_waitcnt vmcnt(2)
    s_add_u32 m0, s36, 14336
    s_nop 0
    buffer_load_dwordx4 v31, s[72:75], s32 offen lds
    s_add_u32 s32, s32, 57344
    s_waitcnt vmcnt(2)
    s_add_u32 m0, s36, 15360
    s_nop 0
    buffer_load_dwordx4 v31, s[72:75], s32 offen lds
    s_add_u32 s32, s32, 57344
    s_waitcnt vmcnt(2)
    s_add_u32 m0, s36, 16384
    s_nop 0
    buffer_load_dwordx4 v31, s[72:75], s32 offen lds
    s_add_u32 s32, s32, 57344
    s_waitcnt vmcnt(2)
    s_add_u32 m0, s36, 17408
    s_nop 0
    buffer_load_dwordx4 v31, s[72:75], s32 offen lds
    s_add_u32 s32, s32, 57344
    s_waitcnt vmcnt(2)
    s_add_u32 m0, s36, 18432
    s_nop 0
    buffer_load_dwordx4 v31, s[72:75], s32 offen lds
    s_add_u32 s32, s32, 57344
    s_waitcnt vmcnt(2)
    s_add_u32 m0, s36, 19456
    s_nop 0
    buffer_load_dwordx4 v31, s[72:75], s32 offen lds
    s_add_u32 s32, s32, 57344
    s_waitcnt vmcnt(2)
    s_add_u32 m0, s36, 20480
    s_nop 0
    buffer_load_dwordx4 v31, s[72:75], s32 offen lds
    s_add_u32 s32, s32, 57344
    s_waitcnt vmcnt(2)
    s_add_u32 m0, s36, 21504
    s_nop 0
    buffer_load_dwordx4 v31, s[72:75], s32 offen lds
    s_add_u32 s32, s32, 57344
    s_waitcnt vmcnt(2)
    s_add_u32 m0, s36, 22528
    s_nop 0
    buffer_load_dwordx4 v31, s[72:75], s32 offen lds
    s_add_u32 s32, s32, 57344
    s_waitcnt vmcnt(2)
    s_add_u32 m0, s36, 23552
    s_nop 0
    buffer_load_dwordx4 v31, s[72:75], s32 offen lds
    s_add_u32 s32, s32, 57344
    s_waitcnt vmcnt(2)
    s_add_u32 m0, s36, 24576
    s_nop 0
    buffer_load_dwordx4 v31, s[72:75], s32 offen lds
    s_add_u32 s32, s32, 57344
    s_waitcnt vmcnt(2)
    s_add_u32 m0, s36, 25600
    s_nop 0
    buffer_load_dwordx4 v31, s[72:75], s32 offen lds
    s_add_u32 s32, s32, 57344
    s_waitcnt vmcnt(2)
    s_add_u32 m0, s36, 26624
    s_nop 0
    buffer_load_dwordx4 v31, s[72:75], s32 offen lds
    s_add_u32 s32, s32, 57344
    s_waitcnt vmcnt(2)
    s_add_u32 m0, s36, 27648
    s_nop 0
    buffer_load_dwordx4 v31, s[72:75], s32 offen lds
    s_add_u32 s32, s32, 57344
    s_waitcnt vmcnt(2)
    v_lshlrev_b32 v32, 1, v30
    buffer_load_ushort v4, v32, s[80:83], s37 offen offset:0
    buffer_load_ushort v5, v32, s[80:83], s37 offen offset:32
    v_bfe_u32 v32, v28, 2, 2
    v_lshl_add_u32 v32, v29, 2, v32
    v_and_b32 v33, 3, v28
    v_lshlrev_b32 v33, 3, v33
    v_lshl_add_u32 v34, v32, 6, v33
    v_add_u32 v34, s36, v34
    v_lshl_add_u32 v36, v32, 8, v33
    v_add_u32 v36, s36, v36
    v_lshlrev_b32 v35, 4, v29
    s_mov_b32 s38, 44864768
    s_mov_b32 s39, 44866560
    v_mov_b32 v52, 0
    v_mov_b32 v53, 0
    v_mov_b32 v54, 0
    v_mov_b32 v55, 0
    s_mov_b32 s40, 0x3f803f80
    buffer_load_dwordx4 v[84:87], v35, s[8:11], s38 offen offset:0
    buffer_load_dwordx4 v[92:95], v35, s[8:11], s39 offen offset:0
    buffer_load_dwordx4 v[88:91], v35, s[8:11], s38 offen offset:64
    buffer_load_dwordx4 v[96:99], v35, s[8:11], s39 offen offset:64
    buffer_load_dwordx4 v[100:103], v35, s[8:11], s38 offen offset:128
    buffer_load_dwordx4 v[108:111], v35, s[8:11], s39 offen offset:128
    buffer_load_dwordx4 v[104:107], v35, s[8:11], s38 offen offset:192
    buffer_load_dwordx4 v[112:115], v35, s[8:11], s39 offen offset:192
    s_waitcnt vmcnt(4)
    v_pk_add_f32 v[92:93], v[92:93], 1.0 op_sel_hi:[1,0]
    v_pk_add_f32 v[94:95], v[94:95], 1.0 op_sel_hi:[1,0]
    v_pk_add_f32 v[96:97], v[96:97], 1.0 op_sel_hi:[1,0]
    v_pk_add_f32 v[98:99], v[98:99], 1.0 op_sel_hi:[1,0]
    ds_read_b64_tr_b16 v[40:41], v34 offset:0
    ds_read_b64_tr_b16 v[42:43], v34 offset:1024
    s_waitcnt lgkmcnt(0)
    v_lshlrev_b32 v44, 16, v40
    v_and_b32 v45, 0xffff0000, v40
    v_lshlrev_b32 v46, 16, v41
    v_and_b32 v47, 0xffff0000, v41
    v_lshlrev_b32 v48, 16, v42
    v_and_b32 v49, 0xffff0000, v42
    v_lshlrev_b32 v50, 16, v43
    v_and_b32 v51, 0xffff0000, v43
    v_fmac_f32 v52, v44, v84
    v_fmac_f32 v52, v45, v85
    v_fmac_f32 v52, v46, v86
    v_fmac_f32 v52, v47, v87
    v_fmac_f32 v52, v48, v88
    v_fmac_f32 v52, v49, v89
    v_fmac_f32 v52, v50, v90
    v_fmac_f32 v52, v51, v91
    v_pk_mul_f32 v[44:45], v[44:45], v[92:93]
    v_pk_mul_f32 v[46:47], v[46:47], v[94:95]
    v_pk_mul_f32 v[48:49], v[48:49], v[96:97]
    v_pk_mul_f32 v[50:51], v[50:51], v[98:99]
    v_cvt_pk_bf16_f32 v128, v44, v45
    v_cvt_pk_bf16_f32 v129, v46, v47
    v_cvt_pk_bf16_f32 v130, v48, v49
    v_cvt_pk_bf16_f32 v131, v50, v51
    v_lshlrev_b32 v44, 16, v128
    v_and_b32 v45, 0xffff0000, v128
    v_add_f32 v54, v54, v44
    v_add_f32 v54, v54, v45
    v_lshlrev_b32 v44, 16, v129
    v_and_b32 v45, 0xffff0000, v129
    v_add_f32 v54, v54, v44
    v_add_f32 v54, v54, v45
    v_lshlrev_b32 v44, 16, v130
    v_and_b32 v45, 0xffff0000, v130
    v_add_f32 v54, v54, v44
    v_add_f32 v54, v54, v45
    v_lshlrev_b32 v44, 16, v131
    v_and_b32 v45, 0xffff0000, v131
    v_add_f32 v54, v54, v44
    v_add_f32 v54, v54, v45
    ds_read_b64_tr_b16 v[40:41], v34 offset:32
    ds_read_b64_tr_b16 v[42:43], v34 offset:1056
    s_waitcnt lgkmcnt(0)
    v_lshlrev_b32 v44, 16, v40
    v_and_b32 v45, 0xffff0000, v40
    v_lshlrev_b32 v46, 16, v41
    v_and_b32 v47, 0xffff0000, v41
    v_lshlrev_b32 v48, 16, v42
    v_and_b32 v49, 0xffff0000, v42
    v_lshlrev_b32 v50, 16, v43
    v_and_b32 v51, 0xffff0000, v43
    v_fmac_f32 v53, v44, v84
    v_fmac_f32 v53, v45, v85
    v_fmac_f32 v53, v46, v86
    v_fmac_f32 v53, v47, v87
    v_fmac_f32 v53, v48, v88
    v_fmac_f32 v53, v49, v89
    v_fmac_f32 v53, v50, v90
    v_fmac_f32 v53, v51, v91
    v_pk_mul_f32 v[44:45], v[44:45], v[92:93]
    v_pk_mul_f32 v[46:47], v[46:47], v[94:95]
    v_pk_mul_f32 v[48:49], v[48:49], v[96:97]
    v_pk_mul_f32 v[50:51], v[50:51], v[98:99]
    v_cvt_pk_bf16_f32 v184, v44, v45
    v_cvt_pk_bf16_f32 v185, v46, v47
    v_cvt_pk_bf16_f32 v186, v48, v49
    v_cvt_pk_bf16_f32 v187, v50, v51
    v_lshlrev_b32 v44, 16, v184
    v_and_b32 v45, 0xffff0000, v184
    v_add_f32 v55, v55, v44
    v_add_f32 v55, v55, v45
    v_lshlrev_b32 v44, 16, v185
    v_and_b32 v45, 0xffff0000, v185
    v_add_f32 v55, v55, v44
    v_add_f32 v55, v55, v45
    v_lshlrev_b32 v44, 16, v186
    v_and_b32 v45, 0xffff0000, v186
    v_add_f32 v55, v55, v44
    v_add_f32 v55, v55, v45
    v_lshlrev_b32 v44, 16, v187
    v_and_b32 v45, 0xffff0000, v187
    v_add_f32 v55, v55, v44
    v_add_f32 v55, v55, v45
    buffer_load_dwordx4 v[84:87], v35, s[8:11], s38 offen offset:256
    buffer_load_dwordx4 v[92:95], v35, s[8:11], s39 offen offset:256
    buffer_load_dwordx4 v[88:91], v35, s[8:11], s38 offen offset:320
    buffer_load_dwordx4 v[96:99], v35, s[8:11], s39 offen offset:320
    s_waitcnt vmcnt(4)
    v_pk_add_f32 v[108:109], v[108:109], 1.0 op_sel_hi:[1,0]
    v_pk_add_f32 v[110:111], v[110:111], 1.0 op_sel_hi:[1,0]
    v_pk_add_f32 v[112:113], v[112:113], 1.0 op_sel_hi:[1,0]
    v_pk_add_f32 v[114:115], v[114:115], 1.0 op_sel_hi:[1,0]
    ds_read_b64_tr_b16 v[40:41], v34 offset:2048
    ds_read_b64_tr_b16 v[42:43], v34 offset:3072
    s_waitcnt lgkmcnt(0)
    v_lshlrev_b32 v44, 16, v40
    v_and_b32 v45, 0xffff0000, v40
    v_lshlrev_b32 v46, 16, v41
    v_and_b32 v47, 0xffff0000, v41
    v_lshlrev_b32 v48, 16, v42
    v_and_b32 v49, 0xffff0000, v42
    v_lshlrev_b32 v50, 16, v43
    v_and_b32 v51, 0xffff0000, v43
    v_fmac_f32 v52, v44, v100
    v_fmac_f32 v52, v45, v101
    v_fmac_f32 v52, v46, v102
    v_fmac_f32 v52, v47, v103
    v_fmac_f32 v52, v48, v104
    v_fmac_f32 v52, v49, v105
    v_fmac_f32 v52, v50, v106
    v_fmac_f32 v52, v51, v107
    v_pk_mul_f32 v[44:45], v[44:45], v[108:109]
    v_pk_mul_f32 v[46:47], v[46:47], v[110:111]
    v_pk_mul_f32 v[48:49], v[48:49], v[112:113]
    v_pk_mul_f32 v[50:51], v[50:51], v[114:115]
    v_cvt_pk_bf16_f32 v132, v44, v45
    v_cvt_pk_bf16_f32 v133, v46, v47
    v_cvt_pk_bf16_f32 v134, v48, v49
    v_cvt_pk_bf16_f32 v135, v50, v51
    v_lshlrev_b32 v44, 16, v132
    v_and_b32 v45, 0xffff0000, v132
    v_add_f32 v54, v54, v44
    v_add_f32 v54, v54, v45
    v_lshlrev_b32 v44, 16, v133
    v_and_b32 v45, 0xffff0000, v133
    v_add_f32 v54, v54, v44
    v_add_f32 v54, v54, v45
    v_lshlrev_b32 v44, 16, v134
    v_and_b32 v45, 0xffff0000, v134
    v_add_f32 v54, v54, v44
    v_add_f32 v54, v54, v45
    v_lshlrev_b32 v44, 16, v135
    v_and_b32 v45, 0xffff0000, v135
    v_add_f32 v54, v54, v44
    v_add_f32 v54, v54, v45
    ds_read_b64_tr_b16 v[40:41], v34 offset:2080
    ds_read_b64_tr_b16 v[42:43], v34 offset:3104
    s_waitcnt lgkmcnt(0)
    v_lshlrev_b32 v44, 16, v40
    v_and_b32 v45, 0xffff0000, v40
    v_lshlrev_b32 v46, 16, v41
    v_and_b32 v47, 0xffff0000, v41
    v_lshlrev_b32 v48, 16, v42
    v_and_b32 v49, 0xffff0000, v42
    v_lshlrev_b32 v50, 16, v43
    v_and_b32 v51, 0xffff0000, v43
    v_fmac_f32 v53, v44, v100
    v_fmac_f32 v53, v45, v101
    v_fmac_f32 v53, v46, v102
    v_fmac_f32 v53, v47, v103
    v_fmac_f32 v53, v48, v104
    v_fmac_f32 v53, v49, v105
    v_fmac_f32 v53, v50, v106
    v_fmac_f32 v53, v51, v107
    v_pk_mul_f32 v[44:45], v[44:45], v[108:109]
    v_pk_mul_f32 v[46:47], v[46:47], v[110:111]
    v_pk_mul_f32 v[48:49], v[48:49], v[112:113]
    v_pk_mul_f32 v[50:51], v[50:51], v[114:115]
    v_cvt_pk_bf16_f32 v188, v44, v45
    v_cvt_pk_bf16_f32 v189, v46, v47
    v_cvt_pk_bf16_f32 v190, v48, v49
    v_cvt_pk_bf16_f32 v191, v50, v51
    v_lshlrev_b32 v44, 16, v188
    v_and_b32 v45, 0xffff0000, v188
    v_add_f32 v55, v55, v44
    v_add_f32 v55, v55, v45
    v_lshlrev_b32 v44, 16, v189
    v_and_b32 v45, 0xffff0000, v189
    v_add_f32 v55, v55, v44
    v_add_f32 v55, v55, v45
    v_lshlrev_b32 v44, 16, v190
    v_and_b32 v45, 0xffff0000, v190
    v_add_f32 v55, v55, v44
    v_add_f32 v55, v55, v45
    v_lshlrev_b32 v44, 16, v191
    v_and_b32 v45, 0xffff0000, v191
    v_add_f32 v55, v55, v44
    v_add_f32 v55, v55, v45
    buffer_load_dwordx4 v[100:103], v35, s[8:11], s38 offen offset:384
    buffer_load_dwordx4 v[108:111], v35, s[8:11], s39 offen offset:384
    buffer_load_dwordx4 v[104:107], v35, s[8:11], s38 offen offset:448
    buffer_load_dwordx4 v[112:115], v35, s[8:11], s39 offen offset:448
    s_waitcnt vmcnt(4)
    v_pk_add_f32 v[92:93], v[92:93], 1.0 op_sel_hi:[1,0]
    v_pk_add_f32 v[94:95], v[94:95], 1.0 op_sel_hi:[1,0]
    v_pk_add_f32 v[96:97], v[96:97], 1.0 op_sel_hi:[1,0]
    v_pk_add_f32 v[98:99], v[98:99], 1.0 op_sel_hi:[1,0]
    ds_read_b64_tr_b16 v[40:41], v34 offset:4096
    ds_read_b64_tr_b16 v[42:43], v34 offset:5120
    s_waitcnt lgkmcnt(0)
    v_lshlrev_b32 v44, 16, v40
    v_and_b32 v45, 0xffff0000, v40
    v_lshlrev_b32 v46, 16, v41
    v_and_b32 v47, 0xffff0000, v41
    v_lshlrev_b32 v48, 16, v42
    v_and_b32 v49, 0xffff0000, v42
    v_lshlrev_b32 v50, 16, v43
    v_and_b32 v51, 0xffff0000, v43
    v_fmac_f32 v52, v44, v84
    v_fmac_f32 v52, v45, v85
    v_fmac_f32 v52, v46, v86
    v_fmac_f32 v52, v47, v87
    v_fmac_f32 v52, v48, v88
    v_fmac_f32 v52, v49, v89
    v_fmac_f32 v52, v50, v90
    v_fmac_f32 v52, v51, v91
    v_pk_mul_f32 v[44:45], v[44:45], v[92:93]
    v_pk_mul_f32 v[46:47], v[46:47], v[94:95]
    v_pk_mul_f32 v[48:49], v[48:49], v[96:97]
    v_pk_mul_f32 v[50:51], v[50:51], v[98:99]
    v_cvt_pk_bf16_f32 v136, v44, v45
    v_cvt_pk_bf16_f32 v137, v46, v47
    v_cvt_pk_bf16_f32 v138, v48, v49
    v_cvt_pk_bf16_f32 v139, v50, v51
    v_lshlrev_b32 v44, 16, v136
    v_and_b32 v45, 0xffff0000, v136
    v_add_f32 v54, v54, v44
    v_add_f32 v54, v54, v45
    v_lshlrev_b32 v44, 16, v137
    v_and_b32 v45, 0xffff0000, v137
    v_add_f32 v54, v54, v44
    v_add_f32 v54, v54, v45
    v_lshlrev_b32 v44, 16, v138
    v_and_b32 v45, 0xffff0000, v138
    v_add_f32 v54, v54, v44
    v_add_f32 v54, v54, v45
    v_lshlrev_b32 v44, 16, v139
    v_and_b32 v45, 0xffff0000, v139
    v_add_f32 v54, v54, v44
    v_add_f32 v54, v54, v45
    ds_read_b64_tr_b16 v[40:41], v34 offset:4128
    ds_read_b64_tr_b16 v[42:43], v34 offset:5152
    s_waitcnt lgkmcnt(0)
    v_lshlrev_b32 v44, 16, v40
    v_and_b32 v45, 0xffff0000, v40
    v_lshlrev_b32 v46, 16, v41
    v_and_b32 v47, 0xffff0000, v41
    v_lshlrev_b32 v48, 16, v42
    v_and_b32 v49, 0xffff0000, v42
    v_lshlrev_b32 v50, 16, v43
    v_and_b32 v51, 0xffff0000, v43
    v_fmac_f32 v53, v44, v84
    v_fmac_f32 v53, v45, v85
    v_fmac_f32 v53, v46, v86
    v_fmac_f32 v53, v47, v87
    v_fmac_f32 v53, v48, v88
    v_fmac_f32 v53, v49, v89
    v_fmac_f32 v53, v50, v90
    v_fmac_f32 v53, v51, v91
    v_pk_mul_f32 v[44:45], v[44:45], v[92:93]
    v_pk_mul_f32 v[46:47], v[46:47], v[94:95]
    v_pk_mul_f32 v[48:49], v[48:49], v[96:97]
    v_pk_mul_f32 v[50:51], v[50:51], v[98:99]
    v_cvt_pk_bf16_f32 v192, v44, v45
    v_cvt_pk_bf16_f32 v193, v46, v47
    v_cvt_pk_bf16_f32 v194, v48, v49
    v_cvt_pk_bf16_f32 v195, v50, v51
    v_lshlrev_b32 v44, 16, v192
    v_and_b32 v45, 0xffff0000, v192
    v_add_f32 v55, v55, v44
    v_add_f32 v55, v55, v45
    v_lshlrev_b32 v44, 16, v193
    v_and_b32 v45, 0xffff0000, v193
    v_add_f32 v55, v55, v44
    v_add_f32 v55, v55, v45
    v_lshlrev_b32 v44, 16, v194
    v_and_b32 v45, 0xffff0000, v194
    v_add_f32 v55, v55, v44
    v_add_f32 v55, v55, v45
    v_lshlrev_b32 v44, 16, v195
    v_and_b32 v45, 0xffff0000, v195
    v_add_f32 v55, v55, v44
    v_add_f32 v55, v55, v45
    buffer_load_dwordx4 v[84:87], v35, s[8:11], s38 offen offset:512
    buffer_load_dwordx4 v[92:95], v35, s[8:11], s39 offen offset:512
    buffer_load_dwordx4 v[88:91], v35, s[8:11], s38 offen offset:576
    buffer_load_dwordx4 v[96:99], v35, s[8:11], s39 offen offset:576
    s_waitcnt vmcnt(4)
    v_pk_add_f32 v[108:109], v[108:109], 1.0 op_sel_hi:[1,0]
    v_pk_add_f32 v[110:111], v[110:111], 1.0 op_sel_hi:[1,0]
    v_pk_add_f32 v[112:113], v[112:113], 1.0 op_sel_hi:[1,0]
    v_pk_add_f32 v[114:115], v[114:115], 1.0 op_sel_hi:[1,0]
    ds_read_b64_tr_b16 v[40:41], v34 offset:6144
    ds_read_b64_tr_b16 v[42:43], v34 offset:7168
    s_waitcnt lgkmcnt(0)
    v_lshlrev_b32 v44, 16, v40
    v_and_b32 v45, 0xffff0000, v40
    v_lshlrev_b32 v46, 16, v41
    v_and_b32 v47, 0xffff0000, v41
    v_lshlrev_b32 v48, 16, v42
    v_and_b32 v49, 0xffff0000, v42
    v_lshlrev_b32 v50, 16, v43
    v_and_b32 v51, 0xffff0000, v43
    v_fmac_f32 v52, v44, v100
    v_fmac_f32 v52, v45, v101
    v_fmac_f32 v52, v46, v102
    v_fmac_f32 v52, v47, v103
    v_fmac_f32 v52, v48, v104
    v_fmac_f32 v52, v49, v105
    v_fmac_f32 v52, v50, v106
    v_fmac_f32 v52, v51, v107
    v_pk_mul_f32 v[44:45], v[44:45], v[108:109]
    v_pk_mul_f32 v[46:47], v[46:47], v[110:111]
    v_pk_mul_f32 v[48:49], v[48:49], v[112:113]
    v_pk_mul_f32 v[50:51], v[50:51], v[114:115]
    v_cvt_pk_bf16_f32 v140, v44, v45
    v_cvt_pk_bf16_f32 v141, v46, v47
    v_cvt_pk_bf16_f32 v142, v48, v49
    v_cvt_pk_bf16_f32 v143, v50, v51
    v_lshlrev_b32 v44, 16, v140
    v_and_b32 v45, 0xffff0000, v140
    v_add_f32 v54, v54, v44
    v_add_f32 v54, v54, v45
    v_lshlrev_b32 v44, 16, v141
    v_and_b32 v45, 0xffff0000, v141
    v_add_f32 v54, v54, v44
    v_add_f32 v54, v54, v45
    v_lshlrev_b32 v44, 16, v142
    v_and_b32 v45, 0xffff0000, v142
    v_add_f32 v54, v54, v44
    v_add_f32 v54, v54, v45
    v_lshlrev_b32 v44, 16, v143
    v_and_b32 v45, 0xffff0000, v143
    v_add_f32 v54, v54, v44
    v_add_f32 v54, v54, v45
    ds_read_b64_tr_b16 v[40:41], v34 offset:6176
    ds_read_b64_tr_b16 v[42:43], v34 offset:7200
    s_waitcnt lgkmcnt(0)
    v_lshlrev_b32 v44, 16, v40
    v_and_b32 v45, 0xffff0000, v40
    v_lshlrev_b32 v46, 16, v41
    v_and_b32 v47, 0xffff0000, v41
    v_lshlrev_b32 v48, 16, v42
    v_and_b32 v49, 0xffff0000, v42
    v_lshlrev_b32 v50, 16, v43
    v_and_b32 v51, 0xffff0000, v43
    v_fmac_f32 v53, v44, v100
    v_fmac_f32 v53, v45, v101
    v_fmac_f32 v53, v46, v102
    v_fmac_f32 v53, v47, v103
    v_fmac_f32 v53, v48, v104
    v_fmac_f32 v53, v49, v105
    v_fmac_f32 v53, v50, v106
    v_fmac_f32 v53, v51, v107
    v_pk_mul_f32 v[44:45], v[44:45], v[108:109]
    v_pk_mul_f32 v[46:47], v[46:47], v[110:111]
    v_pk_mul_f32 v[48:49], v[48:49], v[112:113]
    v_pk_mul_f32 v[50:51], v[50:51], v[114:115]
    v_cvt_pk_bf16_f32 v196, v44, v45
    v_cvt_pk_bf16_f32 v197, v46, v47
    v_cvt_pk_bf16_f32 v198, v48, v49
    v_cvt_pk_bf16_f32 v199, v50, v51
    v_lshlrev_b32 v44, 16, v196
    v_and_b32 v45, 0xffff0000, v196
    v_add_f32 v55, v55, v44
    v_add_f32 v55, v55, v45
    v_lshlrev_b32 v44, 16, v197
    v_and_b32 v45, 0xffff0000, v197
    v_add_f32 v55, v55, v44
    v_add_f32 v55, v55, v45
    v_lshlrev_b32 v44, 16, v198
    v_and_b32 v45, 0xffff0000, v198
    v_add_f32 v55, v55, v44
    v_add_f32 v55, v55, v45
    v_lshlrev_b32 v44, 16, v199
    v_and_b32 v45, 0xffff0000, v199
    v_add_f32 v55, v55, v44
    v_add_f32 v55, v55, v45
    buffer_load_dwordx4 v[100:103], v35, s[8:11], s38 offen offset:640
    buffer_load_dwordx4 v[108:111], v35, s[8:11], s39 offen offset:640
    buffer_load_dwordx4 v[104:107], v35, s[8:11], s38 offen offset:704
    buffer_load_dwordx4 v[112:115], v35, s[8:11], s39 offen offset:704
    s_waitcnt vmcnt(4)
    v_pk_add_f32 v[92:93], v[92:93], 1.0 op_sel_hi:[1,0]
    v_pk_add_f32 v[94:95], v[94:95], 1.0 op_sel_hi:[1,0]
    v_pk_add_f32 v[96:97], v[96:97], 1.0 op_sel_hi:[1,0]
    v_pk_add_f32 v[98:99], v[98:99], 1.0 op_sel_hi:[1,0]
    ds_read_b64_tr_b16 v[40:41], v34 offset:8192
    ds_read_b64_tr_b16 v[42:43], v34 offset:9216
    s_waitcnt lgkmcnt(0)
    v_lshlrev_b32 v44, 16, v40
    v_and_b32 v45, 0xffff0000, v40
    v_lshlrev_b32 v46, 16, v41
    v_and_b32 v47, 0xffff0000, v41
    v_lshlrev_b32 v48, 16, v42
    v_and_b32 v49, 0xffff0000, v42
    v_lshlrev_b32 v50, 16, v43
    v_and_b32 v51, 0xffff0000, v43
    v_fmac_f32 v52, v44, v84
    v_fmac_f32 v52, v45, v85
    v_fmac_f32 v52, v46, v86
    v_fmac_f32 v52, v47, v87
    v_fmac_f32 v52, v48, v88
    v_fmac_f32 v52, v49, v89
    v_fmac_f32 v52, v50, v90
    v_fmac_f32 v52, v51, v91
    v_pk_mul_f32 v[44:45], v[44:45], v[92:93]
    v_pk_mul_f32 v[46:47], v[46:47], v[94:95]
    v_pk_mul_f32 v[48:49], v[48:49], v[96:97]
    v_pk_mul_f32 v[50:51], v[50:51], v[98:99]
    v_cvt_pk_bf16_f32 v144, v44, v45
    v_cvt_pk_bf16_f32 v145, v46, v47
    v_cvt_pk_bf16_f32 v146, v48, v49
    v_cvt_pk_bf16_f32 v147, v50, v51
    v_lshlrev_b32 v44, 16, v144
    v_and_b32 v45, 0xffff0000, v144
    v_add_f32 v54, v54, v44
    v_add_f32 v54, v54, v45
    v_lshlrev_b32 v44, 16, v145
    v_and_b32 v45, 0xffff0000, v145
    v_add_f32 v54, v54, v44
    v_add_f32 v54, v54, v45
    v_lshlrev_b32 v44, 16, v146
    v_and_b32 v45, 0xffff0000, v146
    v_add_f32 v54, v54, v44
    v_add_f32 v54, v54, v45
    v_lshlrev_b32 v44, 16, v147
    v_and_b32 v45, 0xffff0000, v147
    v_add_f32 v54, v54, v44
    v_add_f32 v54, v54, v45
    ds_read_b64_tr_b16 v[40:41], v34 offset:8224
    ds_read_b64_tr_b16 v[42:43], v34 offset:9248
    s_waitcnt lgkmcnt(0)
    v_lshlrev_b32 v44, 16, v40
    v_and_b32 v45, 0xffff0000, v40
    v_lshlrev_b32 v46, 16, v41
    v_and_b32 v47, 0xffff0000, v41
    v_lshlrev_b32 v48, 16, v42
    v_and_b32 v49, 0xffff0000, v42
    v_lshlrev_b32 v50, 16, v43
    v_and_b32 v51, 0xffff0000, v43
    v_fmac_f32 v53, v44, v84
    v_fmac_f32 v53, v45, v85
    v_fmac_f32 v53, v46, v86
    v_fmac_f32 v53, v47, v87
    v_fmac_f32 v53, v48, v88
    v_fmac_f32 v53, v49, v89
    v_fmac_f32 v53, v50, v90
    v_fmac_f32 v53, v51, v91
    v_pk_mul_f32 v[44:45], v[44:45], v[92:93]
    v_pk_mul_f32 v[46:47], v[46:47], v[94:95]
    v_pk_mul_f32 v[48:49], v[48:49], v[96:97]
    v_pk_mul_f32 v[50:51], v[50:51], v[98:99]
    v_cvt_pk_bf16_f32 v200, v44, v45
    v_cvt_pk_bf16_f32 v201, v46, v47
    v_cvt_pk_bf16_f32 v202, v48, v49
    v_cvt_pk_bf16_f32 v203, v50, v51
    v_lshlrev_b32 v44, 16, v200
    v_and_b32 v45, 0xffff0000, v200
    v_add_f32 v55, v55, v44
    v_add_f32 v55, v55, v45
    v_lshlrev_b32 v44, 16, v201
    v_and_b32 v45, 0xffff0000, v201
    v_add_f32 v55, v55, v44
    v_add_f32 v55, v55, v45
    v_lshlrev_b32 v44, 16, v202
    v_and_b32 v45, 0xffff0000, v202
    v_add_f32 v55, v55, v44
    v_add_f32 v55, v55, v45
    v_lshlrev_b32 v44, 16, v203
    v_and_b32 v45, 0xffff0000, v203
    v_add_f32 v55, v55, v44
    v_add_f32 v55, v55, v45
    buffer_load_dwordx4 v[84:87], v35, s[8:11], s38 offen offset:768
    buffer_load_dwordx4 v[92:95], v35, s[8:11], s39 offen offset:768
    buffer_load_dwordx4 v[88:91], v35, s[8:11], s38 offen offset:832
    buffer_load_dwordx4 v[96:99], v35, s[8:11], s39 offen offset:832
    s_waitcnt vmcnt(4)
    v_pk_add_f32 v[108:109], v[108:109], 1.0 op_sel_hi:[1,0]
    v_pk_add_f32 v[110:111], v[110:111], 1.0 op_sel_hi:[1,0]
    v_pk_add_f32 v[112:113], v[112:113], 1.0 op_sel_hi:[1,0]
    v_pk_add_f32 v[114:115], v[114:115], 1.0 op_sel_hi:[1,0]
    ds_read_b64_tr_b16 v[40:41], v34 offset:10240
    ds_read_b64_tr_b16 v[42:43], v34 offset:11264
    s_waitcnt lgkmcnt(0)
    v_lshlrev_b32 v44, 16, v40
    v_and_b32 v45, 0xffff0000, v40
    v_lshlrev_b32 v46, 16, v41
    v_and_b32 v47, 0xffff0000, v41
    v_lshlrev_b32 v48, 16, v42
    v_and_b32 v49, 0xffff0000, v42
    v_lshlrev_b32 v50, 16, v43
    v_and_b32 v51, 0xffff0000, v43
    v_fmac_f32 v52, v44, v100
    v_fmac_f32 v52, v45, v101
    v_fmac_f32 v52, v46, v102
    v_fmac_f32 v52, v47, v103
    v_fmac_f32 v52, v48, v104
    v_fmac_f32 v52, v49, v105
    v_fmac_f32 v52, v50, v106
    v_fmac_f32 v52, v51, v107
    v_pk_mul_f32 v[44:45], v[44:45], v[108:109]
    v_pk_mul_f32 v[46:47], v[46:47], v[110:111]
    v_pk_mul_f32 v[48:49], v[48:49], v[112:113]
    v_pk_mul_f32 v[50:51], v[50:51], v[114:115]
    v_cvt_pk_bf16_f32 v148, v44, v45
    v_cvt_pk_bf16_f32 v149, v46, v47
    v_cvt_pk_bf16_f32 v150, v48, v49
    v_cvt_pk_bf16_f32 v151, v50, v51
    v_lshlrev_b32 v44, 16, v148
    v_and_b32 v45, 0xffff0000, v148
    v_add_f32 v54, v54, v44
    v_add_f32 v54, v54, v45
    v_lshlrev_b32 v44, 16, v149
    v_and_b32 v45, 0xffff0000, v149
    v_add_f32 v54, v54, v44
    v_add_f32 v54, v54, v45
    v_lshlrev_b32 v44, 16, v150
    v_and_b32 v45, 0xffff0000, v150
    v_add_f32 v54, v54, v44
    v_add_f32 v54, v54, v45
    v_lshlrev_b32 v44, 16, v151
    v_and_b32 v45, 0xffff0000, v151
    v_add_f32 v54, v54, v44
    v_add_f32 v54, v54, v45
    ds_read_b64_tr_b16 v[40:41], v34 offset:10272
    ds_read_b64_tr_b16 v[42:43], v34 offset:11296
    s_waitcnt lgkmcnt(0)
    v_lshlrev_b32 v44, 16, v40
    v_and_b32 v45, 0xffff0000, v40
    v_lshlrev_b32 v46, 16, v41
    v_and_b32 v47, 0xffff0000, v41
    v_lshlrev_b32 v48, 16, v42
    v_and_b32 v49, 0xffff0000, v42
    v_lshlrev_b32 v50, 16, v43
    v_and_b32 v51, 0xffff0000, v43
    v_fmac_f32 v53, v44, v100
    v_fmac_f32 v53, v45, v101
    v_fmac_f32 v53, v46, v102
    v_fmac_f32 v53, v47, v103
    v_fmac_f32 v53, v48, v104
    v_fmac_f32 v53, v49, v105
    v_fmac_f32 v53, v50, v106
    v_fmac_f32 v53, v51, v107
    v_pk_mul_f32 v[44:45], v[44:45], v[108:109]
    v_pk_mul_f32 v[46:47], v[46:47], v[110:111]
    v_pk_mul_f32 v[48:49], v[48:49], v[112:113]
    v_pk_mul_f32 v[50:51], v[50:51], v[114:115]
    v_cvt_pk_bf16_f32 v204, v44, v45
    v_cvt_pk_bf16_f32 v205, v46, v47
    v_cvt_pk_bf16_f32 v206, v48, v49
    v_cvt_pk_bf16_f32 v207, v50, v51
    v_lshlrev_b32 v44, 16, v204
    v_and_b32 v45, 0xffff0000, v204
    v_add_f32 v55, v55, v44
    v_add_f32 v55, v55, v45
    v_lshlrev_b32 v44, 16, v205
    v_and_b32 v45, 0xffff0000, v205
    v_add_f32 v55, v55, v44
    v_add_f32 v55, v55, v45
    v_lshlrev_b32 v44, 16, v206
    v_and_b32 v45, 0xffff0000, v206
    v_add_f32 v55, v55, v44
    v_add_f32 v55, v55, v45
    v_lshlrev_b32 v44, 16, v207
    v_and_b32 v45, 0xffff0000, v207
    v_add_f32 v55, v55, v44
    v_add_f32 v55, v55, v45
    buffer_load_dwordx4 v[100:103], v35, s[8:11], s38 offen offset:896
    buffer_load_dwordx4 v[108:111], v35, s[8:11], s39 offen offset:896
    buffer_load_dwordx4 v[104:107], v35, s[8:11], s38 offen offset:960
    buffer_load_dwordx4 v[112:115], v35, s[8:11], s39 offen offset:960
    s_waitcnt vmcnt(4)
    v_pk_add_f32 v[92:93], v[92:93], 1.0 op_sel_hi:[1,0]
    v_pk_add_f32 v[94:95], v[94:95], 1.0 op_sel_hi:[1,0]
    v_pk_add_f32 v[96:97], v[96:97], 1.0 op_sel_hi:[1,0]
    v_pk_add_f32 v[98:99], v[98:99], 1.0 op_sel_hi:[1,0]
    ds_read_b64_tr_b16 v[40:41], v34 offset:12288
    ds_read_b64_tr_b16 v[42:43], v34 offset:13312
    s_waitcnt lgkmcnt(0)
    v_lshlrev_b32 v44, 16, v40
    v_and_b32 v45, 0xffff0000, v40
    v_lshlrev_b32 v46, 16, v41
    v_and_b32 v47, 0xffff0000, v41
    v_lshlrev_b32 v48, 16, v42
    v_and_b32 v49, 0xffff0000, v42
    v_lshlrev_b32 v50, 16, v43
    v_and_b32 v51, 0xffff0000, v43
    v_fmac_f32 v52, v44, v84
    v_fmac_f32 v52, v45, v85
    v_fmac_f32 v52, v46, v86
    v_fmac_f32 v52, v47, v87
    v_fmac_f32 v52, v48, v88
    v_fmac_f32 v52, v49, v89
    v_fmac_f32 v52, v50, v90
    v_fmac_f32 v52, v51, v91
    v_pk_mul_f32 v[44:45], v[44:45], v[92:93]
    v_pk_mul_f32 v[46:47], v[46:47], v[94:95]
    v_pk_mul_f32 v[48:49], v[48:49], v[96:97]
    v_pk_mul_f32 v[50:51], v[50:51], v[98:99]
    v_cvt_pk_bf16_f32 v152, v44, v45
    v_cvt_pk_bf16_f32 v153, v46, v47
    v_cvt_pk_bf16_f32 v154, v48, v49
    v_cvt_pk_bf16_f32 v155, v50, v51
    v_lshlrev_b32 v44, 16, v152
    v_and_b32 v45, 0xffff0000, v152
    v_add_f32 v54, v54, v44
    v_add_f32 v54, v54, v45
    v_lshlrev_b32 v44, 16, v153
    v_and_b32 v45, 0xffff0000, v153
    v_add_f32 v54, v54, v44
    v_add_f32 v54, v54, v45
    v_lshlrev_b32 v44, 16, v154
    v_and_b32 v45, 0xffff0000, v154
    v_add_f32 v54, v54, v44
    v_add_f32 v54, v54, v45
    v_lshlrev_b32 v44, 16, v155
    v_and_b32 v45, 0xffff0000, v155
    v_add_f32 v54, v54, v44
    v_add_f32 v54, v54, v45
    ds_read_b64_tr_b16 v[40:41], v34 offset:12320
    ds_read_b64_tr_b16 v[42:43], v34 offset:13344
    s_waitcnt lgkmcnt(0)
    v_lshlrev_b32 v44, 16, v40
    v_and_b32 v45, 0xffff0000, v40
    v_lshlrev_b32 v46, 16, v41
    v_and_b32 v47, 0xffff0000, v41
    v_lshlrev_b32 v48, 16, v42
    v_and_b32 v49, 0xffff0000, v42
    v_lshlrev_b32 v50, 16, v43
    v_and_b32 v51, 0xffff0000, v43
    v_fmac_f32 v53, v44, v84
    v_fmac_f32 v53, v45, v85
    v_fmac_f32 v53, v46, v86
    v_fmac_f32 v53, v47, v87
    v_fmac_f32 v53, v48, v88
    v_fmac_f32 v53, v49, v89
    v_fmac_f32 v53, v50, v90
    v_fmac_f32 v53, v51, v91
    v_pk_mul_f32 v[44:45], v[44:45], v[92:93]
    v_pk_mul_f32 v[46:47], v[46:47], v[94:95]
    v_pk_mul_f32 v[48:49], v[48:49], v[96:97]
    v_pk_mul_f32 v[50:51], v[50:51], v[98:99]
    v_cvt_pk_bf16_f32 v208, v44, v45
    v_cvt_pk_bf16_f32 v209, v46, v47
    v_cvt_pk_bf16_f32 v210, v48, v49
    v_cvt_pk_bf16_f32 v211, v50, v51
    v_lshlrev_b32 v44, 16, v208
    v_and_b32 v45, 0xffff0000, v208
    v_add_f32 v55, v55, v44
    v_add_f32 v55, v55, v45
    v_lshlrev_b32 v44, 16, v209
    v_and_b32 v45, 0xffff0000, v209
    v_add_f32 v55, v55, v44
    v_add_f32 v55, v55, v45
    v_lshlrev_b32 v44, 16, v210
    v_and_b32 v45, 0xffff0000, v210
    v_add_f32 v55, v55, v44
    v_add_f32 v55, v55, v45
    v_lshlrev_b32 v44, 16, v211
    v_and_b32 v45, 0xffff0000, v211
    v_add_f32 v55, v55, v44
    v_add_f32 v55, v55, v45
    buffer_load_dwordx4 v[84:87], v35, s[8:11], s38 offen offset:1024
    buffer_load_dwordx4 v[92:95], v35, s[8:11], s39 offen offset:1024
    buffer_load_dwordx4 v[88:91], v35, s[8:11], s38 offen offset:1088
    buffer_load_dwordx4 v[96:99], v35, s[8:11], s39 offen offset:1088
    s_waitcnt vmcnt(4)
    v_pk_add_f32 v[108:109], v[108:109], 1.0 op_sel_hi:[1,0]
    v_pk_add_f32 v[110:111], v[110:111], 1.0 op_sel_hi:[1,0]
    v_pk_add_f32 v[112:113], v[112:113], 1.0 op_sel_hi:[1,0]
    v_pk_add_f32 v[114:115], v[114:115], 1.0 op_sel_hi:[1,0]
    ds_read_b64_tr_b16 v[40:41], v34 offset:14336
    ds_read_b64_tr_b16 v[42:43], v34 offset:15360
    s_waitcnt lgkmcnt(0)
    v_lshlrev_b32 v44, 16, v40
    v_and_b32 v45, 0xffff0000, v40
    v_lshlrev_b32 v46, 16, v41
    v_and_b32 v47, 0xffff0000, v41
    v_lshlrev_b32 v48, 16, v42
    v_and_b32 v49, 0xffff0000, v42
    v_lshlrev_b32 v50, 16, v43
    v_and_b32 v51, 0xffff0000, v43
    v_fmac_f32 v52, v44, v100
    v_fmac_f32 v52, v45, v101
    v_fmac_f32 v52, v46, v102
    v_fmac_f32 v52, v47, v103
    v_fmac_f32 v52, v48, v104
    v_fmac_f32 v52, v49, v105
    v_fmac_f32 v52, v50, v106
    v_fmac_f32 v52, v51, v107
    v_pk_mul_f32 v[44:45], v[44:45], v[108:109]
    v_pk_mul_f32 v[46:47], v[46:47], v[110:111]
    v_pk_mul_f32 v[48:49], v[48:49], v[112:113]
    v_pk_mul_f32 v[50:51], v[50:51], v[114:115]
    v_cvt_pk_bf16_f32 v156, v44, v45
    v_cvt_pk_bf16_f32 v157, v46, v47
    v_cvt_pk_bf16_f32 v158, v48, v49
    v_cvt_pk_bf16_f32 v159, v50, v51
    v_lshlrev_b32 v44, 16, v156
    v_and_b32 v45, 0xffff0000, v156
    v_add_f32 v54, v54, v44
    v_add_f32 v54, v54, v45
    v_lshlrev_b32 v44, 16, v157
    v_and_b32 v45, 0xffff0000, v157
    v_add_f32 v54, v54, v44
    v_add_f32 v54, v54, v45
    v_lshlrev_b32 v44, 16, v158
    v_and_b32 v45, 0xffff0000, v158
    v_add_f32 v54, v54, v44
    v_add_f32 v54, v54, v45
    v_lshlrev_b32 v44, 16, v159
    v_and_b32 v45, 0xffff0000, v159
    v_add_f32 v54, v54, v44
    v_add_f32 v54, v54, v45
    ds_read_b64_tr_b16 v[40:41], v34 offset:14368
    ds_read_b64_tr_b16 v[42:43], v34 offset:15392
    s_waitcnt lgkmcnt(0)
    v_lshlrev_b32 v44, 16, v40
    v_and_b32 v45, 0xffff0000, v40
    v_lshlrev_b32 v46, 16, v41
    v_and_b32 v47, 0xffff0000, v41
    v_lshlrev_b32 v48, 16, v42
    v_and_b32 v49, 0xffff0000, v42
    v_lshlrev_b32 v50, 16, v43
    v_and_b32 v51, 0xffff0000, v43
    v_fmac_f32 v53, v44, v100
    v_fmac_f32 v53, v45, v101
    v_fmac_f32 v53, v46, v102
    v_fmac_f32 v53, v47, v103
    v_fmac_f32 v53, v48, v104
    v_fmac_f32 v53, v49, v105
    v_fmac_f32 v53, v50, v106
    v_fmac_f32 v53, v51, v107
    v_pk_mul_f32 v[44:45], v[44:45], v[108:109]
    v_pk_mul_f32 v[46:47], v[46:47], v[110:111]
    v_pk_mul_f32 v[48:49], v[48:49], v[112:113]
    v_pk_mul_f32 v[50:51], v[50:51], v[114:115]
    v_cvt_pk_bf16_f32 v212, v44, v45
    v_cvt_pk_bf16_f32 v213, v46, v47
    v_cvt_pk_bf16_f32 v214, v48, v49
    v_cvt_pk_bf16_f32 v215, v50, v51
    v_lshlrev_b32 v44, 16, v212
    v_and_b32 v45, 0xffff0000, v212
    v_add_f32 v55, v55, v44
    v_add_f32 v55, v55, v45
    v_lshlrev_b32 v44, 16, v213
    v_and_b32 v45, 0xffff0000, v213
    v_add_f32 v55, v55, v44
    v_add_f32 v55, v55, v45
    v_lshlrev_b32 v44, 16, v214
    v_and_b32 v45, 0xffff0000, v214
    v_add_f32 v55, v55, v44
    v_add_f32 v55, v55, v45
    v_lshlrev_b32 v44, 16, v215
    v_and_b32 v45, 0xffff0000, v215
    v_add_f32 v55, v55, v44
    v_add_f32 v55, v55, v45
    buffer_load_dwordx4 v[100:103], v35, s[8:11], s38 offen offset:1152
    buffer_load_dwordx4 v[108:111], v35, s[8:11], s39 offen offset:1152
    buffer_load_dwordx4 v[104:107], v35, s[8:11], s38 offen offset:1216
    buffer_load_dwordx4 v[112:115], v35, s[8:11], s39 offen offset:1216
    s_waitcnt vmcnt(4)
    v_pk_add_f32 v[92:93], v[92:93], 1.0 op_sel_hi:[1,0]
    v_pk_add_f32 v[94:95], v[94:95], 1.0 op_sel_hi:[1,0]
    v_pk_add_f32 v[96:97], v[96:97], 1.0 op_sel_hi:[1,0]
    v_pk_add_f32 v[98:99], v[98:99], 1.0 op_sel_hi:[1,0]
    ds_read_b64_tr_b16 v[40:41], v34 offset:16384
    ds_read_b64_tr_b16 v[42:43], v34 offset:17408
    s_waitcnt lgkmcnt(0)
    v_lshlrev_b32 v44, 16, v40
    v_and_b32 v45, 0xffff0000, v40
    v_lshlrev_b32 v46, 16, v41
    v_and_b32 v47, 0xffff0000, v41
    v_lshlrev_b32 v48, 16, v42
    v_and_b32 v49, 0xffff0000, v42
    v_lshlrev_b32 v50, 16, v43
    v_and_b32 v51, 0xffff0000, v43
    v_fmac_f32 v52, v44, v84
    v_fmac_f32 v52, v45, v85
    v_fmac_f32 v52, v46, v86
    v_fmac_f32 v52, v47, v87
    v_fmac_f32 v52, v48, v88
    v_fmac_f32 v52, v49, v89
    v_fmac_f32 v52, v50, v90
    v_fmac_f32 v52, v51, v91
    v_pk_mul_f32 v[44:45], v[44:45], v[92:93]
    v_pk_mul_f32 v[46:47], v[46:47], v[94:95]
    v_pk_mul_f32 v[48:49], v[48:49], v[96:97]
    v_pk_mul_f32 v[50:51], v[50:51], v[98:99]
    v_cvt_pk_bf16_f32 v160, v44, v45
    v_cvt_pk_bf16_f32 v161, v46, v47
    v_cvt_pk_bf16_f32 v162, v48, v49
    v_cvt_pk_bf16_f32 v163, v50, v51
    v_lshlrev_b32 v44, 16, v160
    v_and_b32 v45, 0xffff0000, v160
    v_add_f32 v54, v54, v44
    v_add_f32 v54, v54, v45
    v_lshlrev_b32 v44, 16, v161
    v_and_b32 v45, 0xffff0000, v161
    v_add_f32 v54, v54, v44
    v_add_f32 v54, v54, v45
    v_lshlrev_b32 v44, 16, v162
    v_and_b32 v45, 0xffff0000, v162
    v_add_f32 v54, v54, v44
    v_add_f32 v54, v54, v45
    v_lshlrev_b32 v44, 16, v163
    v_and_b32 v45, 0xffff0000, v163
    v_add_f32 v54, v54, v44
    v_add_f32 v54, v54, v45
    ds_read_b64_tr_b16 v[40:41], v34 offset:16416
    ds_read_b64_tr_b16 v[42:43], v34 offset:17440
    s_waitcnt lgkmcnt(0)
    v_lshlrev_b32 v44, 16, v40
    v_and_b32 v45, 0xffff0000, v40
    v_lshlrev_b32 v46, 16, v41
    v_and_b32 v47, 0xffff0000, v41
    v_lshlrev_b32 v48, 16, v42
    v_and_b32 v49, 0xffff0000, v42
    v_lshlrev_b32 v50, 16, v43
    v_and_b32 v51, 0xffff0000, v43
    v_fmac_f32 v53, v44, v84
    v_fmac_f32 v53, v45, v85
    v_fmac_f32 v53, v46, v86
    v_fmac_f32 v53, v47, v87
    v_fmac_f32 v53, v48, v88
    v_fmac_f32 v53, v49, v89
    v_fmac_f32 v53, v50, v90
    v_fmac_f32 v53, v51, v91
    v_pk_mul_f32 v[44:45], v[44:45], v[92:93]
    v_pk_mul_f32 v[46:47], v[46:47], v[94:95]
    v_pk_mul_f32 v[48:49], v[48:49], v[96:97]
    v_pk_mul_f32 v[50:51], v[50:51], v[98:99]
    v_cvt_pk_bf16_f32 v216, v44, v45
    v_cvt_pk_bf16_f32 v217, v46, v47
    v_cvt_pk_bf16_f32 v218, v48, v49
    v_cvt_pk_bf16_f32 v219, v50, v51
    v_lshlrev_b32 v44, 16, v216
    v_and_b32 v45, 0xffff0000, v216
    v_add_f32 v55, v55, v44
    v_add_f32 v55, v55, v45
    v_lshlrev_b32 v44, 16, v217
    v_and_b32 v45, 0xffff0000, v217
    v_add_f32 v55, v55, v44
    v_add_f32 v55, v55, v45
    v_lshlrev_b32 v44, 16, v218
    v_and_b32 v45, 0xffff0000, v218
    v_add_f32 v55, v55, v44
    v_add_f32 v55, v55, v45
    v_lshlrev_b32 v44, 16, v219
    v_and_b32 v45, 0xffff0000, v219
    v_add_f32 v55, v55, v44
    v_add_f32 v55, v55, v45
    buffer_load_dwordx4 v[84:87], v35, s[8:11], s38 offen offset:1280
    buffer_load_dwordx4 v[92:95], v35, s[8:11], s39 offen offset:1280
    buffer_load_dwordx4 v[88:91], v35, s[8:11], s38 offen offset:1344
    buffer_load_dwordx4 v[96:99], v35, s[8:11], s39 offen offset:1344
    s_waitcnt vmcnt(4)
    v_pk_add_f32 v[108:109], v[108:109], 1.0 op_sel_hi:[1,0]
    v_pk_add_f32 v[110:111], v[110:111], 1.0 op_sel_hi:[1,0]
    v_pk_add_f32 v[112:113], v[112:113], 1.0 op_sel_hi:[1,0]
    v_pk_add_f32 v[114:115], v[114:115], 1.0 op_sel_hi:[1,0]
    ds_read_b64_tr_b16 v[40:41], v34 offset:18432
    ds_read_b64_tr_b16 v[42:43], v34 offset:19456
    s_waitcnt lgkmcnt(0)
    v_lshlrev_b32 v44, 16, v40
    v_and_b32 v45, 0xffff0000, v40
    v_lshlrev_b32 v46, 16, v41
    v_and_b32 v47, 0xffff0000, v41
    v_lshlrev_b32 v48, 16, v42
    v_and_b32 v49, 0xffff0000, v42
    v_lshlrev_b32 v50, 16, v43
    v_and_b32 v51, 0xffff0000, v43
    v_fmac_f32 v52, v44, v100
    v_fmac_f32 v52, v45, v101
    v_fmac_f32 v52, v46, v102
    v_fmac_f32 v52, v47, v103
    v_fmac_f32 v52, v48, v104
    v_fmac_f32 v52, v49, v105
    v_fmac_f32 v52, v50, v106
    v_fmac_f32 v52, v51, v107
    v_pk_mul_f32 v[44:45], v[44:45], v[108:109]
    v_pk_mul_f32 v[46:47], v[46:47], v[110:111]
    v_pk_mul_f32 v[48:49], v[48:49], v[112:113]
    v_pk_mul_f32 v[50:51], v[50:51], v[114:115]
    v_cvt_pk_bf16_f32 v164, v44, v45
    v_cvt_pk_bf16_f32 v165, v46, v47
    v_cvt_pk_bf16_f32 v166, v48, v49
    v_cvt_pk_bf16_f32 v167, v50, v51
    v_lshlrev_b32 v44, 16, v164
    v_and_b32 v45, 0xffff0000, v164
    v_add_f32 v54, v54, v44
    v_add_f32 v54, v54, v45
    v_lshlrev_b32 v44, 16, v165
    v_and_b32 v45, 0xffff0000, v165
    v_add_f32 v54, v54, v44
    v_add_f32 v54, v54, v45
    v_lshlrev_b32 v44, 16, v166
    v_and_b32 v45, 0xffff0000, v166
    v_add_f32 v54, v54, v44
    v_add_f32 v54, v54, v45
    v_lshlrev_b32 v44, 16, v167
    v_and_b32 v45, 0xffff0000, v167
    v_add_f32 v54, v54, v44
    v_add_f32 v54, v54, v45
    ds_read_b64_tr_b16 v[40:41], v34 offset:18464
    ds_read_b64_tr_b16 v[42:43], v34 offset:19488
    s_waitcnt lgkmcnt(0)
    v_lshlrev_b32 v44, 16, v40
    v_and_b32 v45, 0xffff0000, v40
    v_lshlrev_b32 v46, 16, v41
    v_and_b32 v47, 0xffff0000, v41
    v_lshlrev_b32 v48, 16, v42
    v_and_b32 v49, 0xffff0000, v42
    v_lshlrev_b32 v50, 16, v43
    v_and_b32 v51, 0xffff0000, v43
    v_fmac_f32 v53, v44, v100
    v_fmac_f32 v53, v45, v101
    v_fmac_f32 v53, v46, v102
    v_fmac_f32 v53, v47, v103
    v_fmac_f32 v53, v48, v104
    v_fmac_f32 v53, v49, v105
    v_fmac_f32 v53, v50, v106
    v_fmac_f32 v53, v51, v107
    v_pk_mul_f32 v[44:45], v[44:45], v[108:109]
    v_pk_mul_f32 v[46:47], v[46:47], v[110:111]
    v_pk_mul_f32 v[48:49], v[48:49], v[112:113]
    v_pk_mul_f32 v[50:51], v[50:51], v[114:115]
    v_cvt_pk_bf16_f32 v220, v44, v45
    v_cvt_pk_bf16_f32 v221, v46, v47
    v_cvt_pk_bf16_f32 v222, v48, v49
    v_cvt_pk_bf16_f32 v223, v50, v51
    v_lshlrev_b32 v44, 16, v220
    v_and_b32 v45, 0xffff0000, v220
    v_add_f32 v55, v55, v44
    v_add_f32 v55, v55, v45
    v_lshlrev_b32 v44, 16, v221
    v_and_b32 v45, 0xffff0000, v221
    v_add_f32 v55, v55, v44
    v_add_f32 v55, v55, v45
    v_lshlrev_b32 v44, 16, v222
    v_and_b32 v45, 0xffff0000, v222
    v_add_f32 v55, v55, v44
    v_add_f32 v55, v55, v45
    v_lshlrev_b32 v44, 16, v223
    v_and_b32 v45, 0xffff0000, v223
    v_add_f32 v55, v55, v44
    v_add_f32 v55, v55, v45
    buffer_load_dwordx4 v[100:103], v35, s[8:11], s38 offen offset:1408
    buffer_load_dwordx4 v[108:111], v35, s[8:11], s39 offen offset:1408
    buffer_load_dwordx4 v[104:107], v35, s[8:11], s38 offen offset:1472
    buffer_load_dwordx4 v[112:115], v35, s[8:11], s39 offen offset:1472
    s_waitcnt vmcnt(4)
    v_pk_add_f32 v[92:93], v[92:93], 1.0 op_sel_hi:[1,0]
    v_pk_add_f32 v[94:95], v[94:95], 1.0 op_sel_hi:[1,0]
    v_pk_add_f32 v[96:97], v[96:97], 1.0 op_sel_hi:[1,0]
    v_pk_add_f32 v[98:99], v[98:99], 1.0 op_sel_hi:[1,0]
    ds_read_b64_tr_b16 v[40:41], v34 offset:20480
    ds_read_b64_tr_b16 v[42:43], v34 offset:21504
    s_waitcnt lgkmcnt(0)
    v_lshlrev_b32 v44, 16, v40
    v_and_b32 v45, 0xffff0000, v40
    v_lshlrev_b32 v46, 16, v41
    v_and_b32 v47, 0xffff0000, v41
    v_lshlrev_b32 v48, 16, v42
    v_and_b32 v49, 0xffff0000, v42
    v_lshlrev_b32 v50, 16, v43
    v_and_b32 v51, 0xffff0000, v43
    v_fmac_f32 v52, v44, v84
    v_fmac_f32 v52, v45, v85
    v_fmac_f32 v52, v46, v86
    v_fmac_f32 v52, v47, v87
    v_fmac_f32 v52, v48, v88
    v_fmac_f32 v52, v49, v89
    v_fmac_f32 v52, v50, v90
    v_fmac_f32 v52, v51, v91
    v_pk_mul_f32 v[44:45], v[44:45], v[92:93]
    v_pk_mul_f32 v[46:47], v[46:47], v[94:95]
    v_pk_mul_f32 v[48:49], v[48:49], v[96:97]
    v_pk_mul_f32 v[50:51], v[50:51], v[98:99]
    v_cvt_pk_bf16_f32 v168, v44, v45
    v_cvt_pk_bf16_f32 v169, v46, v47
    v_cvt_pk_bf16_f32 v170, v48, v49
    v_cvt_pk_bf16_f32 v171, v50, v51
    v_lshlrev_b32 v44, 16, v168
    v_and_b32 v45, 0xffff0000, v168
    v_add_f32 v54, v54, v44
    v_add_f32 v54, v54, v45
    v_lshlrev_b32 v44, 16, v169
    v_and_b32 v45, 0xffff0000, v169
    v_add_f32 v54, v54, v44
    v_add_f32 v54, v54, v45
    v_lshlrev_b32 v44, 16, v170
    v_and_b32 v45, 0xffff0000, v170
    v_add_f32 v54, v54, v44
    v_add_f32 v54, v54, v45
    v_lshlrev_b32 v44, 16, v171
    v_and_b32 v45, 0xffff0000, v171
    v_add_f32 v54, v54, v44
    v_add_f32 v54, v54, v45
    ds_read_b64_tr_b16 v[40:41], v34 offset:20512
    ds_read_b64_tr_b16 v[42:43], v34 offset:21536
    s_waitcnt lgkmcnt(0)
    v_lshlrev_b32 v44, 16, v40
    v_and_b32 v45, 0xffff0000, v40
    v_lshlrev_b32 v46, 16, v41
    v_and_b32 v47, 0xffff0000, v41
    v_lshlrev_b32 v48, 16, v42
    v_and_b32 v49, 0xffff0000, v42
    v_lshlrev_b32 v50, 16, v43
    v_and_b32 v51, 0xffff0000, v43
    v_fmac_f32 v53, v44, v84
    v_fmac_f32 v53, v45, v85
    v_fmac_f32 v53, v46, v86
    v_fmac_f32 v53, v47, v87
    v_fmac_f32 v53, v48, v88
    v_fmac_f32 v53, v49, v89
    v_fmac_f32 v53, v50, v90
    v_fmac_f32 v53, v51, v91
    v_pk_mul_f32 v[44:45], v[44:45], v[92:93]
    v_pk_mul_f32 v[46:47], v[46:47], v[94:95]
    v_pk_mul_f32 v[48:49], v[48:49], v[96:97]
    v_pk_mul_f32 v[50:51], v[50:51], v[98:99]
    v_cvt_pk_bf16_f32 v224, v44, v45
    v_cvt_pk_bf16_f32 v225, v46, v47
    v_cvt_pk_bf16_f32 v226, v48, v49
    v_cvt_pk_bf16_f32 v227, v50, v51
    v_lshlrev_b32 v44, 16, v224
    v_and_b32 v45, 0xffff0000, v224
    v_add_f32 v55, v55, v44
    v_add_f32 v55, v55, v45
    v_lshlrev_b32 v44, 16, v225
    v_and_b32 v45, 0xffff0000, v225
    v_add_f32 v55, v55, v44
    v_add_f32 v55, v55, v45
    v_lshlrev_b32 v44, 16, v226
    v_and_b32 v45, 0xffff0000, v226
    v_add_f32 v55, v55, v44
    v_add_f32 v55, v55, v45
    v_lshlrev_b32 v44, 16, v227
    v_and_b32 v45, 0xffff0000, v227
    v_add_f32 v55, v55, v44
    v_add_f32 v55, v55, v45
    buffer_load_dwordx4 v[84:87], v35, s[8:11], s38 offen offset:1536
    buffer_load_dwordx4 v[92:95], v35, s[8:11], s39 offen offset:1536
    buffer_load_dwordx4 v[88:91], v35, s[8:11], s38 offen offset:1600
    buffer_load_dwordx4 v[96:99], v35, s[8:11], s39 offen offset:1600
    s_waitcnt vmcnt(4)
    v_pk_add_f32 v[108:109], v[108:109], 1.0 op_sel_hi:[1,0]
    v_pk_add_f32 v[110:111], v[110:111], 1.0 op_sel_hi:[1,0]
    v_pk_add_f32 v[112:113], v[112:113], 1.0 op_sel_hi:[1,0]
    v_pk_add_f32 v[114:115], v[114:115], 1.0 op_sel_hi:[1,0]
    ds_read_b64_tr_b16 v[40:41], v34 offset:22528
    ds_read_b64_tr_b16 v[42:43], v34 offset:23552
    s_waitcnt lgkmcnt(0)
    v_lshlrev_b32 v44, 16, v40
    v_and_b32 v45, 0xffff0000, v40
    v_lshlrev_b32 v46, 16, v41
    v_and_b32 v47, 0xffff0000, v41
    v_lshlrev_b32 v48, 16, v42
    v_and_b32 v49, 0xffff0000, v42
    v_lshlrev_b32 v50, 16, v43
    v_and_b32 v51, 0xffff0000, v43
    v_fmac_f32 v52, v44, v100
    v_fmac_f32 v52, v45, v101
    v_fmac_f32 v52, v46, v102
    v_fmac_f32 v52, v47, v103
    v_fmac_f32 v52, v48, v104
    v_fmac_f32 v52, v49, v105
    v_fmac_f32 v52, v50, v106
    v_fmac_f32 v52, v51, v107
    v_pk_mul_f32 v[44:45], v[44:45], v[108:109]
    v_pk_mul_f32 v[46:47], v[46:47], v[110:111]
    v_pk_mul_f32 v[48:49], v[48:49], v[112:113]
    v_pk_mul_f32 v[50:51], v[50:51], v[114:115]
    v_cvt_pk_bf16_f32 v172, v44, v45
    v_cvt_pk_bf16_f32 v173, v46, v47
    v_cvt_pk_bf16_f32 v174, v48, v49
    v_cvt_pk_bf16_f32 v175, v50, v51
    v_lshlrev_b32 v44, 16, v172
    v_and_b32 v45, 0xffff0000, v172
    v_add_f32 v54, v54, v44
    v_add_f32 v54, v54, v45
    v_lshlrev_b32 v44, 16, v173
    v_and_b32 v45, 0xffff0000, v173
    v_add_f32 v54, v54, v44
    v_add_f32 v54, v54, v45
    v_lshlrev_b32 v44, 16, v174
    v_and_b32 v45, 0xffff0000, v174
    v_add_f32 v54, v54, v44
    v_add_f32 v54, v54, v45
    v_lshlrev_b32 v44, 16, v175
    v_and_b32 v45, 0xffff0000, v175
    v_add_f32 v54, v54, v44
    v_add_f32 v54, v54, v45
    ds_read_b64_tr_b16 v[40:41], v34 offset:22560
    ds_read_b64_tr_b16 v[42:43], v34 offset:23584
    s_waitcnt lgkmcnt(0)
    v_lshlrev_b32 v44, 16, v40
    v_and_b32 v45, 0xffff0000, v40
    v_lshlrev_b32 v46, 16, v41
    v_and_b32 v47, 0xffff0000, v41
    v_lshlrev_b32 v48, 16, v42
    v_and_b32 v49, 0xffff0000, v42
    v_lshlrev_b32 v50, 16, v43
    v_and_b32 v51, 0xffff0000, v43
    v_fmac_f32 v53, v44, v100
    v_fmac_f32 v53, v45, v101
    v_fmac_f32 v53, v46, v102
    v_fmac_f32 v53, v47, v103
    v_fmac_f32 v53, v48, v104
    v_fmac_f32 v53, v49, v105
    v_fmac_f32 v53, v50, v106
    v_fmac_f32 v53, v51, v107
    v_pk_mul_f32 v[44:45], v[44:45], v[108:109]
    v_pk_mul_f32 v[46:47], v[46:47], v[110:111]
    v_pk_mul_f32 v[48:49], v[48:49], v[112:113]
    v_pk_mul_f32 v[50:51], v[50:51], v[114:115]
    v_cvt_pk_bf16_f32 v228, v44, v45
    v_cvt_pk_bf16_f32 v229, v46, v47
    v_cvt_pk_bf16_f32 v230, v48, v49
    v_cvt_pk_bf16_f32 v231, v50, v51
    v_lshlrev_b32 v44, 16, v228
    v_and_b32 v45, 0xffff0000, v228
    v_add_f32 v55, v55, v44
    v_add_f32 v55, v55, v45
    v_lshlrev_b32 v44, 16, v229
    v_and_b32 v45, 0xffff0000, v229
    v_add_f32 v55, v55, v44
    v_add_f32 v55, v55, v45
    v_lshlrev_b32 v44, 16, v230
    v_and_b32 v45, 0xffff0000, v230
    v_add_f32 v55, v55, v44
    v_add_f32 v55, v55, v45
    v_lshlrev_b32 v44, 16, v231
    v_and_b32 v45, 0xffff0000, v231
    v_add_f32 v55, v55, v44
    v_add_f32 v55, v55, v45
    buffer_load_dwordx4 v[100:103], v35, s[8:11], s38 offen offset:1664
    buffer_load_dwordx4 v[108:111], v35, s[8:11], s39 offen offset:1664
    buffer_load_dwordx4 v[104:107], v35, s[8:11], s38 offen offset:1728
    buffer_load_dwordx4 v[112:115], v35, s[8:11], s39 offen offset:1728
    s_waitcnt vmcnt(4)
    v_pk_add_f32 v[92:93], v[92:93], 1.0 op_sel_hi:[1,0]
    v_pk_add_f32 v[94:95], v[94:95], 1.0 op_sel_hi:[1,0]
    v_pk_add_f32 v[96:97], v[96:97], 1.0 op_sel_hi:[1,0]
    v_pk_add_f32 v[98:99], v[98:99], 1.0 op_sel_hi:[1,0]
    ds_read_b64_tr_b16 v[40:41], v34 offset:24576
    ds_read_b64_tr_b16 v[42:43], v34 offset:25600
    s_waitcnt lgkmcnt(0)
    v_lshlrev_b32 v44, 16, v40
    v_and_b32 v45, 0xffff0000, v40
    v_lshlrev_b32 v46, 16, v41
    v_and_b32 v47, 0xffff0000, v41
    v_lshlrev_b32 v48, 16, v42
    v_and_b32 v49, 0xffff0000, v42
    v_lshlrev_b32 v50, 16, v43
    v_and_b32 v51, 0xffff0000, v43
    v_fmac_f32 v52, v44, v84
    v_fmac_f32 v52, v45, v85
    v_fmac_f32 v52, v46, v86
    v_fmac_f32 v52, v47, v87
    v_fmac_f32 v52, v48, v88
    v_fmac_f32 v52, v49, v89
    v_fmac_f32 v52, v50, v90
    v_fmac_f32 v52, v51, v91
    v_pk_mul_f32 v[44:45], v[44:45], v[92:93]
    v_pk_mul_f32 v[46:47], v[46:47], v[94:95]
    v_pk_mul_f32 v[48:49], v[48:49], v[96:97]
    v_pk_mul_f32 v[50:51], v[50:51], v[98:99]
    v_cvt_pk_bf16_f32 v176, v44, v45
    v_cvt_pk_bf16_f32 v177, v46, v47
    v_cvt_pk_bf16_f32 v178, v48, v49
    v_cvt_pk_bf16_f32 v179, v50, v51
    v_lshlrev_b32 v44, 16, v176
    v_and_b32 v45, 0xffff0000, v176
    v_add_f32 v54, v54, v44
    v_add_f32 v54, v54, v45
    v_lshlrev_b32 v44, 16, v177
    v_and_b32 v45, 0xffff0000, v177
    v_add_f32 v54, v54, v44
    v_add_f32 v54, v54, v45
    v_lshlrev_b32 v44, 16, v178
    v_and_b32 v45, 0xffff0000, v178
    v_add_f32 v54, v54, v44
    v_add_f32 v54, v54, v45
    v_lshlrev_b32 v44, 16, v179
    v_and_b32 v45, 0xffff0000, v179
    v_add_f32 v54, v54, v44
    v_add_f32 v54, v54, v45
    ds_read_b64_tr_b16 v[40:41], v34 offset:24608
    ds_read_b64_tr_b16 v[42:43], v34 offset:25632
    s_waitcnt lgkmcnt(0)
    v_lshlrev_b32 v44, 16, v40
    v_and_b32 v45, 0xffff0000, v40
    v_lshlrev_b32 v46, 16, v41
    v_and_b32 v47, 0xffff0000, v41
    v_lshlrev_b32 v48, 16, v42
    v_and_b32 v49, 0xffff0000, v42
    v_lshlrev_b32 v50, 16, v43
    v_and_b32 v51, 0xffff0000, v43
    v_fmac_f32 v53, v44, v84
    v_fmac_f32 v53, v45, v85
    v_fmac_f32 v53, v46, v86
    v_fmac_f32 v53, v47, v87
    v_fmac_f32 v53, v48, v88
    v_fmac_f32 v53, v49, v89
    v_fmac_f32 v53, v50, v90
    v_fmac_f32 v53, v51, v91
    v_pk_mul_f32 v[44:45], v[44:45], v[92:93]
    v_pk_mul_f32 v[46:47], v[46:47], v[94:95]
    v_pk_mul_f32 v[48:49], v[48:49], v[96:97]
    v_pk_mul_f32 v[50:51], v[50:51], v[98:99]
    v_cvt_pk_bf16_f32 v232, v44, v45
    v_cvt_pk_bf16_f32 v233, v46, v47
    v_cvt_pk_bf16_f32 v234, v48, v49
    v_cvt_pk_bf16_f32 v235, v50, v51
    v_lshlrev_b32 v44, 16, v232
    v_and_b32 v45, 0xffff0000, v232
    v_add_f32 v55, v55, v44
    v_add_f32 v55, v55, v45
    v_lshlrev_b32 v44, 16, v233
    v_and_b32 v45, 0xffff0000, v233
    v_add_f32 v55, v55, v44
    v_add_f32 v55, v55, v45
    v_lshlrev_b32 v44, 16, v234
    v_and_b32 v45, 0xffff0000, v234
    v_add_f32 v55, v55, v44
    v_add_f32 v55, v55, v45
    v_lshlrev_b32 v44, 16, v235
    v_and_b32 v45, 0xffff0000, v235
    v_add_f32 v55, v55, v44
    v_add_f32 v55, v55, v45
    s_waitcnt vmcnt(0)
    v_pk_add_f32 v[108:109], v[108:109], 1.0 op_sel_hi:[1,0]
    v_pk_add_f32 v[110:111], v[110:111], 1.0 op_sel_hi:[1,0]
    v_pk_add_f32 v[112:113], v[112:113], 1.0 op_sel_hi:[1,0]
    v_pk_add_f32 v[114:115], v[114:115], 1.0 op_sel_hi:[1,0]
    ds_read_b64_tr_b16 v[40:41], v34 offset:26624
    ds_read_b64_tr_b16 v[42:43], v34 offset:27648
    s_waitcnt lgkmcnt(0)
    v_lshlrev_b32 v44, 16, v40
    v_and_b32 v45, 0xffff0000, v40
    v_lshlrev_b32 v46, 16, v41
    v_and_b32 v47, 0xffff0000, v41
    v_lshlrev_b32 v48, 16, v42
    v_and_b32 v49, 0xffff0000, v42
    v_lshlrev_b32 v50, 16, v43
    v_and_b32 v51, 0xffff0000, v43
    v_fmac_f32 v52, v44, v100
    v_fmac_f32 v52, v45, v101
    v_fmac_f32 v52, v46, v102
    v_fmac_f32 v52, v47, v103
    v_fmac_f32 v52, v48, v104
    v_fmac_f32 v52, v49, v105
    v_fmac_f32 v52, v50, v106
    v_fmac_f32 v52, v51, v107
    v_pk_mul_f32 v[44:45], v[44:45], v[108:109]
    v_pk_mul_f32 v[46:47], v[46:47], v[110:111]
    v_pk_mul_f32 v[48:49], v[48:49], v[112:113]
    v_pk_mul_f32 v[50:51], v[50:51], v[114:115]
    v_cvt_pk_bf16_f32 v180, v44, v45
    v_cvt_pk_bf16_f32 v181, v46, v47
    v_cvt_pk_bf16_f32 v182, v48, v49
    v_cvt_pk_bf16_f32 v183, v50, v51
    v_lshlrev_b32 v44, 16, v180
    v_and_b32 v45, 0xffff0000, v180
    v_add_f32 v54, v54, v44
    v_add_f32 v54, v54, v45
    v_lshlrev_b32 v44, 16, v181
    v_and_b32 v45, 0xffff0000, v181
    v_add_f32 v54, v54, v44
    v_add_f32 v54, v54, v45
    v_lshlrev_b32 v44, 16, v182
    v_and_b32 v45, 0xffff0000, v182
    v_add_f32 v54, v54, v44
    v_add_f32 v54, v54, v45
    v_lshlrev_b32 v44, 16, v183
    v_and_b32 v45, 0xffff0000, v183
    v_add_f32 v54, v54, v44
    v_add_f32 v54, v54, v45
    ds_read_b64_tr_b16 v[40:41], v34 offset:26656
    ds_read_b64_tr_b16 v[42:43], v34 offset:27680
    s_waitcnt lgkmcnt(0)
    v_lshlrev_b32 v44, 16, v40
    v_and_b32 v45, 0xffff0000, v40
    v_lshlrev_b32 v46, 16, v41
    v_and_b32 v47, 0xffff0000, v41
    v_lshlrev_b32 v48, 16, v42
    v_and_b32 v49, 0xffff0000, v42
    v_lshlrev_b32 v50, 16, v43
    v_and_b32 v51, 0xffff0000, v43
    v_fmac_f32 v53, v44, v100
    v_fmac_f32 v53, v45, v101
    v_fmac_f32 v53, v46, v102
    v_fmac_f32 v53, v47, v103
    v_fmac_f32 v53, v48, v104
    v_fmac_f32 v53, v49, v105
    v_fmac_f32 v53, v50, v106
    v_fmac_f32 v53, v51, v107
    v_pk_mul_f32 v[44:45], v[44:45], v[108:109]
    v_pk_mul_f32 v[46:47], v[46:47], v[110:111]
    v_pk_mul_f32 v[48:49], v[48:49], v[112:113]
    v_pk_mul_f32 v[50:51], v[50:51], v[114:115]
    v_cvt_pk_bf16_f32 v236, v44, v45
    v_cvt_pk_bf16_f32 v237, v46, v47
    v_cvt_pk_bf16_f32 v238, v48, v49
    v_cvt_pk_bf16_f32 v239, v50, v51
    v_lshlrev_b32 v44, 16, v236
    v_and_b32 v45, 0xffff0000, v236
    v_add_f32 v55, v55, v44
    v_add_f32 v55, v55, v45
    v_lshlrev_b32 v44, 16, v237
    v_and_b32 v45, 0xffff0000, v237
    v_add_f32 v55, v55, v44
    v_add_f32 v55, v55, v45
    v_lshlrev_b32 v44, 16, v238
    v_and_b32 v45, 0xffff0000, v238
    v_add_f32 v55, v55, v44
    v_add_f32 v55, v55, v45
    v_lshlrev_b32 v44, 16, v239
    v_and_b32 v45, 0xffff0000, v239
    v_add_f32 v55, v55, v44
    v_add_f32 v55, v55, v45
    v_mul_u32_u24 v31, 896, v29
    v_lshl_add_u32 v31, v30, 4, v31
    v_mov_b32 v32, 1073741824
    v_cmp_gt_u32 vcc, 14, v30
    s_nop 1
    v_cndmask_b32 v31, v32, v31, vcc
    s_mul_i32 s32, s27, 114688
    s_mul_i32 s33, s12, 224
    s_add_u32 s32, s32, s33
    s_add_u32 m0, s36, 0
    s_nop 0
    buffer_load_dwordx4 v31, s[76:79], s32 offen lds
    s_add_u32 s32, s32, 3584
    s_waitcnt vmcnt(2)
    s_add_u32 m0, s36, 1024
    s_nop 0
    buffer_load_dwordx4 v31, s[76:79], s32 offen lds
    s_add_u32 s32, s32, 3584
    s_waitcnt vmcnt(2)
    s_add_u32 m0, s36, 2048
    s_nop 0
    buffer_load_dwordx4 v31, s[76:79], s32 offen lds
    s_add_u32 s32, s32, 3584
    s_waitcnt vmcnt(2)
    s_add_u32 m0, s36, 3072
    s_nop 0
    buffer_load_dwordx4 v31, s[76:79], s32 offen lds
    s_add_u32 s32, s32, 3584
    s_waitcnt vmcnt(2)
    s_add_u32 m0, s36, 4096
    s_nop 0
    buffer_load_dwordx4 v31, s[76:79], s32 offen lds
    s_add_u32 s32, s32, 3584
    s_waitcnt vmcnt(2)
    s_add_u32 m0, s36, 5120
    s_nop 0
    buffer_load_dwordx4 v31, s[76:79], s32 offen lds
    s_add_u32 s32, s32, 3584
    s_waitcnt vmcnt(2)
    s_add_u32 m0, s36, 6144
    s_nop 0
    buffer_load_dwordx4 v31, s[76:79], s32 offen lds
    s_add_u32 s32, s32, 3584
    s_waitcnt vmcnt(2)
    s_add_u32 m0, s36, 7168
    s_nop 0
    buffer_load_dwordx4 v31, s[76:79], s32 offen lds
    s_add_u32 s32, s32, 3584
    s_waitcnt vmcnt(2)
    s_add_u32 m0, s36, 8192
    s_nop 0
    buffer_load_dwordx4 v31, s[76:79], s32 offen lds
    s_add_u32 s32, s32, 3584
    s_waitcnt vmcnt(2)
    s_add_u32 m0, s36, 9216
    s_nop 0
    buffer_load_dwordx4 v31, s[76:79], s32 offen lds
    s_add_u32 s32, s32, 3584
    s_waitcnt vmcnt(2)
    s_add_u32 m0, s36, 10240
    s_nop 0
    buffer_load_dwordx4 v31, s[76:79], s32 offen lds
    s_add_u32 s32, s32, 3584
    s_waitcnt vmcnt(2)
    s_add_u32 m0, s36, 11264
    s_nop 0
    buffer_load_dwordx4 v31, s[76:79], s32 offen lds
    s_add_u32 s32, s32, 3584
    s_waitcnt vmcnt(2)
    s_add_u32 m0, s36, 12288
    s_nop 0
    buffer_load_dwordx4 v31, s[76:79], s32 offen lds
    s_add_u32 s32, s32, 3584
    s_waitcnt vmcnt(2)
    s_add_u32 m0, s36, 13312
    s_nop 0
    buffer_load_dwordx4 v31, s[76:79], s32 offen lds
    s_add_u32 s32, s32, 3584
    s_waitcnt vmcnt(2)
    s_add_u32 m0, s36, 14336
    s_nop 0
    buffer_load_dwordx4 v31, s[76:79], s32 offen lds
    s_add_u32 s32, s32, 3584
    s_waitcnt vmcnt(2)
    s_add_u32 m0, s36, 15360
    s_nop 0
    buffer_load_dwordx4 v31, s[76:79], s32 offen lds
    s_add_u32 s32, s32, 3584
    s_waitcnt vmcnt(2)
    s_add_u32 m0, s36, 16384
    s_nop 0
    buffer_load_dwordx4 v31, s[76:79], s32 offen lds
    s_add_u32 s32, s32, 3584
    s_waitcnt vmcnt(2)
    s_add_u32 m0, s36, 17408
    s_nop 0
    buffer_load_dwordx4 v31, s[76:79], s32 offen lds
    s_add_u32 s32, s32, 3584
    s_waitcnt vmcnt(2)
    s_add_u32 m0, s36, 18432
    s_nop 0
    buffer_load_dwordx4 v31, s[76:79], s32 offen lds
    s_add_u32 s32, s32, 3584
    s_waitcnt vmcnt(2)
    s_add_u32 m0, s36, 19456
    s_nop 0
    buffer_load_dwordx4 v31, s[76:79], s32 offen lds
    s_add_u32 s32, s32, 3584
    s_waitcnt vmcnt(2)
    s_add_u32 m0, s36, 20480
    s_nop 0
    buffer_load_dwordx4 v31, s[76:79], s32 offen lds
    s_add_u32 s32, s32, 3584
    s_waitcnt vmcnt(2)
    s_add_u32 m0, s36, 21504
    s_nop 0
    buffer_load_dwordx4 v31, s[76:79], s32 offen lds
    s_add_u32 s32, s32, 3584
    s_waitcnt vmcnt(2)
    s_add_u32 m0, s36, 22528
    s_nop 0
    buffer_load_dwordx4 v31, s[76:79], s32 offen lds
    s_add_u32 s32, s32, 3584
    s_waitcnt vmcnt(2)
    s_add_u32 m0, s36, 23552
    s_nop 0
    buffer_load_dwordx4 v31, s[76:79], s32 offen lds
    s_add_u32 s32, s32, 3584
    s_waitcnt vmcnt(2)
    s_add_u32 m0, s36, 24576
    s_nop 0
    buffer_load_dwordx4 v31, s[76:79], s32 offen lds
    s_add_u32 s32, s32, 3584
    s_waitcnt vmcnt(2)
    s_add_u32 m0, s36, 25600
    s_nop 0
    buffer_load_dwordx4 v31, s[76:79], s32 offen lds
    s_add_u32 s32, s32, 3584
    s_waitcnt vmcnt(2)
    s_add_u32 m0, s36, 26624
    s_nop 0
    buffer_load_dwordx4 v31, s[76:79], s32 offen lds
    s_add_u32 s32, s32, 3584
    s_waitcnt vmcnt(2)
    s_add_u32 m0, s36, 27648
    s_nop 0
    buffer_load_dwordx4 v31, s[76:79], s32 offen lds
    s_add_u32 s32, s32, 3584
    s_waitcnt vmcnt(2)
    s_add_u32 m0, s36, 28672
    s_nop 0
    buffer_load_dwordx4 v31, s[76:79], s32 offen lds
    s_add_u32 s32, s32, 3584
    s_waitcnt vmcnt(2)
    s_add_u32 m0, s36, 29696
    s_nop 0
    buffer_load_dwordx4 v31, s[76:79], s32 offen lds
    s_add_u32 s32, s32, 3584
    s_waitcnt vmcnt(2)
    s_add_u32 m0, s36, 30720
    s_nop 0
    buffer_load_dwordx4 v31, s[76:79], s32 offen lds
    s_add_u32 s32, s32, 3584
    s_waitcnt vmcnt(2)
    s_add_u32 m0, s36, 31744
    s_nop 0
    buffer_load_dwordx4 v31, s[76:79], s32 offen lds
    s_add_u32 s32, s32, 3584
    s_waitcnt vmcnt(2)
    v_mov_b32 v44, v52
    v_mov_b32 v45, v53
    v_mov_b32 v46, v54
    v_mov_b32 v47, v55
    s_nop 0
    v_permlane16_swap_b32 v52, v44
    v_permlane16_swap_b32 v53, v45
    v_permlane16_swap_b32 v54, v46
    v_permlane16_swap_b32 v55, v47
    v_add_f32 v52, v52, v44
    v_add_f32 v53, v53, v45
    v_add_f32 v54, v54, v46
    v_add_f32 v55, v55, v47
    v_mov_b32 v44, v52
    v_mov_b32 v45, v53
    v_mov_b32 v46, v54
    v_mov_b32 v47, v55
    s_nop 0
    v_permlane32_swap_b32 v52, v44
    v_permlane32_swap_b32 v53, v45
    v_permlane32_swap_b32 v54, v46
    v_permlane32_swap_b32 v55, v47
    v_add_f32 v52, v52, v44
    v_add_f32 v53, v53, v45
    v_add_f32 v54, v54, v46
    v_add_f32 v55, v55, v47
    v_lshlrev_b32 v4, 16, v4
    v_add_f32 v52, v52, v4
    v_lshlrev_b32 v5, 16, v5
    v_add_f32 v53, v53, v5
    s_lshl_b32 s32, s12, 8
    s_add_u32 s32, s32, 131072
    v_lshlrev_b32 v32, 2, v30
    v_add_u32 v32, s32, v32
    v_add_u32 v33, s32, v35
    ds_write_b32 v32, v52 offset:0
    ds_write_b32 v32, v53 offset:64
    ds_write_b32 v32, v54 offset:128
    ds_write_b32 v32, v55 offset:192
    s_waitcnt lgkmcnt(0)
    ds_read_b128 v[4:7], v33 offset:0
    ds_read_b128 v[8:11], v33 offset:64
    ds_read_b128 v[12:15], v33 offset:128
    ds_read_b128 v[16:19], v33 offset:192
    s_waitcnt vmcnt(0)
    ds_read_b64_tr_b16 a[0:1], v36 offset:0
    ds_read_b64_tr_b16 a[2:3], v36 offset:4096
    ds_read_b64_tr_b16 a[4:5], v36 offset:8192
    ds_read_b64_tr_b16 a[6:7], v36 offset:12288
    ds_read_b64_tr_b16 a[8:9], v36 offset:16384
    ds_read_b64_tr_b16 a[10:11], v36 offset:20480
    ds_read_b64_tr_b16 a[12:13], v36 offset:24576
    ds_read_b64_tr_b16 a[14:15], v36 offset:28672
    s_waitcnt lgkmcnt(0)
    ds_read_b64_tr_b16 a[16:17], v36 offset:32
    ds_read_b64_tr_b16 a[18:19], v36 offset:4128
    ds_read_b64_tr_b16 a[20:21], v36 offset:8224
    ds_read_b64_tr_b16 a[22:23], v36 offset:12320
    ds_read_b64_tr_b16 a[24:25], v36 offset:16416
    ds_read_b64_tr_b16 a[26:27], v36 offset:20512
    ds_read_b64_tr_b16 a[28:29], v36 offset:24608
    ds_read_b64_tr_b16 a[30:31], v36 offset:28704
    s_waitcnt lgkmcnt(0)
    ds_read_b64_tr_b16 a[32:33], v36 offset:64
    ds_read_b64_tr_b16 a[34:35], v36 offset:4160
    ds_read_b64_tr_b16 a[36:37], v36 offset:8256
    ds_read_b64_tr_b16 a[38:39], v36 offset:12352
    ds_read_b64_tr_b16 a[40:41], v36 offset:16448
    ds_read_b64_tr_b16 a[42:43], v36 offset:20544
    ds_read_b64_tr_b16 a[44:45], v36 offset:24640
    ds_read_b64_tr_b16 a[46:47], v36 offset:28736
    s_waitcnt lgkmcnt(0)
    ds_read_b64_tr_b16 a[48:49], v36 offset:96
    ds_read_b64_tr_b16 a[50:51], v36 offset:4192
    ds_read_b64_tr_b16 a[52:53], v36 offset:8288
    ds_read_b64_tr_b16 a[54:55], v36 offset:12384
    ds_read_b64_tr_b16 a[56:57], v36 offset:16480
    ds_read_b64_tr_b16 a[58:59], v36 offset:20576
    ds_read_b64_tr_b16 a[60:61], v36 offset:24672
    ds_read_b64_tr_b16 a[62:63], v36 offset:28768
    s_waitcnt lgkmcnt(0)
    ds_read_b64_tr_b16 a[64:65], v36 offset:128
    ds_read_b64_tr_b16 a[66:67], v36 offset:4224
    ds_read_b64_tr_b16 a[68:69], v36 offset:8320
    ds_read_b64_tr_b16 a[70:71], v36 offset:12416
    ds_read_b64_tr_b16 a[72:73], v36 offset:16512
    ds_read_b64_tr_b16 a[74:75], v36 offset:20608
    ds_read_b64_tr_b16 a[76:77], v36 offset:24704
    ds_read_b64_tr_b16 a[78:79], v36 offset:28800
    s_waitcnt lgkmcnt(0)
    ds_read_b64_tr_b16 a[80:81], v36 offset:160
    ds_read_b64_tr_b16 a[82:83], v36 offset:4256
    ds_read_b64_tr_b16 a[84:85], v36 offset:8352
    ds_read_b64_tr_b16 a[86:87], v36 offset:12448
    ds_read_b64_tr_b16 a[88:89], v36 offset:16544
    ds_read_b64_tr_b16 a[90:91], v36 offset:20640
    ds_read_b64_tr_b16 a[92:93], v36 offset:24736
    ds_read_b64_tr_b16 a[94:95], v36 offset:28832
    s_waitcnt lgkmcnt(0)
    ds_read_b64_tr_b16 a[96:97], v36 offset:192
    ds_read_b64_tr_b16 a[98:99], v36 offset:4288
    ds_read_b64_tr_b16 a[100:101], v36 offset:8384
    ds_read_b64_tr_b16 a[102:103], v36 offset:12480
    ds_read_b64_tr_b16 a[104:105], v36 offset:16576
    ds_read_b64_tr_b16 a[106:107], v36 offset:20672
    ds_read_b64_tr_b16 a[108:109], v36 offset:24768
    ds_read_b64_tr_b16 a[110:111], v36 offset:28864
    s_waitcnt lgkmcnt(0)
    v_mov_b32 v1, 1
    v_min_u32 v31, 55, v28
    v_lshlrev_b32 v117, 2, v31
    v_mul_u32_u24 v118, 896, v29
    v_lshl_add_u32 v118, v30, 3, v118
    v_lshlrev_b32 v119, 3, v28
    s_lshl_b32 s32, s12, 11
    s_add_u32 s32, s32, 32768
    v_add_u32 v120, s32, v116
    s_lshr_b32 s36, s12, 1
    s_and_b32 s37, s12, 1
    s_mul_i32 s32, s36, 14336
    s_lshl_b32 s33, s27, 10
    s_add_u32 s32, s32, s33
    s_lshl_b32 s33, s37, 3
    s_add_u32 s32, s32, s33
    v_add_u32 v121, s32, v116
    v_mul_u32_u24 v122, 896, v30
    v_lshl_add_u32 v122, v29, 3, v122
    s_mul_i32 s32, s36, 14336
    s_lshl_b32 s33, s27, 6
    s_add_u32 s32, s32, s33
    s_lshl_b32 s33, s37, 5
    s_add_u32 s32, s32, s33
    v_add_u32 v122, s32, v122
    s_lshl_b32 s32, s27, 2
    s_add_u32 s32, s32, s12
    s_lshl_b32 s32, s32, 2
    v_mov_b32 v123, s32
    s_lshl_b32 s32, s27, 7
    s_lshl_b32 s33, s37, 6
    s_add_u32 s32, s32, s33
    s_add_u32 s32, s32, 44868352
    buffer_load_dwordx4 v[20:23], v35, s[8:11], s32 offen
    s_mul_i32 s32, s12, 7
    s_add_u32 s32, s32, 0
    s_lshr_b32 s33, s32, 1
    s_mul_i32 s33, s33, 28672
    s_and_b32 s32, s32, 1
    s_lshl_b32 s32, s32, 9
    s_add_u32 s32, s32, s33
    s_lshl_b32 s33, s27, 11
    s_add_u32 s44, s32, s33
    s_mul_i32 s32, s12, 7
    s_add_u32 s32, s32, 1
    s_lshr_b32 s33, s32, 1
    s_mul_i32 s33, s33, 28672
    s_and_b32 s32, s32, 1
    s_lshl_b32 s32, s32, 9
    s_add_u32 s32, s32, s33
    s_lshl_b32 s33, s27, 11
    s_add_u32 s45, s32, s33
    s_mul_i32 s32, s12, 7
    s_add_u32 s32, s32, 2
    s_lshr_b32 s33, s32, 1
    s_mul_i32 s33, s33, 28672
    s_and_b32 s32, s32, 1
    s_lshl_b32 s32, s32, 9
    s_add_u32 s32, s32, s33
    s_lshl_b32 s33, s27, 11
    s_add_u32 s46, s32, s33
    s_mul_i32 s32, s12, 7
    s_add_u32 s32, s32, 3
    s_lshr_b32 s33, s32, 1
    s_mul_i32 s33, s33, 28672
    s_and_b32 s32, s32, 1
    s_lshl_b32 s32, s32, 9
    s_add_u32 s32, s32, s33
    s_lshl_b32 s33, s27, 11
    s_add_u32 s47, s32, s33
    s_mul_i32 s32, s12, 7
    s_add_u32 s32, s32, 4
    s_lshr_b32 s33, s32, 1
    s_mul_i32 s33, s33, 28672
    s_and_b32 s32, s32, 1
    s_lshl_b32 s32, s32, 9
    s_add_u32 s32, s32, s33
    s_lshl_b32 s33, s27, 11
    s_add_u32 s48, s32, s33
    s_mul_i32 s32, s12, 7
    s_add_u32 s32, s32, 5
    s_lshr_b32 s33, s32, 1
    s_mul_i32 s33, s33, 28672
    s_and_b32 s32, s32, 1
    s_lshl_b32 s32, s32, 9
    s_add_u32 s32, s32, s33
    s_lshl_b32 s33, s27, 11
    s_add_u32 s49, s32, s33
    s_mul_i32 s32, s12, 7
    s_add_u32 s32, s32, 6
    s_lshr_b32 s33, s32, 1
    s_mul_i32 s33, s33, 28672
    s_and_b32 s32, s32, 1
    s_lshl_b32 s32, s32, 9
    s_add_u32 s32, s32, s33
    s_lshl_b32 s33, s27, 11
    s_add_u32 s50, s32, s33
    s_mul_i32 s51, s27, 28672
    s_lshl_b32 s32, s12, 9
    s_add_u32 s51, s51, s32
    s_lshl_b32 s32, s20, 8
    s_add_u32 s21, s32, 44711936
    s_add_u32 s25, s32, 44728320
    s_mul_i32 s23, s12, 7168
    s_mul_i32 s22, s20, 28672
    s_add_u32 s22, s22, s23
    s_lshl_b32 s24, s20, 13
    s_add_u32 s24, s24, 50118656
    s_mul_i32 s42, s20, 802816
    s_add_u32 s42, s42, 50642944
    s_mov_b32 s55, 401408
    s_mul_i32 s43, s20, 28672
    s_mov_b32 s52, 1069066811
    s_mov_b32 s53, s52
    s_mov_b32 s54, 1114636288
    s_waitcnt vmcnt(0)
    s_barrier
    s_cmp_lg_u32 s15, 0
    s_cbranch_scc1 L_F_segs
L_F_segf:
    s_cmp_eq_u32 s20, 0
    s_cbranch_scc1 L_F_segf_hard
    s_sub_u32 s32, s21, 256
L_wf_31:
    buffer_load_dword v2, v117, s[8:11], s32 offen offset:0 sc1
    s_sub_u32 s26, s26, 1
    s_cbranch_scc1 L_fail
    s_waitcnt vmcnt(0)
    v_cmp_eq_u32 vcc, 0, v2
    s_cbranch_vccz L_wfd_32
    s_sleep 8
    s_branch L_wf_31
L_wfd_32:
L_F_segf_hard:
    buffer_load_dword v84, v117, s[8:11], s21 offen sc1
    s_sleep 1
    s_sleep 1
    s_sleep 1
    s_sleep 1
    s_sleep 1
    buffer_load_dword v85, v117, s[8:11], s21 offen sc1
    s_sleep 1
    s_sleep 1
    s_sleep 1
    s_sleep 1
    s_sleep 1
L_wq_33:
    buffer_load_dword v86, v117, s[8:11], s21 offen sc1
    s_sub_u32 s26, s26, 1
    s_cbranch_scc1 L_fail
    s_waitcnt vmcnt(2)
    v_cmp_eq_u32 vcc, 0, v84
    s_cbranch_vccz L_wq_33_d
    buffer_load_dword v84, v117, s[8:11], s21 offen sc1
    s_waitcnt vmcnt(2)
    v_cmp_eq_u32 vcc, 0, v85
    s_cbranch_vccz L_wq_33_d
    buffer_load_dword v85, v117, s[8:11], s21 offen sc1
    s_waitcnt vmcnt(2)
    v_cmp_eq_u32 vcc, 0, v86
    s_cbranch_vccnz L_wq_33
L_wq_33_d:
    s_add_u32 s32, s24, 3584
    buffer_load_dwordx2 v[28:29], v118, s[8:11], s24 offen offset:0
    buffer_load_dwordx2 v[30:31], v118, s[8:11], s24 offen offset:128
    buffer_load_dwordx2 v[32:33], v118, s[8:11], s24 offen offset:256
    buffer_load_dwordx2 v[34:35], v118, s[8:11], s24 offen offset:384
    buffer_load_dwordx2 v[36:37], v118, s[8:11], s24 offen offset:512
    buffer_load_dwordx2 v[38:39], v118, s[8:11], s24 offen offset:640
    buffer_load_dwordx2 v[40:41], v118, s[8:11], s24 offen offset:768
    buffer_load_dwordx2 v[42:43], v118, s[8:11], s32 offen offset:0
    buffer_load_dwordx2 v[44:45], v118, s[8:11], s32 offen offset:128
    buffer_load_dwordx2 v[46:47], v118, s[8:11], s32 offen offset:256
    buffer_load_dwordx2 v[48:49], v118, s[8:11], s32 offen offset:384
    buffer_load_dwordx2 v[50:51], v118, s[8:11], s32 offen offset:512
    buffer_load_dwordx2 v[52:53], v118, s[8:11], s32 offen offset:640
    buffer_load_dwordx2 v[54:55], v118, s[8:11], s32 offen offset:768
    s_mov_b32 m0, s23
    s_add_u32 s30, s22, 48283648
    buffer_load_dwordx4 v116, s[8:11], s30 offen offset:0 lds
    buffer_load_dwordx4 v116, s[8:11], s30 offen offset:1024 lds
    buffer_load_dwordx4 v116, s[8:11], s30 offen offset:2048 lds
    buffer_load_dwordx4 v116, s[8:11], s30 offen offset:3072 lds
    s_add_u32 m0, s23, 4096
    s_add_u32 s30, s30, 4096
    buffer_load_dwordx4 v116, s[8:11], s30 offen offset:0 lds
    buffer_load_dwordx4 v116, s[8:11], s30 offen offset:1024 lds
    buffer_load_dwordx4 v116, s[8:11], s30 offen offset:2048 lds
    s_waitcnt vmcnt(7)
    v_add_f32 v24, v28, v30
    v_add_f32 v24, v24, v32
    v_add_f32 v24, v24, v34
    v_add_f32 v24, v24, v36
    v_add_f32 v24, v24, v38
    v_add_f32 v24, v24, v40
    v_add_f32 v25, v42, v44
    v_add_f32 v25, v25, v46
    v_add_f32 v25, v25, v48
    v_add_f32 v25, v25, v50
    v_add_f32 v25, v25, v52
    v_add_f32 v25, v25, v54
    v_mov_b32 v56, v24
    v_mov_b32 v57, v25
    s_nop 0
    v_permlane16_swap_b32 v24, v56
    v_permlane16_swap_b32 v25, v57
    v_add_f32 v24, v24, v56
    v_add_f32 v25, v25, v57
    v_mov_b32 v56, v24
    v_mov_b32 v57, v25
    s_nop 0
    v_permlane32_swap_b32 v24, v56
    v_permlane32_swap_b32 v25, v57
    v_add_f32 v24, v24, v56
    v_add_f32 v25, v25, v57
    v_mul_f32 v24, 1024608549, v24
    v_mul_f32 v25, 1024608549, v25
    v_mov_b32 v26, 0
    v_mov_b32 v56, 0
    v_sub_f32 v28, v28, v24
    v_add_f32 v26, v26, v29
    v_fmac_f32 v56, v28, v28
    v_sub_f32 v30, v30, v24
    v_add_f32 v26, v26, v31
    v_fmac_f32 v56, v30, v30
    v_sub_f32 v32, v32, v24
    v_add_f32 v26, v26, v33
    v_fmac_f32 v56, v32, v32
    v_sub_f32 v34, v34, v24
    v_add_f32 v26, v26, v35
    v_fmac_f32 v56, v34, v34
    v_sub_f32 v36, v36, v24
    v_add_f32 v26, v26, v37
    v_fmac_f32 v56, v36, v36
    v_sub_f32 v38, v38, v24
    v_add_f32 v26, v26, v39
    v_fmac_f32 v56, v38, v38
    v_sub_f32 v40, v40, v24
    v_add_f32 v26, v26, v41
    v_fmac_f32 v56, v40, v40
    v_fmac_f32 v26, 1098907648, v56
    v_mov_b32 v27, 0
    v_mov_b32 v57, 0
    v_sub_f32 v42, v42, v25
    v_add_f32 v27, v27, v43
    v_fmac_f32 v57, v42, v42
    v_sub_f32 v44, v44, v25
    v_add_f32 v27, v27, v45
    v_fmac_f32 v57, v44, v44
    v_sub_f32 v46, v46, v25
    v_add_f32 v27, v27, v47
    v_fmac_f32 v57, v46, v46
    v_sub_f32 v48, v48, v25
    v_add_f32 v27, v27, v49
    v_fmac_f32 v57, v48, v48
    v_sub_f32 v50, v50, v25
    v_add_f32 v27, v27, v51
    v_fmac_f32 v57, v50, v50
    v_sub_f32 v52, v52, v25
    v_add_f32 v27, v27, v53
    v_fmac_f32 v57, v52, v52
    v_sub_f32 v54, v54, v25
    v_add_f32 v27, v27, v55
    v_fmac_f32 v57, v54, v54
    v_fmac_f32 v27, 1098907648, v57
    v_mov_b32 v56, v26
    v_mov_b32 v57, v27
    s_nop 0
    v_permlane16_swap_b32 v26, v56
    v_permlane16_swap_b32 v27, v57
    v_add_f32 v26, v26, v56
    v_add_f32 v27, v27, v57
    v_mov_b32 v56, v26
    v_mov_b32 v57, v27
    s_nop 0
    v_permlane32_swap_b32 v26, v56
    v_permlane32_swap_b32 v27, v57
    v_add_f32 v26, v26, v56
    v_add_f32 v27, v27, v57
    v_mov_b32 v56, 925353388
    v_fmac_f32 v56, 991054117, v26
    v_rsq_f32 v26, v56
    v_mov_b32 v57, 925353388
    v_fmac_f32 v57, 991054117, v27
    v_rsq_f32 v27, v57
    s_waitcnt vmcnt(0)
    s_barrier
    ds_read_b128 v[84:87], v116 offset:0
    ds_read_b128 v[88:91], v116 offset:14336
    ds_read_b128 v[92:95], v116 offset:1024
    ds_read_b128 v[96:99], v116 offset:15360
    ds_read_b128 v[100:103], v116 offset:2048
    ds_read_b128 v[104:107], v116 offset:16384
    ds_read_b128 v[108:111], v116 offset:3072
    ds_read_b128 v[112:115], v116 offset:17408
    s_waitcnt lgkmcnt(6)
    v_mfma_f32_16x16x32_bf16 v[60:63], v[128:131], v[84:87], 0
    v_mfma_f32_16x16x32_bf16 v[64:67], v[128:131], v[88:91], 0
    v_mfma_f32_16x16x32_bf16 v[68:71], v[184:187], v[84:87], 0
    v_mfma_f32_16x16x32_bf16 v[72:75], v[184:187], v[88:91], 0
    ds_read_b128 v[84:87], v116 offset:4096
    ds_read_b128 v[88:91], v116 offset:18432
    s_waitcnt lgkmcnt(6)
    v_mfma_f32_16x16x32_bf16 v[60:63], v[132:135], v[92:95], v[60:63]
    v_mfma_f32_16x16x32_bf16 v[64:67], v[132:135], v[96:99], v[64:67]
    v_mfma_f32_16x16x32_bf16 v[68:71], v[188:191], v[92:95], v[68:71]
    v_mfma_f32_16x16x32_bf16 v[72:75], v[188:191], v[96:99], v[72:75]
    ds_read_b128 v[92:95], v116 offset:5120
    ds_read_b128 v[96:99], v116 offset:19456
    s_waitcnt lgkmcnt(6)
    v_mfma_f32_16x16x32_bf16 v[60:63], v[136:139], v[100:103], v[60:63]
    v_mfma_f32_16x16x32_bf16 v[64:67], v[136:139], v[104:107], v[64:67]
    v_mfma_f32_16x16x32_bf16 v[68:71], v[192:195], v[100:103], v[68:71]
    v_mfma_f32_16x16x32_bf16 v[72:75], v[192:195], v[104:107], v[72:75]
    ds_read_b128 v[100:103], v116 offset:6144
    ds_read_b128 v[104:107], v116 offset:20480
    s_waitcnt lgkmcnt(6)
    v_mfma_f32_16x16x32_bf16 v[60:63], v[140:143], v[108:111], v[60:63]
    v_mfma_f32_16x16x32_bf16 v[64:67], v[140:143], v[112:115], v[64:67]
    v_mfma_f32_16x16x32_bf16 v[68:71], v[196:199], v[108:111], v[68:71]
    v_mfma_f32_16x16x32_bf16 v[72:75], v[196:199], v[112:115], v[72:75]
    ds_read_b128 v[108:111], v116 offset:7168
    ds_read_b128 v[112:115], v116 offset:21504
    s_waitcnt lgkmcnt(6)
    v_mfma_f32_16x16x32_bf16 v[60:63], v[144:147], v[84:87], v[60:63]
    v_mfma_f32_16x16x32_bf16 v[64:67], v[144:147], v[88:91], v[64:67]
    v_mfma_f32_16x16x32_bf16 v[68:71], v[200:203], v[84:87], v[68:71]
    v_mfma_f32_16x16x32_bf16 v[72:75], v[200:203], v[88:91], v[72:75]
    ds_read_b128 v[84:87], v116 offset:8192
    ds_read_b128 v[88:91], v116 offset:22528
    s_waitcnt lgkmcnt(6)
    v_mfma_f32_16x16x32_bf16 v[60:63], v[148:151], v[92:95], v[60:63]
    v_mfma_f32_16x16x32_bf16 v[64:67], v[148:151], v[96:99], v[64:67]
    v_mfma_f32_16x16x32_bf16 v[68:71], v[204:207], v[92:95], v[68:71]
    v_mfma_f32_16x16x32_bf16 v[72:75], v[204:207], v[96:99], v[72:75]
    ds_read_b128 v[92:95], v116 offset:9216
    ds_read_b128 v[96:99], v116 offset:23552
    s_waitcnt lgkmcnt(6)
    v_mfma_f32_16x16x32_bf16 v[60:63], v[152:155], v[100:103], v[60:63]
    v_mfma_f32_16x16x32_bf16 v[64:67], v[152:155], v[104:107], v[64:67]
    v_mfma_f32_16x16x32_bf16 v[68:71], v[208:211], v[100:103], v[68:71]
    v_mfma_f32_16x16x32_bf16 v[72:75], v[208:211], v[104:107], v[72:75]
    ds_read_b128 v[100:103], v116 offset:10240
    ds_read_b128 v[104:107], v116 offset:24576
    s_waitcnt lgkmcnt(6)
    v_mfma_f32_16x16x32_bf16 v[60:63], v[156:159], v[108:111], v[60:63]
    v_mfma_f32_16x16x32_bf16 v[64:67], v[156:159], v[112:115], v[64:67]
    v_mfma_f32_16x16x32_bf16 v[68:71], v[212:215], v[108:111], v[68:71]
    v_mfma_f32_16x16x32_bf16 v[72:75], v[212:215], v[112:115], v[72:75]
    ds_read_b128 v[108:111], v116 offset:11264
    ds_read_b128 v[112:115], v116 offset:25600
    s_waitcnt lgkmcnt(6)
    v_mfma_f32_16x16x32_bf16 v[60:63], v[160:163], v[84:87], v[60:63]
    v_mfma_f32_16x16x32_bf16 v[64:67], v[160:163], v[88:91], v[64:67]
    v_mfma_f32_16x16x32_bf16 v[68:71], v[216:219], v[84:87], v[68:71]
    v_mfma_f32_16x16x32_bf16 v[72:75], v[216:219], v[88:91], v[72:75]
    ds_read_b128 v[84:87], v116 offset:12288
    ds_read_b128 v[88:91], v116 offset:26624
    s_waitcnt lgkmcnt(6)
    v_mfma_f32_16x16x32_bf16 v[60:63], v[164:167], v[92:95], v[60:63]
    v_mfma_f32_16x16x32_bf16 v[64:67], v[164:167], v[96:99], v[64:67]
    v_mfma_f32_16x16x32_bf16 v[68:71], v[220:223], v[92:95], v[68:71]
    v_mfma_f32_16x16x32_bf16 v[72:75], v[220:223], v[96:99], v[72:75]
    ds_read_b128 v[92:95], v116 offset:13312
    ds_read_b128 v[96:99], v116 offset:27648
    s_waitcnt lgkmcnt(6)
    v_mfma_f32_16x16x32_bf16 v[60:63], v[168:171], v[100:103], v[60:63]
    v_mfma_f32_16x16x32_bf16 v[64:67], v[168:171], v[104:107], v[64:67]
    v_mfma_f32_16x16x32_bf16 v[68:71], v[224:227], v[100:103], v[68:71]
    v_mfma_f32_16x16x32_bf16 v[72:75], v[224:227], v[104:107], v[72:75]
    s_waitcnt lgkmcnt(4)
    v_mfma_f32_16x16x32_bf16 v[60:63], v[172:175], v[108:111], v[60:63]
    v_mfma_f32_16x16x32_bf16 v[64:67], v[172:175], v[112:115], v[64:67]
    v_mfma_f32_16x16x32_bf16 v[68:71], v[228:231], v[108:111], v[68:71]
    v_mfma_f32_16x16x32_bf16 v[72:75], v[228:231], v[112:115], v[72:75]
    s_waitcnt lgkmcnt(2)
    v_mfma_f32_16x16x32_bf16 v[60:63], v[176:179], v[84:87], v[60:63]
    v_mfma_f32_16x16x32_bf16 v[64:67], v[176:179], v[88:91], v[64:67]
    v_mfma_f32_16x16x32_bf16 v[68:71], v[232:235], v[84:87], v[68:71]
    v_mfma_f32_16x16x32_bf16 v[72:75], v[232:235], v[88:91], v[72:75]
    s_waitcnt lgkmcnt(0)
    v_mfma_f32_16x16x32_bf16 v[60:63], v[180:183], v[92:95], v[60:63]
    v_mfma_f32_16x16x32_bf16 v[64:67], v[180:183], v[96:99], v[64:67]
    v_mfma_f32_16x16x32_bf16 v[68:71], v[236:239], v[92:95], v[68:71]
    v_mfma_f32_16x16x32_bf16 v[72:75], v[236:239], v[96:99], v[72:75]
    ds_read_b64 v[2:3], v121 offset:0
    s_nop 3
    v_pk_fma_f32 v[60:61], v[12:13], v[24:25], v[60:61] op_sel:[0,0,0] op_sel_hi:[1,0,1] neg_lo:[1,0,0] neg_hi:[1,0,0]
    v_pk_fma_f32 v[60:61], v[60:61], v[26:27], v[4:5] op_sel:[0,0,0] op_sel_hi:[1,0,1]
    v_pk_mul_f32 v[28:29], v[60:61], s[52:53]
    v_pk_fma_f32 v[62:63], v[14:15], v[24:25], v[62:63] op_sel:[0,0,0] op_sel_hi:[1,0,1] neg_lo:[1,0,0] neg_hi:[1,0,0]
    v_pk_fma_f32 v[62:63], v[62:63], v[26:27], v[6:7] op_sel:[0,0,0] op_sel_hi:[1,0,1]
    v_pk_mul_f32 v[30:31], v[62:63], s[52:53]
    v_pk_fma_f32 v[64:65], v[12:13], v[24:25], v[64:65] op_sel:[0,1,0] op_sel_hi:[1,1,1] neg_lo:[1,0,0] neg_hi:[1,0,0]
    v_pk_fma_f32 v[64:65], v[64:65], v[26:27], v[4:5] op_sel:[0,1,0] op_sel_hi:[1,1,1]
    v_pk_mul_f32 v[32:33], v[64:65], s[52:53]
    v_pk_fma_f32 v[66:67], v[14:15], v[24:25], v[66:67] op_sel:[0,1,0] op_sel_hi:[1,1,1] neg_lo:[1,0,0] neg_hi:[1,0,0]
    v_pk_fma_f32 v[66:67], v[66:67], v[26:27], v[6:7] op_sel:[0,1,0] op_sel_hi:[1,1,1]
    v_pk_mul_f32 v[34:35], v[66:67], s[52:53]
    v_pk_fma_f32 v[68:69], v[16:17], v[24:25], v[68:69] op_sel:[0,0,0] op_sel_hi:[1,0,1] neg_lo:[1,0,0] neg_hi:[1,0,0]
    v_pk_fma_f32 v[68:69], v[68:69], v[26:27], v[8:9] op_sel:[0,0,0] op_sel_hi:[1,0,1]
    v_pk_mul_f32 v[36:37], v[68:69], s[52:53]
    v_pk_fma_f32 v[70:71], v[18:19], v[24:25], v[70:71] op_sel:[0,0,0] op_sel_hi:[1,0,1] neg_lo:[1,0,0] neg_hi:[1,0,0]
    v_pk_fma_f32 v[70:71], v[70:71], v[26:27], v[10:11] op_sel:[0,0,0] op_sel_hi:[1,0,1]
    v_pk_mul_f32 v[38:39], v[70:71], s[52:53]
    v_pk_fma_f32 v[72:73], v[16:17], v[24:25], v[72:73] op_sel:[0,1,0] op_sel_hi:[1,1,1] neg_lo:[1,0,0] neg_hi:[1,0,0]
    v_pk_fma_f32 v[72:73], v[72:73], v[26:27], v[8:9] op_sel:[0,1,0] op_sel_hi:[1,1,1]
    v_pk_mul_f32 v[40:41], v[72:73], s[52:53]
    v_pk_fma_f32 v[74:75], v[18:19], v[24:25], v[74:75] op_sel:[0,1,0] op_sel_hi:[1,1,1] neg_lo:[1,0,0] neg_hi:[1,0,0]
    v_pk_fma_f32 v[74:75], v[74:75], v[26:27], v[10:11] op_sel:[0,1,0] op_sel_hi:[1,1,1]
    v_pk_mul_f32 v[42:43], v[74:75], s[52:53]
    v_min_f32 v28, s54, v28
    v_min_f32 v29, s54, v29
    v_min_f32 v30, s54, v30
    v_min_f32 v31, s54, v31
    v_min_f32 v32, s54, v32
    v_min_f32 v33, s54, v33
    v_min_f32 v34, s54, v34
    v_min_f32 v35, s54, v35
    v_min_f32 v36, s54, v36
    v_min_f32 v37, s54, v37
    v_min_f32 v38, s54, v38
    v_min_f32 v39, s54, v39
    v_min_f32 v40, s54, v40
    v_min_f32 v41, s54, v41
    v_min_f32 v42, s54, v42
    v_min_f32 v43, s54, v43
    v_exp_f32 v28, v28
    v_exp_f32 v29, v29
    v_exp_f32 v30, v30
    v_exp_f32 v31, v31
    v_exp_f32 v32, v32
    v_exp_f32 v33, v33
    v_exp_f32 v34, v34
    v_exp_f32 v35, v35
    v_exp_f32 v36, v36
    v_exp_f32 v37, v37
    v_exp_f32 v38, v38
    v_exp_f32 v39, v39
    v_exp_f32 v40, v40
    v_exp_f32 v41, v41
    v_exp_f32 v42, v42
    v_exp_f32 v43, v43
    v_pk_add_f32 v[44:45], v[28:29], 2.0 op_sel_hi:[1,0]
    v_pk_mul_f32 v[28:29], v[28:29], v[44:45]
    v_pk_add_f32 v[44:45], v[28:29], 2.0 op_sel_hi:[1,0]
    v_pk_mul_f32 v[60:61], v[60:61], v[28:29]
    v_pk_add_f32 v[46:47], v[30:31], 2.0 op_sel_hi:[1,0]
    v_pk_mul_f32 v[30:31], v[30:31], v[46:47]
    v_pk_add_f32 v[46:47], v[30:31], 2.0 op_sel_hi:[1,0]
    v_pk_mul_f32 v[62:63], v[62:63], v[30:31]
    v_pk_add_f32 v[48:49], v[32:33], 2.0 op_sel_hi:[1,0]
    v_pk_mul_f32 v[32:33], v[32:33], v[48:49]
    v_pk_add_f32 v[48:49], v[32:33], 2.0 op_sel_hi:[1,0]
    v_pk_mul_f32 v[64:65], v[64:65], v[32:33]
    v_pk_add_f32 v[50:51], v[34:35], 2.0 op_sel_hi:[1,0]
    v_pk_mul_f32 v[34:35], v[34:35], v[50:51]
    v_pk_add_f32 v[50:51], v[34:35], 2.0 op_sel_hi:[1,0]
    v_pk_mul_f32 v[66:67], v[66:67], v[34:35]
    v_pk_add_f32 v[52:53], v[36:37], 2.0 op_sel_hi:[1,0]
    v_pk_mul_f32 v[36:37], v[36:37], v[52:53]
    v_pk_add_f32 v[52:53], v[36:37], 2.0 op_sel_hi:[1,0]
    v_pk_mul_f32 v[68:69], v[68:69], v[36:37]
    v_pk_add_f32 v[54:55], v[38:39], 2.0 op_sel_hi:[1,0]
    v_pk_mul_f32 v[38:39], v[38:39], v[54:55]
    v_pk_add_f32 v[54:55], v[38:39], 2.0 op_sel_hi:[1,0]
    v_pk_mul_f32 v[70:71], v[70:71], v[38:39]
    v_pk_add_f32 v[56:57], v[40:41], 2.0 op_sel_hi:[1,0]
    v_pk_mul_f32 v[40:41], v[40:41], v[56:57]
    v_pk_add_f32 v[56:57], v[40:41], 2.0 op_sel_hi:[1,0]
    v_pk_mul_f32 v[72:73], v[72:73], v[40:41]
    v_pk_add_f32 v[58:59], v[42:43], 2.0 op_sel_hi:[1,0]
    v_pk_mul_f32 v[42:43], v[42:43], v[58:59]
    v_pk_add_f32 v[58:59], v[42:43], 2.0 op_sel_hi:[1,0]
    v_pk_mul_f32 v[74:75], v[74:75], v[42:43]
    v_rcp_f32 v44, v44
    v_rcp_f32 v45, v45
    v_rcp_f32 v46, v46
    v_rcp_f32 v47, v47
    v_rcp_f32 v48, v48
    v_rcp_f32 v49, v49
    v_rcp_f32 v50, v50
    v_rcp_f32 v51, v51
    v_rcp_f32 v52, v52
    v_rcp_f32 v53, v53
    v_rcp_f32 v54, v54
    v_rcp_f32 v55, v55
    v_rcp_f32 v56, v56
    v_rcp_f32 v57, v57
    v_rcp_f32 v58, v58
    v_rcp_f32 v59, v59
    v_pk_mul_f32 v[60:61], v[60:61], v[44:45]
    v_pk_mul_f32 v[62:63], v[62:63], v[46:47]
    v_pk_mul_f32 v[64:65], v[64:65], v[48:49]
    v_pk_mul_f32 v[66:67], v[66:67], v[50:51]
    v_pk_mul_f32 v[68:69], v[68:69], v[52:53]
    v_pk_mul_f32 v[70:71], v[70:71], v[54:55]
    v_pk_mul_f32 v[72:73], v[72:73], v[56:57]
    v_pk_mul_f32 v[74:75], v[74:75], v[58:59]
    v_cvt_pk_bf16_f32 v28, v60, v61
    v_cvt_pk_bf16_f32 v29, v62, v63
    v_cvt_pk_bf16_f32 v30, v68, v69
    v_cvt_pk_bf16_f32 v31, v70, v71
    ds_write_b128 v120, v[28:31] offset:0
    v_cvt_pk_bf16_f32 v32, v64, v65
    v_cvt_pk_bf16_f32 v33, v66, v67
    v_cvt_pk_bf16_f32 v34, v72, v73
    v_cvt_pk_bf16_f32 v35, v74, v75
    ds_write_b128 v120, v[32:35] offset:1024
    s_waitcnt lgkmcnt(0)
    s_barrier
    ds_read_b128 v[84:87], v116 offset:32768
    ds_read_b128 v[88:91], v116 offset:33792
    ds_read_b128 v[92:95], v116 offset:34816
    ds_read_b128 v[96:99], v116 offset:35840
    ds_read_b128 v[100:103], v116 offset:36864
    ds_read_b128 v[104:107], v116 offset:37888
    ds_read_b128 v[108:111], v116 offset:38912
    ds_read_b128 v[112:115], v116 offset:39936
    s_waitcnt lgkmcnt(6)
    v_mfma_f32_16x16x32_bf16 v[28:31], a[0:3], v[84:87], 0
    v_mfma_f32_16x16x32_bf16 v[32:35], a[0:3], v[88:91], 0
    s_waitcnt lgkmcnt(4)
    v_mfma_f32_16x16x32_bf16 v[28:31], a[4:7], v[92:95], v[28:31]
    v_mfma_f32_16x16x32_bf16 v[32:35], a[4:7], v[96:99], v[32:35]
    s_waitcnt lgkmcnt(2)
    v_mfma_f32_16x16x32_bf16 v[28:31], a[8:11], v[100:103], v[28:31]
    v_mfma_f32_16x16x32_bf16 v[32:35], a[8:11], v[104:107], v[32:35]
    s_waitcnt lgkmcnt(0)
    v_mfma_f32_16x16x32_bf16 v[28:31], a[12:15], v[108:111], v[28:31]
    v_mfma_f32_16x16x32_bf16 v[32:35], a[12:15], v[112:115], v[32:35]
    v_mfma_f32_16x16x32_bf16 v[36:39], a[16:19], v[84:87], 0
    v_mfma_f32_16x16x32_bf16 v[40:43], a[16:19], v[88:91], 0
    v_mfma_f32_16x16x32_bf16 v[36:39], a[20:23], v[92:95], v[36:39]
    v_mfma_f32_16x16x32_bf16 v[40:43], a[20:23], v[96:99], v[40:43]
    v_mfma_f32_16x16x32_bf16 v[36:39], a[24:27], v[100:103], v[36:39]
    v_mfma_f32_16x16x32_bf16 v[40:43], a[24:27], v[104:107], v[40:43]
    v_mfma_f32_16x16x32_bf16 v[36:39], a[28:31], v[108:111], v[36:39]
    v_mfma_f32_16x16x32_bf16 v[40:43], a[28:31], v[112:115], v[40:43]
    s_add_u32 s32, s42, s44
    v_cvt_pk_bf16_f32 v28, v28, v29
    v_cvt_pk_bf16_f32 v29, v30, v31
    buffer_store_dwordx2 v[28:29], v119, s[8:11], s32 offen offset:0
    v_cvt_pk_bf16_f32 v32, v32, v33
    v_cvt_pk_bf16_f32 v33, v34, v35
    buffer_store_dwordx2 v[32:33], v119, s[8:11], s32 offen offset:1024
    v_mfma_f32_16x16x32_bf16 v[44:47], a[32:35], v[84:87], 0
    v_mfma_f32_16x16x32_bf16 v[48:51], a[32:35], v[88:91], 0
    v_mfma_f32_16x16x32_bf16 v[44:47], a[36:39], v[92:95], v[44:47]
    v_mfma_f32_16x16x32_bf16 v[48:51], a[36:39], v[96:99], v[48:51]
    v_mfma_f32_16x16x32_bf16 v[44:47], a[40:43], v[100:103], v[44:47]
    v_mfma_f32_16x16x32_bf16 v[48:51], a[40:43], v[104:107], v[48:51]
    v_mfma_f32_16x16x32_bf16 v[44:47], a[44:47], v[108:111], v[44:47]
    v_mfma_f32_16x16x32_bf16 v[48:51], a[44:47], v[112:115], v[48:51]
    s_add_u32 s32, s42, s45
    v_cvt_pk_bf16_f32 v36, v36, v37
    v_cvt_pk_bf16_f32 v37, v38, v39
    buffer_store_dwordx2 v[36:37], v119, s[8:11], s32 offen offset:0
    v_cvt_pk_bf16_f32 v40, v40, v41
    v_cvt_pk_bf16_f32 v41, v42, v43
    buffer_store_dwordx2 v[40:41], v119, s[8:11], s32 offen offset:1024
    v_mfma_f32_16x16x32_bf16 v[52:55], a[48:51], v[84:87], 0
    v_mfma_f32_16x16x32_bf16 v[56:59], a[48:51], v[88:91], 0
    v_mfma_f32_16x16x32_bf16 v[52:55], a[52:55], v[92:95], v[52:55]
    v_mfma_f32_16x16x32_bf16 v[56:59], a[52:55], v[96:99], v[56:59]
    v_mfma_f32_16x16x32_bf16 v[52:55], a[56:59], v[100:103], v[52:55]
    v_mfma_f32_16x16x32_bf16 v[56:59], a[56:59], v[104:107], v[56:59]
    v_mfma_f32_16x16x32_bf16 v[52:55], a[60:63], v[108:111], v[52:55]
    v_mfma_f32_16x16x32_bf16 v[56:59], a[60:63], v[112:115], v[56:59]
    s_add_u32 s32, s42, s46
    v_cvt_pk_bf16_f32 v44, v44, v45
    v_cvt_pk_bf16_f32 v45, v46, v47
    buffer_store_dwordx2 v[44:45], v119, s[8:11], s32 offen offset:0
    v_cvt_pk_bf16_f32 v48, v48, v49
    v_cvt_pk_bf16_f32 v49, v50, v51
    buffer_store_dwordx2 v[48:49], v119, s[8:11], s32 offen offset:1024
    v_mfma_f32_16x16x32_bf16 v[60:63], a[64:67], v[84:87], 0
    v_mfma_f32_16x16x32_bf16 v[64:67], a[64:67], v[88:91], 0
    v_mfma_f32_16x16x32_bf16 v[60:63], a[68:71], v[92:95], v[60:63]
    v_mfma_f32_16x16x32_bf16 v[64:67], a[68:71], v[96:99], v[64:67]
    v_mfma_f32_16x16x32_bf16 v[60:63], a[72:75], v[100:103], v[60:63]
    v_mfma_f32_16x16x32_bf16 v[64:67], a[72:75], v[104:107], v[64:67]
    v_mfma_f32_16x16x32_bf16 v[60:63], a[76:79], v[108:111], v[60:63]
    v_mfma_f32_16x16x32_bf16 v[64:67], a[76:79], v[112:115], v[64:67]
    s_add_u32 s32, s42, s47
    v_cvt_pk_bf16_f32 v52, v52, v53
    v_cvt_pk_bf16_f32 v53, v54, v55
    buffer_store_dwordx2 v[52:53], v119, s[8:11], s32 offen offset:0
    v_cvt_pk_bf16_f32 v56, v56, v57
    v_cvt_pk_bf16_f32 v57, v58, v59
    buffer_store_dwordx2 v[56:57], v119, s[8:11], s32 offen offset:1024
    v_mfma_f32_16x16x32_bf16 v[68:71], a[80:83], v[84:87], 0
    v_mfma_f32_16x16x32_bf16 v[72:75], a[80:83], v[88:91], 0
    v_mfma_f32_16x16x32_bf16 v[68:71], a[84:87], v[92:95], v[68:71]
    v_mfma_f32_16x16x32_bf16 v[72:75], a[84:87], v[96:99], v[72:75]
    v_mfma_f32_16x16x32_bf16 v[68:71], a[88:91], v[100:103], v[68:71]
    v_mfma_f32_16x16x32_bf16 v[72:75], a[88:91], v[104:107], v[72:75]
    v_mfma_f32_16x16x32_bf16 v[68:71], a[92:95], v[108:111], v[68:71]
    v_mfma_f32_16x16x32_bf16 v[72:75], a[92:95], v[112:115], v[72:75]
    s_add_u32 s32, s42, s48
    v_cvt_pk_bf16_f32 v60, v60, v61
    v_cvt_pk_bf16_f32 v61, v62, v63
    buffer_store_dwordx2 v[60:61], v119, s[8:11], s32 offen offset:0
    v_cvt_pk_bf16_f32 v64, v64, v65
    v_cvt_pk_bf16_f32 v65, v66, v67
    buffer_store_dwordx2 v[64:65], v119, s[8:11], s32 offen offset:1024
    v_mfma_f32_16x16x32_bf16 v[76:79], a[96:99], v[84:87], 0
    v_mfma_f32_16x16x32_bf16 v[80:83], a[96:99], v[88:91], 0
    v_mfma_f32_16x16x32_bf16 v[76:79], a[100:103], v[92:95], v[76:79]
    v_mfma_f32_16x16x32_bf16 v[80:83], a[100:103], v[96:99], v[80:83]
    v_mfma_f32_16x16x32_bf16 v[76:79], a[104:107], v[100:103], v[76:79]
    v_mfma_f32_16x16x32_bf16 v[80:83], a[104:107], v[104:107], v[80:83]
    v_mfma_f32_16x16x32_bf16 v[76:79], a[108:111], v[108:111], v[76:79]
    v_mfma_f32_16x16x32_bf16 v[80:83], a[108:111], v[112:115], v[80:83]
    s_add_u32 s32, s42, s49
    v_cvt_pk_bf16_f32 v68, v68, v69
    v_cvt_pk_bf16_f32 v69, v70, v71
    buffer_store_dwordx2 v[68:69], v119, s[8:11], s32 offen offset:0
    v_cvt_pk_bf16_f32 v72, v72, v73
    v_cvt_pk_bf16_f32 v73, v74, v75
    buffer_store_dwordx2 v[72:73], v119, s[8:11], s32 offen offset:1024
    s_nop 7
    s_add_u32 s32, s42, s50
    v_cvt_pk_bf16_f32 v76, v76, v77
    v_cvt_pk_bf16_f32 v77, v78, v79
    buffer_store_dwordx2 v[76:77], v119, s[8:11], s32 offen offset:0
    v_cvt_pk_bf16_f32 v80, v80, v81
    v_cvt_pk_bf16_f32 v81, v82, v83
    buffer_store_dwordx2 v[80:81], v119, s[8:11], s32 offen offset:1024
    s_waitcnt vmcnt(0)
    buffer_store_dword v1, v123, s[8:11], s25 offen
L_wf_34:
    buffer_load_dword v84, v117, s[8:11], s25 offen offset:0 sc1
    s_sub_u32 s26, s26, 1
    s_cbranch_scc1 L_fail
    s_waitcnt vmcnt(0)
    v_cmp_eq_u32 vcc, 0, v84
    s_cbranch_vccz L_wfd_35
    s_branch L_wf_34
L_wfd_35:
    s_add_u32 s32, s42, s51
    buffer_load_dwordx2 v[28:29], v119, s[8:11], s32 offen offset:0 sc1
    buffer_load_dwordx2 v[30:31], v119, s[8:11], s32 offen offset:2048 sc1
    s_add_u32 s32, s32, 4096
    buffer_load_dwordx2 v[32:33], v119, s[8:11], s32 offen offset:0 sc1
    buffer_load_dwordx2 v[34:35], v119, s[8:11], s32 offen offset:2048 sc1
    s_add_u32 s32, s32, 4096
    buffer_load_dwordx2 v[36:37], v119, s[8:11], s32 offen offset:0 sc1
    buffer_load_dwordx2 v[38:39], v119, s[8:11], s32 offen offset:2048 sc1
    s_add_u32 s32, s32, 4096
    buffer_load_dwordx2 v[40:41], v119, s[8:11], s32 offen offset:0 sc1
    buffer_load_dwordx2 v[42:43], v119, s[8:11], s32 offen offset:2048 sc1
    s_add_u32 s32, s32, 4096
    buffer_load_dwordx2 v[44:45], v119, s[8:11], s32 offen offset:0 sc1
    buffer_load_dwordx2 v[46:47], v119, s[8:11], s32 offen offset:2048 sc1
    s_add_u32 s32, s32, 4096
    buffer_load_dwordx2 v[48:49], v119, s[8:11], s32 offen offset:0 sc1
    buffer_load_dwordx2 v[50:51], v119, s[8:11], s32 offen offset:2048 sc1
    s_add_u32 s32, s32, 4096
    buffer_load_dwordx2 v[52:53], v119, s[8:11], s32 offen offset:0 sc1
    buffer_load_dwordx2 v[54:55], v119, s[8:11], s32 offen offset:2048 sc1
    s_add_u32 s32, s32, 4096
    s_waitcnt vmcnt(13)
    v_lshlrev_b32 v84, 16, v28
    v_and_b32 v85, 0xffff0000, v28
    v_lshlrev_b32 v86, 16, v29
    v_and_b32 v87, 0xffff0000, v29
    s_waitcnt vmcnt(12)
    v_lshlrev_b32 v88, 16, v30
    v_and_b32 v89, 0xffff0000, v30
    v_lshlrev_b32 v90, 16, v31
    v_and_b32 v91, 0xffff0000, v31
    v_pk_add_f32 v[84:85], v[84:85], v[88:89]
    v_pk_add_f32 v[86:87], v[86:87], v[90:91]
    s_waitcnt vmcnt(11)
    v_lshlrev_b32 v88, 16, v32
    v_and_b32 v89, 0xffff0000, v32
    v_lshlrev_b32 v90, 16, v33
    v_and_b32 v91, 0xffff0000, v33
    v_pk_add_f32 v[84:85], v[84:85], v[88:89]
    v_pk_add_f32 v[86:87], v[86:87], v[90:91]
    s_waitcnt vmcnt(10)
    v_lshlrev_b32 v88, 16, v34
    v_and_b32 v89, 0xffff0000, v34
    v_lshlrev_b32 v90, 16, v35
    v_and_b32 v91, 0xffff0000, v35
    v_pk_add_f32 v[84:85], v[84:85], v[88:89]
    v_pk_add_f32 v[86:87], v[86:87], v[90:91]
    s_waitcnt vmcnt(9)
    v_lshlrev_b32 v88, 16, v36
    v_and_b32 v89, 0xffff0000, v36
    v_lshlrev_b32 v90, 16, v37
    v_and_b32 v91, 0xffff0000, v37
    v_pk_add_f32 v[84:85], v[84:85], v[88:89]
    v_pk_add_f32 v[86:87], v[86:87], v[90:91]
    s_waitcnt vmcnt(8)
    v_lshlrev_b32 v88, 16, v38
    v_and_b32 v89, 0xffff0000, v38
    v_lshlrev_b32 v90, 16, v39
    v_and_b32 v91, 0xffff0000, v39
    v_pk_add_f32 v[84:85], v[84:85], v[88:89]
    v_pk_add_f32 v[86:87], v[86:87], v[90:91]
    s_waitcnt vmcnt(7)
    v_lshlrev_b32 v88, 16, v40
    v_and_b32 v89, 0xffff0000, v40
    v_lshlrev_b32 v90, 16, v41
    v_and_b32 v91, 0xffff0000, v41
    v_pk_add_f32 v[84:85], v[84:85], v[88:89]
    v_pk_add_f32 v[86:87], v[86:87], v[90:91]
    s_waitcnt vmcnt(6)
    v_lshlrev_b32 v88, 16, v42
    v_and_b32 v89, 0xffff0000, v42
    v_lshlrev_b32 v90, 16, v43
    v_and_b32 v91, 0xffff0000, v43
    v_pk_add_f32 v[84:85], v[84:85], v[88:89]
    v_pk_add_f32 v[86:87], v[86:87], v[90:91]
    s_waitcnt vmcnt(5)
    v_lshlrev_b32 v88, 16, v44
    v_and_b32 v89, 0xffff0000, v44
    v_lshlrev_b32 v90, 16, v45
    v_and_b32 v91, 0xffff0000, v45
    v_pk_add_f32 v[84:85], v[84:85], v[88:89]
    v_pk_add_f32 v[86:87], v[86:87], v[90:91]
    s_waitcnt vmcnt(4)
    v_lshlrev_b32 v88, 16, v46
    v_and_b32 v89, 0xffff0000, v46
    v_lshlrev_b32 v90, 16, v47
    v_and_b32 v91, 0xffff0000, v47
    v_pk_add_f32 v[84:85], v[84:85], v[88:89]
    v_pk_add_f32 v[86:87], v[86:87], v[90:91]
    s_waitcnt vmcnt(3)
    v_lshlrev_b32 v88, 16, v48
    v_and_b32 v89, 0xffff0000, v48
    v_lshlrev_b32 v90, 16, v49
    v_and_b32 v91, 0xffff0000, v49
    v_pk_add_f32 v[84:85], v[84:85], v[88:89]
    v_pk_add_f32 v[86:87], v[86:87], v[90:91]
    s_waitcnt vmcnt(2)
    v_lshlrev_b32 v88, 16, v50
    v_and_b32 v89, 0xffff0000, v50
    v_lshlrev_b32 v90, 16, v51
    v_and_b32 v91, 0xffff0000, v51
    v_pk_add_f32 v[84:85], v[84:85], v[88:89]
    v_pk_add_f32 v[86:87], v[86:87], v[90:91]
    s_waitcnt vmcnt(1)
    v_lshlrev_b32 v88, 16, v52
    v_and_b32 v89, 0xffff0000, v52
    v_lshlrev_b32 v90, 16, v53
    v_and_b32 v91, 0xffff0000, v53
    v_pk_add_f32 v[84:85], v[84:85], v[88:89]
    v_pk_add_f32 v[86:87], v[86:87], v[90:91]
    s_waitcnt vmcnt(0)
    v_lshlrev_b32 v88, 16, v54
    v_and_b32 v89, 0xffff0000, v54
    v_lshlrev_b32 v90, 16, v55
    v_and_b32 v91, 0xffff0000, v55
    v_pk_add_f32 v[84:85], v[84:85], v[88:89]
    v_pk_add_f32 v[86:87], v[86:87], v[90:91]
    v_lshlrev_b32 v88, 16, v2
    v_and_b32 v89, 0xffff0000, v2
    v_lshlrev_b32 v90, 16, v3
    v_and_b32 v91, 0xffff0000, v3
    v_pk_fma_f32 v[84:85], v[84:85], v[20:21], v[88:89]
    v_pk_fma_f32 v[86:87], v[86:87], v[22:23], v[90:91]
    v_cvt_pk_bf16_f32 v84, v84, v85
    v_cvt_pk_bf16_f32 v85, v86, v87
    buffer_store_dwordx2 v[84:85], v122, s[68:71], s43 offen
    s_add_u32 s20, s20, 6
    s_cmp_ge_u32 s20, 64
    s_cbranch_scc1 L_exit
    s_add_u32 s21, s21, 1536
    s_add_u32 s25, s25, 1536
    s_add_u32 s22, s22, 172032
    s_add_u32 s24, s24, 49152
    s_add_u32 s42, s42, s55
    s_sub_u32 s55, 0, s55
    s_add_u32 s43, s43, 172032
    s_branch L_F_segf
L_F_segs:
    s_cmp_eq_u32 s20, 0
    s_cbranch_scc1 L_F_segs_hard
    s_sub_u32 s32, s21, 256
L_wf_36:
    buffer_load_dword v2, v117, s[8:11], s32 offen offset:0 sc1
    s_sub_u32 s26, s26, 1
    s_cbranch_scc1 L_fail
    s_waitcnt vmcnt(0)
    v_cmp_eq_u32 vcc, 0, v2
    s_cbranch_vccz L_wfd_37
    s_sleep 8
    s_branch L_wf_36
L_wfd_37:
L_F_segs_hard:
    buffer_load_dword v84, v117, s[8:11], s21 offen sc1
    s_sleep 1
    s_sleep 1
    s_sleep 1
    s_sleep 1
    s_sleep 1
    buffer_load_dword v85, v117, s[8:11], s21 offen sc1
    s_sleep 1
    s_sleep 1
    s_sleep 1
    s_sleep 1
    s_sleep 1
L_wq_38:
    buffer_load_dword v86, v117, s[8:11], s21 offen sc1
    s_sub_u32 s26, s26, 1
    s_cbranch_scc1 L_fail
    s_waitcnt vmcnt(2)
    v_cmp_eq_u32 vcc, 0, v84
    s_cbranch_vccz L_wq_38_d
    buffer_load_dword v84, v117, s[8:11], s21 offen sc1
    s_waitcnt vmcnt(2)
    v_cmp_eq_u32 vcc, 0, v85
    s_cbranch_vccz L_wq_38_d
    buffer_load_dword v85, v117, s[8:11], s21 offen sc1
    s_waitcnt vmcnt(2)
    v_cmp_eq_u32 vcc, 0, v86
    s_cbranch_vccnz L_wq_38
L_wq_38_d:
    s_add_u32 s32, s24, 3584
    buffer_load_dwordx2 v[28:29], v118, s[8:11], s24 offen offset:0
    buffer_load_dwordx2 v[30:31], v118, s[8:11], s24 offen offset:128
    buffer_load_dwordx2 v[32:33], v118, s[8:11], s24 offen offset:256
    buffer_load_dwordx2 v[34:35], v118, s[8:11], s24 offen offset:384
    buffer_load_dwordx2 v[36:37], v118, s[8:11], s24 offen offset:512
    buffer_load_dwordx2 v[38:39], v118, s[8:11], s24 offen offset:640
    buffer_load_dwordx2 v[40:41], v118, s[8:11], s24 offen offset:768
    buffer_load_dwordx2 v[42:43], v118, s[8:11], s32 offen offset:0
    buffer_load_dwordx2 v[44:45], v118, s[8:11], s32 offen offset:128
    buffer_load_dwordx2 v[46:47], v118, s[8:11], s32 offen offset:256
    buffer_load_dwordx2 v[48:49], v118, s[8:11], s32 offen offset:384
    buffer_load_dwordx2 v[50:51], v118, s[8:11], s32 offen offset:512
    buffer_load_dwordx2 v[52:53], v118, s[8:11], s32 offen offset:640
    buffer_load_dwordx2 v[54:55], v118, s[8:11], s32 offen offset:768
    s_mov_b32 m0, s23
    s_add_u32 s30, s22, 48283648
    buffer_load_dwordx4 v116, s[8:11], s30 offen offset:0 lds
    buffer_load_dwordx4 v116, s[8:11], s30 offen offset:1024 lds
    buffer_load_dwordx4 v116, s[8:11], s30 offen offset:2048 lds
    buffer_load_dwordx4 v116, s[8:11], s30 offen offset:3072 lds
    s_add_u32 m0, s23, 4096
    s_add_u32 s30, s30, 4096
    buffer_load_dwordx4 v116, s[8:11], s30 offen offset:0 lds
    buffer_load_dwordx4 v116, s[8:11], s30 offen offset:1024 lds
    buffer_load_dwordx4 v116, s[8:11], s30 offen offset:2048 lds
    s_waitcnt vmcnt(7)
    v_add_f32 v24, v28, v30
    v_add_f32 v24, v24, v32
    v_add_f32 v24, v24, v34
    v_add_f32 v24, v24, v36
    v_add_f32 v24, v24, v38
    v_add_f32 v24, v24, v40
    v_add_f32 v25, v42, v44
    v_add_f32 v25, v25, v46
    v_add_f32 v25, v25, v48
    v_add_f32 v25, v25, v50
    v_add_f32 v25, v25, v52
    v_add_f32 v25, v25, v54
    v_mov_b32 v56, v24
    v_mov_b32 v57, v25
    s_nop 0
    v_permlane16_swap_b32 v24, v56
    v_permlane16_swap_b32 v25, v57
    v_add_f32 v24, v24, v56
    v_add_f32 v25, v25, v57
    v_mov_b32 v56, v24
    v_mov_b32 v57, v25
    s_nop 0
    v_permlane32_swap_b32 v24, v56
    v_permlane32_swap_b32 v25, v57
    v_add_f32 v24, v24, v56
    v_add_f32 v25, v25, v57
    v_mul_f32 v24, 1024608549, v24
    v_mul_f32 v25, 1024608549, v25
    v_mov_b32 v26, 0
    v_mov_b32 v56, 0
    v_sub_f32 v28, v28, v24
    v_add_f32 v26, v26, v29
    v_fmac_f32 v56, v28, v28
    v_sub_f32 v30, v30, v24
    v_add_f32 v26, v26, v31
    v_fmac_f32 v56, v30, v30
    v_sub_f32 v32, v32, v24
    v_add_f32 v26, v26, v33
    v_fmac_f32 v56, v32, v32
    v_sub_f32 v34, v34, v24
    v_add_f32 v26, v26, v35
    v_fmac_f32 v56, v34, v34
    v_sub_f32 v36, v36, v24
    v_add_f32 v26, v26, v37
    v_fmac_f32 v56, v36, v36
    v_sub_f32 v38, v38, v24
    v_add_f32 v26, v26, v39
    v_fmac_f32 v56, v38, v38
    v_sub_f32 v40, v40, v24
    v_add_f32 v26, v26, v41
    v_fmac_f32 v56, v40, v40
    v_fmac_f32 v26, 1098907648, v56
    v_mov_b32 v27, 0
    v_mov_b32 v57, 0
    v_sub_f32 v42, v42, v25
    v_add_f32 v27, v27, v43
    v_fmac_f32 v57, v42, v42
    v_sub_f32 v44, v44, v25
    v_add_f32 v27, v27, v45
    v_fmac_f32 v57, v44, v44
    v_sub_f32 v46, v46, v25
    v_add_f32 v27, v27, v47
    v_fmac_f32 v57, v46, v46
    v_sub_f32 v48, v48, v25
    v_add_f32 v27, v27, v49
    v_fmac_f32 v57, v48, v48
    v_sub_f32 v50, v50, v25
    v_add_f32 v27, v27, v51
    v_fmac_f32 v57, v50, v50
    v_sub_f32 v52, v52, v25
    v_add_f32 v27, v27, v53
    v_fmac_f32 v57, v52, v52
    v_sub_f32 v54, v54, v25
    v_add_f32 v27, v27, v55
    v_fmac_f32 v57, v54, v54
    v_fmac_f32 v27, 1098907648, v57
    v_mov_b32 v56, v26
    v_mov_b32 v57, v27
    s_nop 0
    v_permlane16_swap_b32 v26, v56
    v_permlane16_swap_b32 v27, v57
    v_add_f32 v26, v26, v56
    v_add_f32 v27, v27, v57
    v_mov_b32 v56, v26
    v_mov_b32 v57, v27
    s_nop 0
    v_permlane32_swap_b32 v26, v56
    v_permlane32_swap_b32 v27, v57
    v_add_f32 v26, v26, v56
    v_add_f32 v27, v27, v57
    v_mov_b32 v56, 925353388
    v_fmac_f32 v56, 991054117, v26
    v_rsq_f32 v26, v56
    v_mov_b32 v57, 925353388
    v_fmac_f32 v57, 991054117, v27
    v_rsq_f32 v27, v57
    s_waitcnt vmcnt(0)
    s_barrier
    ds_read_b128 v[84:87], v116 offset:0
    ds_read_b128 v[88:91], v116 offset:14336
    ds_read_b128 v[92:95], v116 offset:1024
    ds_read_b128 v[96:99], v116 offset:15360
    ds_read_b128 v[100:103], v116 offset:2048
    ds_read_b128 v[104:107], v116 offset:16384
    ds_read_b128 v[108:111], v116 offset:3072
    ds_read_b128 v[112:115], v116 offset:17408
    s_waitcnt lgkmcnt(6)
    v_mfma_f32_16x16x32_bf16 v[60:63], v[128:131], v[84:87], 0
    v_mfma_f32_16x16x32_bf16 v[64:67], v[128:131], v[88:91], 0
    v_mfma_f32_16x16x32_bf16 v[68:71], v[184:187], v[84:87], 0
    v_mfma_f32_16x16x32_bf16 v[72:75], v[184:187], v[88:91], 0
    ds_read_b128 v[84:87], v116 offset:4096
    ds_read_b128 v[88:91], v116 offset:18432
    s_waitcnt lgkmcnt(6)
    v_mfma_f32_16x16x32_bf16 v[60:63], v[132:135], v[92:95], v[60:63]
    v_mfma_f32_16x16x32_bf16 v[64:67], v[132:135], v[96:99], v[64:67]
    v_mfma_f32_16x16x32_bf16 v[68:71], v[188:191], v[92:95], v[68:71]
    v_mfma_f32_16x16x32_bf16 v[72:75], v[188:191], v[96:99], v[72:75]
    ds_read_b128 v[92:95], v116 offset:5120
    ds_read_b128 v[96:99], v116 offset:19456
    s_waitcnt lgkmcnt(6)
    v_mfma_f32_16x16x32_bf16 v[60:63], v[136:139], v[100:103], v[60:63]
    v_mfma_f32_16x16x32_bf16 v[64:67], v[136:139], v[104:107], v[64:67]
    v_mfma_f32_16x16x32_bf16 v[68:71], v[192:195], v[100:103], v[68:71]
    v_mfma_f32_16x16x32_bf16 v[72:75], v[192:195], v[104:107], v[72:75]
    ds_read_b128 v[100:103], v116 offset:6144
    ds_read_b128 v[104:107], v116 offset:20480
    s_waitcnt lgkmcnt(6)
    v_mfma_f32_16x16x32_bf16 v[60:63], v[140:143], v[108:111], v[60:63]
    v_mfma_f32_16x16x32_bf16 v[64:67], v[140:143], v[112:115], v[64:67]
    v_mfma_f32_16x16x32_bf16 v[68:71], v[196:199], v[108:111], v[68:71]
    v_mfma_f32_16x16x32_bf16 v[72:75], v[196:199], v[112:115], v[72:75]
    ds_read_b128 v[108:111], v116 offset:7168
    ds_read_b128 v[112:115], v116 offset:21504
    s_waitcnt lgkmcnt(6)
    v_mfma_f32_16x16x32_bf16 v[60:63], v[144:147], v[84:87], v[60:63]
    v_mfma_f32_16x16x32_bf16 v[64:67], v[144:147], v[88:91], v[64:67]
    v_mfma_f32_16x16x32_bf16 v[68:71], v[200:203], v[84:87], v[68:71]
    v_mfma_f32_16x16x32_bf16 v[72:75], v[200:203], v[88:91], v[72:75]
    ds_read_b128 v[84:87], v116 offset:8192
    ds_read_b128 v[88:91], v116 offset:22528
    s_waitcnt lgkmcnt(6)
    v_mfma_f32_16x16x32_bf16 v[60:63], v[148:151], v[92:95], v[60:63]
    v_mfma_f32_16x16x32_bf16 v[64:67], v[148:151], v[96:99], v[64:67]
    v_mfma_f32_16x16x32_bf16 v[68:71], v[204:207], v[92:95], v[68:71]
    v_mfma_f32_16x16x32_bf16 v[72:75], v[204:207], v[96:99], v[72:75]
    ds_read_b128 v[92:95], v116 offset:9216
    ds_read_b128 v[96:99], v116 offset:23552
    s_waitcnt lgkmcnt(6)
    v_mfma_f32_16x16x32_bf16 v[60:63], v[152:155], v[100:103], v[60:63]
    v_mfma_f32_16x16x32_bf16 v[64:67], v[152:155], v[104:107], v[64:67]
    v_mfma_f32_16x16x32_bf16 v[68:71], v[208:211], v[100:103], v[68:71]
    v_mfma_f32_16x16x32_bf16 v[72:75], v[208:211], v[104:107], v[72:75]
    ds_read_b128 v[100:103], v116 offset:10240
    ds_read_b128 v[104:107], v116 offset:24576
    s_waitcnt lgkmcnt(6)
    v_mfma_f32_16x16x32_bf16 v[60:63], v[156:159], v[108:111], v[60:63]
    v_mfma_f32_16x16x32_bf16 v[64:67], v[156:159], v[112:115], v[64:67]
    v_mfma_f32_16x16x32_bf16 v[68:71], v[212:215], v[108:111], v[68:71]
    v_mfma_f32_16x16x32_bf16 v[72:75], v[212:215], v[112:115], v[72:75]
    ds_read_b128 v[108:111], v116 offset:11264
    ds_read_b128 v[112:115], v116 offset:25600
    s_waitcnt lgkmcnt(6)
    v_mfma_f32_16x16x32_bf16 v[60:63], v[160:163], v[84:87], v[60:63]
    v_mfma_f32_16x16x32_bf16 v[64:67], v[160:163], v[88:91], v[64:67]
    v_mfma_f32_16x16x32_bf16 v[68:71], v[216:219], v[84:87], v[68:71]
    v_mfma_f32_16x16x32_bf16 v[72:75], v[216:219], v[88:91], v[72:75]
    ds_read_b128 v[84:87], v116 offset:12288
    ds_read_b128 v[88:91], v116 offset:26624
    s_waitcnt lgkmcnt(6)
    v_mfma_f32_16x16x32_bf16 v[60:63], v[164:167], v[92:95], v[60:63]
    v_mfma_f32_16x16x32_bf16 v[64:67], v[164:167], v[96:99], v[64:67]
    v_mfma_f32_16x16x32_bf16 v[68:71], v[220:223], v[92:95], v[68:71]
    v_mfma_f32_16x16x32_bf16 v[72:75], v[220:223], v[96:99], v[72:75]
    ds_read_b128 v[92:95], v116 offset:13312
    ds_read_b128 v[96:99], v116 offset:27648
    s_waitcnt lgkmcnt(6)
    v_mfma_f32_16x16x32_bf16 v[60:63], v[168:171], v[100:103], v[60:63]
    v_mfma_f32_16x16x32_bf16 v[64:67], v[168:171], v[104:107], v[64:67]
    v_mfma_f32_16x16x32_bf16 v[68:71], v[224:227], v[100:103], v[68:71]
    v_mfma_f32_16x16x32_bf16 v[72:75], v[224:227], v[104:107], v[72:75]
    s_waitcnt lgkmcnt(4)
    v_mfma_f32_16x16x32_bf16 v[60:63], v[172:175], v[108:111], v[60:63]
    v_mfma_f32_16x16x32_bf16 v[64:67], v[172:175], v[112:115], v[64:67]
    v_mfma_f32_16x16x32_bf16 v[68:71], v[228:231], v[108:111], v[68:71]
    v_mfma_f32_16x16x32_bf16 v[72:75], v[228:231], v[112:115], v[72:75]
    s_waitcnt lgkmcnt(2)
    v_mfma_f32_16x16x32_bf16 v[60:63], v[176:179], v[84:87], v[60:63]
    v_mfma_f32_16x16x32_bf16 v[64:67], v[176:179], v[88:91], v[64:67]
    v_mfma_f32_16x16x32_bf16 v[68:71], v[232:235], v[84:87], v[68:71]
    v_mfma_f32_16x16x32_bf16 v[72:75], v[232:235], v[88:91], v[72:75]
    s_waitcnt lgkmcnt(0)
    v_mfma_f32_16x16x32_bf16 v[60:63], v[180:183], v[92:95], v[60:63]
    v_mfma_f32_16x16x32_bf16 v[64:67], v[180:183], v[96:99], v[64:67]
    v_mfma_f32_16x16x32_bf16 v[68:71], v[236:239], v[92:95], v[68:71]
    v_mfma_f32_16x16x32_bf16 v[72:75], v[236:239], v[96:99], v[72:75]
    ds_read_b64 v[2:3], v121 offset:0
    s_nop 3
    v_pk_fma_f32 v[60:61], v[12:13], v[24:25], v[60:61] op_sel:[0,0,0] op_sel_hi:[1,0,1] neg_lo:[1,0,0] neg_hi:[1,0,0]
    v_pk_fma_f32 v[60:61], v[60:61], v[26:27], v[4:5] op_sel:[0,0,0] op_sel_hi:[1,0,1]
    v_pk_mul_f32 v[28:29], v[60:61], s[52:53]
    v_pk_fma_f32 v[62:63], v[14:15], v[24:25], v[62:63] op_sel:[0,0,0] op_sel_hi:[1,0,1] neg_lo:[1,0,0] neg_hi:[1,0,0]
    v_pk_fma_f32 v[62:63], v[62:63], v[26:27], v[6:7] op_sel:[0,0,0] op_sel_hi:[1,0,1]
    v_pk_mul_f32 v[30:31], v[62:63], s[52:53]
    v_pk_fma_f32 v[64:65], v[12:13], v[24:25], v[64:65] op_sel:[0,1,0] op_sel_hi:[1,1,1] neg_lo:[1,0,0] neg_hi:[1,0,0]
    v_pk_fma_f32 v[64:65], v[64:65], v[26:27], v[4:5] op_sel:[0,1,0] op_sel_hi:[1,1,1]
    v_pk_mul_f32 v[32:33], v[64:65], s[52:53]
    v_pk_fma_f32 v[66:67], v[14:15], v[24:25], v[66:67] op_sel:[0,1,0] op_sel_hi:[1,1,1] neg_lo:[1,0,0] neg_hi:[1,0,0]
    v_pk_fma_f32 v[66:67], v[66:67], v[26:27], v[6:7] op_sel:[0,1,0] op_sel_hi:[1,1,1]
    v_pk_mul_f32 v[34:35], v[66:67], s[52:53]
    v_pk_fma_f32 v[68:69], v[16:17], v[24:25], v[68:69] op_sel:[0,0,0] op_sel_hi:[1,0,1] neg_lo:[1,0,0] neg_hi:[1,0,0]
    v_pk_fma_f32 v[68:69], v[68:69], v[26:27], v[8:9] op_sel:[0,0,0] op_sel_hi:[1,0,1]
    v_pk_mul_f32 v[36:37], v[68:69], s[52:53]
    v_pk_fma_f32 v[70:71], v[18:19], v[24:25], v[70:71] op_sel:[0,0,0] op_sel_hi:[1,0,1] neg_lo:[1,0,0] neg_hi:[1,0,0]
    v_pk_fma_f32 v[70:71], v[70:71], v[26:27], v[10:11] op_sel:[0,0,0] op_sel_hi:[1,0,1]
    v_pk_mul_f32 v[38:39], v[70:71], s[52:53]
    v_pk_fma_f32 v[72:73], v[16:17], v[24:25], v[72:73] op_sel:[0,1,0] op_sel_hi:[1,1,1] neg_lo:[1,0,0] neg_hi:[1,0,0]
    v_pk_fma_f32 v[72:73], v[72:73], v[26:27], v[8:9] op_sel:[0,1,0] op_sel_hi:[1,1,1]
    v_pk_mul_f32 v[40:41], v[72:73], s[52:53]
    v_pk_fma_f32 v[74:75], v[18:19], v[24:25], v[74:75] op_sel:[0,1,0] op_sel_hi:[1,1,1] neg_lo:[1,0,0] neg_hi:[1,0,0]
    v_pk_fma_f32 v[74:75], v[74:75], v[26:27], v[10:11] op_sel:[0,1,0] op_sel_hi:[1,1,1]
    v_pk_mul_f32 v[42:43], v[74:75], s[52:53]
    v_min_f32 v28, s54, v28
    v_min_f32 v29, s54, v29
    v_min_f32 v30, s54, v30
    v_min_f32 v31, s54, v31
    v_min_f32 v32, s54, v32
    v_min_f32 v33, s54, v33
    v_min_f32 v34, s54, v34
    v_min_f32 v35, s54, v35
    v_min_f32 v36, s54, v36
    v_min_f32 v37, s54, v37
    v_min_f32 v38, s54, v38
    v_min_f32 v39, s54, v39
    v_min_f32 v40, s54, v40
    v_min_f32 v41, s54, v41
    v_min_f32 v42, s54, v42
    v_min_f32 v43, s54, v43
    v_exp_f32 v28, v28
    v_exp_f32 v29, v29
    v_exp_f32 v30, v30
    v_exp_f32 v31, v31
    v_exp_f32 v32, v32
    v_exp_f32 v33, v33
    v_exp_f32 v34, v34
    v_exp_f32 v35, v35
    v_exp_f32 v36, v36
    v_exp_f32 v37, v37
    v_exp_f32 v38, v38
    v_exp_f32 v39, v39
    v_exp_f32 v40, v40
    v_exp_f32 v41, v41
    v_exp_f32 v42, v42
    v_exp_f32 v43, v43
    v_pk_add_f32 v[44:45], v[28:29], 2.0 op_sel_hi:[1,0]
    v_pk_mul_f32 v[28:29], v[28:29], v[44:45]
    v_pk_add_f32 v[44:45], v[28:29], 2.0 op_sel_hi:[1,0]
    v_pk_mul_f32 v[60:61], v[60:61], v[28:29]
    v_pk_add_f32 v[46:47], v[30:31], 2.0 op_sel_hi:[1,0]
    v_pk_mul_f32 v[30:31], v[30:31], v[46:47]
    v_pk_add_f32 v[46:47], v[30:31], 2.0 op_sel_hi:[1,0]
    v_pk_mul_f32 v[62:63], v[62:63], v[30:31]
    v_pk_add_f32 v[48:49], v[32:33], 2.0 op_sel_hi:[1,0]
    v_pk_mul_f32 v[32:33], v[32:33], v[48:49]
    v_pk_add_f32 v[48:49], v[32:33], 2.0 op_sel_hi:[1,0]
    v_pk_mul_f32 v[64:65], v[64:65], v[32:33]
    v_pk_add_f32 v[50:51], v[34:35], 2.0 op_sel_hi:[1,0]
    v_pk_mul_f32 v[34:35], v[34:35], v[50:51]
    v_pk_add_f32 v[50:51], v[34:35], 2.0 op_sel_hi:[1,0]
    v_pk_mul_f32 v[66:67], v[66:67], v[34:35]
    v_pk_add_f32 v[52:53], v[36:37], 2.0 op_sel_hi:[1,0]
    v_pk_mul_f32 v[36:37], v[36:37], v[52:53]
    v_pk_add_f32 v[52:53], v[36:37], 2.0 op_sel_hi:[1,0]
    v_pk_mul_f32 v[68:69], v[68:69], v[36:37]
    v_pk_add_f32 v[54:55], v[38:39], 2.0 op_sel_hi:[1,0]
    v_pk_mul_f32 v[38:39], v[38:39], v[54:55]
    v_pk_add_f32 v[54:55], v[38:39], 2.0 op_sel_hi:[1,0]
    v_pk_mul_f32 v[70:71], v[70:71], v[38:39]
    v_pk_add_f32 v[56:57], v[40:41], 2.0 op_sel_hi:[1,0]
    v_pk_mul_f32 v[40:41], v[40:41], v[56:57]
    v_pk_add_f32 v[56:57], v[40:41], 2.0 op_sel_hi:[1,0]
    v_pk_mul_f32 v[72:73], v[72:73], v[40:41]
    v_pk_add_f32 v[58:59], v[42:43], 2.0 op_sel_hi:[1,0]
    v_pk_mul_f32 v[42:43], v[42:43], v[58:59]
    v_pk_add_f32 v[58:59], v[42:43], 2.0 op_sel_hi:[1,0]
    v_pk_mul_f32 v[74:75], v[74:75], v[42:43]
    v_rcp_f32 v44, v44
    v_rcp_f32 v45, v45
    v_rcp_f32 v46, v46
    v_rcp_f32 v47, v47
    v_rcp_f32 v48, v48
    v_rcp_f32 v49, v49
    v_rcp_f32 v50, v50
    v_rcp_f32 v51, v51
    v_rcp_f32 v52, v52
    v_rcp_f32 v53, v53
    v_rcp_f32 v54, v54
    v_rcp_f32 v55, v55
    v_rcp_f32 v56, v56
    v_rcp_f32 v57, v57
    v_rcp_f32 v58, v58
    v_rcp_f32 v59, v59
    v_pk_mul_f32 v[60:61], v[60:61], v[44:45]
    v_pk_mul_f32 v[62:63], v[62:63], v[46:47]
    v_pk_mul_f32 v[64:65], v[64:65], v[48:49]
    v_pk_mul_f32 v[66:67], v[66:67], v[50:51]
    v_pk_mul_f32 v[68:69], v[68:69], v[52:53]
    v_pk_mul_f32 v[70:71], v[70:71], v[54:55]
    v_pk_mul_f32 v[72:73], v[72:73], v[56:57]
    v_pk_mul_f32 v[74:75], v[74:75], v[58:59]
    v_cvt_pk_bf16_f32 v28, v60, v61
    v_cvt_pk_bf16_f32 v29, v62, v63
    v_cvt_pk_bf16_f32 v30, v68, v69
    v_cvt_pk_bf16_f32 v31, v70, v71
    ds_write_b128 v120, v[28:31] offset:0
    v_cvt_pk_bf16_f32 v32, v64, v65
    v_cvt_pk_bf16_f32 v33, v66, v67
    v_cvt_pk_bf16_f32 v34, v72, v73
    v_cvt_pk_bf16_f32 v35, v74, v75
    ds_write_b128 v120, v[32:35] offset:1024
    s_waitcnt lgkmcnt(0)
    s_barrier
    ds_read_b128 v[84:87], v116 offset:32768
    ds_read_b128 v[88:91], v116 offset:33792
    ds_read_b128 v[92:95], v116 offset:34816
    ds_read_b128 v[96:99], v116 offset:35840
    ds_read_b128 v[100:103], v116 offset:36864
    ds_read_b128 v[104:107], v116 offset:37888
    ds_read_b128 v[108:111], v116 offset:38912
    ds_read_b128 v[112:115], v116 offset:39936
    s_waitcnt lgkmcnt(6)
    v_mfma_f32_16x16x32_bf16 v[28:31], a[0:3], v[84:87], 0
    v_mfma_f32_16x16x32_bf16 v[32:35], a[0:3], v[88:91], 0
    s_waitcnt lgkmcnt(4)
    v_mfma_f32_16x16x32_bf16 v[28:31], a[4:7], v[92:95], v[28:31]
    v_mfma_f32_16x16x32_bf16 v[32:35], a[4:7], v[96:99], v[32:35]
    s_waitcnt lgkmcnt(2)
    v_mfma_f32_16x16x32_bf16 v[28:31], a[8:11], v[100:103], v[28:31]
    v_mfma_f32_16x16x32_bf16 v[32:35], a[8:11], v[104:107], v[32:35]
    s_waitcnt lgkmcnt(0)
    v_mfma_f32_16x16x32_bf16 v[28:31], a[12:15], v[108:111], v[28:31]
    v_mfma_f32_16x16x32_bf16 v[32:35], a[12:15], v[112:115], v[32:35]
    v_mfma_f32_16x16x32_bf16 v[36:39], a[16:19], v[84:87], 0
    v_mfma_f32_16x16x32_bf16 v[40:43], a[16:19], v[88:91], 0
    v_mfma_f32_16x16x32_bf16 v[36:39], a[20:23], v[92:95], v[36:39]
    v_mfma_f32_16x16x32_bf16 v[40:43], a[20:23], v[96:99], v[40:43]
    v_mfma_f32_16x16x32_bf16 v[36:39], a[24:27], v[100:103], v[36:39]
    v_mfma_f32_16x16x32_bf16 v[40:43], a[24:27], v[104:107], v[40:43]
    v_mfma_f32_16x16x32_bf16 v[36:39], a[28:31], v[108:111], v[36:39]
    v_mfma_f32_16x16x32_bf16 v[40:43], a[28:31], v[112:115], v[40:43]
    s_add_u32 s32, s42, s44
    v_cvt_pk_bf16_f32 v28, v28, v29
    v_cvt_pk_bf16_f32 v29, v30, v31
    buffer_store_dwordx2 v[28:29], v119, s[8:11], s32 offen offset:0 sc1
    v_cvt_pk_bf16_f32 v32, v32, v33
    v_cvt_pk_bf16_f32 v33, v34, v35
    buffer_store_dwordx2 v[32:33], v119, s[8:11], s32 offen offset:1024 sc1
    v_mfma_f32_16x16x32_bf16 v[44:47], a[32:35], v[84:87], 0
    v_mfma_f32_16x16x32_bf16 v[48:51], a[32:35], v[88:91], 0
    v_mfma_f32_16x16x32_bf16 v[44:47], a[36:39], v[92:95], v[44:47]
    v_mfma_f32_16x16x32_bf16 v[48:51], a[36:39], v[96:99], v[48:51]
    v_mfma_f32_16x16x32_bf16 v[44:47], a[40:43], v[100:103], v[44:47]
    v_mfma_f32_16x16x32_bf16 v[48:51], a[40:43], v[104:107], v[48:51]
    v_mfma_f32_16x16x32_bf16 v[44:47], a[44:47], v[108:111], v[44:47]
    v_mfma_f32_16x16x32_bf16 v[48:51], a[44:47], v[112:115], v[48:51]
    s_add_u32 s32, s42, s45
    v_cvt_pk_bf16_f32 v36, v36, v37
    v_cvt_pk_bf16_f32 v37, v38, v39
    buffer_store_dwordx2 v[36:37], v119, s[8:11], s32 offen offset:0 sc1
    v_cvt_pk_bf16_f32 v40, v40, v41
    v_cvt_pk_bf16_f32 v41, v42, v43
    buffer_store_dwordx2 v[40:41], v119, s[8:11], s32 offen offset:1024 sc1
    v_mfma_f32_16x16x32_bf16 v[52:55], a[48:51], v[84:87], 0
    v_mfma_f32_16x16x32_bf16 v[56:59], a[48:51], v[88:91], 0
    v_mfma_f32_16x16x32_bf16 v[52:55], a[52:55], v[92:95], v[52:55]
    v_mfma_f32_16x16x32_bf16 v[56:59], a[52:55], v[96:99], v[56:59]
    v_mfma_f32_16x16x32_bf16 v[52:55], a[56:59], v[100:103], v[52:55]
    v_mfma_f32_16x16x32_bf16 v[56:59], a[56:59], v[104:107], v[56:59]
    v_mfma_f32_16x16x32_bf16 v[52:55], a[60:63], v[108:111], v[52:55]
    v_mfma_f32_16x16x32_bf16 v[56:59], a[60:63], v[112:115], v[56:59]
    s_add_u32 s32, s42, s46
    v_cvt_pk_bf16_f32 v44, v44, v45
    v_cvt_pk_bf16_f32 v45, v46, v47
    buffer_store_dwordx2 v[44:45], v119, s[8:11], s32 offen offset:0 sc1
    v_cvt_pk_bf16_f32 v48, v48, v49
    v_cvt_pk_bf16_f32 v49, v50, v51
    buffer_store_dwordx2 v[48:49], v119, s[8:11], s32 offen offset:1024 sc1
    v_mfma_f32_16x16x32_bf16 v[60:63], a[64:67], v[84:87], 0
    v_mfma_f32_16x16x32_bf16 v[64:67], a[64:67], v[88:91], 0
    v_mfma_f32_16x16x32_bf16 v[60:63], a[68:71], v[92:95], v[60:63]
    v_mfma_f32_16x16x32_bf16 v[64:67], a[68:71], v[96:99], v[64:67]
    v_mfma_f32_16x16x32_bf16 v[60:63], a[72:75], v[100:103], v[60:63]
    v_mfma_f32_16x16x32_bf16 v[64:67], a[72:75], v[104:107], v[64:67]
    v_mfma_f32_16x16x32_bf16 v[60:63], a[76:79], v[108:111], v[60:63]
    v_mfma_f32_16x16x32_bf16 v[64:67], a[76:79], v[112:115], v[64:67]
    s_add_u32 s32, s42, s47
    v_cvt_pk_bf16_f32 v52, v52, v53
    v_cvt_pk_bf16_f32 v53, v54, v55
    buffer_store_dwordx2 v[52:53], v119, s[8:11], s32 offen offset:0 sc1
    v_cvt_pk_bf16_f32 v56, v56, v57
    v_cvt_pk_bf16_f32 v57, v58, v59
    buffer_store_dwordx2 v[56:57], v119, s[8:11], s32 offen offset:1024 sc1
    v_mfma_f32_16x16x32_bf16 v[68:71], a[80:83], v[84:87], 0
    v_mfma_f32_16x16x32_bf16 v[72:75], a[80:83], v[88:91], 0
    v_mfma_f32_16x16x32_bf16 v[68:71], a[84:87], v[92:95], v[68:71]
    v_mfma_f32_16x16x32_bf16 v[72:75], a[84:87], v[96:99], v[72:75]
    v_mfma_f32_16x16x32_bf16 v[68:71], a[88:91], v[100:103], v[68:71]
    v_mfma_f32_16x16x32_bf16 v[72:75], a[88:91], v[104:107], v[72:75]
    v_mfma_f32_16x16x32_bf16 v[68:71], a[92:95], v[108:111], v[68:71]
    v_mfma_f32_16x16x32_bf16 v[72:75], a[92:95], v[112:115], v[72:75]
    s_add_u32 s32, s42, s48
    v_cvt_pk_bf16_f32 v60, v60, v61
    v_cvt_pk_bf16_f32 v61, v62, v63
    buffer_store_dwordx2 v[60:61], v119, s[8:11], s32 offen offset:0 sc1
    v_cvt_pk_bf16_f32 v64, v64, v65
    v_cvt_pk_bf16_f32 v65, v66, v67
    buffer_store_dwordx2 v[64:65], v119, s[8:11], s32 offen offset:1024 sc1
    v_mfma_f32_16x16x32_bf16 v[76:79], a[96:99], v[84:87], 0
    v_mfma_f32_16x16x32_bf16 v[80:83], a[96:99], v[88:91], 0
    v_mfma_f32_16x16x32_bf16 v[76:79], a[100:103], v[92:95], v[76:79]
    v_mfma_f32_16x16x32_bf16 v[80:83], a[100:103], v[96:99], v[80:83]
    v_mfma_f32_16x16x32_bf16 v[76:79], a[104:107], v[100:103], v[76:79]
    v_mfma_f32_16x16x32_bf16 v[80:83], a[104:107], v[104:107], v[80:83]
    v_mfma_f32_16x16x32_bf16 v[76:79], a[108:111], v[108:111], v[76:79]
    v_mfma_f32_16x16x32_bf16 v[80:83], a[108:111], v[112:115], v[80:83]
    s_add_u32 s32, s42, s49
    v_cvt_pk_bf16_f32 v68, v68, v69
    v_cvt_pk_bf16_f32 v69, v70, v71
    buffer_store_dwordx2 v[68:69], v119, s[8:11], s32 offen offset:0 sc1
    v_cvt_pk_bf16_f32 v72, v72, v73
    v_cvt_pk_bf16_f32 v73, v74, v75
    buffer_store_dwordx2 v[72:73], v119, s[8:11], s32 offen offset:1024 sc1
    s_nop 7
    s_add_u32 s32, s42, s50
    v_cvt_pk_bf16_f32 v76, v76, v77
    v_cvt_pk_bf16_f32 v77, v78, v79
    buffer_store_dwordx2 v[76:77], v119, s[8:11], s32 offen offset:0 sc1
    v_cvt_pk_bf16_f32 v80, v80, v81
    v_cvt_pk_bf16_f32 v81, v82, v83
    buffer_store_dwordx2 v[80:81], v119, s[8:11], s32 offen offset:1024 sc1
    s_waitcnt vmcnt(0)
    buffer_store_dword v1, v123, s[8:11], s25 offen sc1
L_wf_39:
    buffer_load_dword v84, v117, s[8:11], s25 offen offset:0 sc1
    s_sub_u32 s26, s26, 1
    s_cbranch_scc1 L_fail
    s_waitcnt vmcnt(0)
    v_cmp_eq_u32 vcc, 0, v84
    s_cbranch_vccz L_wfd_40
    s_branch L_wf_39
L_wfd_40:
    s_add_u32 s32, s42, s51
    buffer_load_dwordx2 v[28:29], v119, s[8:11], s32 offen offset:0 sc1
    buffer_load_dwordx2 v[30:31], v119, s[8:11], s32 offen offset:2048 sc1
    s_add_u32 s32, s32, 4096
    buffer_load_dwordx2 v[32:33], v119, s[8:11], s32 offen offset:0 sc1
    buffer_load_dwordx2 v[34:35], v119, s[8:11], s32 offen offset:2048 sc1
    s_add_u32 s32, s32, 4096
    buffer_load_dwordx2 v[36:37], v119, s[8:11], s32 offen offset:0 sc1
    buffer_load_dwordx2 v[38:39], v119, s[8:11], s32 offen offset:2048 sc1
    s_add_u32 s32, s32, 4096
    buffer_load_dwordx2 v[40:41], v119, s[8:11], s32 offen offset:0 sc1
    buffer_load_dwordx2 v[42:43], v119, s[8:11], s32 offen offset:2048 sc1
    s_add_u32 s32, s32, 4096
    buffer_load_dwordx2 v[44:45], v119, s[8:11], s32 offen offset:0 sc1
    buffer_load_dwordx2 v[46:47], v119, s[8:11], s32 offen offset:2048 sc1
    s_add_u32 s32, s32, 4096
    buffer_load_dwordx2 v[48:49], v119, s[8:11], s32 offen offset:0 sc1
    buffer_load_dwordx2 v[50:51], v119, s[8:11], s32 offen offset:2048 sc1
    s_add_u32 s32, s32, 4096
    buffer_load_dwordx2 v[52:53], v119, s[8:11], s32 offen offset:0 sc1
    buffer_load_dwordx2 v[54:55], v119, s[8:11], s32 offen offset:2048 sc1
    s_add_u32 s32, s32, 4096
    s_waitcnt vmcnt(13)
    v_lshlrev_b32 v84, 16, v28
    v_and_b32 v85, 0xffff0000, v28
    v_lshlrev_b32 v86, 16, v29
    v_and_b32 v87, 0xffff0000, v29
    s_waitcnt vmcnt(12)
    v_lshlrev_b32 v88, 16, v30
    v_and_b32 v89, 0xffff0000, v30
    v_lshlrev_b32 v90, 16, v31
    v_and_b32 v91, 0xffff0000, v31
    v_pk_add_f32 v[84:85], v[84:85], v[88:89]
    v_pk_add_f32 v[86:87], v[86:87], v[90:91]
    s_waitcnt vmcnt(11)
    v_lshlrev_b32 v88, 16, v32
    v_and_b32 v89, 0xffff0000, v32
    v_lshlrev_b32 v90, 16, v33
    v_and_b32 v91, 0xffff0000, v33
    v_pk_add_f32 v[84:85], v[84:85], v[88:89]
    v_pk_add_f32 v[86:87], v[86:87], v[90:91]
    s_waitcnt vmcnt(10)
    v_lshlrev_b32 v88, 16, v34
    v_and_b32 v89, 0xffff0000, v34
    v_lshlrev_b32 v90, 16, v35
    v_and_b32 v91, 0xffff0000, v35
    v_pk_add_f32 v[84:85], v[84:85], v[88:89]
    v_pk_add_f32 v[86:87], v[86:87], v[90:91]
    s_waitcnt vmcnt(9)
    v_lshlrev_b32 v88, 16, v36
    v_and_b32 v89, 0xffff0000, v36
    v_lshlrev_b32 v90, 16, v37
    v_and_b32 v91, 0xffff0000, v37
    v_pk_add_f32 v[84:85], v[84:85], v[88:89]
    v_pk_add_f32 v[86:87], v[86:87], v[90:91]
    s_waitcnt vmcnt(8)
    v_lshlrev_b32 v88, 16, v38
    v_and_b32 v89, 0xffff0000, v38
    v_lshlrev_b32 v90, 16, v39
    v_and_b32 v91, 0xffff0000, v39
    v_pk_add_f32 v[84:85], v[84:85], v[88:89]
    v_pk_add_f32 v[86:87], v[86:87], v[90:91]
    s_waitcnt vmcnt(7)
    v_lshlrev_b32 v88, 16, v40
    v_and_b32 v89, 0xffff0000, v40
    v_lshlrev_b32 v90, 16, v41
    v_and_b32 v91, 0xffff0000, v41
    v_pk_add_f32 v[84:85], v[84:85], v[88:89]
    v_pk_add_f32 v[86:87], v[86:87], v[90:91]
    s_waitcnt vmcnt(6)
    v_lshlrev_b32 v88, 16, v42
    v_and_b32 v89, 0xffff0000, v42
    v_lshlrev_b32 v90, 16, v43
    v_and_b32 v91, 0xffff0000, v43
    v_pk_add_f32 v[84:85], v[84:85], v[88:89]
    v_pk_add_f32 v[86:87], v[86:87], v[90:91]
    s_waitcnt vmcnt(5)
    v_lshlrev_b32 v88, 16, v44
    v_and_b32 v89, 0xffff0000, v44
    v_lshlrev_b32 v90, 16, v45
    v_and_b32 v91, 0xffff0000, v45
    v_pk_add_f32 v[84:85], v[84:85], v[88:89]
    v_pk_add_f32 v[86:87], v[86:87], v[90:91]
    s_waitcnt vmcnt(4)
    v_lshlrev_b32 v88, 16, v46
    v_and_b32 v89, 0xffff0000, v46
    v_lshlrev_b32 v90, 16, v47
    v_and_b32 v91, 0xffff0000, v47
    v_pk_add_f32 v[84:85], v[84:85], v[88:89]
    v_pk_add_f32 v[86:87], v[86:87], v[90:91]
    s_waitcnt vmcnt(3)
    v_lshlrev_b32 v88, 16, v48
    v_and_b32 v89, 0xffff0000, v48
    v_lshlrev_b32 v90, 16, v49
    v_and_b32 v91, 0xffff0000, v49
    v_pk_add_f32 v[84:85], v[84:85], v[88:89]
    v_pk_add_f32 v[86:87], v[86:87], v[90:91]
    s_waitcnt vmcnt(2)
    v_lshlrev_b32 v88, 16, v50
    v_and_b32 v89, 0xffff0000, v50
    v_lshlrev_b32 v90, 16, v51
    v_and_b32 v91, 0xffff0000, v51
    v_pk_add_f32 v[84:85], v[84:85], v[88:89]
    v_pk_add_f32 v[86:87], v[86:87], v[90:91]
    s_waitcnt vmcnt(1)
    v_lshlrev_b32 v88, 16, v52
    v_and_b32 v89, 0xffff0000, v52
    v_lshlrev_b32 v90, 16, v53
    v_and_b32 v91, 0xffff0000, v53
    v_pk_add_f32 v[84:85], v[84:85], v[88:89]
    v_pk_add_f32 v[86:87], v[86:87], v[90:91]
    s_waitcnt vmcnt(0)
    v_lshlrev_b32 v88, 16, v54
    v_and_b32 v89, 0xffff0000, v54
    v_lshlrev_b32 v90, 16, v55
    v_and_b32 v91, 0xffff0000, v55
    v_pk_add_f32 v[84:85], v[84:85], v[88:89]
    v_pk_add_f32 v[86:87], v[86:87], v[90:91]
    v_lshlrev_b32 v88, 16, v2
    v_and_b32 v89, 0xffff0000, v2
    v_lshlrev_b32 v90, 16, v3
    v_and_b32 v91, 0xffff0000, v3
    v_pk_fma_f32 v[84:85], v[84:85], v[20:21], v[88:89]
    v_pk_fma_f32 v[86:87], v[86:87], v[22:23], v[90:91]
    v_cvt_pk_bf16_f32 v84, v84, v85
    v_cvt_pk_bf16_f32 v85, v86, v87
    buffer_store_dwordx2 v[84:85], v122, s[68:71], s43 offen
    s_add_u32 s20, s20, 6
    s_cmp_ge_u32 s20, 64
    s_cbranch_scc1 L_exit
    s_add_u32 s21, s21, 1536
    s_add_u32 s25, s25, 1536
    s_add_u32 s22, s22, 172032
    s_add_u32 s24, s24, 49152
    s_add_u32 s42, s42, s55
    s_sub_u32 s55, 0, s55
    s_add_u32 s43, s43, 172032
    s_branch L_F_segs
L_LN:
    v_and_b32 v1, 63, v0
    v_lshrrev_b32 v2, 4, v1
    v_and_b32 v3, 15, v1
    s_mov_b32 s26, 1048576
    s_lshl_b32 s20, s13, 2
    s_add_u32 s20, s20, s12
    s_mul_i32 s21, s20, 14336
    v_lshlrev_b32 v4, 4, v1
    s_mul_i32 s22, s12, 20480
    s_mov_b32 exec_hi, 0x00ffffff
    s_add_u32 m0, s22, 0
    s_add_u32 s23, s21, 0
    buffer_load_dwordx4 v4, s[64:67], s23 offen lds
    s_add_u32 m0, s22, 912
    s_add_u32 s23, s21, 896
    buffer_load_dwordx4 v4, s[64:67], s23 offen lds
    s_add_u32 m0, s22, 1824
    s_add_u32 s23, s21, 1792
    buffer_load_dwordx4 v4, s[64:67], s23 offen lds
    s_add_u32 m0, s22, 2736
    s_add_u32 s23, s21, 2688
    buffer_load_dwordx4 v4, s[64:67], s23 offen lds
    s_add_u32 m0, s22, 3648
    s_add_u32 s23, s21, 3584
    buffer_load_dwordx4 v4, s[64:67], s23 offen lds
    s_add_u32 m0, s22, 4560
    s_add_u32 s23, s21, 4480
    buffer_load_dwordx4 v4, s[64:67], s23 offen lds
    s_add_u32 m0, s22, 5472
    s_add_u32 s23, s21, 5376
    buffer_load_dwordx4 v4, s[64:67], s23 offen lds
    s_add_u32 m0, s22, 6384
    s_add_u32 s23, s21, 6272
    buffer_load_dwordx4 v4, s[64:67], s23 offen lds
    s_add_u32 m0, s22, 7296
    s_add_u32 s23, s21, 7168
    buffer_load_dwordx4 v4, s[64:67], s23 offen lds
    s_add_u32 m0, s22, 8208
    s_add_u32 s23, s21, 8064
    buffer_load_dwordx4 v4, s[64:67], s23 offen lds
    s_add_u32 m0, s22, 9120
    s_add_u32 s23, s21, 8960
    buffer_load_dwordx4 v4, s[64:67], s23 offen lds
    s_add_u32 m0, s22, 10032
    s_add_u32 s23, s21, 9856
    buffer_load_dwordx4 v4, s[64:67], s23 offen lds
    s_add_u32 m0, s22, 10944
    s_add_u32 s23, s21, 10752
    buffer_load_dwordx4 v4, s[64:67], s23 offen lds
    s_add_u32 m0, s22, 11856
    s_add_u32 s23, s21, 11648
    buffer_load_dwordx4 v4, s[64:67], s23 offen lds
    s_add_u32 m0, s22, 12768
    s_add_u32 s23, s21, 12544
    buffer_load_dwordx4 v4, s[64:67], s23 offen lds
    s_add_u32 m0, s22, 13680
    s_add_u32 s23, s21, 13440
    buffer_load_dwordx4 v4, s[64:67], s23 offen lds
    s_mov_b32 exec_hi, -1
    s_mov_b32 s27, s20
    s_add_u32 s24, s22, 16384
    v_mul_u32_u24 v12, 912, v3
    v_lshl_add_u32 v12, v2, 3, v12
    v_add_u32 v12, s22, v12
    v_lshlrev_b32 v13, 4, v2
    v_add_u32 v13, s24, v13
    v_mov_b32 v6, v12
    v_mov_b32 v5, v13
    s_cmp_lg_u32 s12, 0
    s_cbranch_scc1 L_dn_41_ok
    v_and_b32 v244, 63, v0
    v_lshlrev_b32 v244, 4, v244
    v_min_u32 v244, 1008, v244
    s_mov_b32 s30, 44793856
L_dn_41:
    buffer_load_dwordx4 v[240:243], v244, s[8:11], s30 offen sc1
    s_sub_u32 s26, s26, 1
    s_cbranch_scc1 L_fail
    s_waitcnt vmcnt(0)
    v_xor_b32 v240, s17, v240
    v_xor_b32 v241, s17, v241
    v_xor_b32 v242, s17, v242
    v_xor_b32 v243, s17, v243
    v_or3_b32 v240, v240, v241, v242
    v_or_b32 v240, v240, v243
    v_cmp_ne_u32 vcc, 0, v240
    s_cbranch_vccz L_dn_41_ok
    s_sleep 4
    s_branch L_dn_41
L_dn_41_ok:
    s_barrier
    s_mov_b32 m0, s24
    s_mov_b32 s23, 44859392
    buffer_load_dwordx4 v4, s[8:11], s23 offen offset:0 lds
    buffer_load_dwordx4 v4, s[8:11], s23 offen offset:1024 lds
    buffer_load_dwordx4 v4, s[8:11], s23 offen offset:2048 lds
    buffer_load_dwordx4 v4, s[8:11], s23 offen offset:3072 lds
    s_waitcnt vmcnt(4)
    ds_read2_b64 v[8:11], v6 offset0:0 offset1:4
    ds_read2_b64 v[12:15], v6 offset0:8 offset1:12
    ds_read2_b64 v[16:19], v6 offset0:16 offset1:20
    ds_read2_b64 v[20:23], v6 offset0:24 offset1:28
    ds_read2_b64 v[24:27], v6 offset0:32 offset1:36
    ds_read2_b64 v[28:31], v6 offset0:40 offset1:44
    ds_read2_b64 v[32:35], v6 offset0:48 offset1:52
    ds_read2_b64 v[36:39], v6 offset0:56 offset1:60
    ds_read2_b64 v[40:43], v6 offset0:64 offset1:68
    ds_read2_b64 v[44:47], v6 offset0:72 offset1:76
    ds_read2_b64 v[48:51], v6 offset0:80 offset1:84
    ds_read2_b64 v[52:55], v6 offset0:88 offset1:92
    ds_read2_b64 v[56:59], v6 offset0:96 offset1:100
    ds_read2_b64 v[60:63], v6 offset0:104 offset1:108
    s_waitcnt lgkmcnt(0)
    v_lshlrev_b32 v64, 16, v8
    v_and_b32 v65, 0xffff0000, v8
    v_lshlrev_b32 v66, 16, v9
    v_and_b32 v67, 0xffff0000, v9
    v_lshlrev_b32 v68, 16, v10
    v_and_b32 v69, 0xffff0000, v10
    v_lshlrev_b32 v70, 16, v11
    v_and_b32 v71, 0xffff0000, v11
    v_lshlrev_b32 v72, 16, v12
    v_and_b32 v73, 0xffff0000, v12
    v_lshlrev_b32 v74, 16, v13
    v_and_b32 v75, 0xffff0000, v13
    v_lshlrev_b32 v76, 16, v14
    v_and_b32 v77, 0xffff0000, v14
    v_lshlrev_b32 v78, 16, v15
    v_and_b32 v79, 0xffff0000, v15
    v_lshlrev_b32 v80, 16, v16
    v_and_b32 v81, 0xffff0000, v16
    v_lshlrev_b32 v82, 16, v17
    v_and_b32 v83, 0xffff0000, v17
    v_lshlrev_b32 v84, 16, v18
    v_and_b32 v85, 0xffff0000, v18
    v_lshlrev_b32 v86, 16, v19
    v_and_b32 v87, 0xffff0000, v19
    v_lshlrev_b32 v88, 16, v20
    v_and_b32 v89, 0xffff0000, v20
    v_lshlrev_b32 v90, 16, v21
    v_and_b32 v91, 0xffff0000, v21
    v_lshlrev_b32 v92, 16, v22
    v_and_b32 v93, 0xffff0000, v22
    v_lshlrev_b32 v94, 16, v23
    v_and_b32 v95, 0xffff0000, v23
    v_lshlrev_b32 v96, 16, v24
    v_and_b32 v97, 0xffff0000, v24
    v_lshlrev_b32 v98, 16, v25
    v_and_b32 v99, 0xffff0000, v25
    v_lshlrev_b32 v100, 16, v26
    v_and_b32 v101, 0xffff0000, v26
    v_lshlrev_b32 v102, 16, v27
    v_and_b32 v103, 0xffff0000, v27
    v_lshlrev_b32 v104, 16, v28
    v_and_b32 v105, 0xffff0000, v28
    v_lshlrev_b32 v106, 16, v29
    v_and_b32 v107, 0xffff0000, v29
    v_lshlrev_b32 v108, 16, v30
    v_and_b32 v109, 0xffff0000, v30
    v_lshlrev_b32 v110, 16, v31
    v_and_b32 v111, 0xffff0000, v31
    v_lshlrev_b32 v112, 16, v32
    v_and_b32 v113, 0xffff0000, v32
    v_lshlrev_b32 v114, 16, v33
    v_and_b32 v115, 0xffff0000, v33
    v_lshlrev_b32 v116, 16, v34
    v_and_b32 v117, 0xffff0000, v34
    v_lshlrev_b32 v118, 16, v35
    v_and_b32 v119, 0xffff0000, v35
    v_lshlrev_b32 v120, 16, v36
    v_and_b32 v121, 0xffff0000, v36
    v_lshlrev_b32 v122, 16, v37
    v_and_b32 v123, 0xffff0000, v37
    v_lshlrev_b32 v124, 16, v38
    v_and_b32 v125, 0xffff0000, v38
    v_lshlrev_b32 v126, 16, v39
    v_and_b32 v127, 0xffff0000, v39
    v_lshlrev_b32 v128, 16, v40
    v_and_b32 v129, 0xffff0000, v40
    v_lshlrev_b32 v130, 16, v41
    v_and_b32 v131, 0xffff0000, v41
    v_lshlrev_b32 v132, 16, v42
    v_and_b32 v133, 0xffff0000, v42
    v_lshlrev_b32 v134, 16, v43
    v_and_b32 v135, 0xffff0000, v43
    v_lshlrev_b32 v136, 16, v44
    v_and_b32 v137, 0xffff0000, v44
    v_lshlrev_b32 v138, 16, v45
    v_and_b32 v139, 0xffff0000, v45
    v_lshlrev_b32 v140, 16, v46
    v_and_b32 v141, 0xffff0000, v46
    v_lshlrev_b32 v142, 16, v47
    v_and_b32 v143, 0xffff0000, v47
    v_lshlrev_b32 v144, 16, v48
    v_and_b32 v145, 0xffff0000, v48
    v_lshlrev_b32 v146, 16, v49
    v_and_b32 v147, 0xffff0000, v49
    v_lshlrev_b32 v148, 16, v50
    v_and_b32 v149, 0xffff0000, v50
    v_lshlrev_b32 v150, 16, v51
    v_and_b32 v151, 0xffff0000, v51
    v_lshlrev_b32 v152, 16, v52
    v_and_b32 v153, 0xffff0000, v52
    v_lshlrev_b32 v154, 16, v53
    v_and_b32 v155, 0xffff0000, v53
    v_lshlrev_b32 v156, 16, v54
    v_and_b32 v157, 0xffff0000, v54
    v_lshlrev_b32 v158, 16, v55
    v_and_b32 v159, 0xffff0000, v55
    v_lshlrev_b32 v160, 16, v56
    v_and_b32 v161, 0xffff0000, v56
    v_lshlrev_b32 v162, 16, v57
    v_and_b32 v163, 0xffff0000, v57
    v_lshlrev_b32 v164, 16, v58
    v_and_b32 v165, 0xffff0000, v58
    v_lshlrev_b32 v166, 16, v59
    v_and_b32 v167, 0xffff0000, v59
    v_lshlrev_b32 v168, 16, v60
    v_and_b32 v169, 0xffff0000, v60
    v_lshlrev_b32 v170, 16, v61
    v_and_b32 v171, 0xffff0000, v61
    v_lshlrev_b32 v172, 16, v62
    v_and_b32 v173, 0xffff0000, v62
    v_lshlrev_b32 v174, 16, v63
    v_and_b32 v175, 0xffff0000, v63
    v_pk_add_f32 v[6:7], v[64:65], v[66:67]
    v_pk_add_f32 v[6:7], v[6:7], v[68:69]
    v_pk_add_f32 v[6:7], v[6:7], v[70:71]
    v_pk_add_f32 v[6:7], v[6:7], v[72:73]
    v_pk_add_f32 v[6:7], v[6:7], v[74:75]
    v_pk_add_f32 v[6:7], v[6:7], v[76:77]
    v_pk_add_f32 v[6:7], v[6:7], v[78:79]
    v_pk_add_f32 v[6:7], v[6:7], v[80:81]
    v_pk_add_f32 v[6:7], v[6:7], v[82:83]
    v_pk_add_f32 v[6:7], v[6:7], v[84:85]
    v_pk_add_f32 v[6:7], v[6:7], v[86:87]
    v_pk_add_f32 v[6:7], v[6:7], v[88:89]
    v_pk_add_f32 v[6:7], v[6:7], v[90:91]
    v_pk_add_f32 v[6:7], v[6:7], v[92:93]
    v_pk_add_f32 v[6:7], v[6:7], v[94:95]
    v_pk_add_f32 v[6:7], v[6:7], v[96:97]
    v_pk_add_f32 v[6:7], v[6:7], v[98:99]
    v_pk_add_f32 v[6:7], v[6:7], v[100:101]
    v_pk_add_f32 v[6:7], v[6:7], v[102:103]
    v_pk_add_f32 v[6:7], v[6:7], v[104:105]
    v_pk_add_f32 v[6:7], v[6:7], v[106:107]
    v_pk_add_f32 v[6:7], v[6:7], v[108:109]
    v_pk_add_f32 v[6:7], v[6:7], v[110:111]
    v_pk_add_f32 v[6:7], v[6:7], v[112:113]
    v_pk_add_f32 v[6:7], v[6:7], v[114:115]
    v_pk_add_f32 v[6:7], v[6:7], v[116:117]
    v_pk_add_f32 v[6:7], v[6:7], v[118:119]
    v_pk_add_f32 v[6:7], v[6:7], v[120:121]
    v_pk_add_f32 v[6:7], v[6:7], v[122:123]
    v_pk_add_f32 v[6:7], v[6:7], v[124:125]
    v_pk_add_f32 v[6:7], v[6:7], v[126:127]
    v_pk_add_f32 v[6:7], v[6:7], v[128:129]
    v_pk_add_f32 v[6:7], v[6:7], v[130:131]
    v_pk_add_f32 v[6:7], v[6:7], v[132:133]
    v_pk_add_f32 v[6:7], v[6:7], v[134:135]
    v_pk_add_f32 v[6:7], v[6:7], v[136:137]
    v_pk_add_f32 v[6:7], v[6:7], v[138:139]
    v_pk_add_f32 v[6:7], v[6:7], v[140:141]
    v_pk_add_f32 v[6:7], v[6:7], v[142:143]
    v_pk_add_f32 v[6:7], v[6:7], v[144:145]
    v_pk_add_f32 v[6:7], v[6:7], v[146:147]
    v_pk_add_f32 v[6:7], v[6:7], v[148:149]
    v_pk_add_f32 v[6:7], v[6:7], v[150:151]
    v_pk_add_f32 v[6:7], v[6:7], v[152:153]
    v_pk_add_f32 v[6:7], v[6:7], v[154:155]
    v_pk_add_f32 v[6:7], v[6:7], v[156:157]
    v_pk_add_f32 v[6:7], v[6:7], v[158:159]
    v_pk_add_f32 v[6:7], v[6:7], v[160:161]
    v_pk_add_f32 v[6:7], v[6:7], v[162:163]
    v_pk_add_f32 v[6:7], v[6:7], v[164:165]
    v_pk_add_f32 v[6:7], v[6:7], v[166:167]
    v_pk_add_f32 v[6:7], v[6:7], v[168:169]
    v_pk_add_f32 v[6:7], v[6:7], v[170:171]
    v_pk_add_f32 v[6:7], v[6:7], v[172:173]
    v_pk_add_f32 v[6:7], v[6:7], v[174:175]
    v_add_f32 v6, v6, v7
    v_mov_b32 v7, v6
    s_nop 1
    v_permlane16_swap_b32 v6, v7
    v_add_f32 v6, v6, v7
    v_mov_b32 v7, v6
    s_nop 1
    v_permlane32_swap_b32 v6, v7
    v_add_f32 v6, v6, v7
    v_mul_f32 v6, 3138537765, v6
    v_pk_add_f32 v[64:65], v[64:65], v[6:7] op_sel_hi:[1,0]
    v_pk_add_f32 v[66:67], v[66:67], v[6:7] op_sel_hi:[1,0]
    v_pk_add_f32 v[68:69], v[68:69], v[6:7] op_sel_hi:[1,0]
    v_pk_add_f32 v[70:71], v[70:71], v[6:7] op_sel_hi:[1,0]
    v_pk_add_f32 v[72:73], v[72:73], v[6:7] op_sel_hi:[1,0]
    v_pk_add_f32 v[74:75], v[74:75], v[6:7] op_sel_hi:[1,0]
    v_pk_add_f32 v[76:77], v[76:77], v[6:7] op_sel_hi:[1,0]
    v_pk_add_f32 v[78:79], v[78:79], v[6:7] op_sel_hi:[1,0]
    v_pk_add_f32 v[80:81], v[80:81], v[6:7] op_sel_hi:[1,0]
    v_pk_add_f32 v[82:83], v[82:83], v[6:7] op_sel_hi:[1,0]
    v_pk_add_f32 v[84:85], v[84:85], v[6:7] op_sel_hi:[1,0]
    v_pk_add_f32 v[86:87], v[86:87], v[6:7] op_sel_hi:[1,0]
    v_pk_add_f32 v[88:89], v[88:89], v[6:7] op_sel_hi:[1,0]
    v_pk_add_f32 v[90:91], v[90:91], v[6:7] op_sel_hi:[1,0]
    v_pk_add_f32 v[92:93], v[92:93], v[6:7] op_sel_hi:[1,0]
    v_pk_add_f32 v[94:95], v[94:95], v[6:7] op_sel_hi:[1,0]
    v_pk_add_f32 v[96:97], v[96:97], v[6:7] op_sel_hi:[1,0]
    v_pk_add_f32 v[98:99], v[98:99], v[6:7] op_sel_hi:[1,0]
    v_pk_add_f32 v[100:101], v[100:101], v[6:7] op_sel_hi:[1,0]
    v_pk_add_f32 v[102:103], v[102:103], v[6:7] op_sel_hi:[1,0]
    v_pk_add_f32 v[104:105], v[104:105], v[6:7] op_sel_hi:[1,0]
    v_pk_add_f32 v[106:107], v[106:107], v[6:7] op_sel_hi:[1,0]
    v_pk_add_f32 v[108:109], v[108:109], v[6:7] op_sel_hi:[1,0]
    v_pk_add_f32 v[110:111], v[110:111], v[6:7] op_sel_hi:[1,0]
    v_pk_add_f32 v[112:113], v[112:113], v[6:7] op_sel_hi:[1,0]
    v_pk_add_f32 v[114:115], v[114:115], v[6:7] op_sel_hi:[1,0]
    v_pk_add_f32 v[116:117], v[116:117], v[6:7] op_sel_hi:[1,0]
    v_pk_add_f32 v[118:119], v[118:119], v[6:7] op_sel_hi:[1,0]
    v_pk_add_f32 v[120:121], v[120:121], v[6:7] op_sel_hi:[1,0]
    v_pk_add_f32 v[122:123], v[122:123], v[6:7] op_sel_hi:[1,0]
    v_pk_add_f32 v[124:125], v[124:125], v[6:7] op_sel_hi:[1,0]
    v_pk_add_f32 v[126:127], v[126:127], v[6:7] op_sel_hi:[1,0]
    v_pk_add_f32 v[128:129], v[128:129], v[6:7] op_sel_hi:[1,0]
    v_pk_add_f32 v[130:131], v[130:131], v[6:7] op_sel_hi:[1,0]
    v_pk_add_f32 v[132:133], v[132:133], v[6:7] op_sel_hi:[1,0]
    v_pk_add_f32 v[134:135], v[134:135], v[6:7] op_sel_hi:[1,0]
    v_pk_add_f32 v[136:137], v[136:137], v[6:7] op_sel_hi:[1,0]
    v_pk_add_f32 v[138:139], v[138:139], v[6:7] op_sel_hi:[1,0]
    v_pk_add_f32 v[140:141], v[140:141], v[6:7] op_sel_hi:[1,0]
    v_pk_add_f32 v[142:143], v[142:143], v[6:7] op_sel_hi:[1,0]
    v_pk_add_f32 v[144:145], v[144:145], v[6:7] op_sel_hi:[1,0]
    v_pk_add_f32 v[146:147], v[146:147], v[6:7] op_sel_hi:[1,0]
    v_pk_add_f32 v[148:149], v[148:149], v[6:7] op_sel_hi:[1,0]
    v_pk_add_f32 v[150:151], v[150:151], v[6:7] op_sel_hi:[1,0]
    v_pk_add_f32 v[152:153], v[152:153], v[6:7] op_sel_hi:[1,0]
    v_pk_add_f32 v[154:155], v[154:155], v[6:7] op_sel_hi:[1,0]
    v_pk_add_f32 v[156:157], v[156:157], v[6:7] op_sel_hi:[1,0]
    v_pk_add_f32 v[158:159], v[158:159], v[6:7] op_sel_hi:[1,0]
    v_pk_add_f32 v[160:161], v[160:161], v[6:7] op_sel_hi:[1,0]
    v_pk_add_f32 v[162:163], v[162:163], v[6:7] op_sel_hi:[1,0]
    v_pk_add_f32 v[164:165], v[164:165], v[6:7] op_sel_hi:[1,0]
    v_pk_add_f32 v[166:167], v[166:167], v[6:7] op_sel_hi:[1,0]
    v_pk_add_f32 v[168:169], v[168:169], v[6:7] op_sel_hi:[1,0]
    v_pk_add_f32 v[170:171], v[170:171], v[6:7] op_sel_hi:[1,0]
    v_pk_add_f32 v[172:173], v[172:173], v[6:7] op_sel_hi:[1,0]
    v_pk_add_f32 v[174:175], v[174:175], v[6:7] op_sel_hi:[1,0]
    v_pk_mul_f32 v[6:7], v[64:65], v[64:65]
    v_pk_fma_f32 v[6:7], v[66:67], v[66:67], v[6:7]
    v_pk_fma_f32 v[6:7], v[68:69], v[68:69], v[6:7]
    v_pk_fma_f32 v[6:7], v[70:71], v[70:71], v[6:7]
    v_pk_fma_f32 v[6:7], v[72:73], v[72:73], v[6:7]
    v_pk_fma_f32 v[6:7], v[74:75], v[74:75], v[6:7]
    v_pk_fma_f32 v[6:7], v[76:77], v[76:77], v[6:7]
    v_pk_fma_f32 v[6:7], v[78:79], v[78:79], v[6:7]
    v_pk_fma_f32 v[6:7], v[80:81], v[80:81], v[6:7]
    v_pk_fma_f32 v[6:7], v[82:83], v[82:83], v[6:7]
    v_pk_fma_f32 v[6:7], v[84:85], v[84:85], v[6:7]
    v_pk_fma_f32 v[6:7], v[86:87], v[86:87], v[6:7]
    v_pk_fma_f32 v[6:7], v[88:89], v[88:89], v[6:7]
    v_pk_fma_f32 v[6:7], v[90:91], v[90:91], v[6:7]
    v_pk_fma_f32 v[6:7], v[92:93], v[92:93], v[6:7]
    v_pk_fma_f32 v[6:7], v[94:95], v[94:95], v[6:7]
    v_pk_fma_f32 v[6:7], v[96:97], v[96:97], v[6:7]
    v_pk_fma_f32 v[6:7], v[98:99], v[98:99], v[6:7]
    v_pk_fma_f32 v[6:7], v[100:101], v[100:101], v[6:7]
    v_pk_fma_f32 v[6:7], v[102:103], v[102:103], v[6:7]
    v_pk_fma_f32 v[6:7], v[104:105], v[104:105], v[6:7]
    v_pk_fma_f32 v[6:7], v[106:107], v[106:107], v[6:7]
    v_pk_fma_f32 v[6:7], v[108:109], v[108:109], v[6:7]
    v_pk_fma_f32 v[6:7], v[110:111], v[110:111], v[6:7]
    v_pk_fma_f32 v[6:7], v[112:113], v[112:113], v[6:7]
    v_pk_fma_f32 v[6:7], v[114:115], v[114:115], v[6:7]
    v_pk_fma_f32 v[6:7], v[116:117], v[116:117], v[6:7]
    v_pk_fma_f32 v[6:7], v[118:119], v[118:119], v[6:7]
    v_pk_fma_f32 v[6:7], v[120:121], v[120:121], v[6:7]
    v_pk_fma_f32 v[6:7], v[122:123], v[122:123], v[6:7]
    v_pk_fma_f32 v[6:7], v[124:125], v[124:125], v[6:7]
    v_pk_fma_f32 v[6:7], v[126:127], v[126:127], v[6:7]
    v_pk_fma_f32 v[6:7], v[128:129], v[128:129], v[6:7]
    v_pk_fma_f32 v[6:7], v[130:131], v[130:131], v[6:7]
    v_pk_fma_f32 v[6:7], v[132:133], v[132:133], v[6:7]
    v_pk_fma_f32 v[6:7], v[134:135], v[134:135], v[6:7]
    v_pk_fma_f32 v[6:7], v[136:137], v[136:137], v[6:7]
    v_pk_fma_f32 v[6:7], v[138:139], v[138:139], v[6:7]
    v_pk_fma_f32 v[6:7], v[140:141], v[140:141], v[6:7]
    v_pk_fma_f32 v[6:7], v[142:143], v[142:143], v[6:7]
    v_pk_fma_f32 v[6:7], v[144:145], v[144:145], v[6:7]
    v_pk_fma_f32 v[6:7], v[146:147], v[146:147], v[6:7]
    v_pk_fma_f32 v[6:7], v[148:149], v[148:149], v[6:7]
    v_pk_fma_f32 v[6:7], v[150:151], v[150:151], v[6:7]
    v_pk_fma_f32 v[6:7], v[152:153], v[152:153], v[6:7]
    v_pk_fma_f32 v[6:7], v[154:155], v[154:155], v[6:7]
    v_pk_fma_f32 v[6:7], v[156:157], v[156:157], v[6:7]
    v_pk_fma_f32 v[6:7], v[158:159], v[158:159], v[6:7]
    v_pk_fma_f32 v[6:7], v[160:161], v[160:161], v[6:7]
    v_pk_fma_f32 v[6:7], v[162:163], v[162:163], v[6:7]
    v_pk_fma_f32 v[6:7], v[164:165], v[164:165], v[6:7]
    v_pk_fma_f32 v[6:7], v[166:167], v[166:167], v[6:7]
    v_pk_fma_f32 v[6:7], v[168:169], v[168:169], v[6:7]
    v_pk_fma_f32 v[6:7], v[170:171], v[170:171], v[6:7]
    v_pk_fma_f32 v[6:7], v[172:173], v[172:173], v[6:7]
    v_pk_fma_f32 v[6:7], v[174:175], v[174:175], v[6:7]
    v_add_f32 v6, v6, v7
    v_mov_b32 v7, v6
    s_nop 1
    v_permlane16_swap_b32 v6, v7
    v_add_f32 v6, v6, v7
    v_mov_b32 v7, v6
    s_nop 1
    v_permlane32_swap_b32 v6, v7
    v_add_f32 v6, v6, v7
    v_mov_b32 v7, 925353388
    v_fmac_f32 v7, 991054117, v6
    v_rsq_f32 v6, v7
    s_mul_i32 s21, s20, 14336
    s_add_u32 s21, s21, 12845056
    s_waitcnt vmcnt(0)
    ds_read_b128 v[8:11], v5 offset:1792
    ds_read_b128 v[16:19], v5 offset:0
    ds_read_b128 v[12:15], v5 offset:1856
    ds_read_b128 v[20:23], v5 offset:64
    ds_read_b128 v[24:27], v5 offset:1920
    ds_read_b128 v[32:35], v5 offset:128
    ds_read_b128 v[28:31], v5 offset:1984
    ds_read_b128 v[36:39], v5 offset:192
    ds_read_b128 v[40:43], v5 offset:2048
    ds_read_b128 v[48:51], v5 offset:256
    ds_read_b128 v[44:47], v5 offset:2112
    ds_read_b128 v[52:55], v5 offset:320
    s_waitcnt lgkmcnt(8)
    v_pk_mul_f32 v[64:65], v[64:65], v[6:7] op_sel_hi:[1,0]
    v_pk_fma_f32 v[8:9], v[8:9], v[64:65], v[64:65]
    v_pk_add_f32 v[64:65], v[8:9], v[16:17]
    v_pk_mul_f32 v[66:67], v[66:67], v[6:7] op_sel_hi:[1,0]
    v_pk_fma_f32 v[10:11], v[10:11], v[66:67], v[66:67]
    v_pk_add_f32 v[66:67], v[10:11], v[18:19]
    v_pk_mul_f32 v[68:69], v[68:69], v[6:7] op_sel_hi:[1,0]
    v_pk_fma_f32 v[12:13], v[12:13], v[68:69], v[68:69]
    v_pk_add_f32 v[68:69], v[12:13], v[20:21]
    v_pk_mul_f32 v[70:71], v[70:71], v[6:7] op_sel_hi:[1,0]
    v_pk_fma_f32 v[14:15], v[14:15], v[70:71], v[70:71]
    v_pk_add_f32 v[70:71], v[14:15], v[22:23]
    v_cvt_pk_bf16_f32 v64, v64, v65
    v_cvt_pk_bf16_f32 v65, v66, v67
    v_cvt_pk_bf16_f32 v66, v68, v69
    v_cvt_pk_bf16_f32 v67, v70, v71
    buffer_store_dwordx4 v[64:67], v4, s[8:11], s21 offen offset:0 sc1
    ds_read_b128 v[8:11], v5 offset:2176
    ds_read_b128 v[16:19], v5 offset:384
    ds_read_b128 v[12:15], v5 offset:2240
    ds_read_b128 v[20:23], v5 offset:448
    s_waitcnt lgkmcnt(8)
    v_pk_mul_f32 v[72:73], v[72:73], v[6:7] op_sel_hi:[1,0]
    v_pk_fma_f32 v[24:25], v[24:25], v[72:73], v[72:73]
    v_pk_add_f32 v[72:73], v[24:25], v[32:33]
    v_pk_mul_f32 v[74:75], v[74:75], v[6:7] op_sel_hi:[1,0]
    v_pk_fma_f32 v[26:27], v[26:27], v[74:75], v[74:75]
    v_pk_add_f32 v[74:75], v[26:27], v[34:35]
    v_pk_mul_f32 v[76:77], v[76:77], v[6:7] op_sel_hi:[1,0]
    v_pk_fma_f32 v[28:29], v[28:29], v[76:77], v[76:77]
    v_pk_add_f32 v[76:77], v[28:29], v[36:37]
    v_pk_mul_f32 v[78:79], v[78:79], v[6:7] op_sel_hi:[1,0]
    v_pk_fma_f32 v[30:31], v[30:31], v[78:79], v[78:79]
    v_pk_add_f32 v[78:79], v[30:31], v[38:39]
    v_cvt_pk_bf16_f32 v72, v72, v73
    v_cvt_pk_bf16_f32 v73, v74, v75
    v_cvt_pk_bf16_f32 v74, v76, v77
    v_cvt_pk_bf16_f32 v75, v78, v79
    buffer_store_dwordx4 v[72:75], v4, s[8:11], s21 offen offset:1024 sc1
    ds_read_b128 v[24:27], v5 offset:2304
    ds_read_b128 v[32:35], v5 offset:512
    ds_read_b128 v[28:31], v5 offset:2368
    ds_read_b128 v[36:39], v5 offset:576
    s_waitcnt lgkmcnt(8)
    v_pk_mul_f32 v[80:81], v[80:81], v[6:7] op_sel_hi:[1,0]
    v_pk_fma_f32 v[40:41], v[40:41], v[80:81], v[80:81]
    v_pk_add_f32 v[80:81], v[40:41], v[48:49]
    v_pk_mul_f32 v[82:83], v[82:83], v[6:7] op_sel_hi:[1,0]
    v_pk_fma_f32 v[42:43], v[42:43], v[82:83], v[82:83]
    v_pk_add_f32 v[82:83], v[42:43], v[50:51]
    v_pk_mul_f32 v[84:85], v[84:85], v[6:7] op_sel_hi:[1,0]
    v_pk_fma_f32 v[44:45], v[44:45], v[84:85], v[84:85]
    v_pk_add_f32 v[84:85], v[44:45], v[52:53]
    v_pk_mul_f32 v[86:87], v[86:87], v[6:7] op_sel_hi:[1,0]
    v_pk_fma_f32 v[46:47], v[46:47], v[86:87], v[86:87]
    v_pk_add_f32 v[86:87], v[46:47], v[54:55]
    v_cvt_pk_bf16_f32 v80, v80, v81
    v_cvt_pk_bf16_f32 v81, v82, v83
    v_cvt_pk_bf16_f32 v82, v84, v85
    v_cvt_pk_bf16_f32 v83, v86, v87
    buffer_store_dwordx4 v[80:83], v4, s[8:11], s21 offen offset:2048 sc1
    ds_read_b128 v[40:43], v5 offset:2432
    ds_read_b128 v[48:51], v5 offset:640
    ds_read_b128 v[44:47], v5 offset:2496
    ds_read_b128 v[52:55], v5 offset:704
    s_waitcnt lgkmcnt(8)
    v_pk_mul_f32 v[88:89], v[88:89], v[6:7] op_sel_hi:[1,0]
    v_pk_fma_f32 v[8:9], v[8:9], v[88:89], v[88:89]
    v_pk_add_f32 v[88:89], v[8:9], v[16:17]
    v_pk_mul_f32 v[90:91], v[90:91], v[6:7] op_sel_hi:[1,0]
    v_pk_fma_f32 v[10:11], v[10:11], v[90:91], v[90:91]
    v_pk_add_f32 v[90:91], v[10:11], v[18:19]
    v_pk_mul_f32 v[92:93], v[92:93], v[6:7] op_sel_hi:[1,0]
    v_pk_fma_f32 v[12:13], v[12:13], v[92:93], v[92:93]
    v_pk_add_f32 v[92:93], v[12:13], v[20:21]
    v_pk_mul_f32 v[94:95], v[94:95], v[6:7] op_sel_hi:[1,0]
    v_pk_fma_f32 v[14:15], v[14:15], v[94:95], v[94:95]
    v_pk_add_f32 v[94:95], v[14:15], v[22:23]
    v_cvt_pk_bf16_f32 v88, v88, v89
    v_cvt_pk_bf16_f32 v89, v90, v91
    v_cvt_pk_bf16_f32 v90, v92, v93
    v_cvt_pk_bf16_f32 v91, v94, v95
    buffer_store_dwordx4 v[88:91], v4, s[8:11], s21 offen offset:3072 sc1
    s_add_u32 s21, s21, 4096
    ds_read_b128 v[8:11], v5 offset:2560
    ds_read_b128 v[16:19], v5 offset:768
    ds_read_b128 v[12:15], v5 offset:2624
    ds_read_b128 v[20:23], v5 offset:832
    s_waitcnt lgkmcnt(8)
    v_pk_mul_f32 v[96:97], v[96:97], v[6:7] op_sel_hi:[1,0]
    v_pk_fma_f32 v[24:25], v[24:25], v[96:97], v[96:97]
    v_pk_add_f32 v[96:97], v[24:25], v[32:33]
    v_pk_mul_f32 v[98:99], v[98:99], v[6:7] op_sel_hi:[1,0]
    v_pk_fma_f32 v[26:27], v[26:27], v[98:99], v[98:99]
    v_pk_add_f32 v[98:99], v[26:27], v[34:35]
    v_pk_mul_f32 v[100:101], v[100:101], v[6:7] op_sel_hi:[1,0]
    v_pk_fma_f32 v[28:29], v[28:29], v[100:101], v[100:101]
    v_pk_add_f32 v[100:101], v[28:29], v[36:37]
    v_pk_mul_f32 v[102:103], v[102:103], v[6:7] op_sel_hi:[1,0]
    v_pk_fma_f32 v[30:31], v[30:31], v[102:103], v[102:103]
    v_pk_add_f32 v[102:103], v[30:31], v[38:39]
    v_cvt_pk_bf16_f32 v96, v96, v97
    v_cvt_pk_bf16_f32 v97, v98, v99
    v_cvt_pk_bf16_f32 v98, v100, v101
    v_cvt_pk_bf16_f32 v99, v102, v103
    buffer_store_dwordx4 v[96:99], v4, s[8:11], s21 offen offset:0 sc1
    ds_read_b128 v[24:27], v5 offset:2688
    ds_read_b128 v[32:35], v5 offset:896
    ds_read_b128 v[28:31], v5 offset:2752
    ds_read_b128 v[36:39], v5 offset:960
    s_waitcnt lgkmcnt(8)
    v_pk_mul_f32 v[104:105], v[104:105], v[6:7] op_sel_hi:[1,0]
    v_pk_fma_f32 v[40:41], v[40:41], v[104:105], v[104:105]
    v_pk_add_f32 v[104:105], v[40:41], v[48:49]
    v_pk_mul_f32 v[106:107], v[106:107], v[6:7] op_sel_hi:[1,0]
    v_pk_fma_f32 v[42:43], v[42:43], v[106:107], v[106:107]
    v_pk_add_f32 v[106:107], v[42:43], v[50:51]
    v_pk_mul_f32 v[108:109], v[108:109], v[6:7] op_sel_hi:[1,0]
    v_pk_fma_f32 v[44:45], v[44:45], v[108:109], v[108:109]
    v_pk_add_f32 v[108:109], v[44:45], v[52:53]
    v_pk_mul_f32 v[110:111], v[110:111], v[6:7] op_sel_hi:[1,0]
    v_pk_fma_f32 v[46:47], v[46:47], v[110:111], v[110:111]
    v_pk_add_f32 v[110:111], v[46:47], v[54:55]
    v_cvt_pk_bf16_f32 v104, v104, v105
    v_cvt_pk_bf16_f32 v105, v106, v107
    v_cvt_pk_bf16_f32 v106, v108, v109
    v_cvt_pk_bf16_f32 v107, v110, v111
    buffer_store_dwordx4 v[104:107], v4, s[8:11], s21 offen offset:1024 sc1
    ds_read_b128 v[40:43], v5 offset:2816
    ds_read_b128 v[48:51], v5 offset:1024
    ds_read_b128 v[44:47], v5 offset:2880
    ds_read_b128 v[52:55], v5 offset:1088
    s_waitcnt lgkmcnt(8)
    v_pk_mul_f32 v[112:113], v[112:113], v[6:7] op_sel_hi:[1,0]
    v_pk_fma_f32 v[8:9], v[8:9], v[112:113], v[112:113]
    v_pk_add_f32 v[112:113], v[8:9], v[16:17]
    v_pk_mul_f32 v[114:115], v[114:115], v[6:7] op_sel_hi:[1,0]
    v_pk_fma_f32 v[10:11], v[10:11], v[114:115], v[114:115]
    v_pk_add_f32 v[114:115], v[10:11], v[18:19]
    v_pk_mul_f32 v[116:117], v[116:117], v[6:7] op_sel_hi:[1,0]
    v_pk_fma_f32 v[12:13], v[12:13], v[116:117], v[116:117]
    v_pk_add_f32 v[116:117], v[12:13], v[20:21]
    v_pk_mul_f32 v[118:119], v[118:119], v[6:7] op_sel_hi:[1,0]
    v_pk_fma_f32 v[14:15], v[14:15], v[118:119], v[118:119]
    v_pk_add_f32 v[118:119], v[14:15], v[22:23]
    v_cvt_pk_bf16_f32 v112, v112, v113
    v_cvt_pk_bf16_f32 v113, v114, v115
    v_cvt_pk_bf16_f32 v114, v116, v117
    v_cvt_pk_bf16_f32 v115, v118, v119
    buffer_store_dwordx4 v[112:115], v4, s[8:11], s21 offen offset:2048 sc1
    ds_read_b128 v[8:11], v5 offset:2944
    ds_read_b128 v[16:19], v5 offset:1152
    ds_read_b128 v[12:15], v5 offset:3008
    ds_read_b128 v[20:23], v5 offset:1216
    s_waitcnt lgkmcnt(8)
    v_pk_mul_f32 v[120:121], v[120:121], v[6:7] op_sel_hi:[1,0]
    v_pk_fma_f32 v[24:25], v[24:25], v[120:121], v[120:121]
    v_pk_add_f32 v[120:121], v[24:25], v[32:33]
    v_pk_mul_f32 v[122:123], v[122:123], v[6:7] op_sel_hi:[1,0]
    v_pk_fma_f32 v[26:27], v[26:27], v[122:123], v[122:123]
    v_pk_add_f32 v[122:123], v[26:27], v[34:35]
    v_pk_mul_f32 v[124:125], v[124:125], v[6:7] op_sel_hi:[1,0]
    v_pk_fma_f32 v[28:29], v[28:29], v[124:125], v[124:125]
    v_pk_add_f32 v[124:125], v[28:29], v[36:37]
    v_pk_mul_f32 v[126:127], v[126:127], v[6:7] op_sel_hi:[1,0]
    v_pk_fma_f32 v[30:31], v[30:31], v[126:127], v[126:127]
    v_pk_add_f32 v[126:127], v[30:31], v[38:39]
    v_cvt_pk_bf16_f32 v120, v120, v121
    v_cvt_pk_bf16_f32 v121, v122, v123
    v_cvt_pk_bf16_f32 v122, v124, v125
    v_cvt_pk_bf16_f32 v123, v126, v127
    buffer_store_dwordx4 v[120:123], v4, s[8:11], s21 offen offset:3072 sc1
    s_add_u32 s21, s21, 4096
    ds_read_b128 v[24:27], v5 offset:3072
    ds_read_b128 v[32:35], v5 offset:1280
    ds_read_b128 v[28:31], v5 offset:3136
    ds_read_b128 v[36:39], v5 offset:1344
    s_waitcnt lgkmcnt(8)
    v_pk_mul_f32 v[128:129], v[128:129], v[6:7] op_sel_hi:[1,0]
    v_pk_fma_f32 v[40:41], v[40:41], v[128:129], v[128:129]
    v_pk_add_f32 v[128:129], v[40:41], v[48:49]
    v_pk_mul_f32 v[130:131], v[130:131], v[6:7] op_sel_hi:[1,0]
    v_pk_fma_f32 v[42:43], v[42:43], v[130:131], v[130:131]
    v_pk_add_f32 v[130:131], v[42:43], v[50:51]
    v_pk_mul_f32 v[132:133], v[132:133], v[6:7] op_sel_hi:[1,0]
    v_pk_fma_f32 v[44:45], v[44:45], v[132:133], v[132:133]
    v_pk_add_f32 v[132:133], v[44:45], v[52:53]
    v_pk_mul_f32 v[134:135], v[134:135], v[6:7] op_sel_hi:[1,0]
    v_pk_fma_f32 v[46:47], v[46:47], v[134:135], v[134:135]
    v_pk_add_f32 v[134:135], v[46:47], v[54:55]
    v_cvt_pk_bf16_f32 v128, v128, v129
    v_cvt_pk_bf16_f32 v129, v130, v131
    v_cvt_pk_bf16_f32 v130, v132, v133
    v_cvt_pk_bf16_f32 v131, v134, v135
    buffer_store_dwordx4 v[128:131], v4, s[8:11], s21 offen offset:0 sc1
    ds_read_b128 v[40:43], v5 offset:3200
    ds_read_b128 v[48:51], v5 offset:1408
    ds_read_b128 v[44:47], v5 offset:3264
    ds_read_b128 v[52:55], v5 offset:1472
    s_waitcnt lgkmcnt(8)
    v_pk_mul_f32 v[136:137], v[136:137], v[6:7] op_sel_hi:[1,0]
    v_pk_fma_f32 v[8:9], v[8:9], v[136:137], v[136:137]
    v_pk_add_f32 v[136:137], v[8:9], v[16:17]
    v_pk_mul_f32 v[138:139], v[138:139], v[6:7] op_sel_hi:[1,0]
    v_pk_fma_f32 v[10:11], v[10:11], v[138:139], v[138:139]
    v_pk_add_f32 v[138:139], v[10:11], v[18:19]
    v_pk_mul_f32 v[140:141], v[140:141], v[6:7] op_sel_hi:[1,0]
    v_pk_fma_f32 v[12:13], v[12:13], v[140:141], v[140:141]
    v_pk_add_f32 v[140:141], v[12:13], v[20:21]
    v_pk_mul_f32 v[142:143], v[142:143], v[6:7] op_sel_hi:[1,0]
    v_pk_fma_f32 v[14:15], v[14:15], v[142:143], v[142:143]
    v_pk_add_f32 v[142:143], v[14:15], v[22:23]
    v_cvt_pk_bf16_f32 v136, v136, v137
    v_cvt_pk_bf16_f32 v137, v138, v139
    v_cvt_pk_bf16_f32 v138, v140, v141
    v_cvt_pk_bf16_f32 v139, v142, v143
    buffer_store_dwordx4 v[136:139], v4, s[8:11], s21 offen offset:1024 sc1
    ds_read_b128 v[8:11], v5 offset:3328
    ds_read_b128 v[16:19], v5 offset:1536
    ds_read_b128 v[12:15], v5 offset:3392
    ds_read_b128 v[20:23], v5 offset:1600
    s_waitcnt lgkmcnt(8)
    v_pk_mul_f32 v[144:145], v[144:145], v[6:7] op_sel_hi:[1,0]
    v_pk_fma_f32 v[24:25], v[24:25], v[144:145], v[144:145]
    v_pk_add_f32 v[144:145], v[24:25], v[32:33]
    v_pk_mul_f32 v[146:147], v[146:147], v[6:7] op_sel_hi:[1,0]
    v_pk_fma_f32 v[26:27], v[26:27], v[146:147], v[146:147]
    v_pk_add_f32 v[146:147], v[26:27], v[34:35]
    v_pk_mul_f32 v[148:149], v[148:149], v[6:7] op_sel_hi:[1,0]
    v_pk_fma_f32 v[28:29], v[28:29], v[148:149], v[148:149]
    v_pk_add_f32 v[148:149], v[28:29], v[36:37]
    v_pk_mul_f32 v[150:151], v[150:151], v[6:7] op_sel_hi:[1,0]
    v_pk_fma_f32 v[30:31], v[30:31], v[150:151], v[150:151]
    v_pk_add_f32 v[150:151], v[30:31], v[38:39]
    v_cvt_pk_bf16_f32 v144, v144, v145
    v_cvt_pk_bf16_f32 v145, v146, v147
    v_cvt_pk_bf16_f32 v146, v148, v149
    v_cvt_pk_bf16_f32 v147, v150, v151
    buffer_store_dwordx4 v[144:147], v4, s[8:11], s21 offen offset:2048 sc1
    ds_read_b128 v[24:27], v5 offset:3456
    ds_read_b128 v[32:35], v5 offset:1664
    ds_read_b128 v[28:31], v5 offset:3520
    ds_read_b128 v[36:39], v5 offset:1728
    s_waitcnt lgkmcnt(8)
    v_pk_mul_f32 v[152:153], v[152:153], v[6:7] op_sel_hi:[1,0]
    v_pk_fma_f32 v[40:41], v[40:41], v[152:153], v[152:153]
    v_pk_add_f32 v[152:153], v[40:41], v[48:49]
    v_pk_mul_f32 v[154:155], v[154:155], v[6:7] op_sel_hi:[1,0]
    v_pk_fma_f32 v[42:43], v[42:43], v[154:155], v[154:155]
    v_pk_add_f32 v[154:155], v[42:43], v[50:51]
    v_pk_mul_f32 v[156:157], v[156:157], v[6:7] op_sel_hi:[1,0]
    v_pk_fma_f32 v[44:45], v[44:45], v[156:157], v[156:157]
    v_pk_add_f32 v[156:157], v[44:45], v[52:53]
    v_pk_mul_f32 v[158:159], v[158:159], v[6:7] op_sel_hi:[1,0]
    v_pk_fma_f32 v[46:47], v[46:47], v[158:159], v[158:159]
    v_pk_add_f32 v[158:159], v[46:47], v[54:55]
    v_cvt_pk_bf16_f32 v152, v152, v153
    v_cvt_pk_bf16_f32 v153, v154, v155
    v_cvt_pk_bf16_f32 v154, v156, v157
    v_cvt_pk_bf16_f32 v155, v158, v159
    buffer_store_dwordx4 v[152:155], v4, s[8:11], s21 offen offset:3072 sc1
    s_add_u32 s21, s21, 4096
    s_waitcnt lgkmcnt(4)
    v_pk_mul_f32 v[160:161], v[160:161], v[6:7] op_sel_hi:[1,0]
    v_pk_fma_f32 v[8:9], v[8:9], v[160:161], v[160:161]
    v_pk_add_f32 v[160:161], v[8:9], v[16:17]
    v_pk_mul_f32 v[162:163], v[162:163], v[6:7] op_sel_hi:[1,0]
    v_pk_fma_f32 v[10:11], v[10:11], v[162:163], v[162:163]
    v_pk_add_f32 v[162:163], v[10:11], v[18:19]
    v_pk_mul_f32 v[164:165], v[164:165], v[6:7] op_sel_hi:[1,0]
    v_pk_fma_f32 v[12:13], v[12:13], v[164:165], v[164:165]
    v_pk_add_f32 v[164:165], v[12:13], v[20:21]
    v_pk_mul_f32 v[166:167], v[166:167], v[6:7] op_sel_hi:[1,0]
    v_pk_fma_f32 v[14:15], v[14:15], v[166:167], v[166:167]
    v_pk_add_f32 v[166:167], v[14:15], v[22:23]
    v_cvt_pk_bf16_f32 v160, v160, v161
    v_cvt_pk_bf16_f32 v161, v162, v163
    v_cvt_pk_bf16_f32 v162, v164, v165
    v_cvt_pk_bf16_f32 v163, v166, v167
    buffer_store_dwordx4 v[160:163], v4, s[8:11], s21 offen offset:0 sc1
    s_waitcnt lgkmcnt(0)
    v_pk_mul_f32 v[168:169], v[168:169], v[6:7] op_sel_hi:[1,0]
    v_pk_fma_f32 v[24:25], v[24:25], v[168:169], v[168:169]
    v_pk_add_f32 v[168:169], v[24:25], v[32:33]
    v_pk_mul_f32 v[170:171], v[170:171], v[6:7] op_sel_hi:[1,0]
    v_pk_fma_f32 v[26:27], v[26:27], v[170:171], v[170:171]
    v_pk_add_f32 v[170:171], v[26:27], v[34:35]
    v_pk_mul_f32 v[172:173], v[172:173], v[6:7] op_sel_hi:[1,0]
    v_pk_fma_f32 v[28:29], v[28:29], v[172:173], v[172:173]
    v_pk_add_f32 v[172:173], v[28:29], v[36:37]
    v_pk_mul_f32 v[174:175], v[174:175], v[6:7] op_sel_hi:[1,0]
    v_pk_fma_f32 v[30:31], v[30:31], v[174:175], v[174:175]
    v_pk_add_f32 v[174:175], v[30:31], v[38:39]
    v_cvt_pk_bf16_f32 v168, v168, v169
    v_cvt_pk_bf16_f32 v169, v170, v171
    v_cvt_pk_bf16_f32 v170, v172, v173
    v_cvt_pk_bf16_f32 v171, v174, v175
    buffer_store_dwordx4 v[168:171], v4, s[8:11], s21 offen offset:1024 sc1
    v_mov_b32 v5, s17
    s_lshl_b32 s20, s20, 2
    s_add_u32 s20, s20, 44796416
    v_mov_b32 v4, 0
    s_waitcnt vmcnt(0)
    buffer_store_dword v5, v4, s[8:11], s20 offen sc1
    s_barrier
    s_branch L_roles
L_team7:
    s_cmp_lt_u32 s13, 28
    s_cbranch_scc1 L_V
    s_cmp_lg_u32 s15, 0
    s_cbranch_scc1 L_ver_42_ok
    v_and_b32 v40, 15, v0
    v_and_b32 v41, 7, v40
    v_lshlrev_b32 v41, 5, v41
    v_lshrrev_b32 v42, 3, v40
    v_cmp_gt_u32 vcc, 8, v40
    v_lshl_add_u32 v41, v42, 2, v41
    s_nop 0
    v_cndmask_b32 v40, 0, 32, vcc
L_ver_42:
    buffer_load_dword v42, v41, s[84:87], 0 offen sc1
    s_sub_u32 s26, s26, 1
    s_cbranch_scc1 L_fail
    s_waitcnt vmcnt(0)
    v_cmp_gt_u32 vcc, v42, v40
    s_cbranch_vccnz L_irregular
    v_cmp_ne_u32 vcc, v42, v40
    s_cbranch_vccnz L_ver_42
L_ver_42_ok:
    s_branch L_exit
L_V:
    s_lshl_b32 s30, s12, 1
    s_add_u32 s30, s30, 1
    v_and_b32 v41, 31, v0
    v_lshlrev_b32 v41, 5, v41
    s_lshl_b32 s30, s30, 2
    s_add_u32 s30, s30, 44793856
L_wf_43:
    buffer_load_dword v40, v41, s[8:11], s30 offen offset:0 sc1
    s_sub_u32 s26, s26, 1
    s_cbranch_scc1 L_fail
    s_waitcnt vmcnt(0)
    v_cmp_ne_u32 vcc, s17, v40
    s_cbranch_vccz L_wfd_44
    s_sleep 4
    s_branch L_wf_43
L_wfd_44:
    v_and_b32 v2, 63, v0
    v_lshlrev_b32 v2, 4, v2
    s_mov_b32 s26, 1048576
    s_lshr_b32 s27, s13, 1
    s_and_b32 s28, s13, 1
    s_mul_i32 s32, s27, 458752
    s_mul_i32 s33, s12, 114688
    s_add_u32 s32, s32, s33
    s_mul_i32 s33, s28, 14336
    s_add_u32 s32, s32, s33
    s_add_u32 s32, s32, 6422528
    s_mul_i32 s23, s12, 7168
    s_mov_b32 s22, s23
    s_add_u32 s33, s32, 0
    buffer_load_dwordx4 a[0:3], v2, s[8:11], s33 offen offset:0
    buffer_load_dwordx4 a[4:7], v2, s[8:11], s33 offen offset:1024
    buffer_load_dwordx4 a[8:11], v2, s[8:11], s33 offen offset:2048
    buffer_load_dwordx4 a[12:15], v2, s[8:11], s33 offen offset:3072
    s_add_u32 s33, s32, 4096
    buffer_load_dwordx4 a[16:19], v2, s[8:11], s33 offen offset:0
    buffer_load_dwordx4 a[20:23], v2, s[8:11], s33 offen offset:1024
    buffer_load_dwordx4 a[24:27], v2, s[8:11], s33 offen offset:2048
    buffer_load_dwordx4 a[28:31], v2, s[8:11], s33 offen offset:3072
    s_add_u32 s33, s32, 8192
    buffer_load_dwordx4 a[32:35], v2, s[8:11], s33 offen offset:0
    buffer_load_dwordx4 a[36:39], v2, s[8:11], s33 offen offset:1024
    buffer_load_dwordx4 a[40:43], v2, s[8:11], s33 offen offset:2048
    buffer_load_dwordx4 a[44:47], v2, s[8:11], s33 offen offset:3072
    s_add_u32 s33, s32, 12288
    buffer_load_dwordx4 a[48:51], v2, s[8:11], s33 offen offset:0
    buffer_load_dwordx4 a[52:55], v2, s[8:11], s33 offen offset:1024
    s_add_u32 s33, s32, 28672
    buffer_load_dwordx4 a[56:59], v2, s[8:11], s33 offen offset:0
    buffer_load_dwordx4 a[60:63], v2, s[8:11], s33 offen offset:1024
    buffer_load_dwordx4 a[64:67], v2, s[8:11], s33 offen offset:2048
    buffer_load_dwordx4 a[68:71], v2, s[8:11], s33 offen offset:3072
    s_add_u32 s33, s32, 32768
    buffer_load_dwordx4 a[72:75], v2, s[8:11], s33 offen offset:0
    buffer_load_dwordx4 a[76:79], v2, s[8:11], s33 offen offset:1024
    buffer_load_dwordx4 a[80:83], v2, s[8:11], s33 offen offset:2048
    buffer_load_dwordx4 a[84:87], v2, s[8:11], s33 offen offset:3072
    s_add_u32 s33, s32, 36864
    buffer_load_dwordx4 a[88:91], v2, s[8:11], s33 offen offset:0
    buffer_load_dwordx4 a[92:95], v2, s[8:11], s33 offen offset:1024
    buffer_load_dwordx4 a[96:99], v2, s[8:11], s33 offen offset:2048
    buffer_load_dwordx4 a[100:103], v2, s[8:11], s33 offen offset:3072
    s_add_u32 s33, s32, 40960
    buffer_load_dwordx4 a[104:107], v2, s[8:11], s33 offen offset:0
    buffer_load_dwordx4 a[108:111], v2, s[8:11], s33 offen offset:1024
    s_add_u32 s33, s32, 57344
    buffer_load_dwordx4 a[112:115], v2, s[8:11], s33 offen offset:0
    buffer_load_dwordx4 a[116:119], v2, s[8:11], s33 offen offset:1024
    buffer_load_dwordx4 a[120:123], v2, s[8:11], s33 offen offset:2048
    buffer_load_dwordx4 a[124:127], v2, s[8:11], s33 offen offset:3072
    s_add_u32 s33, s32, 61440
    buffer_load_dwordx4 a[128:131], v2, s[8:11], s33 offen offset:0
    buffer_load_dwordx4 a[132:135], v2, s[8:11], s33 offen offset:1024
    buffer_load_dwordx4 a[136:139], v2, s[8:11], s33 offen offset:2048
    buffer_load_dwordx4 a[140:143], v2, s[8:11], s33 offen offset:3072
    s_add_u32 s33, s32, 65536
    buffer_load_dwordx4 a[144:147], v2, s[8:11], s33 offen offset:0
    buffer_load_dwordx4 a[148:151], v2, s[8:11], s33 offen offset:1024
    buffer_load_dwordx4 a[152:155], v2, s[8:11], s33 offen offset:2048
    buffer_load_dwordx4 a[156:159], v2, s[8:11], s33 offen offset:3072
    v_and_b32 v16, 15, v0
    v_and_b32 v17, 7, v16
    v_lshlrev_b32 v17, 5, v17
    v_lshrrev_b32 v18, 3, v16
    v_cmp_gt_u32 vcc, 8, v16
    v_lshl_add_u32 v17, v18, 2, v17
    v_and_b32 v18, 63, v0
    v_cndmask_b32 v16, 0, 32, vcc
    v_lshlrev_b32 v19, 3, v18
    v_lshlrev_b32 v18, 4, v18
    buffer_load_dword v14, v17, s[84:87], 0 offen sc1
    s_mov_b32 s18, 44793856
    buffer_load_dwordx4 v[8:11], v18, s[8:11], s18 offen sc1
    s_mov_b32 s18, 44796416
    buffer_load_dwordx2 v[12:13], v19, s[8:11], s18 offen sc1
    s_add_u32 s33, s32, 69632
    buffer_load_dwordx4 a[160:163], v2, s[8:11], s33 offen offset:0
    s_waitcnt vmcnt(24)
    buffer_load_dwordx4 a[164:167], v2, s[8:11], s33 offen offset:1024
    s_add_u32 s33, s32, 86016
    buffer_load_dwordx4 a[168:171], v2, s[8:11], s33 offen offset:0
    buffer_load_dwordx4 a[172:175], v2, s[8:11], s33 offen offset:1024
    buffer_load_dwordx4 a[176:179], v2, s[8:11], s33 offen offset:2048
    buffer_load_dwordx4 a[180:183], v2, s[8:11], s33 offen offset:3072
    s_add_u32 s33, s32, 90112
    buffer_load_dwordx4 a[184:187], v2, s[8:11], s33 offen offset:0
    buffer_load_dwordx4 a[188:191], v2, s[8:11], s33 offen offset:1024
    s_waitcnt vmcnt(8)
    v_xor_b32 v8, s17, v8
    v_xor_b32 v9, s17, v9
    v_xor_b32 v10, s17, v10
    v_xor_b32 v11, s17, v11
    v_xor_b32 v12, s17, v12
    v_xor_b32 v13, s17, v13
    v_xor_b32 v14, v14, v16
    s_cmp_eq_u32 s15, 0
    s_cselect_b32 s18, -1, 0
    v_and_b32 v14, s18, v14
    v_or3_b32 v8, v8, v9, v10
    v_or3_b32 v8, v8, v11, v14
    v_or3_b32 v8, v8, v12, v13
    v_cmp_ne_u32 vcc, 0, v8
    s_cmp_eq_u64 vcc, 0
    s_cselect_b32 s18, 1, 0
    s_cmp_eq_u32 s18, 0
    s_cbranch_scc1 L_V_nodma
    s_mov_b32 m0, s23
    s_add_u32 s30, s22, 12845056
    buffer_load_dwordx4 v2, s[8:11], s30 offen offset:0 lds
    buffer_load_dwordx4 v2, s[8:11], s30 offen offset:1024 lds
    buffer_load_dwordx4 v2, s[8:11], s30 offen offset:2048 lds
    buffer_load_dwordx4 v2, s[8:11], s30 offen offset:3072 lds
    s_add_u32 m0, s23, 4096
    s_add_u32 s30, s30, 4096
    buffer_load_dwordx4 v2, s[8:11], s30 offen offset:0 lds
    buffer_load_dwordx4 v2, s[8:11], s30 offen offset:1024 lds
    buffer_load_dwordx4 v2, s[8:11], s30 offen offset:2048 lds
L_V_nodma:
    buffer_load_dwordx4 a[192:195], v2, s[8:11], s33 offen offset:2048
    buffer_load_dwordx4 a[196:199], v2, s[8:11], s33 offen offset:3072
    s_add_u32 s33, s32, 94208
    buffer_load_dwordx4 a[200:203], v2, s[8:11], s33 offen offset:0
    buffer_load_dwordx4 a[204:207], v2, s[8:11], s33 offen offset:1024
    buffer_load_dwordx4 a[208:211], v2, s[8:11], s33 offen offset:2048
    buffer_load_dwordx4 a[212:215], v2, s[8:11], s33 offen offset:3072
    s_add_u32 s33, s32, 98304
    buffer_load_dwordx4 a[216:219], v2, s[8:11], s33 offen offset:0
    buffer_load_dwordx4 a[220:223], v2, s[8:11], s33 offen offset:1024
    v_mov_b32 v1, s17
    v_mov_b32 v4, v2
    s_lshl_b32 s32, s27, 2
    s_add_u32 s32, s32, s12
    s_lshl_b32 s33, s32, 1
    s_add_u32 s33, s33, s28
    s_lshl_b32 s33, s33, 2
    v_mov_b32 v3, s33
    s_lshl_b32 s42, s32, 13
    s_lshl_b32 s28, s28, 10
    s_add_u32 s42, s42, s28
    s_add_u32 s42, s42, 14680064
    s_mov_b32 s43, 44662272
    s_mov_b32 s48, 0
    s_mov_b32 s41, 28672
    s_cmp_eq_u32 s18, 1
    s_cbranch_scc1 L_V_ready
    s_cmp_lg_u32 s15, 0
    s_cbranch_scc1 L_ver_45_ok
    v_and_b32 v40, 15, v0
    v_and_b32 v41, 7, v40
    v_lshlrev_b32 v41, 5, v41
    v_lshrrev_b32 v42, 3, v40
    v_cmp_gt_u32 vcc, 8, v40
    v_lshl_add_u32 v41, v42, 2, v41
    s_nop 0
    v_cndmask_b32 v40, 0, 32, vcc
L_ver_45:
    buffer_load_dword v42, v41, s[84:87], 0 offen sc1
    s_sub_u32 s26, s26, 1
    s_cbranch_scc1 L_fail
    s_waitcnt vmcnt(0)
    v_cmp_gt_u32 vcc, v42, v40
    s_cbranch_vccnz L_irregular
    v_cmp_ne_u32 vcc, v42, v40
    s_cbranch_vccnz L_ver_45
L_ver_45_ok:
    v_and_b32 v44, 63, v0
    v_lshlrev_b32 v44, 4, v44
    s_mov_b32 s30, 44793856
L_qs_46:
    buffer_load_dwordx4 v[40:43], v44, s[8:11], s30 offen sc1
    s_sub_u32 s26, s26, 1
    s_cbranch_scc1 L_fail
    s_waitcnt vmcnt(0)
    v_xor_b32 v40, s17, v40
    v_xor_b32 v41, s17, v41
    v_xor_b32 v42, s17, v42
    v_xor_b32 v43, s17, v43
    v_or3_b32 v40, v40, v41, v42
    v_or_b32 v40, v40, v43
    v_cmp_ne_u32 vcc, 0, v40
    s_cbranch_vccnz L_qs_46
    v_and_b32 v42, 63, v0
    v_lshlrev_b32 v42, 3, v42
    s_mov_b32 s30, 44796416
L_wf_47:
    buffer_load_dwordx2 v[40:41], v42, s[8:11], s30 offen offset:0 sc1
    s_sub_u32 s26, s26, 1
    s_cbranch_scc1 L_fail
    s_waitcnt vmcnt(0)
    v_xor_b32 v41, s17, v41
    v_xor_b32 v40, s17, v40
    v_or_b32 v40, v40, v41
    v_cmp_ne_u32 vcc, 0, v40
    s_cbranch_vccz L_wfd_48
    s_sleep 4
    s_branch L_wf_47
L_wfd_48:
    s_mov_b32 m0, s23
    s_add_u32 s30, s22, 12845056
    buffer_load_dwordx4 v2, s[8:11], s30 offen offset:0 lds
    buffer_load_dwordx4 v2, s[8:11], s30 offen offset:1024 lds
    buffer_load_dwordx4 v2, s[8:11], s30 offen offset:2048 lds
    buffer_load_dwordx4 v2, s[8:11], s30 offen offset:3072 lds
    s_add_u32 m0, s23, 4096
    s_add_u32 s30, s30, 4096
    buffer_load_dwordx4 v2, s[8:11], s30 offen offset:0 lds
    buffer_load_dwordx4 v2, s[8:11], s30 offen offset:1024 lds
    buffer_load_dwordx4 v2, s[8:11], s30 offen offset:2048 lds
L_V_ready:
    s_waitcnt vmcnt(0)
L_V_seg:
    s_waitcnt vmcnt(5)
    s_barrier
    s_add_u32 s22, s22, 28672
    s_add_u32 s23, s23, s41
    s_mov_b32 m0, s23
    s_add_u32 s30, s22, 12845056
    s_add_u32 s31, s30, 4096
    ds_read_b128 v[40:43], v4 offset:0
    ds_read_b128 v[44:47], v4 offset:14336
    ds_read_b128 v[48:51], v4 offset:1024
    ds_read_b128 v[52:55], v4 offset:15360
    s_waitcnt lgkmcnt(2)
    v_mfma_f32_16x16x32_bf16 v[8:11], v[40:43], a[0:3], 0
    ds_read_b128 v[56:59], v4 offset:2048
    v_mfma_f32_16x16x32_bf16 v[24:27], v[44:47], a[0:3], 0
    ds_read_b128 v[60:63], v4 offset:16384
    v_mfma_f32_16x16x32_bf16 v[12:15], v[40:43], a[56:59], 0
    v_mfma_f32_16x16x32_bf16 v[28:31], v[44:47], a[56:59], 0
    buffer_load_dwordx4 v2, s[8:11], s30 offen offset:0 lds
    v_mfma_f32_16x16x32_bf16 v[16:19], v[40:43], a[112:115], 0
    v_mfma_f32_16x16x32_bf16 v[32:35], v[44:47], a[112:115], 0
    v_mfma_f32_16x16x32_bf16 v[20:23], v[40:43], a[168:171], 0
    v_mfma_f32_16x16x32_bf16 v[36:39], v[44:47], a[168:171], 0
    s_waitcnt lgkmcnt(2)
    v_mfma_f32_16x16x32_bf16 v[8:11], v[48:51], a[4:7], v[8:11]
    ds_read_b128 v[40:43], v4 offset:3072
    v_mfma_f32_16x16x32_bf16 v[24:27], v[52:55], a[4:7], v[24:27]
    ds_read_b128 v[44:47], v4 offset:17408
    v_mfma_f32_16x16x32_bf16 v[12:15], v[48:51], a[60:63], v[12:15]
    v_mfma_f32_16x16x32_bf16 v[28:31], v[52:55], a[60:63], v[28:31]
    buffer_load_dwordx4 v2, s[8:11], s30 offen offset:1024 lds
    v_mfma_f32_16x16x32_bf16 v[16:19], v[48:51], a[116:119], v[16:19]
    v_mfma_f32_16x16x32_bf16 v[32:35], v[52:55], a[116:119], v[32:35]
    v_mfma_f32_16x16x32_bf16 v[20:23], v[48:51], a[172:175], v[20:23]
    v_mfma_f32_16x16x32_bf16 v[36:39], v[52:55], a[172:175], v[36:39]
    s_waitcnt lgkmcnt(2)
    v_mfma_f32_16x16x32_bf16 v[8:11], v[56:59], a[8:11], v[8:11]
    ds_read_b128 v[48:51], v4 offset:4096
    v_mfma_f32_16x16x32_bf16 v[24:27], v[60:63], a[8:11], v[24:27]
    ds_read_b128 v[52:55], v4 offset:18432
    v_mfma_f32_16x16x32_bf16 v[12:15], v[56:59], a[64:67], v[12:15]
    v_mfma_f32_16x16x32_bf16 v[28:31], v[60:63], a[64:67], v[28:31]
    buffer_load_dwordx4 v2, s[8:11], s30 offen offset:2048 lds
    v_mfma_f32_16x16x32_bf16 v[16:19], v[56:59], a[120:123], v[16:19]
    v_mfma_f32_16x16x32_bf16 v[32:35], v[60:63], a[120:123], v[32:35]
    v_mfma_f32_16x16x32_bf16 v[20:23], v[56:59], a[176:179], v[20:23]
    v_mfma_f32_16x16x32_bf16 v[36:39], v[60:63], a[176:179], v[36:39]
    s_waitcnt lgkmcnt(2)
    v_mfma_f32_16x16x32_bf16 v[8:11], v[40:43], a[12:15], v[8:11]
    ds_read_b128 v[56:59], v4 offset:5120
    v_mfma_f32_16x16x32_bf16 v[24:27], v[44:47], a[12:15], v[24:27]
    ds_read_b128 v[60:63], v4 offset:19456
    v_mfma_f32_16x16x32_bf16 v[12:15], v[40:43], a[68:71], v[12:15]
    v_mfma_f32_16x16x32_bf16 v[28:31], v[44:47], a[68:71], v[28:31]
    buffer_load_dwordx4 v2, s[8:11], s30 offen offset:3072 lds
    v_mfma_f32_16x16x32_bf16 v[16:19], v[40:43], a[124:127], v[16:19]
    v_mfma_f32_16x16x32_bf16 v[32:35], v[44:47], a[124:127], v[32:35]
    s_add_u32 m0, s23, 4096
    v_mfma_f32_16x16x32_bf16 v[20:23], v[40:43], a[180:183], v[20:23]
    v_mfma_f32_16x16x32_bf16 v[36:39], v[44:47], a[180:183], v[36:39]
    s_waitcnt lgkmcnt(2)
    v_mfma_f32_16x16x32_bf16 v[8:11], v[48:51], a[16:19], v[8:11]
    ds_read_b128 v[40:43], v4 offset:6144
    v_mfma_f32_16x16x32_bf16 v[24:27], v[52:55], a[16:19], v[24:27]
    ds_read_b128 v[44:47], v4 offset:20480
    v_mfma_f32_16x16x32_bf16 v[12:15], v[48:51], a[72:75], v[12:15]
    v_mfma_f32_16x16x32_bf16 v[28:31], v[52:55], a[72:75], v[28:31]
    buffer_load_dwordx4 v2, s[8:11], s31 offen offset:0 lds
    v_mfma_f32_16x16x32_bf16 v[16:19], v[48:51], a[128:131], v[16:19]
    v_mfma_f32_16x16x32_bf16 v[32:35], v[52:55], a[128:131], v[32:35]
    v_mfma_f32_16x16x32_bf16 v[20:23], v[48:51], a[184:187], v[20:23]
    v_mfma_f32_16x16x32_bf16 v[36:39], v[52:55], a[184:187], v[36:39]
    s_waitcnt lgkmcnt(2)
    v_mfma_f32_16x16x32_bf16 v[8:11], v[56:59], a[20:23], v[8:11]
    ds_read_b128 v[48:51], v4 offset:7168
    v_mfma_f32_16x16x32_bf16 v[24:27], v[60:63], a[20:23], v[24:27]
    ds_read_b128 v[52:55], v4 offset:21504
    v_mfma_f32_16x16x32_bf16 v[12:15], v[56:59], a[76:79], v[12:15]
    v_mfma_f32_16x16x32_bf16 v[28:31], v[60:63], a[76:79], v[28:31]
    buffer_load_dwordx4 v2, s[8:11], s31 offen offset:1024 lds
    v_mfma_f32_16x16x32_bf16 v[16:19], v[56:59], a[132:135], v[16:19]
    v_mfma_f32_16x16x32_bf16 v[32:35], v[60:63], a[132:135], v[32:35]
    v_mfma_f32_16x16x32_bf16 v[20:23], v[56:59], a[188:191], v[20:23]
    v_mfma_f32_16x16x32_bf16 v[36:39], v[60:63], a[188:191], v[36:39]
    s_waitcnt lgkmcnt(2)
    v_mfma_f32_16x16x32_bf16 v[8:11], v[40:43], a[24:27], v[8:11]
    ds_read_b128 v[56:59], v4 offset:8192
    v_mfma_f32_16x16x32_bf16 v[24:27], v[44:47], a[24:27], v[24:27]
    ds_read_b128 v[60:63], v4 offset:22528
    v_mfma_f32_16x16x32_bf16 v[12:15], v[40:43], a[80:83], v[12:15]
    v_mfma_f32_16x16x32_bf16 v[28:31], v[44:47], a[80:83], v[28:31]
    buffer_load_dwordx4 v2, s[8:11], s31 offen offset:2048 lds
    v_mfma_f32_16x16x32_bf16 v[16:19], v[40:43], a[136:139], v[16:19]
    v_mfma_f32_16x16x32_bf16 v[32:35], v[44:47], a[136:139], v[32:35]
    v_mfma_f32_16x16x32_bf16 v[20:23], v[40:43], a[192:195], v[20:23]
    v_mfma_f32_16x16x32_bf16 v[36:39], v[44:47], a[192:195], v[36:39]
    s_waitcnt lgkmcnt(2)
    v_mfma_f32_16x16x32_bf16 v[8:11], v[48:51], a[28:31], v[8:11]
    ds_read_b128 v[40:43], v4 offset:9216
    v_mfma_f32_16x16x32_bf16 v[24:27], v[52:55], a[28:31], v[24:27]
    ds_read_b128 v[44:47], v4 offset:23552
    v_mfma_f32_16x16x32_bf16 v[12:15], v[48:51], a[84:87], v[12:15]
    v_mfma_f32_16x16x32_bf16 v[28:31], v[52:55], a[84:87], v[28:31]
    v_mfma_f32_16x16x32_bf16 v[16:19], v[48:51], a[140:143], v[16:19]
    v_mfma_f32_16x16x32_bf16 v[32:35], v[52:55], a[140:143], v[32:35]
    v_mfma_f32_16x16x32_bf16 v[20:23], v[48:51], a[196:199], v[20:23]
    v_mfma_f32_16x16x32_bf16 v[36:39], v[52:55], a[196:199], v[36:39]
    s_waitcnt lgkmcnt(2)
    v_mfma_f32_16x16x32_bf16 v[8:11], v[56:59], a[32:35], v[8:11]
    ds_read_b128 v[48:51], v4 offset:10240
    v_mfma_f32_16x16x32_bf16 v[24:27], v[60:63], a[32:35], v[24:27]
    ds_read_b128 v[52:55], v4 offset:24576
    v_mfma_f32_16x16x32_bf16 v[12:15], v[56:59], a[88:91], v[12:15]
    v_mfma_f32_16x16x32_bf16 v[28:31], v[60:63], a[88:91], v[28:31]
    v_mfma_f32_16x16x32_bf16 v[16:19], v[56:59], a[144:147], v[16:19]
    v_mfma_f32_16x16x32_bf16 v[32:35], v[60:63], a[144:147], v[32:35]
    v_mfma_f32_16x16x32_bf16 v[20:23], v[56:59], a[200:203], v[20:23]
    v_mfma_f32_16x16x32_bf16 v[36:39], v[60:63], a[200:203], v[36:39]
    s_waitcnt lgkmcnt(2)
    v_mfma_f32_16x16x32_bf16 v[8:11], v[40:43], a[36:39], v[8:11]
    ds_read_b128 v[56:59], v4 offset:11264
    v_mfma_f32_16x16x32_bf16 v[24:27], v[44:47], a[36:39], v[24:27]
    ds_read_b128 v[60:63], v4 offset:25600
    v_mfma_f32_16x16x32_bf16 v[12:15], v[40:43], a[92:95], v[12:15]
    v_mfma_f32_16x16x32_bf16 v[28:31], v[44:47], a[92:95], v[28:31]
    v_mfma_f32_16x16x32_bf16 v[16:19], v[40:43], a[148:151], v[16:19]
    v_mfma_f32_16x16x32_bf16 v[32:35], v[44:47], a[148:151], v[32:35]
    v_mfma_f32_16x16x32_bf16 v[20:23], v[40:43], a[204:207], v[20:23]
    v_mfma_f32_16x16x32_bf16 v[36:39], v[44:47], a[204:207], v[36:39]
    s_cmp_eq_u32 s48, 0
    s_cbranch_scc1 L_vf_49
    s_waitcnt vmcnt(7)
    buffer_store_dword v1, v3, s[8:11], s43 offen sc1
L_vf_49:
    s_waitcnt lgkmcnt(2)
    v_mfma_f32_16x16x32_bf16 v[8:11], v[48:51], a[40:43], v[8:11]
    ds_read_b128 v[40:43], v4 offset:12288
    v_mfma_f32_16x16x32_bf16 v[24:27], v[52:55], a[40:43], v[24:27]
    ds_read_b128 v[44:47], v4 offset:26624
    v_mfma_f32_16x16x32_bf16 v[12:15], v[48:51], a[96:99], v[12:15]
    v_mfma_f32_16x16x32_bf16 v[28:31], v[52:55], a[96:99], v[28:31]
    v_mfma_f32_16x16x32_bf16 v[16:19], v[48:51], a[152:155], v[16:19]
    v_mfma_f32_16x16x32_bf16 v[32:35], v[52:55], a[152:155], v[32:35]
    v_mfma_f32_16x16x32_bf16 v[20:23], v[48:51], a[208:211], v[20:23]
    v_mfma_f32_16x16x32_bf16 v[36:39], v[52:55], a[208:211], v[36:39]
    s_waitcnt lgkmcnt(2)
    v_mfma_f32_16x16x32_bf16 v[8:11], v[56:59], a[44:47], v[8:11]
    ds_read_b128 v[48:51], v4 offset:13312
    v_mfma_f32_16x16x32_bf16 v[24:27], v[60:63], a[44:47], v[24:27]
    ds_read_b128 v[52:55], v4 offset:27648
    v_mfma_f32_16x16x32_bf16 v[12:15], v[56:59], a[100:103], v[12:15]
    v_mfma_f32_16x16x32_bf16 v[28:31], v[60:63], a[100:103], v[28:31]
    v_mfma_f32_16x16x32_bf16 v[16:19], v[56:59], a[156:159], v[16:19]
    v_mfma_f32_16x16x32_bf16 v[32:35], v[60:63], a[156:159], v[32:35]
    v_mfma_f32_16x16x32_bf16 v[20:23], v[56:59], a[212:215], v[20:23]
    v_mfma_f32_16x16x32_bf16 v[36:39], v[60:63], a[212:215], v[36:39]
    s_waitcnt lgkmcnt(2)
    v_mfma_f32_16x16x32_bf16 v[8:11], v[40:43], a[48:51], v[8:11]
    v_mfma_f32_16x16x32_bf16 v[24:27], v[44:47], a[48:51], v[24:27]
    v_mfma_f32_16x16x32_bf16 v[12:15], v[40:43], a[104:107], v[12:15]
    v_mfma_f32_16x16x32_bf16 v[28:31], v[44:47], a[104:107], v[28:31]
    v_mfma_f32_16x16x32_bf16 v[16:19], v[40:43], a[160:163], v[16:19]
    v_mfma_f32_16x16x32_bf16 v[32:35], v[44:47], a[160:163], v[32:35]
    v_mfma_f32_16x16x32_bf16 v[20:23], v[40:43], a[216:219], v[20:23]
    v_mfma_f32_16x16x32_bf16 v[36:39], v[44:47], a[216:219], v[36:39]
    s_waitcnt lgkmcnt(0)
    v_mfma_f32_16x16x32_bf16 v[8:11], v[48:51], a[52:55], v[8:11]
    v_mfma_f32_16x16x32_bf16 v[24:27], v[52:55], a[52:55], v[24:27]
    v_mfma_f32_16x16x32_bf16 v[12:15], v[48:51], a[108:111], v[12:15]
    v_mfma_f32_16x16x32_bf16 v[28:31], v[52:55], a[108:111], v[28:31]
    v_mfma_f32_16x16x32_bf16 v[16:19], v[48:51], a[164:167], v[16:19]
    v_mfma_f32_16x16x32_bf16 v[32:35], v[52:55], a[164:167], v[32:35]
    v_mfma_f32_16x16x32_bf16 v[20:23], v[48:51], a[220:223], v[20:23]
    v_mfma_f32_16x16x32_bf16 v[36:39], v[52:55], a[220:223], v[36:39]
    s_add_u32 s32, s42, 4096
    s_nop 1
    v_cvt_pk_bf16_f32 v8, v8, v9
    v_cvt_pk_bf16_f32 v9, v10, v11
    v_cvt_pk_bf16_f32 v10, v24, v25
    v_cvt_pk_bf16_f32 v11, v26, v27
    buffer_store_dwordx4 v[8:11], v2, s[8:11], s42 offen offset:0 sc1
    v_cvt_pk_bf16_f32 v12, v12, v13
    v_cvt_pk_bf16_f32 v13, v14, v15
    v_cvt_pk_bf16_f32 v14, v28, v29
    v_cvt_pk_bf16_f32 v15, v30, v31
    buffer_store_dwordx4 v[12:15], v2, s[8:11], s42 offen offset:2048 sc1
    v_cvt_pk_bf16_f32 v16, v16, v17
    v_cvt_pk_bf16_f32 v17, v18, v19
    v_cvt_pk_bf16_f32 v18, v32, v33
    v_cvt_pk_bf16_f32 v19, v34, v35
    buffer_store_dwordx4 v[16:19], v2, s[8:11], s32 offen offset:0 sc1
    v_cvt_pk_bf16_f32 v20, v20, v21
    v_cvt_pk_bf16_f32 v21, v22, v23
    v_cvt_pk_bf16_f32 v22, v36, v37
    v_cvt_pk_bf16_f32 v23, v38, v39
    buffer_store_dwordx4 v[20:23], v2, s[8:11], s32 offen offset:2048 sc1
    s_cmp_ge_u32 s48, 1
    s_cbranch_scc1 L_vf0_50
    s_waitcnt vmcnt(0)
    buffer_store_dword v1, v3, s[8:11], s43 offen offset:512 sc1
L_vf0_50:
    v_add_u32 v4, s41, v4
    s_sub_u32 s41, 0, s41
    s_add_u32 s48, s48, 1
    s_add_u32 s42, s42, 458752
    s_add_u32 s43, s43, 512
    s_cmp_lt_u32 s48, 64
    s_cbranch_scc1 L_V_seg
    s_waitcnt vmcnt(0)
    buffer_store_dword v1, v3, s[8:11], s43 offen sc1
    s_branch L_exit
L_RAs:
    s_lshr_b32 s30, s13, 2
    s_lshl_b32 s30, s30, 1
    s_and_b32 s31, s13, 3
    s_lshl_b32 s31, s31, 6
    s_add_u32 s30, s30, s31
    s_lshl_b32 s31, s12, 3
    s_add_u32 s30, s30, s31
    v_and_b32 v9, 1, v0
    v_lshlrev_b32 v9, 7, v9
    s_lshl_b32 s30, s30, 2
    s_add_u32 s30, s30, 44793856
L_wf_51:
    buffer_load_dword v8, v9, s[8:11], s30 offen offset:0 sc1
    s_sub_u32 s26, s26, 1
    s_cbranch_scc1 L_fail
    s_waitcnt vmcnt(0)
    v_cmp_ne_u32 vcc, s17, v8
    s_cbranch_vccz L_wfd_52
    s_sleep 4
    s_branch L_wf_51
L_wfd_52:
    v_and_b32 v8, 63, v0
    v_lshrrev_b32 v9, 4, v8
    v_and_b32 v10, 15, v8
    v_lshlrev_b32 v108, 4, v8
    s_mul_i32 s28, s13, 401408
    s_mul_i32 s29, s12, 100352
    s_add_u32 s28, s28, s29
    s_lshl_b32 s30, s12, 2
    s_lshr_b32 s44, 21536, s30
    s_and_b32 s44, s44, 15
    s_lshl_b32 s44, s44, 11
    s_lshr_b32 s45, 25905, s30
    s_and_b32 s45, s45, 15
    s_lshl_b32 s45, s45, 11
    s_lshr_b32 s46, 2, s30
    s_and_b32 s46, s46, 15
    s_lshl_b32 s46, s46, 11
    s_lshr_b32 s47, 4371, s30
    s_and_b32 s47, s47, 15
    s_lshl_b32 s47, s47, 11
    s_lshr_b32 s48, 8772, s30
    s_and_b32 s48, s48, 15
    s_lshl_b32 s48, s48, 11
    s_lshr_b32 s49, 13141, s30
    s_and_b32 s49, s49, 15
    s_lshl_b32 s49, s49, 11
    s_lshr_b32 s50, 18022, s30
    s_and_b32 s50, s50, 15
    s_lshl_b32 s50, s50, 11
    s_lshr_b32 s29, s46, 1
    v_add_u32 v109, s29, v108
    s_lshr_b32 s29, s48, 1
    v_add_u32 v110, s29, v108
    s_lshr_b32 s29, s50, 1
    v_add_u32 v111, s29, v108
    s_mul_i32 s24, s12, 7168
    s_add_u32 s25, s24, 24576
    s_add_u32 s24, s24, 12845056
    s_add_u32 s29, s28, s44
    buffer_load_dwordx4 a[0:3], v108, s[8:11], s29 offen offset:0
    buffer_load_dwordx4 a[4:7], v108, s[8:11], s29 offen offset:1024
    s_add_u32 s29, s28, s45
    buffer_load_dwordx4 a[8:11], v108, s[8:11], s29 offen offset:0
    buffer_load_dwordx4 a[12:15], v108, s[8:11], s29 offen offset:1024
    s_add_u32 s29, s28, s46
    buffer_load_dwordx4 a[16:19], v108, s[8:11], s29 offen offset:0
    buffer_load_dwordx4 a[20:23], v108, s[8:11], s29 offen offset:1024
    s_add_u32 s29, s28, s47
    buffer_load_dwordx4 a[24:27], v108, s[8:11], s29 offen offset:0
    buffer_load_dwordx4 a[28:31], v108, s[8:11], s29 offen offset:1024
    s_add_u32 s29, s28, s48
    buffer_load_dwordx4 a[32:35], v108, s[8:11], s29 offen offset:0
    buffer_load_dwordx4 a[36:39], v108, s[8:11], s29 offen offset:1024
    s_add_u32 s29, s28, s49
    buffer_load_dwordx4 a[40:43], v108, s[8:11], s29 offen offset:0
    buffer_load_dwordx4 a[44:47], v108, s[8:11], s29 offen offset:1024
    s_add_u32 s29, s28, s50
    buffer_load_dwordx4 a[48:51], v108, s[8:11], s29 offen offset:0
    buffer_load_dwordx4 a[52:55], v108, s[8:11], s29 offen offset:1024
    s_add_u32 s28, s28, 14336
    s_add_u32 s29, s28, s44
    buffer_load_dwordx4 a[56:59], v108, s[8:11], s29 offen offset:0
    buffer_load_dwordx4 a[60:63], v108, s[8:11], s29 offen offset:1024
    s_add_u32 s29, s28, s45
    buffer_load_dwordx4 a[64:67], v108, s[8:11], s29 offen offset:0
    buffer_load_dwordx4 a[68:71], v108, s[8:11], s29 offen offset:1024
    s_add_u32 s29, s28, s46
    buffer_load_dwordx4 a[72:75], v108, s[8:11], s29 offen offset:0
    buffer_load_dwordx4 a[76:79], v108, s[8:11], s29 offen offset:1024
    s_add_u32 s29, s28, s47
    buffer_load_dwordx4 a[80:83], v108, s[8:11], s29 offen offset:0
    buffer_load_dwordx4 a[84:87], v108, s[8:11], s29 offen offset:1024
    s_add_u32 s29, s28, s48
    buffer_load_dwordx4 a[88:91], v108, s[8:11], s29 offen offset:0
    buffer_load_dwordx4 a[92:95], v108, s[8:11], s29 offen offset:1024
    s_add_u32 s29, s28, s49
    buffer_load_dwordx4 a[96:99], v108, s[8:11], s29 offen offset:0
    buffer_load_dwordx4 a[100:103], v108, s[8:11], s29 offen offset:1024
    s_add_u32 s29, s28, s50
    buffer_load_dwordx4 a[104:107], v108, s[8:11], s29 offen offset:0
    buffer_load_dwordx4 a[108:111], v108, s[8:11], s29 offen offset:1024
    s_add_u32 s28, s28, 14336
    s_add_u32 s29, s28, s44
    buffer_load_dwordx4 a[112:115], v108, s[8:11], s29 offen offset:0
    buffer_load_dwordx4 a[116:119], v108, s[8:11], s29 offen offset:1024
    s_add_u32 s29, s28, s45
    buffer_load_dwordx4 a[120:123], v108, s[8:11], s29 offen offset:0
    buffer_load_dwordx4 a[124:127], v108, s[8:11], s29 offen offset:1024
    s_add_u32 s29, s28, s46
    buffer_load_dwordx4 a[128:131], v108, s[8:11], s29 offen offset:0
    buffer_load_dwordx4 a[132:135], v108, s[8:11], s29 offen offset:1024
    s_add_u32 s29, s28, s47
    buffer_load_dwordx4 a[136:139], v108, s[8:11], s29 offen offset:0
    buffer_load_dwordx4 a[140:143], v108, s[8:11], s29 offen offset:1024
    s_add_u32 s29, s28, s48
    buffer_load_dwordx4 a[144:147], v108, s[8:11], s29 offen offset:0
    buffer_load_dwordx4 a[148:151], v108, s[8:11], s29 offen offset:1024
    s_add_u32 s29, s28, s49
    buffer_load_dwordx4 a[152:155], v108, s[8:11], s29 offen offset:0
    buffer_load_dwordx4 a[156:159], v108, s[8:11], s29 offen offset:1024
    s_add_u32 s29, s28, s50
    buffer_load_dwordx4 a[160:163], v108, s[8:11], s29 offen offset:0
    buffer_load_dwordx4 a[164:167], v108, s[8:11], s29 offen offset:1024
    s_add_u32 s28, s28, 14336
    s_waitcnt vmcnt(40)
    s_add_u32 s29, s28, s44
    buffer_load_dwordx4 a[168:171], v108, s[8:11], s29 offen offset:0
    buffer_load_dwordx4 a[172:175], v108, s[8:11], s29 offen offset:1024
    s_waitcnt vmcnt(40)
    s_add_u32 s29, s28, s45
    buffer_load_dwordx4 a[176:179], v108, s[8:11], s29 offen offset:0
    buffer_load_dwordx4 a[180:183], v108, s[8:11], s29 offen offset:1024
    s_waitcnt vmcnt(40)
    s_add_u32 s29, s28, s46
    buffer_load_dwordx4 a[184:187], v108, s[8:11], s29 offen offset:0
    buffer_load_dwordx4 a[188:191], v108, s[8:11], s29 offen offset:1024
    s_waitcnt vmcnt(40)
    s_add_u32 s29, s28, s47
    buffer_load_dwordx4 a[192:195], v108, s[8:11], s29 offen offset:0
    buffer_load_dwordx4 a[196:199], v108, s[8:11], s29 offen offset:1024
    s_waitcnt vmcnt(40)
    s_add_u32 s29, s28, s48
    buffer_load_dwordx4 a[200:203], v108, s[8:11], s29 offen offset:0
    buffer_load_dwordx4 a[204:207], v108, s[8:11], s29 offen offset:1024
    s_waitcnt vmcnt(40)
    s_add_u32 s29, s28, s49
    buffer_load_dwordx4 a[208:211], v108, s[8:11], s29 offen offset:0
    buffer_load_dwordx4 a[212:215], v108, s[8:11], s29 offen offset:1024
    s_waitcnt vmcnt(40)
    s_add_u32 s29, s28, s50
    buffer_load_dwordx4 a[216:219], v108, s[8:11], s29 offen offset:0
    buffer_load_dwordx4 a[220:223], v108, s[8:11], s29 offen offset:1024
    s_add_u32 s28, s28, 14336
    s_waitcnt vmcnt(40)
    s_add_u32 s29, s28, s44
    buffer_load_dwordx4 a[224:227], v108, s[8:11], s29 offen offset:0
    buffer_load_dwordx4 a[228:231], v108, s[8:11], s29 offen offset:1024
    s_waitcnt vmcnt(40)
    v_and_b32 v88, 15, v0
    v_and_b32 v89, 7, v88
    v_lshlrev_b32 v89, 5, v89
    v_lshrrev_b32 v90, 3, v88
    v_cmp_gt_u32 vcc, 8, v88
    v_lshl_add_u32 v89, v90, 2, v89
    v_and_b32 v90, 63, v0
    v_cndmask_b32 v88, 0, 32, vcc
    v_lshlrev_b32 v91, 3, v90
    v_lshlrev_b32 v90, 4, v90
    buffer_load_dword v86, v89, s[84:87], 0 offen sc1
    s_mov_b32 s18, 44793856
    buffer_load_dwordx4 v[80:83], v90, s[8:11], s18 offen sc1
    s_mov_b32 s18, 44796416
    buffer_load_dwordx2 v[84:85], v91, s[8:11], s18 offen sc1
    s_add_u32 s29, s28, s45
    buffer_load_dwordx4 a[232:235], v108, s[8:11], s29 offen offset:0
    buffer_load_dwordx4 a[236:239], v108, s[8:11], s29 offen offset:1024
    s_waitcnt vmcnt(40)
    s_add_u32 s29, s28, s46
    buffer_load_dwordx4 a[240:243], v108, s[8:11], s29 offen offset:0
    buffer_load_dwordx4 a[244:247], v108, s[8:11], s29 offen offset:1024
    s_waitcnt vmcnt(40)
    s_add_u32 s29, s28, s47
    buffer_load_dwordx4 a[248:251], v108, s[8:11], s29 offen offset:0
    buffer_load_dwordx4 a[252:255], v108, s[8:11], s29 offen offset:1024
    s_waitcnt vmcnt(40)
    s_add_u32 s29, s28, s48
    buffer_load_dwordx4 v[120:123], v108, s[8:11], s29 offen offset:0
    buffer_load_dwordx4 v[124:127], v108, s[8:11], s29 offen offset:1024
    s_waitcnt vmcnt(40)
    s_add_u32 s29, s28, s49
    buffer_load_dwordx4 v[128:131], v108, s[8:11], s29 offen offset:0
    buffer_load_dwordx4 v[132:135], v108, s[8:11], s29 offen offset:1024
    s_waitcnt vmcnt(40)
    s_add_u32 s29, s28, s50
    buffer_load_dwordx4 v[136:139], v108, s[8:11], s29 offen offset:0
    buffer_load_dwordx4 v[140:143], v108, s[8:11], s29 offen offset:1024
    s_add_u32 s28, s28, 14336
    s_waitcnt vmcnt(40)
    s_waitcnt vmcnt(12)
    v_xor_b32 v80, s17, v80
    v_xor_b32 v81, s17, v81
    v_xor_b32 v82, s17, v82
    v_xor_b32 v83, s17, v83
    v_xor_b32 v84, s17, v84
    v_xor_b32 v85, s17, v85
    v_xor_b32 v86, v86, v88
    s_cmp_eq_u32 s15, 0
    s_cselect_b32 s18, -1, 0
    v_and_b32 v86, s18, v86
    v_or3_b32 v80, v80, v81, v82
    v_or3_b32 v80, v80, v83, v86
    v_or3_b32 v80, v80, v84, v85
    v_cmp_ne_u32 vcc, 0, v80
    s_cmp_eq_u64 vcc, 0
    s_cselect_b32 s18, 1, 0
    s_cmp_eq_u32 s18, 0
    s_cbranch_scc1 L_RAs_nodma
    s_mov_b32 m0, s25
    s_nop 0
    buffer_load_dwordx4 v108, s[8:11], s24 offen offset:0 lds
    buffer_load_dwordx4 v108, s[8:11], s24 offen offset:1024 lds
    buffer_load_dwordx4 v108, s[8:11], s24 offen offset:2048 lds
    buffer_load_dwordx4 v108, s[8:11], s24 offen offset:3072 lds
    s_add_u32 m0, s25, 4096
    s_add_u32 s19, s24, 4096
    buffer_load_dwordx4 v108, s[8:11], s19 offen offset:0 lds
    buffer_load_dwordx4 v108, s[8:11], s19 offen offset:1024 lds
    buffer_load_dwordx4 v108, s[8:11], s19 offen offset:2048 lds
L_RAs_nodma:
    s_add_u32 s29, s28, s44
    buffer_load_dwordx4 v[144:147], v108, s[8:11], s29 offen offset:0
    buffer_load_dwordx4 v[148:151], v108, s[8:11], s29 offen offset:1024
    s_waitcnt vmcnt(40)
    s_add_u32 s29, s28, s45
    buffer_load_dwordx4 v[152:155], v108, s[8:11], s29 offen offset:0
    buffer_load_dwordx4 v[156:159], v108, s[8:11], s29 offen offset:1024
    s_waitcnt vmcnt(40)
    s_add_u32 s29, s28, s46
    buffer_load_dwordx4 v[160:163], v108, s[8:11], s29 offen offset:0
    buffer_load_dwordx4 v[164:167], v108, s[8:11], s29 offen offset:1024
    s_waitcnt vmcnt(40)
    s_add_u32 s29, s28, s47
    buffer_load_dwordx4 v[168:171], v108, s[8:11], s29 offen offset:0
    buffer_load_dwordx4 v[172:175], v108, s[8:11], s29 offen offset:1024
    s_waitcnt vmcnt(40)
    s_add_u32 s29, s28, s48
    buffer_load_dwordx4 v[176:179], v108, s[8:11], s29 offen offset:0
    buffer_load_dwordx4 v[180:183], v108, s[8:11], s29 offen offset:1024
    s_waitcnt vmcnt(40)
    s_add_u32 s29, s28, s49
    buffer_load_dwordx4 v[184:187], v108, s[8:11], s29 offen offset:0
    buffer_load_dwordx4 v[188:191], v108, s[8:11], s29 offen offset:1024
    s_waitcnt vmcnt(40)
    s_add_u32 s29, s28, s50
    buffer_load_dwordx4 v[192:195], v108, s[8:11], s29 offen offset:0
    buffer_load_dwordx4 v[196:199], v108, s[8:11], s29 offen offset:1024
    s_add_u32 s28, s28, 14336
    s_waitcnt vmcnt(40)
    s_add_u32 s29, s28, s44
    buffer_load_dwordx4 v[200:203], v108, s[8:11], s29 offen offset:0
    buffer_load_dwordx4 v[204:207], v108, s[8:11], s29 offen offset:1024
    s_waitcnt vmcnt(40)
    s_add_u32 s29, s28, s45
    buffer_load_dwordx4 v[208:211], v108, s[8:11], s29 offen offset:0
    buffer_load_dwordx4 v[212:215], v108, s[8:11], s29 offen offset:1024
    s_waitcnt vmcnt(40)
    s_add_u32 s29, s28, s46
    buffer_load_dwordx4 v[216:219], v108, s[8:11], s29 offen offset:0
    buffer_load_dwordx4 v[220:223], v108, s[8:11], s29 offen offset:1024
    s_waitcnt vmcnt(40)
    s_add_u32 s29, s28, s47
    buffer_load_dwordx4 v[224:227], v108, s[8:11], s29 offen offset:0
    buffer_load_dwordx4 v[228:231], v108, s[8:11], s29 offen offset:1024
    s_waitcnt vmcnt(40)
    s_add_u32 s29, s28, s48
    buffer_load_dwordx4 v[232:235], v108, s[8:11], s29 offen offset:0
    buffer_load_dwordx4 v[236:239], v108, s[8:11], s29 offen offset:1024
    s_waitcnt vmcnt(40)
    s_add_u32 s29, s28, s49
    buffer_load_dwordx4 v[240:243], v108, s[8:11], s29 offen offset:0
    buffer_load_dwordx4 v[244:247], v108, s[8:11], s29 offen offset:1024
    s_waitcnt vmcnt(40)
    s_add_u32 s29, s28, s50
    buffer_load_dwordx4 v[248:251], v108, s[8:11], s29 offen offset:0
    buffer_load_dwordx4 v[252:255], v108, s[8:11], s29 offen offset:1024
    s_add_u32 s28, s28, 14336
    s_waitcnt vmcnt(40)
    v_mov_b32 v1, 0x4444
    v_mov_b32 v11, 0xeeee
    v_cmp_lt_u32 vcc, 7, v10
    s_nop 1
    v_cndmask_b32 v1, v1, v11, vcc
    v_mov_b32 v106, 0x4444
    v_mov_b32 v11, 0xeeee
    v_and_b32 v12, 2, v10
    v_cmp_ne_u32 vcc, 0, v12
    s_nop 1
    v_cndmask_b32 v106, v106, v11, vcc
    v_and_b32 v11, 1, v10
    v_lshlrev_b32 v11, 4, v11
    v_mov_b32 v12, 0x3f80
    v_lshlrev_b32 v12, v11, v12
    v_lshrrev_b32 v11, 3, v10
    v_and_b32 v13, 1, v9
    v_cmp_eq_u32 vcc, v11, v13
    s_nop 1
    v_cndmask_b32 v12, 0, v12, vcc
    v_bfe_u32 v11, v10, 2, 1
    v_bfe_u32 v13, v10, 1, 1
    v_lshl_add_u32 v11, v13, 1, v11
    v_cmp_eq_u32 vcc, 0, v11
    s_nop 1
    v_cndmask_b32 v4, 0, v12, vcc
    v_cmp_eq_u32 vcc, 1, v11
    s_nop 1
    v_cndmask_b32 v5, 0, v12, vcc
    v_cmp_eq_u32 vcc, 2, v11
    s_nop 1
    v_cndmask_b32 v6, 0, v12, vcc
    v_cmp_eq_u32 vcc, 3, v11
    s_nop 1
    v_cndmask_b32 v7, 0, v12, vcc
    s_and_b32 s28, s12, 1
    s_cmp_eq_u32 s28, 0
    s_cselect_b64 vcc, -1, 0
    s_nop 1
    v_cndmask_b32 v2, v6, v4, vcc
    v_cndmask_b32 v3, v7, v5, vcc
    s_lshl_b32 s28, s12, 11
    s_min_u32 s28, s28, 5120
    v_add_u32 v107, s28, v108
    s_lshl_b32 s30, s12, 3
    s_lshr_b32 s28, 185009152, s30
    s_and_b32 s28, s28, 255
    s_lshr_b32 s29, 201852161, s30
    s_and_b32 s29, s29, 255
    v_and_b32 v11, 1, v9
    v_cmp_eq_u32 vcc, 1, v11
    v_mov_b32 v12, s28
    v_mov_b32 v13, s29
    v_cndmask_b32 v12, v12, v13, vcc
    v_lshrrev_b32 v13, 1, v9
    v_and_b32 v11, 7, v10
    v_lshlrev_b32 v11, 4, v11
    v_lshl_add_u32 v11, v13, 3, v11
    v_lshl_add_u32 v112, v12, 9, v11
    v_lshlrev_b32 v11, 4, v10
    v_lshl_add_u32 v11, v13, 8, v11
    v_lshl_add_u32 v11, v12, 10, v11
    v_add_u32 v114, 24576, v11
    s_lshl_b32 s30, s12, 3
    s_lshr_b32 s28, 218695170, s30
    s_and_b32 s28, s28, 255
    s_lshr_b32 s29, 168428291, s30
    s_and_b32 s29, s29, 255
    v_and_b32 v11, 1, v9
    v_cmp_eq_u32 vcc, 1, v11
    v_mov_b32 v12, s28
    v_mov_b32 v13, s29
    v_cndmask_b32 v12, v12, v13, vcc
    v_lshrrev_b32 v13, 1, v9
    v_and_b32 v11, 7, v10
    v_lshlrev_b32 v11, 4, v11
    v_lshl_add_u32 v11, v13, 3, v11
    v_lshl_add_u32 v113, v12, 9, v11
    v_lshlrev_b32 v11, 4, v10
    v_lshl_add_u32 v11, v13, 8, v11
    v_lshl_add_u32 v11, v12, 10, v11
    v_add_u32 v115, 24576, v11
    v_and_b32 v11, 31, v8
    v_min_u32 v11, 19, v11
    v_lshlrev_b32 v11, 3, v11
    v_lshrrev_b32 v12, 5, v8
    v_lshl_add_u32 v11, v12, 8, v11
    s_lshl_b32 s28, s12, 9
    s_add_u32 s28, s28, 8192
    v_add_u32 v116, s28, v11
    s_lshl_b32 s28, s12, 11
    s_add_u32 s28, s28, 8192
    v_lshlrev_b32 v11, 9, v9
    v_add_u32 v11, s28, v11
    v_lshl_add_u32 v118, v10, 2, v11
    v_add_u32 v118, 128, v118
    v_bfe_u32 v12, v10, 3, 1
    v_lshl_add_u32 v11, v12, 6, v11
    v_bfe_u32 v12, v10, 1, 1
    v_lshl_add_u32 v11, v12, 5, v11
    v_bfe_u32 v12, v10, 2, 1
    v_lshl_add_u32 v11, v12, 4, v11
    v_bfe_u32 v12, v10, 0, 1
    v_lshl_add_u32 v11, v12, 2, v11
    v_mov_b32 v117, v11
    s_mov_b32 vcc_lo, 0x000fffff
    s_mov_b32 vcc_hi, 0x000fffff
    v_mov_b32 v11, 0xff800000
    v_cndmask_b32 v104, v11, 0, vcc
    v_bfe_u32 v12, v8, 3, 1
    v_lshlrev_b32 v119, 8, v12
    v_bfe_u32 v12, v8, 2, 1
    v_lshl_add_u32 v119, v12, 5, v119
    s_lshl_b32 s28, s13, 9
    v_add_u32 v119, s28, v119
    s_lshr_b32 s28, s13, 1
    s_lshl_b32 s28, s28, 8
    s_and_b32 s29, s13, 1
    s_lshl_b32 s29, s29, 5
    s_add_u32 s28, s28, s29
    s_add_u32 s31, s28, 8192
    v_mov_b32 v12, s31
    v_and_b32 v13, 16, v8
    v_cmp_ne_u32 s[36:37], 0, v13
    s_nop 1
    v_cndmask_b32 v119, v119, v12, s[36:37]
    v_and_b32 v12, 3, v8
    v_lshl_add_u32 v119, v12, 2, v119
    v_lshrrev_b32 v12, 5, v8
    v_lshl_add_u32 v119, v12, 4, v119
    s_lshl_b32 s28, s12, 6
    v_add_u32 v119, s28, v119
    v_mov_b32 v11, 1073741824
    v_cndmask_b32 v119, v11, v119, vcc
    s_lshl_b32 s28, s13, 8
    s_lshl_b32 s29, s12, 6
    s_add_u32 s28, s28, s29
    s_add_u32 s28, s28, 44746496
    v_lshlrev_b32 v12, 2, v10
    v_add_u32 v105, s28, v12
    s_lshl_b32 s28, s13, 2
    s_add_u32 s28, s28, 44744704
    v_lshlrev_b32 v12, 7, v8
    v_add_u32 v12, s28, v12
    v_cmp_gt_u32 vcc, 14, v8
    s_cmp_eq_u32 s12, 0
    s_cselect_b64 vcc, vcc, 0
    s_nop 1
    v_cndmask_b32 v68, v11, v12, vcc
    s_mov_b32 s20, 0
    s_mov_b32 s21, 44564480
    s_mov_b32 s22, 44597248
    s_mov_b32 s26, 1048576
    s_mov_b32 s40, 0xfffefffe
    s_mov_b32 s41, 28672
    s_mov_b32 s36, 20
    s_cmp_eq_u32 s18, 1
    s_cbranch_scc1 L_RAs_ready
    s_cmp_lg_u32 s15, 0
    s_cbranch_scc1 L_ver_53_ok
    v_and_b32 v8, 15, v0
    v_and_b32 v9, 7, v8
    v_lshlrev_b32 v9, 5, v9
    v_lshrrev_b32 v10, 3, v8
    v_cmp_gt_u32 vcc, 8, v8
    v_lshl_add_u32 v9, v10, 2, v9
    s_nop 0
    v_cndmask_b32 v8, 0, 32, vcc
L_ver_53:
    buffer_load_dword v10, v9, s[84:87], 0 offen sc1
    s_sub_u32 s26, s26, 1
    s_cbranch_scc1 L_fail
    s_waitcnt vmcnt(0)
    v_cmp_gt_u32 vcc, v10, v8
    s_cbranch_vccnz L_irregular
    v_cmp_ne_u32 vcc, v10, v8
    s_cbranch_vccnz L_ver_53
L_ver_53_ok:
    v_and_b32 v12, 63, v0
    v_lshlrev_b32 v12, 4, v12
    s_mov_b32 s30, 44793856
L_qs_54:
    buffer_load_dwordx4 v[8:11], v12, s[8:11], s30 offen sc1
    s_sub_u32 s26, s26, 1
    s_cbranch_scc1 L_fail
    s_waitcnt vmcnt(0)
    v_xor_b32 v8, s17, v8
    v_xor_b32 v9, s17, v9
    v_xor_b32 v10, s17, v10
    v_xor_b32 v11, s17, v11
    v_or3_b32 v8, v8, v9, v10
    v_or_b32 v8, v8, v11
    v_cmp_ne_u32 vcc, 0, v8
    s_cbranch_vccnz L_qs_54
    v_and_b32 v10, 63, v0
    v_lshlrev_b32 v10, 3, v10
    s_mov_b32 s30, 44796416
L_wf_55:
    buffer_load_dwordx2 v[8:9], v10, s[8:11], s30 offen offset:0 sc1
    s_sub_u32 s26, s26, 1
    s_cbranch_scc1 L_fail
    s_waitcnt vmcnt(0)
    v_xor_b32 v9, s17, v9
    v_xor_b32 v8, s17, v8
    v_or_b32 v8, v8, v9
    v_cmp_ne_u32 vcc, 0, v8
    s_cbranch_vccz L_wfd_56
    s_sleep 4
    s_branch L_wf_55
L_wfd_56:
    s_mov_b32 m0, s25
    s_nop 0
    buffer_load_dwordx4 v108, s[8:11], s24 offen offset:0 lds
    buffer_load_dwordx4 v108, s[8:11], s24 offen offset:1024 lds
    buffer_load_dwordx4 v108, s[8:11], s24 offen offset:2048 lds
    buffer_load_dwordx4 v108, s[8:11], s24 offen offset:3072 lds
    s_add_u32 m0, s25, 4096
    s_add_u32 s19, s24, 4096
    buffer_load_dwordx4 v108, s[8:11], s19 offen offset:0 lds
    buffer_load_dwordx4 v108, s[8:11], s19 offen offset:1024 lds
    buffer_load_dwordx4 v108, s[8:11], s19 offen offset:2048 lds
L_RAs_ready:
    v_mov_b32 v0, v68
    s_add_u32 s24, s24, 28672
    v_mov_b64 v[28:29], 0
    v_mov_b64 v[30:31], 0
    v_mov_b64 v[32:33], 0
    v_mov_b64 v[34:35], 0
    v_mov_b64 v[36:37], 0
    v_mov_b64 v[38:39], 0
    v_mov_b64 v[40:41], 0
    v_mov_b64 v[42:43], 0
    v_mov_b64 v[44:45], 0
    v_mov_b64 v[46:47], 0
    v_mov_b64 v[48:49], 0
    v_mov_b64 v[50:51], 0
    v_mov_b64 v[52:53], 0
    v_mov_b64 v[54:55], 0
    v_mov_b64 v[56:57], 0
    v_mov_b64 v[58:59], 0
    v_mov_b64 v[60:61], 0
    v_mov_b64 v[62:63], 0
    v_mov_b64 v[64:65], 0
    v_mov_b64 v[66:67], 0
    s_waitcnt vmcnt(0)
.p2align 6
    s_nop 0
    s_nop 0
L_RAs_step:
    buffer_load_dwordx4 v[80:83], v107, s[8:11], s21 offen offset:0 sc1
    buffer_load_dwordx4 v[84:87], v107, s[8:11], s21 offen offset:1024 sc1
    s_sleep 1
    s_sleep 1
L_RAs_pm_loop:
    buffer_load_dwordx4 v[88:91], v107, s[8:11], s21 offen offset:0 sc1
    buffer_load_dwordx4 v[92:95], v107, s[8:11], s21 offen offset:1024 sc1
    s_sub_u32 s26, s26, 1
    s_cbranch_scc1 L_fail
    s_waitcnt vmcnt(2)
    v_pk_max_u16 v76, v80, v81
    v_pk_max_u16 v76, v76, v82
    v_pk_max_u16 v76, v76, v83
    v_pk_max_u16 v76, v76, v84
    v_pk_max_u16 v76, v76, v85
    v_pk_max_u16 v76, v76, v86
    v_pk_max_u16 v76, v76, v87
    v_lshlrev_b32 v77, 16, v76
    v_max_u32 v76, v76, v77
    v_cmp_le_u32 vcc, 0xffff0000, v76
    s_cbranch_vccz L_RAs_pm_ok0
    buffer_load_dwordx4 v[80:83], v107, s[8:11], s21 offen offset:0 sc1
    buffer_load_dwordx4 v[84:87], v107, s[8:11], s21 offen offset:1024 sc1
    s_waitcnt vmcnt(2)
    v_pk_max_u16 v76, v88, v89
    v_pk_max_u16 v76, v76, v90
    v_pk_max_u16 v76, v76, v91
    v_pk_max_u16 v76, v76, v92
    v_pk_max_u16 v76, v76, v93
    v_pk_max_u16 v76, v76, v94
    v_pk_max_u16 v76, v76, v95
    v_lshlrev_b32 v77, 16, v76
    v_max_u32 v76, v76, v77
    v_cmp_le_u32 vcc, 0xffff0000, v76
    s_cbranch_vccnz L_RAs_pm_loop
L_RAs_pm_ok1:
    v_smfmac_f32_16x16x64_bf16 v[28:31], v[88:91], a[0:7], v1
    ds_write_b128 v107, v[88:91] offset:0
    v_smfmac_f32_16x16x64_bf16 v[32:35], v[88:91], a[56:63], v1
    ds_write_b128 v107, v[92:95] offset:1024
    v_smfmac_f32_16x16x64_bf16 v[36:39], v[88:91], a[112:119], v1
    v_smfmac_f32_16x16x64_bf16 v[40:43], v[88:91], a[168:175], v1
    v_smfmac_f32_16x16x64_bf16 v[44:47], v[88:91], a[224:231], v1
    v_smfmac_f32_16x16x64_bf16 v[48:51], v[88:91], v[144:151], v1
    v_smfmac_f32_16x16x64_bf16 v[52:55], v[88:91], v[200:207], v1
    v_smfmac_f32_16x16x64_bf16 v[28:31], v[92:95], a[8:15], v1
    v_smfmac_f32_16x16x64_bf16 v[32:35], v[92:95], a[64:71], v1
    s_waitcnt lgkmcnt(0)
    v_smfmac_f32_16x16x64_bf16 v[36:39], v[92:95], a[120:127], v1
    s_barrier
    v_smfmac_f32_16x16x64_bf16 v[40:43], v[92:95], a[176:183], v1
    ds_read_b128 v[8:11], v109 offset:0
    v_smfmac_f32_16x16x64_bf16 v[44:47], v[92:95], a[232:239], v1
    ds_read_b128 v[12:15], v109 offset:1024
    v_smfmac_f32_16x16x64_bf16 v[48:51], v[92:95], v[152:159], v1
    ds_read_b128 v[16:19], v110 offset:0
    v_smfmac_f32_16x16x64_bf16 v[52:55], v[92:95], v[208:215], v1
    ds_read_b128 v[20:23], v110 offset:1024
    s_branch L_RAs_pm_done
L_RAs_pm_ok0:
    v_smfmac_f32_16x16x64_bf16 v[28:31], v[80:83], a[0:7], v1
    ds_write_b128 v107, v[80:83] offset:0
    v_smfmac_f32_16x16x64_bf16 v[32:35], v[80:83], a[56:63], v1
    ds_write_b128 v107, v[84:87] offset:1024
    v_smfmac_f32_16x16x64_bf16 v[36:39], v[80:83], a[112:119], v1
    v_smfmac_f32_16x16x64_bf16 v[40:43], v[80:83], a[168:175], v1
    v_smfmac_f32_16x16x64_bf16 v[44:47], v[80:83], a[224:231], v1
    v_smfmac_f32_16x16x64_bf16 v[48:51], v[80:83], v[144:151], v1
    v_smfmac_f32_16x16x64_bf16 v[52:55], v[80:83], v[200:207], v1
    v_smfmac_f32_16x16x64_bf16 v[28:31], v[84:87], a[8:15], v1
    v_smfmac_f32_16x16x64_bf16 v[32:35], v[84:87], a[64:71], v1
    s_waitcnt lgkmcnt(0)
    v_smfmac_f32_16x16x64_bf16 v[36:39], v[84:87], a[120:127], v1
    s_barrier
    v_smfmac_f32_16x16x64_bf16 v[40:43], v[84:87], a[176:183], v1
    ds_read_b128 v[8:11], v109 offset:0
    v_smfmac_f32_16x16x64_bf16 v[44:47], v[84:87], a[232:239], v1
    ds_read_b128 v[12:15], v109 offset:1024
    v_smfmac_f32_16x16x64_bf16 v[48:51], v[84:87], v[152:159], v1
    ds_read_b128 v[16:19], v110 offset:0
    v_smfmac_f32_16x16x64_bf16 v[52:55], v[84:87], v[208:215], v1
    ds_read_b128 v[20:23], v110 offset:1024
L_RAs_pm_done:
    ds_read_b128 v[24:27], v111 offset:0
    s_waitcnt lgkmcnt(4)
    v_smfmac_f32_16x16x64_bf16 v[28:31], v[8:11], a[16:23], v1
    s_waitcnt lgkmcnt(3)
    v_smfmac_f32_16x16x64_bf16 v[28:31], v[12:15], a[24:31], v1
    s_waitcnt lgkmcnt(2)
    v_smfmac_f32_16x16x64_bf16 v[28:31], v[16:19], a[32:39], v1
    s_waitcnt lgkmcnt(1)
    v_smfmac_f32_16x16x64_bf16 v[28:31], v[20:23], a[40:47], v1
    s_waitcnt lgkmcnt(0)
    v_smfmac_f32_16x16x64_bf16 v[28:31], v[24:27], a[48:55], v1
    s_waitcnt vmcnt(0)
    v_smfmac_f32_16x16x64_bf16 v[32:35], v[8:11], a[72:79], v1
    ds_read2_b32 v[80:81], v112 offset0:0 offset1:32
    v_smfmac_f32_16x16x64_bf16 v[32:35], v[12:15], a[80:87], v1
    ds_read2_b32 v[82:83], v112 offset0:1 offset1:33
    v_smfmac_f32_16x16x64_bf16 v[32:35], v[16:19], a[88:95], v1
    ds_read2_b32 v[84:85], v112 offset0:64 offset1:96
    v_smfmac_f32_16x16x64_bf16 v[32:35], v[20:23], a[96:103], v1
    ds_read2_b32 v[86:87], v112 offset0:65 offset1:97
    v_smfmac_f32_16x16x64_bf16 v[32:35], v[24:27], a[104:111], v1
    v_cvt_pk_bf16_f32 v68, v28, v29
    v_smfmac_f32_16x16x64_bf16 v[36:39], v[8:11], a[128:135], v1
    v_cvt_pk_bf16_f32 v69, v30, v31
    v_smfmac_f32_16x16x64_bf16 v[36:39], v[12:15], a[136:143], v1
    ds_read_b128 v[88:91], v114 offset:0
    v_smfmac_f32_16x16x64_bf16 v[36:39], v[16:19], a[144:151], v1
    ds_read_b128 v[92:95], v114 offset:512
    v_smfmac_f32_16x16x64_bf16 v[36:39], v[20:23], a[152:159], v1
    v_cvt_pk_bf16_f32 v70, v32, v33
    v_smfmac_f32_16x16x64_bf16 v[36:39], v[24:27], a[160:167], v1
    v_cvt_pk_bf16_f32 v71, v34, v35
    v_smfmac_f32_16x16x64_bf16 v[40:43], v[8:11], a[184:191], v1
    ds_read2_b32 v[28:29], v113 offset0:0 offset1:32
    v_smfmac_f32_16x16x64_bf16 v[40:43], v[12:15], a[192:199], v1
    v_mfma_f32_16x16x32_bf16 v[72:75], v[68:71], v[4:7], 0
    ds_read2_b32 v[30:31], v113 offset0:1 offset1:33
    ds_read2_b32 v[32:33], v113 offset0:64 offset1:96
    v_smfmac_f32_16x16x64_bf16 v[40:43], v[16:19], a[200:207], v1
    ds_read2_b32 v[34:35], v113 offset0:65 offset1:97
    v_smfmac_f32_16x16x64_bf16 v[40:43], v[20:23], a[208:215], v1
    v_cvt_pk_bf16_f32 v68, v36, v37
    v_smfmac_f32_16x16x64_bf16 v[40:43], v[24:27], a[216:223], v1
    v_cvt_pk_bf16_f32 v69, v38, v39
    v_smfmac_f32_16x16x64_bf16 v[44:47], v[8:11], a[240:247], v1
    v_cvt_pk_bf16_f32 v76, v72, v73
    v_smfmac_f32_16x16x64_bf16 v[44:47], v[12:15], a[248:255], v1
    v_cvt_pk_bf16_f32 v77, v74, v75
    v_smfmac_f32_16x16x64_bf16 v[44:47], v[16:19], v[120:127], v1
    ds_read_b128 v[36:39], v115 offset:0
    v_smfmac_f32_16x16x64_bf16 v[44:47], v[20:23], v[128:135], v1
    v_cvt_pk_bf16_f32 v70, v40, v41
    v_smfmac_f32_16x16x64_bf16 v[44:47], v[24:27], v[136:143], v1
    v_cvt_pk_bf16_f32 v71, v42, v43
    v_smfmac_f32_16x16x64_bf16 v[48:51], v[8:11], v[160:167], v1
    ds_read_b128 v[40:43], v115 offset:512
    v_smfmac_f32_16x16x64_bf16 v[48:51], v[12:15], v[168:175], v1
    v_mfma_f32_16x16x32_bf16 v[72:75], v[68:71], v[4:7], 0
    v_smfmac_f32_16x16x64_bf16 v[48:51], v[16:19], v[176:183], v1
    ds_read_b128 v[96:99], v114 offset:14336
    v_smfmac_f32_16x16x64_bf16 v[48:51], v[20:23], v[184:191], v1
    v_cvt_pk_bf16_f32 v68, v44, v45
    v_smfmac_f32_16x16x64_bf16 v[48:51], v[24:27], v[192:199], v1
    v_cvt_pk_bf16_f32 v69, v46, v47
    v_smfmac_f32_16x16x64_bf16 v[52:55], v[8:11], v[216:223], v1
    ds_read_b128 v[100:103], v114 offset:14848
    v_smfmac_f32_16x16x64_bf16 v[52:55], v[12:15], v[224:231], v1
    v_cvt_pk_bf16_f32 v78, v72, v73
    v_smfmac_f32_16x16x64_bf16 v[52:55], v[16:19], v[232:239], v1
    v_cvt_pk_bf16_f32 v79, v74, v75
    v_smfmac_f32_16x16x64_bf16 v[52:55], v[20:23], v[240:247], v1
    v_cvt_pk_bf16_f32 v70, v48, v49
    v_smfmac_f32_16x16x64_bf16 v[52:55], v[24:27], v[248:255], v1
    v_cvt_pk_bf16_f32 v71, v50, v51
    s_waitcnt lgkmcnt(0)
    v_smfmac_f32_16x16x64_bf16 v[56:59], v[76:79], v[80:87], v106
    v_mfma_f32_16x16x32_bf16 v[72:75], v[68:71], v[4:7], 0
    ds_read_b128 v[8:11], v115 offset:14336
    ds_read_b128 v[12:15], v115 offset:14848
    v_smfmac_f32_16x16x64_bf16 v[60:63], v[76:79], v[88:95], v106
    v_smfmac_f32_16x16x64_bf16 v[64:67], v[76:79], v[96:103], v106
    v_cvt_pk_bf16_f32 v68, v52, v53
    v_cvt_pk_bf16_f32 v69, v54, v55
    s_nop 1
    v_mfma_f32_16x16x16_bf16 v[44:47], v[68:69], v[2:3], 0
    v_cvt_pk_bf16_f32 v24, v72, v73
    v_cvt_pk_bf16_f32 v25, v74, v75
    s_nop 4
    s_waitcnt lgkmcnt(0)
    v_cvt_pk_bf16_f32 v26, v44, v45
    v_cvt_pk_bf16_f32 v27, v46, v47
    s_nop 1
    v_smfmac_f32_16x16x64_bf16 v[56:59], v[24:27], v[28:35], v106
    v_smfmac_f32_16x16x64_bf16 v[60:63], v[24:27], v[36:43], v106
    v_smfmac_f32_16x16x64_bf16 v[64:67], v[24:27], v[8:15], v106
    s_nop 5
    v_pk_add_f32 v[56:57], v[56:57], v[58:59]
    ds_write2_b32 v118, v56, v57 offset0:0 offset1:64
    v_pk_add_f32 v[60:61], v[60:61], v[62:63]
    ds_write2_b32 v117, v60, v61 offset0:0 offset1:64
    v_pk_add_f32 v[64:65], v[64:65], v[66:67]
    ds_write2_b32 v117, v64, v65 offset0:2 offset1:66
    s_waitcnt lgkmcnt(0)
    s_barrier
    ds_read_b64 v[8:9], v116 offset:0
    ds_read_b64 v[10:11], v116 offset:2048
    ds_read_b64 v[12:13], v116 offset:4096
    ds_read_b64 v[14:15], v116 offset:6144
    s_waitcnt lgkmcnt(3)
    v_pk_add_f32 v[8:9], v[8:9], v[104:105] op_sel_hi:[1,0]
    s_waitcnt lgkmcnt(2)
    v_pk_add_f32 v[8:9], v[8:9], v[10:11]
    s_waitcnt lgkmcnt(0)
    v_pk_add_f32 v[12:13], v[12:13], v[14:15]
    v_pk_add_f32 v[8:9], v[8:9], v[12:13]
    v_exp_f32 v12, v8
    v_exp_f32 v13, v9
    s_nop 0
    v_add_f32 v10, v12, v13
    s_nop 1
    v_add_f32_dpp v10, v10, v10 quad_perm:[1,0,3,2] row_mask:0xf bank_mask:0xf
    s_nop 1
    v_add_f32_dpp v10, v10, v10 quad_perm:[2,3,0,1] row_mask:0xf bank_mask:0xf
    s_nop 1
    v_add_f32_dpp v10, v10, v10 row_half_mirror row_mask:0xf bank_mask:0xf
    s_nop 1
    v_add_f32_dpp v11, v10, v10 row_mirror row_mask:0xf bank_mask:0xf
    v_add_f32_dpp v10, v10, v10 row_mirror row_mask:0xf bank_mask:0xf
    s_nop 1
    v_permlane16_swap_b32 v10, v11
    v_add_f32 v10, v10, v11
    v_rcp_f32 v14, v10
    v_subrev_u32 v10, 0x1f800000, v10
    v_pk_mul_f32 v[12:13], v[12:13], v[14:15] op_sel_hi:[1,0]
    v_cmp_le_u32 vcc, 2.0, v10
    v_cvt_pk_bf16_f32 v12, v12, v13
    s_cbranch_vccnz L_RAs_slow
L_RAs_pub:
    buffer_store_dword v12, v119, s[8:11], s22 offen sc1
    s_add_u32 s20, s20, 1
    s_cmp_ge_u32 s20, 63
    s_cbranch_scc1 L_RAs_end
    v_mov_b32 v16, -1
    s_add_u32 s28, s20, 1
    s_and_b32 s28, s28, 3
    s_lshl_b32 s28, s28, 14
    s_add_u32 s28, s28, 44597248
    buffer_store_dword v16, v119, s[8:11], s28 offen sc1
    s_add_u32 s25, s25, s41
    v_add_u32 v114, s41, v114
    v_add_u32 v115, s41, v115
    s_sub_u32 s41, 0, s41
    s_mov_b32 m0, s25
    s_nop 0
    buffer_load_dwordx4 v108, s[8:11], s24 offen offset:0 lds
    buffer_load_dwordx4 v108, s[8:11], s24 offen offset:1024 lds
    buffer_load_dwordx4 v108, s[8:11], s24 offen offset:2048 lds
    buffer_load_dwordx4 v108, s[8:11], s24 offen offset:3072 lds
    s_add_u32 m0, s25, 4096
    s_add_u32 s19, s24, 4096
    buffer_load_dwordx4 v108, s[8:11], s19 offen offset:0 lds
    buffer_load_dwordx4 v108, s[8:11], s19 offen offset:1024 lds
    buffer_load_dwordx4 v108, s[8:11], s19 offen offset:2048 lds
    s_add_u32 s24, s24, 28672
    v_mov_b64 v[28:29], 0
    v_mov_b64 v[30:31], 0
    v_mov_b64 v[32:33], 0
    v_mov_b64 v[34:35], 0
    v_mov_b64 v[36:37], 0
    v_mov_b64 v[38:39], 0
    v_mov_b64 v[40:41], 0
    v_mov_b64 v[42:43], 0
    v_mov_b64 v[44:45], 0
    v_mov_b64 v[46:47], 0
    v_mov_b64 v[48:49], 0
    v_mov_b64 v[50:51], 0
    v_mov_b64 v[52:53], 0
    v_mov_b64 v[54:55], 0
    v_mov_b64 v[56:57], 0
    v_mov_b64 v[58:59], 0
    v_mov_b64 v[60:61], 0
    v_mov_b64 v[62:63], 0
    v_mov_b64 v[64:65], 0
    v_mov_b64 v[66:67], 0
    s_and_b32 s28, s20, 3
    s_lshl_b32 s29, s28, 13
    s_add_u32 s21, s29, 44564480
    s_lshl_b32 s29, s28, 14
    s_add_u32 s22, s29, 44597248
    s_sleep 1
    s_sleep 1
    s_sleep 1
    s_sleep 1
    s_sleep 1
    s_sleep 1
    s_sleep 1
    s_sleep 1
    s_sleep 1
    s_nop 7
    s_branch L_RAs_step
L_RAs_end:
    s_or_b32 s28, s13, s12
    s_cmp_lg_u32 s28, 0
    s_cbranch_scc1 L_exit
    v_mov_b32 v8, s17
    s_mov_b32 s28, 44797952
    buffer_store_dword v8, off, s[8:11], s28
    s_branch L_exit
L_RAs_slow:
    v_max_f32 v10, v8, v9
    s_nop 1
    v_max_f32_dpp v10, v10, v10 quad_perm:[1,0,3,2] row_mask:0xf bank_mask:0xf
    s_nop 1
    v_max_f32_dpp v10, v10, v10 quad_perm:[2,3,0,1] row_mask:0xf bank_mask:0xf
    s_nop 1
    v_max_f32_dpp v10, v10, v10 row_half_mirror row_mask:0xf bank_mask:0xf
    s_nop 1
    v_max_f32_dpp v11, v10, v10 row_mirror row_mask:0xf bank_mask:0xf
    v_max_f32_dpp v10, v10, v10 row_mirror row_mask:0xf bank_mask:0xf
    s_nop 1
    v_permlane16_swap_b32 v10, v11
    v_max_f32 v10, v10, v11
    v_sub_f32 v8, v8, v10
    v_sub_f32 v9, v9, v10
    v_exp_f32 v12, v8
    v_exp_f32 v13, v9
    s_nop 0
    v_add_f32 v10, v12, v13
    s_nop 1
    v_add_f32_dpp v10, v10, v10 quad_perm:[1,0,3,2] row_mask:0xf bank_mask:0xf
    s_nop 1
    v_add_f32_dpp v10, v10, v10 quad_perm:[2,3,0,1] row_mask:0xf bank_mask:0xf
    s_nop 1
    v_add_f32_dpp v10, v10, v10 row_half_mirror row_mask:0xf bank_mask:0xf
    s_nop 1
    v_add_f32_dpp v11, v10, v10 row_mirror row_mask:0xf bank_mask:0xf
    v_add_f32_dpp v10, v10, v10 row_mirror row_mask:0xf bank_mask:0xf
    s_nop 1
    v_permlane16_swap_b32 v10, v11
    v_add_f32 v10, v10, v11
    v_rcp_f32 v14, v10
    s_nop 0
    v_pk_mul_f32 v[12:13], v[12:13], v[14:15] op_sel_hi:[1,0]
    v_cvt_pk_bf16_f32 v12, v12, v13
    v_pk_min_u16 v12, v12, s40
    s_branch L_RAs_pub
L_RBs:
    s_lshl_b32 s30, s12, 1
    s_add_u32 s30, s30, 1
    v_and_b32 v5, 31, v0
    v_lshlrev_b32 v5, 5, v5
    s_lshl_b32 s30, s30, 2
    s_add_u32 s30, s30, 44793856
L_wf_57:
    buffer_load_dword v4, v5, s[8:11], s30 offen offset:0 sc1
    s_sub_u32 s26, s26, 1
    s_cbranch_scc1 L_fail
    s_waitcnt vmcnt(0)
    v_cmp_ne_u32 vcc, s17, v4
    s_cbranch_vccz L_wfd_58
    s_sleep 4
    s_branch L_wf_57
L_wfd_58:
    v_and_b32 v4, 63, v0
    v_lshrrev_b32 v5, 4, v4
    v_and_b32 v6, 15, v4
    s_sub_u32 s27, s13, 16
    v_lshlrev_b32 v154, 4, v4
    s_lshl_b32 s30, s12, 2
    s_lshr_b32 s44, 21536, s30
    s_and_b32 s44, s44, 15
    s_lshl_b32 s44, s44, 11
    s_lshr_b32 s45, 25905, s30
    s_and_b32 s45, s45, 15
    s_lshl_b32 s45, s45, 11
    s_lshr_b32 s46, 2, s30
    s_and_b32 s46, s46, 15
    s_lshl_b32 s46, s46, 11
    s_lshr_b32 s47, 4371, s30
    s_and_b32 s47, s47, 15
    s_lshl_b32 s47, s47, 11
    s_lshr_b32 s48, 8772, s30
    s_and_b32 s48, s48, 15
    s_lshl_b32 s48, s48, 11
    s_lshr_b32 s49, 13141, s30
    s_and_b32 s49, s49, 15
    s_lshl_b32 s49, s49, 11
    s_lshr_b32 s50, 18022, s30
    s_and_b32 s50, s50, 15
    s_lshl_b32 s50, s50, 11
    s_lshr_b32 s29, s46, 1
    v_add_u32 v164, s29, v154
    s_lshr_b32 s29, s48, 1
    v_add_u32 v165, s29, v154
    s_lshr_b32 s29, s50, 1
    v_add_u32 v166, s29, v154
    s_mul_i32 s28, s27, 458752
    s_mul_i32 s29, s12, 114688
    s_add_u32 s28, s28, s29
    s_add_u32 s28, s28, 6422528
    s_mul_i32 s30, s12, 28672
    s_add_u32 s30, s30, 16384
    v_add_u32 v162, s30, v154
    s_add_u32 s29, s28, s44
    buffer_load_dwordx4 a[0:3], v154, s[8:11], s29 offen offset:0
    buffer_load_dwordx4 a[4:7], v154, s[8:11], s29 offen offset:1024
    s_add_u32 s29, s28, s45
    buffer_load_dwordx4 a[8:11], v154, s[8:11], s29 offen offset:0
    buffer_load_dwordx4 a[12:15], v154, s[8:11], s29 offen offset:1024
    s_add_u32 s29, s28, s46
    buffer_load_dwordx4 a[16:19], v154, s[8:11], s29 offen offset:0
    buffer_load_dwordx4 a[20:23], v154, s[8:11], s29 offen offset:1024
    s_add_u32 s29, s28, s47
    buffer_load_dwordx4 a[24:27], v154, s[8:11], s29 offen offset:0
    buffer_load_dwordx4 a[28:31], v154, s[8:11], s29 offen offset:1024
    s_add_u32 s29, s28, s48
    buffer_load_dwordx4 a[32:35], v154, s[8:11], s29 offen offset:0
    buffer_load_dwordx4 a[36:39], v154, s[8:11], s29 offen offset:1024
    s_add_u32 s29, s28, s49
    buffer_load_dwordx4 v[240:243], v154, s[8:11], s29 offen offset:0
    buffer_load_dwordx4 v[244:247], v154, s[8:11], s29 offen offset:1024
    s_add_u32 s29, s28, s50
    s_add_u32 m0, s30, 0
    s_nop 0
    buffer_load_dwordx4 v154, s[8:11], s29 offen offset:0  lds
    buffer_load_dwordx4 v154, s[8:11], s29 offen offset:1024  lds
    s_add_u32 s28, s28, 14336
    s_add_u32 s29, s28, s44
    buffer_load_dwordx4 a[40:43], v154, s[8:11], s29 offen offset:0
    buffer_load_dwordx4 a[44:47], v154, s[8:11], s29 offen offset:1024
    s_add_u32 s29, s28, s45
    buffer_load_dwordx4 a[48:51], v154, s[8:11], s29 offen offset:0
    buffer_load_dwordx4 a[52:55], v154, s[8:11], s29 offen offset:1024
    s_add_u32 s29, s28, s46
    buffer_load_dwordx4 a[56:59], v154, s[8:11], s29 offen offset:0
    buffer_load_dwordx4 a[60:63], v154, s[8:11], s29 offen offset:1024
    s_add_u32 s29, s28, s47
    buffer_load_dwordx4 a[64:67], v154, s[8:11], s29 offen offset:0
    buffer_load_dwordx4 a[68:71], v154, s[8:11], s29 offen offset:1024
    s_add_u32 s29, s28, s48
    buffer_load_dwordx4 a[72:75], v154, s[8:11], s29 offen offset:0
    buffer_load_dwordx4 a[76:79], v154, s[8:11], s29 offen offset:1024
    s_add_u32 s29, s28, s49
    buffer_load_dwordx4 v[248:251], v154, s[8:11], s29 offen offset:0
    buffer_load_dwordx4 v[252:255], v154, s[8:11], s29 offen offset:1024
    s_add_u32 s29, s28, s50
    s_add_u32 m0, s30, 2048
    s_nop 0
    buffer_load_dwordx4 v154, s[8:11], s29 offen offset:0  lds
    buffer_load_dwordx4 v154, s[8:11], s29 offen offset:1024  lds
    s_add_u32 s28, s28, 14336
    s_add_u32 s29, s28, s44
    buffer_load_dwordx4 a[80:83], v154, s[8:11], s29 offen offset:0
    buffer_load_dwordx4 a[84:87], v154, s[8:11], s29 offen offset:1024
    s_add_u32 s29, s28, s45
    buffer_load_dwordx4 a[88:91], v154, s[8:11], s29 offen offset:0
    buffer_load_dwordx4 a[92:95], v154, s[8:11], s29 offen offset:1024
    s_add_u32 s29, s28, s46
    buffer_load_dwordx4 a[96:99], v154, s[8:11], s29 offen offset:0
    buffer_load_dwordx4 a[100:103], v154, s[8:11], s29 offen offset:1024
    s_add_u32 s29, s28, s47
    buffer_load_dwordx4 a[104:107], v154, s[8:11], s29 offen offset:0
    buffer_load_dwordx4 a[108:111], v154, s[8:11], s29 offen offset:1024
    s_add_u32 s29, s28, s48
    buffer_load_dwordx4 a[112:115], v154, s[8:11], s29 offen offset:0
    buffer_load_dwordx4 a[116:119], v154, s[8:11], s29 offen offset:1024
    s_add_u32 s29, s28, s49
    s_add_u32 m0, s30, 4096
    s_nop 0
    buffer_load_dwordx4 v154, s[8:11], s29 offen offset:0  lds
    buffer_load_dwordx4 v154, s[8:11], s29 offen offset:1024  lds
    s_add_u32 s29, s28, s50
    s_add_u32 m0, s30, 6144
    s_nop 0
    buffer_load_dwordx4 v154, s[8:11], s29 offen offset:0  lds
    buffer_load_dwordx4 v154, s[8:11], s29 offen offset:1024  lds
    s_add_u32 s28, s28, 14336
    s_waitcnt vmcnt(32)
    s_add_u32 s29, s28, s44
    buffer_load_dwordx4 a[120:123], v154, s[8:11], s29 offen offset:0
    buffer_load_dwordx4 a[124:127], v154, s[8:11], s29 offen offset:1024
    s_add_u32 s29, s28, s45
    buffer_load_dwordx4 a[128:131], v154, s[8:11], s29 offen offset:0
    buffer_load_dwordx4 a[132:135], v154, s[8:11], s29 offen offset:1024
    s_add_u32 s29, s28, s46
    buffer_load_dwordx4 a[136:139], v154, s[8:11], s29 offen offset:0
    buffer_load_dwordx4 a[140:143], v154, s[8:11], s29 offen offset:1024
    s_add_u32 s29, s28, s47
    buffer_load_dwordx4 a[144:147], v154, s[8:11], s29 offen offset:0
    buffer_load_dwordx4 a[148:151], v154, s[8:11], s29 offen offset:1024
    s_add_u32 s29, s28, s48
    buffer_load_dwordx4 a[152:155], v154, s[8:11], s29 offen offset:0
    buffer_load_dwordx4 a[156:159], v154, s[8:11], s29 offen offset:1024
    s_add_u32 s29, s28, s49
    s_add_u32 m0, s30, 8192
    s_nop 0
    buffer_load_dwordx4 v154, s[8:11], s29 offen offset:0  lds
    buffer_load_dwordx4 v154, s[8:11], s29 offen offset:1024  lds
    s_add_u32 s29, s28, s50
    s_add_u32 m0, s30, 10240
    s_nop 0
    buffer_load_dwordx4 v154, s[8:11], s29 offen offset:0  lds
    buffer_load_dwordx4 v154, s[8:11], s29 offen offset:1024  lds
    s_add_u32 s28, s28, 14336
    s_waitcnt vmcnt(32)
    s_add_u32 s29, s28, s44
    buffer_load_dwordx4 a[160:163], v154, s[8:11], s29 offen offset:0
    buffer_load_dwordx4 a[164:167], v154, s[8:11], s29 offen offset:1024
    s_add_u32 s29, s28, s45
    buffer_load_dwordx4 a[168:171], v154, s[8:11], s29 offen offset:0
    buffer_load_dwordx4 a[172:175], v154, s[8:11], s29 offen offset:1024
    s_add_u32 s29, s28, s46
    buffer_load_dwordx4 a[176:179], v154, s[8:11], s29 offen offset:0
    buffer_load_dwordx4 a[180:183], v154, s[8:11], s29 offen offset:1024
    s_add_u32 s29, s28, s47
    buffer_load_dwordx4 a[184:187], v154, s[8:11], s29 offen offset:0
    buffer_load_dwordx4 a[188:191], v154, s[8:11], s29 offen offset:1024
    s_add_u32 s29, s28, s48
    buffer_load_dwordx4 a[192:195], v154, s[8:11], s29 offen offset:0
    buffer_load_dwordx4 a[196:199], v154, s[8:11], s29 offen offset:1024
    s_add_u32 s29, s28, s49
    s_add_u32 m0, s30, 12288
    s_nop 0
    buffer_load_dwordx4 v154, s[8:11], s29 offen offset:0  lds
    buffer_load_dwordx4 v154, s[8:11], s29 offen offset:1024  lds
    s_add_u32 s29, s28, s50
    s_add_u32 m0, s30, 14336
    s_nop 0
    buffer_load_dwordx4 v154, s[8:11], s29 offen offset:0  lds
    buffer_load_dwordx4 v154, s[8:11], s29 offen offset:1024  lds
    s_add_u32 s28, s28, 14336
    s_waitcnt vmcnt(32)
    v_and_b32 v120, 15, v0
    v_and_b32 v121, 7, v120
    v_lshlrev_b32 v121, 5, v121
    v_lshrrev_b32 v122, 3, v120
    v_cmp_gt_u32 vcc, 8, v120
    v_lshl_add_u32 v121, v122, 2, v121
    v_and_b32 v122, 63, v0
    v_cndmask_b32 v120, 0, 32, vcc
    v_lshlrev_b32 v123, 3, v122
    v_lshlrev_b32 v122, 4, v122
    buffer_load_dword v118, v121, s[84:87], 0 offen sc1
    s_mov_b32 s18, 44793856
    buffer_load_dwordx4 v[112:115], v122, s[8:11], s18 offen sc1
    s_mov_b32 s18, 44796416
    buffer_load_dwordx2 v[116:117], v123, s[8:11], s18 offen sc1
    s_add_u32 s29, s28, s44
    buffer_load_dwordx4 a[200:203], v154, s[8:11], s29 offen offset:0
    buffer_load_dwordx4 a[204:207], v154, s[8:11], s29 offen offset:1024
    s_add_u32 s29, s28, s45
    buffer_load_dwordx4 a[208:211], v154, s[8:11], s29 offen offset:0
    buffer_load_dwordx4 a[212:215], v154, s[8:11], s29 offen offset:1024
    s_add_u32 s29, s28, s46
    buffer_load_dwordx4 a[216:219], v154, s[8:11], s29 offen offset:0
    buffer_load_dwordx4 a[220:223], v154, s[8:11], s29 offen offset:1024
    s_add_u32 s29, s28, s47
    buffer_load_dwordx4 a[224:227], v154, s[8:11], s29 offen offset:0
    buffer_load_dwordx4 a[228:231], v154, s[8:11], s29 offen offset:1024
    s_add_u32 s29, s28, s48
    buffer_load_dwordx4 a[232:235], v154, s[8:11], s29 offen offset:0
    buffer_load_dwordx4 a[236:239], v154, s[8:11], s29 offen offset:1024
    s_add_u32 s29, s28, s49
    s_add_u32 m0, s30, 16384
    s_nop 0
    buffer_load_dwordx4 v154, s[8:11], s29 offen offset:0  lds
    buffer_load_dwordx4 v154, s[8:11], s29 offen offset:1024  lds
    s_add_u32 s29, s28, s50
    s_add_u32 m0, s30, 18432
    s_nop 0
    buffer_load_dwordx4 v154, s[8:11], s29 offen offset:0  lds
    buffer_load_dwordx4 v154, s[8:11], s29 offen offset:1024  lds
    s_add_u32 s28, s28, 14336
    s_waitcnt vmcnt(32)
    s_waitcnt vmcnt(14)
    v_xor_b32 v112, s17, v112
    v_xor_b32 v113, s17, v113
    v_xor_b32 v114, s17, v114
    v_xor_b32 v115, s17, v115
    v_xor_b32 v118, v118, v120
    s_cmp_eq_u32 s15, 0
    s_cselect_b32 s18, -1, 0
    v_and_b32 v118, s18, v118
    v_or3_b32 v112, v112, v113, v114
    v_or3_b32 v112, v112, v115, v118
    v_cmp_ne_u32 vcc, 0, v112
    s_cmp_eq_u64 vcc, 0
    s_cselect_b32 s18, 1, 0
    s_add_u32 s29, s28, s44
    buffer_load_dwordx4 a[240:243], v154, s[8:11], s29 offen offset:0
    buffer_load_dwordx4 a[244:247], v154, s[8:11], s29 offen offset:1024
    s_add_u32 s29, s28, s45
    buffer_load_dwordx4 a[248:251], v154, s[8:11], s29 offen offset:0
    buffer_load_dwordx4 a[252:255], v154, s[8:11], s29 offen offset:1024
    s_add_u32 s29, s28, s46
    buffer_load_dwordx4 v[176:179], v154, s[8:11], s29 offen offset:0
    buffer_load_dwordx4 v[180:183], v154, s[8:11], s29 offen offset:1024
    s_add_u32 s29, s28, s47
    buffer_load_dwordx4 v[184:187], v154, s[8:11], s29 offen offset:0
    buffer_load_dwordx4 v[188:191], v154, s[8:11], s29 offen offset:1024
    s_add_u32 s29, s28, s48
    buffer_load_dwordx4 v[192:195], v154, s[8:11], s29 offen offset:0
    buffer_load_dwordx4 v[196:199], v154, s[8:11], s29 offen offset:1024
    s_add_u32 s29, s28, s49
    s_add_u32 m0, s30, 20480
    s_nop 0
    buffer_load_dwordx4 v154, s[8:11], s29 offen offset:0  lds
    buffer_load_dwordx4 v154, s[8:11], s29 offen offset:1024  lds
    s_add_u32 s29, s28, s50
    s_add_u32 m0, s30, 22528
    s_nop 0
    buffer_load_dwordx4 v154, s[8:11], s29 offen offset:0  lds
    buffer_load_dwordx4 v154, s[8:11], s29 offen offset:1024  lds
    s_add_u32 s28, s28, 14336
    s_waitcnt vmcnt(32)
    s_add_u32 s29, s28, s44
    buffer_load_dwordx4 v[200:203], v154, s[8:11], s29 offen offset:0
    buffer_load_dwordx4 v[204:207], v154, s[8:11], s29 offen offset:1024
    s_add_u32 s29, s28, s45
    buffer_load_dwordx4 v[208:211], v154, s[8:11], s29 offen offset:0
    buffer_load_dwordx4 v[212:215], v154, s[8:11], s29 offen offset:1024
    s_add_u32 s29, s28, s46
    buffer_load_dwordx4 v[216:219], v154, s[8:11], s29 offen offset:0
    buffer_load_dwordx4 v[220:223], v154, s[8:11], s29 offen offset:1024
    s_add_u32 s29, s28, s47
    buffer_load_dwordx4 v[224:227], v154, s[8:11], s29 offen offset:0
    buffer_load_dwordx4 v[228:231], v154, s[8:11], s29 offen offset:1024
    s_add_u32 s29, s28, s48
    buffer_load_dwordx4 v[232:235], v154, s[8:11], s29 offen offset:0
    buffer_load_dwordx4 v[236:239], v154, s[8:11], s29 offen offset:1024
    s_add_u32 s29, s28, s49
    s_add_u32 m0, s30, 24576
    s_nop 0
    buffer_load_dwordx4 v154, s[8:11], s29 offen offset:0  lds
    buffer_load_dwordx4 v154, s[8:11], s29 offen offset:1024  lds
    s_add_u32 s29, s28, s50
    s_add_u32 m0, s30, 26624
    s_nop 0
    buffer_load_dwordx4 v154, s[8:11], s29 offen offset:0  lds
    buffer_load_dwordx4 v154, s[8:11], s29 offen offset:1024  lds
    s_add_u32 s28, s28, 14336
    s_waitcnt vmcnt(32)
    s_lshl_b32 s28, s27, 7
    s_lshl_b32 s29, s12, 4
    s_add_u32 s28, s28, s29
    s_add_u32 s28, s28, 44744704
    v_and_b32 v7, 3, v4
    v_lshlrev_b32 v7, 2, v7
    v_add_u32 v168, s28, v7
    s_lshr_b32 s28, s27, 2
    s_lshl_b32 s29, s28, 2
    s_min_u32 s29, s29, 10
    s_sub_u32 s29, s27, s29
    s_lshl_b32 s29, s29, 4
    s_lshl_b32 s28, s28, 6
    s_add_u32 s28, s28, s29
    s_sub_u32 s29, s27, 10
    s_lshl_b32 s30, s29, 4
    s_add_u32 s30, s30, 192
    s_cmp_lt_u32 s29, 2
    s_cselect_b32 s30, s30, 1073741824
    v_mov_b32 v7, s28
    v_mov_b32 v8, s30
    v_mov_b32 v9, 1073741824
    v_cmp_eq_u32 vcc, 1, v5
    s_nop 1
    v_cndmask_b32 v7, v7, v8, vcc
    v_cmp_lt_u32 vcc, 1, v5
    s_nop 1
    v_cndmask_b32 v7, v7, v9, vcc
    v_lshl_add_u32 v7, v6, 8, v7
    s_lshl_b32 s28, s12, 2
    s_add_u32 s28, s28, 44746496
    v_add_u32 v169, s28, v7
    v_mov_b32 v1, 0x4444
    v_mov_b32 v7, 0xeeee
    v_cmp_lt_u32 vcc, 7, v6
    s_nop 1
    v_cndmask_b32 v1, v1, v7, vcc
    v_mov_b32 v167, 0x4444
    v_and_b32 v8, 2, v6
    v_cmp_ne_u32 vcc, 0, v8
    s_nop 1
    v_cndmask_b32 v167, v167, v7, vcc
    s_lshl_b32 s28, s12, 11
    v_add_u32 v156, s28, v154
    s_min_u32 s28, s28, 5120
    v_add_u32 v155, s28, v154
    v_lshrrev_b32 v7, 1, v5
    v_lshlrev_b32 v7, 8, v7
    v_lshl_add_u32 v7, v6, 4, v7
    s_lshl_b32 s28, s12, 9
    s_add_u32 s28, s28, 8192
    v_add_u32 v157, s28, v7
    s_mul_i32 s28, s12, 1792
    s_add_u32 s28, s28, 8192
    v_mul_u32_u24 v158, 192, v5
    v_lshl_add_u32 v163, v6, 3, v158
    v_add_u32 v163, s28, v163
    v_bfe_u32 v8, v4, 3, 1
    v_lshl_add_u32 v158, v8, 2, v158
    v_bfe_u32 v8, v4, 2, 1
    v_lshl_add_u32 v158, v8, 5, v158
    v_bfe_u32 v8, v4, 0, 1
    v_lshl_add_u32 v158, v8, 3, v158
    v_bfe_u32 v8, v4, 1, 1
    v_mul_u32_u24 v8, 784, v8
    v_add_u32 v158, v8, v158
    s_lshr_b32 s28, s12, 1
    s_lshl_b32 s28, s28, 6
    s_and_b32 s29, s12, 1
    s_lshl_b32 s29, s29, 4
    s_add_u32 s28, s28, s29
    s_add_u32 s28, s28, 8192
    v_add_u32 v158, s28, v158
    s_lshl_b32 s28, s12, 7
    s_lshl_b32 s29, s27, 9
    s_add_u32 s28, s28, s29
    v_lshlrev_b32 v159, 1, v4
    v_add_u32 v159, s28, v159
    v_add_u32 v160, s29, v154
    v_mov_b32 v7, 1073741824
    v_cmp_gt_u32 vcc, 32, v4
    s_cmp_eq_u32 s12, 0
    s_cselect_b64 vcc, vcc, 0
    s_nop 1
    v_cndmask_b32 v160, v7, v160, vcc
    s_lshl_b32 s28, s27, 2
    s_add_u32 s28, s28, s12
    s_lshl_b32 s29, s28, 3
    v_and_b32 v161, 1, v4
    v_lshlrev_b32 v161, 2, v161
    v_add_u32 v161, s29, v161
    s_lshl_b32 s23, s28, 13
    s_add_u32 s23, s23, 14680064
    s_mov_b32 s24, 44662784
    s_mov_b32 s25, 44040192
    s_mov_b32 s20, 0
    s_mov_b32 s21, 44564480
    s_mov_b32 s22, 44597248
    s_mov_b32 s26, 1048576
    s_mov_b32 s40, 0xfffefffe
    s_mov_b32 s36, 16
    v_mov_b32 v153, 0
    s_add_u32 s32, s23, 4096
    s_mov_b32 s33, 44580864
    v_mov_b32 v148, -1
    v_mov_b32 v149, -1
    v_mov_b32 v150, -1
    v_mov_b32 v151, -1
    v_mov_b64 v[24:25], 0
    v_mov_b64 v[26:27], 0
    v_mov_b64 v[28:29], 0
    v_mov_b64 v[30:31], 0
    v_mov_b64 v[32:33], 0
    v_mov_b64 v[34:35], 0
    v_mov_b64 v[36:37], 0
    v_mov_b64 v[38:39], 0
    v_mov_b64 v[40:41], 0
    v_mov_b64 v[42:43], 0
    v_mov_b64 v[44:45], 0
    v_mov_b64 v[46:47], 0
    v_mov_b64 v[48:49], 0
    v_mov_b64 v[50:51], 0
    v_mov_b64 v[52:53], 0
    v_mov_b64 v[54:55], 0
    v_mov_b64 v[104:105], 0
    v_mov_b64 v[106:107], 0
    v_mov_b64 v[108:109], 0
    v_mov_b64 v[110:111], 0
    s_cmp_eq_u32 s18, 1
    s_cbranch_scc1 L_RBs_ready
    s_cmp_lg_u32 s15, 0
    s_cbranch_scc1 L_ver_59_ok
    v_and_b32 v4, 15, v0
    v_and_b32 v5, 7, v4
    v_lshlrev_b32 v5, 5, v5
    v_lshrrev_b32 v6, 3, v4
    v_cmp_gt_u32 vcc, 8, v4
    v_lshl_add_u32 v5, v6, 2, v5
    s_nop 0
    v_cndmask_b32 v4, 0, 32, vcc
L_ver_59:
    buffer_load_dword v6, v5, s[84:87], 0 offen sc1
    s_sub_u32 s26, s26, 1
    s_cbranch_scc1 L_fail
    s_waitcnt vmcnt(0)
    v_cmp_gt_u32 vcc, v6, v4
    s_cbranch_vccnz L_irregular
    v_cmp_ne_u32 vcc, v6, v4
    s_cbranch_vccnz L_ver_59
L_ver_59_ok:
    v_and_b32 v8, 63, v0
    v_lshlrev_b32 v8, 4, v8
    s_mov_b32 s30, 44793856
L_qs_60:
    buffer_load_dwordx4 v[4:7], v8, s[8:11], s30 offen sc1
    s_sub_u32 s26, s26, 1
    s_cbranch_scc1 L_fail
    s_waitcnt vmcnt(0)
    v_xor_b32 v4, s17, v4
    v_xor_b32 v5, s17, v5
    v_xor_b32 v6, s17, v6
    v_xor_b32 v7, s17, v7
    v_or3_b32 v4, v4, v5, v6
    v_or_b32 v4, v4, v7
    v_cmp_ne_u32 vcc, 0, v4
    s_cbranch_vccnz L_qs_60
L_RBs_ready:
    s_waitcnt vmcnt(0)
    ds_read_b128 v[112:115], v162 offset:0
    ds_read_b128 v[116:119], v162 offset:1024
    ds_read_b128 v[120:123], v162 offset:2048
    ds_read_b128 v[124:127], v162 offset:3072
    ds_read_b128 v[128:131], v162 offset:4096
    ds_read_b128 v[132:135], v162 offset:5120
    ds_read_b128 v[136:139], v162 offset:6144
    ds_read_b128 v[140:143], v162 offset:7168
.p2align 6
    s_nop 0
    s_nop 0
L_RBs_step:
    v_cmp_eq_u32 vcc, 0, v153
    s_cbranch_vccz L_RBs_vok
L_RBs_vspin:
    buffer_load_dword v153, v161, s[8:11], s24 offen sc1
    s_sub_u32 s26, s26, 1
    s_cbranch_scc1 L_fail
    s_waitcnt vmcnt(0)
    v_cmp_eq_u32 vcc, 0, v153
    s_cbranch_vccnz L_RBs_vspin
L_RBs_vok:
    s_sleep 1
L_RBs_pm_loop:
    buffer_load_dwordx4 v[56:59], v155, s[8:11], s21 offen offset:0 sc1
    buffer_load_dwordx4 v[60:63], v155, s[8:11], s21 offen offset:1024 sc1
    s_sub_u32 s26, s26, 1
    s_cbranch_scc1 L_fail
    s_waitcnt vmcnt(0)
    v_pk_max_u16 v4, v56, v57
    v_pk_max_u16 v4, v4, v58
    v_pk_max_u16 v4, v4, v59
    v_pk_max_u16 v4, v4, v60
    v_pk_max_u16 v4, v4, v61
    v_pk_max_u16 v4, v4, v62
    v_pk_max_u16 v4, v4, v63
    v_lshlrev_b32 v5, 16, v4
    v_max_u32 v4, v4, v5
    v_cmp_le_u32 vcc, 0xffff0000, v4
    s_cbranch_vccnz L_RBs_pm_loop
L_RBs_pm_ok0:
    s_cmp_lg_u32 s27, 0
    s_cbranch_scc1 L_nopub_61
    buffer_store_dwordx4 v[56:59], v155, s[8:11], s25 offen sc1
    buffer_store_dwordx4 v[60:63], v155, s[8:11], s25 offen offset:1024 sc1
    s_cmp_lg_u32 s20, 0
    s_cbranch_scc1 L_nopub_61
    v_mov_b32 v152, s17
    s_mov_b32 s30, 44797440
    buffer_store_dword v152, off, s[8:11], s30 sc1
L_nopub_61:
    v_smfmac_f32_16x16x64_bf16 v[24:27], v[56:59], a[0:7], v1
    ds_write_b128 v155, v[56:59] offset:0
    v_smfmac_f32_16x16x64_bf16 v[28:31], v[56:59], a[40:47], v1
    ds_write_b128 v155, v[60:63] offset:1024
    v_smfmac_f32_16x16x64_bf16 v[32:35], v[56:59], a[80:87], v1
    buffer_load_dwordx4 v[72:75], v154, s[8:11], s23 offen offset:0 sc1
    v_smfmac_f32_16x16x64_bf16 v[36:39], v[56:59], a[120:127], v1
    v_smfmac_f32_16x16x64_bf16 v[40:43], v[56:59], a[160:167], v1
    buffer_load_dwordx4 v[80:83], v154, s[8:11], s23 offen offset:1024 sc1
    v_smfmac_f32_16x16x64_bf16 v[44:47], v[56:59], a[200:207], v1
    v_smfmac_f32_16x16x64_bf16 v[48:51], v[56:59], a[240:247], v1
    buffer_load_dwordx4 v[76:79], v154, s[8:11], s23 offen offset:2048 sc1
    v_smfmac_f32_16x16x64_bf16 v[52:55], v[56:59], v[200:207], v1
    v_smfmac_f32_16x16x64_bf16 v[24:27], v[60:63], a[8:15], v1
    buffer_load_dwordx4 v[84:87], v154, s[8:11], s23 offen offset:3072 sc1
    v_smfmac_f32_16x16x64_bf16 v[28:31], v[60:63], a[48:55], v1
    s_waitcnt lgkmcnt(0)
    v_smfmac_f32_16x16x64_bf16 v[32:35], v[60:63], a[88:95], v1
    s_barrier
    v_smfmac_f32_16x16x64_bf16 v[36:39], v[60:63], a[128:135], v1
    ds_read_b128 v[4:7], v164 offset:0
    v_smfmac_f32_16x16x64_bf16 v[40:43], v[60:63], a[168:175], v1
    ds_read_b128 v[8:11], v164 offset:1024
    v_smfmac_f32_16x16x64_bf16 v[44:47], v[60:63], a[208:215], v1
    ds_read_b128 v[12:15], v165 offset:0
    v_smfmac_f32_16x16x64_bf16 v[48:51], v[60:63], a[248:255], v1
    ds_read_b128 v[16:19], v165 offset:1024
    v_smfmac_f32_16x16x64_bf16 v[52:55], v[60:63], v[208:215], v1
    ds_read_b128 v[20:23], v166 offset:0
L_RBs_pm_done:
    s_waitcnt lgkmcnt(4)
    v_smfmac_f32_16x16x64_bf16 v[24:27], v[4:7], a[16:23], v1
    s_waitcnt lgkmcnt(3)
    v_smfmac_f32_16x16x64_bf16 v[24:27], v[8:11], a[24:31], v1
    buffer_load_dwordx4 v[88:91], v154, s[8:11], s32 offen offset:0 sc1
    s_waitcnt lgkmcnt(2)
    v_smfmac_f32_16x16x64_bf16 v[24:27], v[12:15], a[32:39], v1
    s_waitcnt lgkmcnt(1)
    v_smfmac_f32_16x16x64_bf16 v[24:27], v[16:19], v[240:247], v1
    buffer_load_dwordx4 v[96:99], v154, s[8:11], s32 offen offset:1024 sc1
    s_waitcnt lgkmcnt(0)
    v_smfmac_f32_16x16x64_bf16 v[24:27], v[20:23], v[112:119], v1
    ds_read_b128 v[112:115], v162 offset:8192
    v_smfmac_f32_16x16x64_bf16 v[28:31], v[4:7], a[56:63], v1
    ds_read_b128 v[116:119], v162 offset:9216
    v_smfmac_f32_16x16x64_bf16 v[28:31], v[8:11], a[64:71], v1
    buffer_load_dwordx4 v[92:95], v154, s[8:11], s32 offen offset:2048 sc1
    v_smfmac_f32_16x16x64_bf16 v[28:31], v[12:15], a[72:79], v1
    v_smfmac_f32_16x16x64_bf16 v[28:31], v[16:19], v[248:255], v1
    buffer_load_dwordx4 v[100:103], v154, s[8:11], s32 offen offset:3072 sc1
    v_smfmac_f32_16x16x64_bf16 v[28:31], v[20:23], v[120:127], v1
    ds_read_b128 v[120:123], v162 offset:10240
    v_smfmac_f32_16x16x64_bf16 v[32:35], v[4:7], a[96:103], v1
    ds_read_b128 v[124:127], v162 offset:11264
    v_cvt_pk_bf16_f32 v56, v24, v25
    v_smfmac_f32_16x16x64_bf16 v[32:35], v[8:11], a[104:111], v1
    v_cvt_pk_bf16_f32 v58, v26, v27
    v_smfmac_f32_16x16x64_bf16 v[32:35], v[12:15], a[112:119], v1
    buffer_load_dword v153, v161, s[8:11], s24 offen offset:512 sc1
    v_smfmac_f32_16x16x64_bf16 v[32:35], v[16:19], v[128:135], v1
    ds_read_b128 v[128:131], v162 offset:12288
    v_smfmac_f32_16x16x64_bf16 v[32:35], v[20:23], v[136:143], v1
    ds_read_b128 v[132:135], v162 offset:13312
    ds_read_b128 v[136:139], v162 offset:14336
    v_smfmac_f32_16x16x64_bf16 v[36:39], v[4:7], a[136:143], v1
    ds_read_b128 v[140:143], v162 offset:15360
    buffer_store_dwordx4 v[148:151], v160, s[8:11], s33 offen sc1
    v_smfmac_f32_16x16x64_bf16 v[36:39], v[8:11], a[144:151], v1
    v_cvt_pk_bf16_f32 v64, v28, v29
    v_smfmac_f32_16x16x64_bf16 v[36:39], v[12:15], a[152:159], v1
    v_cvt_pk_bf16_f32 v66, v30, v31
    s_waitcnt lgkmcnt(6)
    v_smfmac_f32_16x16x64_bf16 v[36:39], v[16:19], v[112:119], v1
    ds_read_b128 v[112:115], v162 offset:16384
    s_waitcnt lgkmcnt(5)
    v_smfmac_f32_16x16x64_bf16 v[36:39], v[20:23], v[120:127], v1
    ds_read_b128 v[116:119], v162 offset:17408
    ds_read_b128 v[120:123], v162 offset:18432
    v_smfmac_f32_16x16x64_bf16 v[40:43], v[4:7], a[176:183], v1
    ds_read_b128 v[124:127], v162 offset:19456
    v_smfmac_f32_16x16x64_bf16 v[40:43], v[8:11], a[184:191], v1
    v_cvt_pk_bf16_f32 v57, v32, v33
    v_smfmac_f32_16x16x64_bf16 v[40:43], v[12:15], a[192:199], v1
    v_cvt_pk_bf16_f32 v59, v34, v35
    s_waitcnt lgkmcnt(6)
    v_smfmac_f32_16x16x64_bf16 v[40:43], v[16:19], v[128:135], v1
    ds_read_b128 v[128:131], v162 offset:20480
    s_waitcnt lgkmcnt(5)
    v_smfmac_f32_16x16x64_bf16 v[40:43], v[20:23], v[136:143], v1
    ds_read_b128 v[132:135], v162 offset:21504
    ds_read_b128 v[136:139], v162 offset:22528
    v_smfmac_f32_16x16x64_bf16 v[44:47], v[4:7], a[216:223], v1
    ds_read_b128 v[140:143], v162 offset:23552
    v_smfmac_f32_16x16x64_bf16 v[44:47], v[8:11], a[224:231], v1
    v_cvt_pk_bf16_f32 v65, v36, v37
    v_smfmac_f32_16x16x64_bf16 v[44:47], v[12:15], a[232:239], v1
    v_cvt_pk_bf16_f32 v67, v38, v39
    s_waitcnt lgkmcnt(6)
    v_smfmac_f32_16x16x64_bf16 v[44:47], v[16:19], v[112:119], v1
    ds_read_b128 v[112:115], v162 offset:24576
    s_waitcnt lgkmcnt(5)
    v_smfmac_f32_16x16x64_bf16 v[44:47], v[20:23], v[120:127], v1
    ds_read_b128 v[116:119], v162 offset:25600
    ds_read_b128 v[120:123], v162 offset:26624
    v_smfmac_f32_16x16x64_bf16 v[48:51], v[4:7], v[176:183], v1
    ds_read_b128 v[124:127], v162 offset:27648
    v_smfmac_f32_16x16x64_bf16 v[48:51], v[8:11], v[184:191], v1
    v_cvt_pk_bf16_f32 v60, v40, v41
    v_smfmac_f32_16x16x64_bf16 v[48:51], v[12:15], v[192:199], v1
    v_cvt_pk_bf16_f32 v62, v42, v43
    s_waitcnt lgkmcnt(6)
    v_smfmac_f32_16x16x64_bf16 v[48:51], v[16:19], v[128:135], v1
    s_waitcnt lgkmcnt(4)
    v_smfmac_f32_16x16x64_bf16 v[48:51], v[20:23], v[136:143], v1
    v_smfmac_f32_16x16x64_bf16 v[52:55], v[4:7], v[216:223], v1
    v_smfmac_f32_16x16x64_bf16 v[52:55], v[8:11], v[224:231], v1
    v_cvt_pk_bf16_f32 v68, v44, v45
    v_smfmac_f32_16x16x64_bf16 v[52:55], v[12:15], v[232:239], v1
    v_cvt_pk_bf16_f32 v70, v46, v47
    s_waitcnt lgkmcnt(2)
    v_smfmac_f32_16x16x64_bf16 v[52:55], v[16:19], v[112:119], v1
    s_waitcnt lgkmcnt(0)
    v_smfmac_f32_16x16x64_bf16 v[52:55], v[20:23], v[120:127], v1
    v_cvt_pk_bf16_f32 v61, v48, v49
    v_cvt_pk_bf16_f32 v63, v50, v51
    s_add_u32 s20, s20, 1
    s_and_b32 s28, s20, 3
    s_lshl_b32 s29, s28, 13
    s_add_u32 s21, s29, 44564480
    s_nop 1
    v_cvt_pk_bf16_f32 v69, v52, v53
    v_cvt_pk_bf16_f32 v71, v54, v55
    v_mov_b32 v170, s20
    s_sleep 1
    s_sleep 1
    s_sleep 1
    s_nop 11
    buffer_load_dwordx4 v[112:115], v156, s[8:11], s22 offen offset:0 sc1
    buffer_load_dwordx4 v[116:119], v156, s[8:11], s22 offen offset:1024 sc1
    buffer_load_dwordx4 v[120:123], v157, s[8:11], s22 offen offset:0 sc1
    s_sleep 1
    s_sleep 1
L_RBs_pp_loop:
    buffer_load_dwordx4 v[124:127], v156, s[8:11], s22 offen offset:0 sc1
    buffer_load_dwordx4 v[128:131], v156, s[8:11], s22 offen offset:1024 sc1
    buffer_load_dwordx4 v[132:135], v157, s[8:11], s22 offen offset:0 sc1
    s_sub_u32 s26, s26, 1
    s_cbranch_scc1 L_fail
    s_waitcnt vmcnt(3)
    v_pk_max_u16 v12, v112, v113
    v_pk_max_u16 v12, v12, v114
    v_pk_max_u16 v12, v12, v115
    v_pk_max_u16 v12, v12, v116
    v_pk_max_u16 v12, v12, v117
    v_pk_max_u16 v12, v12, v118
    v_pk_max_u16 v12, v12, v119
    v_pk_max_u16 v12, v12, v120
    v_pk_max_u16 v12, v12, v121
    v_pk_max_u16 v12, v12, v122
    v_pk_max_u16 v12, v12, v123
    v_lshlrev_b32 v13, 16, v12
    v_max_u32 v12, v12, v13
    v_cmp_le_u32 vcc, 0xffff0000, v12
    s_cbranch_vccz L_RBs_pp_ok0
    buffer_load_dwordx4 v[112:115], v156, s[8:11], s22 offen offset:0 sc1
    buffer_load_dwordx4 v[116:119], v156, s[8:11], s22 offen offset:1024 sc1
    buffer_load_dwordx4 v[120:123], v157, s[8:11], s22 offen offset:0 sc1
    s_waitcnt vmcnt(3)
    v_pk_max_u16 v12, v124, v125
    v_pk_max_u16 v12, v12, v126
    v_pk_max_u16 v12, v12, v127
    v_pk_max_u16 v12, v12, v128
    v_pk_max_u16 v12, v12, v129
    v_pk_max_u16 v12, v12, v130
    v_pk_max_u16 v12, v12, v131
    v_pk_max_u16 v12, v12, v132
    v_pk_max_u16 v12, v12, v133
    v_pk_max_u16 v12, v12, v134
    v_pk_max_u16 v12, v12, v135
    v_lshlrev_b32 v13, 16, v12
    v_max_u32 v12, v12, v13
    v_cmp_le_u32 vcc, 0xffff0000, v12
    s_cbranch_vccnz L_RBs_pp_loop
L_RBs_pp_ok1:
    v_smfmac_f32_16x16x64_bf16 v[104:107], v[124:127], v[72:79], v167
    v_smfmac_f32_16x16x64_bf16 v[104:107], v[128:131], v[88:95], v167
    v_smfmac_f32_16x16x64_bf16 v[104:107], v[132:135], v[56:63], v167
    v_smfmac_f32_16x16x64_bf16 v[108:111], v[124:127], v[80:87], v167
    v_smfmac_f32_16x16x64_bf16 v[108:111], v[128:131], v[96:103], v167
    v_smfmac_f32_16x16x64_bf16 v[108:111], v[132:135], v[64:71], v167
    s_branch L_RBs_pp_done
L_RBs_pp_ok0:
    v_smfmac_f32_16x16x64_bf16 v[104:107], v[112:115], v[72:79], v167
    v_smfmac_f32_16x16x64_bf16 v[104:107], v[116:119], v[88:95], v167
    v_smfmac_f32_16x16x64_bf16 v[104:107], v[120:123], v[56:63], v167
    v_smfmac_f32_16x16x64_bf16 v[108:111], v[112:115], v[80:87], v167
    v_smfmac_f32_16x16x64_bf16 v[108:111], v[116:119], v[96:103], v167
    v_smfmac_f32_16x16x64_bf16 v[108:111], v[120:123], v[64:71], v167
L_RBs_pp_done:
    s_nop 4
    v_pk_add_f32 v[104:105], v[104:105], v[106:107]
    ds_write_b64 v163, v[104:105]
    s_nop 0
    v_pk_add_f32 v[108:109], v[108:109], v[110:111]
    ds_write_b64 v163, v[108:109] offset:784
    s_waitcnt lgkmcnt(0)
    s_barrier
    ds_read2st64_b32 v[104:105], v158 offset0:0 offset1:7
    ds_read2st64_b32 v[106:107], v158 offset0:14 offset1:21
    s_waitcnt lgkmcnt(1)
    v_add_f32 v104, v104, v105
    s_waitcnt lgkmcnt(0)
    v_add_f32 v106, v106, v107
    v_add_f32 v104, v104, v106
    v_cvt_pk_bf16_f32 v104, v104, v104
    v_pk_min_u16 v104, v104, s40
    buffer_store_short v104, v159, s[8:11], s21 offen sc1
    s_cmp_lt_u32 s20, 63
    s_cbranch_scc1 L_RBs_more
    s_lshl_b32 s28, s12, 7
    s_add_u32 s29, s28, 15360
    v_lshrrev_b32 v4, 3, v154
    v_add_u32 v4, s29, v4
    v_add_u32 v5, s29, v154
    ds_write_b16 v4, v104
    s_waitcnt lgkmcnt(0)
    s_mov_b64 exec, 0xff
    ds_read_b128 v[8:11], v5
    s_lshl_b32 s29, s27, 9
    s_add_u32 s28, s28, s29
    s_add_u32 s28, s28, 44556288
    s_waitcnt lgkmcnt(0)
    buffer_store_dwordx4 v[8:11], v154, s[8:11], s28 offen sc1
    s_mov_b64 exec, -1
    s_branch L_RBs_end
L_RBs_more:
    s_lshl_b32 s29, s28, 14
    s_add_u32 s22, s29, 44597248
    s_add_u32 s25, s25, 8192
    s_lshl_b32 s29, s28, 13
    s_xor_b32 s29, s29, 16384
    s_add_u32 s33, s29, 44564480
    s_add_u32 s23, s23, 458752
    s_add_u32 s32, s23, 4096
    s_add_u32 s24, s24, 512
    v_mov_b64 v[24:25], 0
    v_mov_b64 v[26:27], 0
    v_mov_b64 v[28:29], 0
    v_mov_b64 v[30:31], 0
    v_mov_b64 v[32:33], 0
    v_mov_b64 v[34:35], 0
    v_mov_b64 v[36:37], 0
    v_mov_b64 v[38:39], 0
    v_mov_b64 v[40:41], 0
    v_mov_b64 v[42:43], 0
    v_mov_b64 v[44:45], 0
    v_mov_b64 v[46:47], 0
    v_mov_b64 v[48:49], 0
    v_mov_b64 v[50:51], 0
    v_mov_b64 v[52:53], 0
    v_mov_b64 v[54:55], 0
    v_mov_b64 v[104:105], 0
    v_mov_b64 v[106:107], 0
    v_mov_b64 v[108:109], 0
    v_mov_b64 v[110:111], 0
    s_waitcnt vmcnt(1)
    ds_read_b128 v[112:115], v162 offset:0
    ds_read_b128 v[116:119], v162 offset:1024
    ds_read_b128 v[120:123], v162 offset:2048
    ds_read_b128 v[124:127], v162 offset:3072
    ds_read_b128 v[128:131], v162 offset:4096
    ds_read_b128 v[132:135], v162 offset:5120
    ds_read_b128 v[136:139], v162 offset:6144
    ds_read_b128 v[140:143], v162 offset:7168
    s_branch L_RBs_step
L_RBs_end:
    s_branch L_exit
L_XAs:
    v_and_b32 v4, 63, v0
    v_lshrrev_b32 v5, 4, v4
    v_and_b32 v6, 15, v4
    s_mov_b32 s26, 1048576
    v_lshlrev_b32 v104, 4, v4
    v_mov_b32 v62, 0
    s_mov_b32 s30, 44797440
L_wf_62:
    buffer_load_dword v60, v62, s[8:11], s30 offen offset:0 sc1
    s_sub_u32 s26, s26, 1
    s_cbranch_scc1 L_fail
    s_waitcnt vmcnt(0)
    v_cmp_ne_u32 vcc, s17, v60
    s_cbranch_vccz L_wfd_63
    s_sleep 24
    s_branch L_wf_62
L_wfd_63:
    s_mul_i32 s32, s13, 401408
    s_mul_i32 s33, s12, 100352
    s_add_u32 s32, s32, s33
    buffer_load_dwordx4 a[0:3], v104, s[8:11], s32 offen offset:0
    buffer_load_dwordx4 a[4:7], v104, s[8:11], s32 offen offset:1024
    s_waitcnt vmcnt(1)
    buffer_load_dwordx4 a[8:11], v104, s[8:11], s32 offen offset:2048
    s_waitcnt vmcnt(1)
    buffer_load_dwordx4 a[12:15], v104, s[8:11], s32 offen offset:3072
    s_add_u32 s32, s32, 4096
    s_waitcnt vmcnt(1)
    buffer_load_dwordx4 a[16:19], v104, s[8:11], s32 offen offset:0
    s_waitcnt vmcnt(1)
    buffer_load_dwordx4 a[20:23], v104, s[8:11], s32 offen offset:1024
    s_waitcnt vmcnt(1)
    buffer_load_dwordx4 a[24:27], v104, s[8:11], s32 offen offset:2048
    s_waitcnt vmcnt(1)
    buffer_load_dwordx4 a[28:31], v104, s[8:11], s32 offen offset:3072
    s_add_u32 s32, s32, 4096
    s_waitcnt vmcnt(1)
    buffer_load_dwordx4 a[32:35], v104, s[8:11], s32 offen offset:0
    s_waitcnt vmcnt(1)
    buffer_load_dwordx4 a[36:39], v104, s[8:11], s32 offen offset:1024
    s_waitcnt vmcnt(1)
    buffer_load_dwordx4 a[40:43], v104, s[8:11], s32 offen offset:2048
    s_waitcnt vmcnt(1)
    buffer_load_dwordx4 a[44:47], v104, s[8:11], s32 offen offset:3072
    s_add_u32 s32, s32, 4096
    s_waitcnt vmcnt(1)
    buffer_load_dwordx4 a[48:51], v104, s[8:11], s32 offen offset:0
    s_waitcnt vmcnt(1)
    buffer_load_dwordx4 a[52:55], v104, s[8:11], s32 offen offset:1024
    s_waitcnt vmcnt(1)
    buffer_load_dwordx4 a[56:59], v104, s[8:11], s32 offen offset:2048
    s_waitcnt vmcnt(1)
    buffer_load_dwordx4 a[60:63], v104, s[8:11], s32 offen offset:3072
    s_add_u32 s32, s32, 4096
    s_waitcnt vmcnt(1)
    buffer_load_dwordx4 a[64:67], v104, s[8:11], s32 offen offset:0
    s_waitcnt vmcnt(1)
    buffer_load_dwordx4 a[68:71], v104, s[8:11], s32 offen offset:1024
    s_waitcnt vmcnt(1)
    buffer_load_dwordx4 a[72:75], v104, s[8:11], s32 offen offset:2048
    s_waitcnt vmcnt(1)
    buffer_load_dwordx4 a[76:79], v104, s[8:11], s32 offen offset:3072
    s_add_u32 s32, s32, 4096
    s_waitcnt vmcnt(1)
    buffer_load_dwordx4 a[80:83], v104, s[8:11], s32 offen offset:0
    s_waitcnt vmcnt(1)
    buffer_load_dwordx4 a[84:87], v104, s[8:11], s32 offen offset:1024
    s_waitcnt vmcnt(1)
    buffer_load_dwordx4 a[88:91], v104, s[8:11], s32 offen offset:2048
    s_waitcnt vmcnt(1)
    buffer_load_dwordx4 a[92:95], v104, s[8:11], s32 offen offset:3072
    s_add_u32 s32, s32, 4096
    s_waitcnt vmcnt(1)
    buffer_load_dwordx4 a[96:99], v104, s[8:11], s32 offen offset:0
    s_waitcnt vmcnt(1)
    buffer_load_dwordx4 a[100:103], v104, s[8:11], s32 offen offset:1024
    s_waitcnt vmcnt(1)
    buffer_load_dwordx4 a[104:107], v104, s[8:11], s32 offen offset:2048
    s_waitcnt vmcnt(1)
    buffer_load_dwordx4 a[108:111], v104, s[8:11], s32 offen offset:3072
    s_add_u32 s32, s32, 4096
    s_waitcnt vmcnt(1)
    buffer_load_dwordx4 a[112:115], v104, s[8:11], s32 offen offset:0
    s_waitcnt vmcnt(1)
    buffer_load_dwordx4 a[116:119], v104, s[8:11], s32 offen offset:1024
    s_waitcnt vmcnt(1)
    buffer_load_dwordx4 a[120:123], v104, s[8:11], s32 offen offset:2048
    s_waitcnt vmcnt(1)
    buffer_load_dwordx4 a[124:127], v104, s[8:11], s32 offen offset:3072
    s_add_u32 s32, s32, 4096
    s_waitcnt vmcnt(1)
    buffer_load_dwordx4 a[128:131], v104, s[8:11], s32 offen offset:0
    s_waitcnt vmcnt(1)
    buffer_load_dwordx4 a[132:135], v104, s[8:11], s32 offen offset:1024
    s_waitcnt vmcnt(1)
    buffer_load_dwordx4 a[136:139], v104, s[8:11], s32 offen offset:2048
    s_waitcnt vmcnt(1)
    buffer_load_dwordx4 a[140:143], v104, s[8:11], s32 offen offset:3072
    s_add_u32 s32, s32, 4096
    s_waitcnt vmcnt(1)
    buffer_load_dwordx4 a[144:147], v104, s[8:11], s32 offen offset:0
    s_waitcnt vmcnt(1)
    buffer_load_dwordx4 a[148:151], v104, s[8:11], s32 offen offset:1024
    s_waitcnt vmcnt(1)
    buffer_load_dwordx4 a[152:155], v104, s[8:11], s32 offen offset:2048
    s_waitcnt vmcnt(1)
    buffer_load_dwordx4 a[156:159], v104, s[8:11], s32 offen offset:3072
    s_add_u32 s32, s32, 4096
    s_waitcnt vmcnt(1)
    buffer_load_dwordx4 a[160:163], v104, s[8:11], s32 offen offset:0
    s_waitcnt vmcnt(1)
    buffer_load_dwordx4 a[164:167], v104, s[8:11], s32 offen offset:1024
    s_waitcnt vmcnt(1)
    buffer_load_dwordx4 a[168:171], v104, s[8:11], s32 offen offset:2048
    s_waitcnt vmcnt(1)
    buffer_load_dwordx4 a[172:175], v104, s[8:11], s32 offen offset:3072
    s_add_u32 s32, s32, 4096
    s_waitcnt vmcnt(1)
    buffer_load_dwordx4 a[176:179], v104, s[8:11], s32 offen offset:0
    s_waitcnt vmcnt(1)
    buffer_load_dwordx4 a[180:183], v104, s[8:11], s32 offen offset:1024
    s_waitcnt vmcnt(1)
    buffer_load_dwordx4 a[184:187], v104, s[8:11], s32 offen offset:2048
    s_waitcnt vmcnt(1)
    buffer_load_dwordx4 a[188:191], v104, s[8:11], s32 offen offset:3072
    s_add_u32 s32, s32, 4096
    s_waitcnt vmcnt(1)
    buffer_load_dwordx4 a[192:195], v104, s[8:11], s32 offen offset:0
    s_waitcnt vmcnt(1)
    buffer_load_dwordx4 a[196:199], v104, s[8:11], s32 offen offset:1024
    s_waitcnt vmcnt(1)
    buffer_load_dwordx4 a[200:203], v104, s[8:11], s32 offen offset:2048
    s_waitcnt vmcnt(1)
    buffer_load_dwordx4 a[204:207], v104, s[8:11], s32 offen offset:3072
    s_add_u32 s32, s32, 4096
    s_waitcnt vmcnt(1)
    buffer_load_dwordx4 a[208:211], v104, s[8:11], s32 offen offset:0
    s_waitcnt vmcnt(1)
    buffer_load_dwordx4 a[212:215], v104, s[8:11], s32 offen offset:1024
    s_waitcnt vmcnt(1)
    buffer_load_dwordx4 a[216:219], v104, s[8:11], s32 offen offset:2048
    s_waitcnt vmcnt(1)
    buffer_load_dwordx4 a[220:223], v104, s[8:11], s32 offen offset:3072
    s_add_u32 s32, s32, 4096
    s_waitcnt vmcnt(1)
    buffer_load_dwordx4 a[224:227], v104, s[8:11], s32 offen offset:0
    s_waitcnt vmcnt(1)
    buffer_load_dwordx4 a[228:231], v104, s[8:11], s32 offen offset:1024
    s_waitcnt vmcnt(1)
    buffer_load_dwordx4 a[232:235], v104, s[8:11], s32 offen offset:2048
    s_waitcnt vmcnt(1)
    buffer_load_dwordx4 a[236:239], v104, s[8:11], s32 offen offset:3072
    s_add_u32 s32, s32, 4096
    s_waitcnt vmcnt(1)
    buffer_load_dwordx4 a[240:243], v104, s[8:11], s32 offen offset:0
    s_waitcnt vmcnt(1)
    buffer_load_dwordx4 a[244:247], v104, s[8:11], s32 offen offset:1024
    s_waitcnt vmcnt(1)
    buffer_load_dwordx4 a[248:251], v104, s[8:11], s32 offen offset:2048
    s_waitcnt vmcnt(1)
    buffer_load_dwordx4 a[252:255], v104, s[8:11], s32 offen offset:3072
    s_add_u32 s32, s32, 4096
    s_waitcnt vmcnt(1)
    buffer_load_dwordx4 v[120:123], v104, s[8:11], s32 offen offset:0
    s_waitcnt vmcnt(1)
    buffer_load_dwordx4 v[124:127], v104, s[8:11], s32 offen offset:1024
    s_waitcnt vmcnt(1)
    buffer_load_dwordx4 v[128:131], v104, s[8:11], s32 offen offset:2048
    s_waitcnt vmcnt(1)
    buffer_load_dwordx4 v[132:135], v104, s[8:11], s32 offen offset:3072
    s_add_u32 s32, s32, 4096
    s_waitcnt vmcnt(1)
    buffer_load_dwordx4 v[136:139], v104, s[8:11], s32 offen offset:0
    s_waitcnt vmcnt(1)
    buffer_load_dwordx4 v[140:143], v104, s[8:11], s32 offen offset:1024
    s_waitcnt vmcnt(1)
    buffer_load_dwordx4 v[144:147], v104, s[8:11], s32 offen offset:2048
    s_waitcnt vmcnt(1)
    buffer_load_dwordx4 v[148:151], v104, s[8:11], s32 offen offset:3072
    s_add_u32 s32, s32, 4096
    s_waitcnt vmcnt(1)
    buffer_load_dwordx4 v[152:155], v104, s[8:11], s32 offen offset:0
    s_waitcnt vmcnt(1)
    buffer_load_dwordx4 v[156:159], v104, s[8:11], s32 offen offset:1024
    s_waitcnt vmcnt(1)
    buffer_load_dwordx4 v[160:163], v104, s[8:11], s32 offen offset:2048
    s_waitcnt vmcnt(1)
    buffer_load_dwordx4 v[164:167], v104, s[8:11], s32 offen offset:3072
    s_add_u32 s32, s32, 4096
    s_waitcnt vmcnt(1)
    buffer_load_dwordx4 v[168:171], v104, s[8:11], s32 offen offset:0
    s_waitcnt vmcnt(1)
    buffer_load_dwordx4 v[172:175], v104, s[8:11], s32 offen offset:1024
    s_waitcnt vmcnt(1)
    buffer_load_dwordx4 v[176:179], v104, s[8:11], s32 offen offset:2048
    s_waitcnt vmcnt(1)
    buffer_load_dwordx4 v[180:183], v104, s[8:11], s32 offen offset:3072
    s_add_u32 s32, s32, 4096
    s_waitcnt vmcnt(1)
    buffer_load_dwordx4 v[184:187], v104, s[8:11], s32 offen offset:0
    s_waitcnt vmcnt(1)
    buffer_load_dwordx4 v[188:191], v104, s[8:11], s32 offen offset:1024
    s_waitcnt vmcnt(1)
    buffer_load_dwordx4 v[192:195], v104, s[8:11], s32 offen offset:2048
    s_waitcnt vmcnt(1)
    buffer_load_dwordx4 v[196:199], v104, s[8:11], s32 offen offset:3072
    s_add_u32 s32, s32, 4096
    s_waitcnt vmcnt(1)
    buffer_load_dwordx4 v[200:203], v104, s[8:11], s32 offen offset:0
    s_waitcnt vmcnt(1)
    buffer_load_dwordx4 v[204:207], v104, s[8:11], s32 offen offset:1024
    s_waitcnt vmcnt(1)
    buffer_load_dwordx4 v[208:211], v104, s[8:11], s32 offen offset:2048
    s_waitcnt vmcnt(1)
    buffer_load_dwordx4 v[212:215], v104, s[8:11], s32 offen offset:3072
    s_add_u32 s32, s32, 4096
    s_waitcnt vmcnt(1)
    buffer_load_dwordx4 v[216:219], v104, s[8:11], s32 offen offset:0
    s_waitcnt vmcnt(1)
    buffer_load_dwordx4 v[220:223], v104, s[8:11], s32 offen offset:1024
    s_waitcnt vmcnt(1)
    buffer_load_dwordx4 v[224:227], v104, s[8:11], s32 offen offset:2048
    s_waitcnt vmcnt(1)
    buffer_load_dwordx4 v[228:231], v104, s[8:11], s32 offen offset:3072
    s_add_u32 s32, s32, 4096
    s_waitcnt vmcnt(1)
    buffer_load_dwordx4 v[232:235], v104, s[8:11], s32 offen offset:0
    s_waitcnt vmcnt(1)
    buffer_load_dwordx4 v[236:239], v104, s[8:11], s32 offen offset:1024
    s_waitcnt vmcnt(1)
    buffer_load_dwordx4 v[240:243], v104, s[8:11], s32 offen offset:2048
    s_waitcnt vmcnt(1)
    buffer_load_dwordx4 v[244:247], v104, s[8:11], s32 offen offset:3072
    s_add_u32 s32, s32, 4096
    s_waitcnt vmcnt(1)
    buffer_load_dwordx4 v[248:251], v104, s[8:11], s32 offen offset:0
    s_waitcnt vmcnt(1)
    buffer_load_dwordx4 v[252:255], v104, s[8:11], s32 offen offset:1024
    s_waitcnt vmcnt(1)
    s_lshl_b32 s34, s12, 3
    s_lshr_b32 s32, 185009152, s34
    s_and_b32 s32, s32, 255
    s_lshr_b32 s33, 168428291, s34
    s_and_b32 s33, s33, 255
    v_add_u32 v105, 32768, v104
    s_lshl_b32 s34, s32, 10
    v_add_u32 v106, s34, v105
    s_lshl_b32 s34, s33, 10
    v_add_u32 v107, s34, v105
    v_lshrrev_b32 v7, 1, v5
    v_lshlrev_b32 v7, 8, v7
    v_and_b32 v8, 7, v6
    v_lshl_add_u32 v7, v8, 4, v7
    v_and_b32 v8, 1, v5
    v_lshl_add_u32 v7, v8, 3, v7
    s_lshl_b32 s34, s32, 9
    v_add_u32 v108, s34, v7
    v_add_u32 v109, 1024, v108
    s_lshl_b32 s34, s33, 9
    v_add_u32 v110, s34, v7
    s_lshl_b32 s32, s12, 11
    s_min_u32 s32, s32, 5120
    v_add_u32 v111, s32, v104
    v_mov_b32 v112, 7164
    s_and_b32 s36, s12, 1
    s_lshl_b32 s32, s12, 10
    v_add_u32 v113, s32, v104
    s_lshl_b32 s32, s36, 12
    v_add_u32 v114, s32, v104
    s_lshl_b32 s32, s36, 4
    v_add_u32 v7, s32, v6
    v_lshlrev_b32 v8, 2, v5
    v_sub_u32 v7, v7, v8
    v_mov_b32 v8, 0xff800000
    v_cmp_le_i32 vcc, 0, v7
    s_nop 1
    v_cndmask_b32 v96, v8, 0, vcc
    v_cmp_le_i32 vcc, 1, v7
    s_nop 1
    v_cndmask_b32 v97, v8, 0, vcc
    v_cmp_le_i32 vcc, 2, v7
    s_nop 1
    v_cndmask_b32 v98, v8, 0, vcc
    v_cmp_le_i32 vcc, 3, v7
    s_nop 1
    v_cndmask_b32 v99, v8, 0, vcc
    v_cmp_le_i32 vcc, 16, v7
    s_nop 1
    v_cndmask_b32 v100, v8, 0, vcc
    v_cmp_le_i32 vcc, 17, v7
    s_nop 1
    v_cndmask_b32 v101, v8, 0, vcc
    v_cmp_le_i32 vcc, 18, v7
    s_nop 1
    v_cndmask_b32 v102, v8, 0, vcc
    v_cmp_le_i32 vcc, 19, v7
    s_nop 1
    v_cndmask_b32 v103, v8, 0, vcc
    s_mul_i32 s32, s13, 3328
    s_mul_i32 s33, s36, 1664
    s_add_u32 s32, s32, s33
    s_lshl_b32 s33, s13, 1
    s_add_u32 s33, s33, s36
    s_lshl_b32 s33, s33, 2
    s_cmp_lt_u32 s12, 2
    s_cselect_b32 s32, s32, 1073741824
    s_cselect_b32 s33, s33, 1073741824
    v_add_u32 v115, s32, v104
    v_lshlrev_b32 v7, 3, v4
    v_add_u32 v116, s32, v7
    v_mov_b32 v2, s33
    v_lshlrev_b32 v7, 2, v6
    v_add_u32 v117, s32, v7
    v_mov_b32 v1, 1
    s_sub_u32 s20, s14, 1
    s_lshl_b32 s21, s20, 13
    s_add_u32 s21, s21, 44040192
    s_mul_i32 s22, s20, 28672
    s_mul_i32 s23, s12, 7168
    s_add_u32 s22, s22, s23
    s_add_u32 s23, s23, 32768
    s_mul_i32 s24, s20, 53248
    s_add_u32 s24, s24, 44875776
    s_lshl_b32 s25, s20, 7
    s_add_u32 s25, s25, 44695552
    s_mov_b32 s41, 28672
    s_bitcmp1_b32 s12, 0
    s_cselect_b64 s[38:39], -1, 0
    s_waitcnt vmcnt(0)
    v_and_b32 v62, 63, v0
    v_lshlrev_b32 v62, 3, v62
    s_mov_b32 s30, 44796416
L_wf_64:
    buffer_load_dwordx2 v[60:61], v62, s[8:11], s30 offen offset:0 sc1
    s_sub_u32 s26, s26, 1
    s_cbranch_scc1 L_fail
    s_waitcnt vmcnt(0)
    v_xor_b32 v61, s17, v61
    v_xor_b32 v60, s17, v60
    v_or_b32 v60, v60, v61
    v_cmp_ne_u32 vcc, 0, v60
    s_cbranch_vccz L_wfd_65
    s_sleep 4
    s_branch L_wf_64
L_wfd_65:
    s_mov_b32 m0, s23
    s_add_u32 s30, s22, 12845056
    buffer_load_dwordx4 v104, s[8:11], s30 offen offset:0 lds
    buffer_load_dwordx4 v104, s[8:11], s30 offen offset:1024 lds
    buffer_load_dwordx4 v104, s[8:11], s30 offen offset:2048 lds
    buffer_load_dwordx4 v104, s[8:11], s30 offen offset:3072 lds
    s_add_u32 m0, s23, 4096
    s_add_u32 s30, s30, 4096
    buffer_load_dwordx4 v104, s[8:11], s30 offen offset:0 lds
    buffer_load_dwordx4 v104, s[8:11], s30 offen offset:1024 lds
    buffer_load_dwordx4 v104, s[8:11], s30 offen offset:2048 lds
L_XAs_seg:
    s_waitcnt vmcnt(0)
    s_barrier
    s_add_u32 s22, s22, 86016
    s_add_u32 s23, s23, s41
    s_mov_b32 m0, s23
    s_add_u32 s30, s22, 12845056
    s_add_u32 s31, s30, 4096
    ds_read_b128 v[60:63], v105 offset:0
    ds_read_b128 v[64:67], v105 offset:14336
    s_waitcnt lgkmcnt(0)
    v_mfma_f32_16x16x32_bf16 v[4:7], a[0:3], v[60:63], 0
    v_mfma_f32_16x16x32_bf16 v[8:11], a[0:3], v[64:67], 0
    ds_read_b128 v[68:71], v105 offset:1024
    v_mfma_f32_16x16x32_bf16 v[12:15], a[56:59], v[60:63], 0
    ds_read_b128 v[72:75], v105 offset:15360
    v_mfma_f32_16x16x32_bf16 v[16:19], a[56:59], v[64:67], 0
    v_mfma_f32_16x16x32_bf16 v[20:23], a[112:115], v[60:63], 0
    v_mfma_f32_16x16x32_bf16 v[24:27], a[112:115], v[64:67], 0
    buffer_load_dwordx4 v104, s[8:11], s30 offen offset:0 lds
    v_mfma_f32_16x16x32_bf16 v[28:31], a[168:171], v[60:63], 0
    v_mfma_f32_16x16x32_bf16 v[32:35], a[168:171], v[64:67], 0
    v_mfma_f32_16x16x32_bf16 v[36:39], a[224:227], v[60:63], 0
    v_mfma_f32_16x16x32_bf16 v[40:43], a[224:227], v[64:67], 0
    v_mfma_f32_16x16x32_bf16 v[44:47], v[144:147], v[60:63], 0
    v_mfma_f32_16x16x32_bf16 v[48:51], v[144:147], v[64:67], 0
    v_mfma_f32_16x16x32_bf16 v[52:55], v[200:203], v[60:63], 0
    v_mfma_f32_16x16x32_bf16 v[56:59], v[200:203], v[64:67], 0
    s_waitcnt lgkmcnt(0)
    v_mfma_f32_16x16x32_bf16 v[4:7], a[4:7], v[68:71], v[4:7]
    v_mfma_f32_16x16x32_bf16 v[8:11], a[4:7], v[72:75], v[8:11]
    ds_read_b128 v[60:63], v105 offset:2048
    v_mfma_f32_16x16x32_bf16 v[12:15], a[60:63], v[68:71], v[12:15]
    ds_read_b128 v[64:67], v105 offset:16384
    v_mfma_f32_16x16x32_bf16 v[16:19], a[60:63], v[72:75], v[16:19]
    v_mfma_f32_16x16x32_bf16 v[20:23], a[116:119], v[68:71], v[20:23]
    v_mfma_f32_16x16x32_bf16 v[24:27], a[116:119], v[72:75], v[24:27]
    buffer_load_dwordx4 v104, s[8:11], s30 offen offset:1024 lds
    v_mfma_f32_16x16x32_bf16 v[28:31], a[172:175], v[68:71], v[28:31]
    v_mfma_f32_16x16x32_bf16 v[32:35], a[172:175], v[72:75], v[32:35]
    v_mfma_f32_16x16x32_bf16 v[36:39], a[228:231], v[68:71], v[36:39]
    v_mfma_f32_16x16x32_bf16 v[40:43], a[228:231], v[72:75], v[40:43]
    v_mfma_f32_16x16x32_bf16 v[44:47], v[148:151], v[68:71], v[44:47]
    v_mfma_f32_16x16x32_bf16 v[48:51], v[148:151], v[72:75], v[48:51]
    v_mfma_f32_16x16x32_bf16 v[52:55], v[204:207], v[68:71], v[52:55]
    v_mfma_f32_16x16x32_bf16 v[56:59], v[204:207], v[72:75], v[56:59]
    s_waitcnt lgkmcnt(0)
    v_mfma_f32_16x16x32_bf16 v[4:7], a[8:11], v[60:63], v[4:7]
    v_mfma_f32_16x16x32_bf16 v[8:11], a[8:11], v[64:67], v[8:11]
    ds_read_b128 v[68:71], v105 offset:3072
    v_mfma_f32_16x16x32_bf16 v[12:15], a[64:67], v[60:63], v[12:15]
    ds_read_b128 v[72:75], v105 offset:17408
    v_mfma_f32_16x16x32_bf16 v[16:19], a[64:67], v[64:67], v[16:19]
    v_mfma_f32_16x16x32_bf16 v[20:23], a[120:123], v[60:63], v[20:23]
    v_mfma_f32_16x16x32_bf16 v[24:27], a[120:123], v[64:67], v[24:27]
    buffer_load_dwordx4 v104, s[8:11], s30 offen offset:2048 lds
    v_mfma_f32_16x16x32_bf16 v[28:31], a[176:179], v[60:63], v[28:31]
    v_mfma_f32_16x16x32_bf16 v[32:35], a[176:179], v[64:67], v[32:35]
    v_mfma_f32_16x16x32_bf16 v[36:39], a[232:235], v[60:63], v[36:39]
    v_mfma_f32_16x16x32_bf16 v[40:43], a[232:235], v[64:67], v[40:43]
    v_mfma_f32_16x16x32_bf16 v[44:47], v[152:155], v[60:63], v[44:47]
    v_mfma_f32_16x16x32_bf16 v[48:51], v[152:155], v[64:67], v[48:51]
    v_mfma_f32_16x16x32_bf16 v[52:55], v[208:211], v[60:63], v[52:55]
    v_mfma_f32_16x16x32_bf16 v[56:59], v[208:211], v[64:67], v[56:59]
    s_waitcnt lgkmcnt(0)
    v_mfma_f32_16x16x32_bf16 v[4:7], a[12:15], v[68:71], v[4:7]
    v_mfma_f32_16x16x32_bf16 v[8:11], a[12:15], v[72:75], v[8:11]
    ds_read_b128 v[60:63], v105 offset:4096
    v_mfma_f32_16x16x32_bf16 v[12:15], a[68:71], v[68:71], v[12:15]
    ds_read_b128 v[64:67], v105 offset:18432
    v_mfma_f32_16x16x32_bf16 v[16:19], a[68:71], v[72:75], v[16:19]
    v_mfma_f32_16x16x32_bf16 v[20:23], a[124:127], v[68:71], v[20:23]
    v_mfma_f32_16x16x32_bf16 v[24:27], a[124:127], v[72:75], v[24:27]
    buffer_load_dwordx4 v104, s[8:11], s30 offen offset:3072 lds
    v_mfma_f32_16x16x32_bf16 v[28:31], a[180:183], v[68:71], v[28:31]
    v_mfma_f32_16x16x32_bf16 v[32:35], a[180:183], v[72:75], v[32:35]
    v_mfma_f32_16x16x32_bf16 v[36:39], a[236:239], v[68:71], v[36:39]
    s_add_u32 m0, s23, 4096
    v_mfma_f32_16x16x32_bf16 v[40:43], a[236:239], v[72:75], v[40:43]
    v_mfma_f32_16x16x32_bf16 v[44:47], v[156:159], v[68:71], v[44:47]
    v_mfma_f32_16x16x32_bf16 v[48:51], v[156:159], v[72:75], v[48:51]
    v_mfma_f32_16x16x32_bf16 v[52:55], v[212:215], v[68:71], v[52:55]
    v_mfma_f32_16x16x32_bf16 v[56:59], v[212:215], v[72:75], v[56:59]
    s_waitcnt lgkmcnt(0)
    v_mfma_f32_16x16x32_bf16 v[4:7], a[16:19], v[60:63], v[4:7]
    v_mfma_f32_16x16x32_bf16 v[8:11], a[16:19], v[64:67], v[8:11]
    ds_read_b128 v[68:71], v105 offset:5120
    v_mfma_f32_16x16x32_bf16 v[12:15], a[72:75], v[60:63], v[12:15]
    ds_read_b128 v[72:75], v105 offset:19456
    v_mfma_f32_16x16x32_bf16 v[16:19], a[72:75], v[64:67], v[16:19]
    v_mfma_f32_16x16x32_bf16 v[20:23], a[128:131], v[60:63], v[20:23]
    v_mfma_f32_16x16x32_bf16 v[24:27], a[128:131], v[64:67], v[24:27]
    buffer_load_dwordx4 v104, s[8:11], s31 offen offset:0 lds
    v_mfma_f32_16x16x32_bf16 v[28:31], a[184:187], v[60:63], v[28:31]
    v_mfma_f32_16x16x32_bf16 v[32:35], a[184:187], v[64:67], v[32:35]
    v_mfma_f32_16x16x32_bf16 v[36:39], a[240:243], v[60:63], v[36:39]
    v_mfma_f32_16x16x32_bf16 v[40:43], a[240:243], v[64:67], v[40:43]
    v_mfma_f32_16x16x32_bf16 v[44:47], v[160:163], v[60:63], v[44:47]
    v_mfma_f32_16x16x32_bf16 v[48:51], v[160:163], v[64:67], v[48:51]
    v_mfma_f32_16x16x32_bf16 v[52:55], v[216:219], v[60:63], v[52:55]
    v_mfma_f32_16x16x32_bf16 v[56:59], v[216:219], v[64:67], v[56:59]
    s_waitcnt lgkmcnt(0)
    v_mfma_f32_16x16x32_bf16 v[4:7], a[20:23], v[68:71], v[4:7]
    v_mfma_f32_16x16x32_bf16 v[8:11], a[20:23], v[72:75], v[8:11]
    ds_read_b128 v[60:63], v105 offset:6144
    v_mfma_f32_16x16x32_bf16 v[12:15], a[76:79], v[68:71], v[12:15]
    ds_read_b128 v[64:67], v105 offset:20480
    v_mfma_f32_16x16x32_bf16 v[16:19], a[76:79], v[72:75], v[16:19]
    v_mfma_f32_16x16x32_bf16 v[20:23], a[132:135], v[68:71], v[20:23]
    v_mfma_f32_16x16x32_bf16 v[24:27], a[132:135], v[72:75], v[24:27]
    buffer_load_dwordx4 v104, s[8:11], s31 offen offset:1024 lds
    v_mfma_f32_16x16x32_bf16 v[28:31], a[188:191], v[68:71], v[28:31]
    v_mfma_f32_16x16x32_bf16 v[32:35], a[188:191], v[72:75], v[32:35]
    v_mfma_f32_16x16x32_bf16 v[36:39], a[244:247], v[68:71], v[36:39]
    v_mfma_f32_16x16x32_bf16 v[40:43], a[244:247], v[72:75], v[40:43]
    v_mfma_f32_16x16x32_bf16 v[44:47], v[164:167], v[68:71], v[44:47]
    v_mfma_f32_16x16x32_bf16 v[48:51], v[164:167], v[72:75], v[48:51]
    v_mfma_f32_16x16x32_bf16 v[52:55], v[220:223], v[68:71], v[52:55]
    v_mfma_f32_16x16x32_bf16 v[56:59], v[220:223], v[72:75], v[56:59]
    s_waitcnt lgkmcnt(0)
    v_mfma_f32_16x16x32_bf16 v[4:7], a[24:27], v[60:63], v[4:7]
    v_mfma_f32_16x16x32_bf16 v[8:11], a[24:27], v[64:67], v[8:11]
    ds_read_b128 v[68:71], v105 offset:7168
    v_mfma_f32_16x16x32_bf16 v[12:15], a[80:83], v[60:63], v[12:15]
    ds_read_b128 v[72:75], v105 offset:21504
    v_mfma_f32_16x16x32_bf16 v[16:19], a[80:83], v[64:67], v[16:19]
    v_mfma_f32_16x16x32_bf16 v[20:23], a[136:139], v[60:63], v[20:23]
    v_mfma_f32_16x16x32_bf16 v[24:27], a[136:139], v[64:67], v[24:27]
    buffer_load_dwordx4 v104, s[8:11], s31 offen offset:2048 lds
    v_mfma_f32_16x16x32_bf16 v[28:31], a[192:195], v[60:63], v[28:31]
    v_mfma_f32_16x16x32_bf16 v[32:35], a[192:195], v[64:67], v[32:35]
    v_mfma_f32_16x16x32_bf16 v[36:39], a[248:251], v[60:63], v[36:39]
    v_mfma_f32_16x16x32_bf16 v[40:43], a[248:251], v[64:67], v[40:43]
    v_mfma_f32_16x16x32_bf16 v[44:47], v[168:171], v[60:63], v[44:47]
    v_mfma_f32_16x16x32_bf16 v[48:51], v[168:171], v[64:67], v[48:51]
    v_mfma_f32_16x16x32_bf16 v[52:55], v[224:227], v[60:63], v[52:55]
    v_mfma_f32_16x16x32_bf16 v[56:59], v[224:227], v[64:67], v[56:59]
    s_waitcnt lgkmcnt(0)
    v_mfma_f32_16x16x32_bf16 v[4:7], a[28:31], v[68:71], v[4:7]
    v_mfma_f32_16x16x32_bf16 v[8:11], a[28:31], v[72:75], v[8:11]
    ds_read_b128 v[60:63], v105 offset:8192
    v_mfma_f32_16x16x32_bf16 v[12:15], a[84:87], v[68:71], v[12:15]
    ds_read_b128 v[64:67], v105 offset:22528
    v_mfma_f32_16x16x32_bf16 v[16:19], a[84:87], v[72:75], v[16:19]
    v_mfma_f32_16x16x32_bf16 v[20:23], a[140:143], v[68:71], v[20:23]
    v_mfma_f32_16x16x32_bf16 v[24:27], a[140:143], v[72:75], v[24:27]
    v_mfma_f32_16x16x32_bf16 v[28:31], a[196:199], v[68:71], v[28:31]
    v_mfma_f32_16x16x32_bf16 v[32:35], a[196:199], v[72:75], v[32:35]
    v_mfma_f32_16x16x32_bf16 v[36:39], a[252:255], v[68:71], v[36:39]
    v_mfma_f32_16x16x32_bf16 v[40:43], a[252:255], v[72:75], v[40:43]
    v_mfma_f32_16x16x32_bf16 v[44:47], v[172:175], v[68:71], v[44:47]
    v_mfma_f32_16x16x32_bf16 v[48:51], v[172:175], v[72:75], v[48:51]
    v_mfma_f32_16x16x32_bf16 v[52:55], v[228:231], v[68:71], v[52:55]
    v_mfma_f32_16x16x32_bf16 v[56:59], v[228:231], v[72:75], v[56:59]
    s_waitcnt lgkmcnt(0)
    v_mfma_f32_16x16x32_bf16 v[4:7], a[32:35], v[60:63], v[4:7]
    v_mfma_f32_16x16x32_bf16 v[8:11], a[32:35], v[64:67], v[8:11]
    ds_read_b128 v[68:71], v105 offset:9216
    v_mfma_f32_16x16x32_bf16 v[12:15], a[88:91], v[60:63], v[12:15]
    ds_read_b128 v[72:75], v105 offset:23552
    v_mfma_f32_16x16x32_bf16 v[16:19], a[88:91], v[64:67], v[16:19]
    v_mfma_f32_16x16x32_bf16 v[20:23], a[144:147], v[60:63], v[20:23]
    v_mfma_f32_16x16x32_bf16 v[24:27], a[144:147], v[64:67], v[24:27]
    v_mfma_f32_16x16x32_bf16 v[28:31], a[200:203], v[60:63], v[28:31]
    v_mfma_f32_16x16x32_bf16 v[32:35], a[200:203], v[64:67], v[32:35]
    v_mfma_f32_16x16x32_bf16 v[36:39], v[120:123], v[60:63], v[36:39]
    v_mfma_f32_16x16x32_bf16 v[40:43], v[120:123], v[64:67], v[40:43]
    v_mfma_f32_16x16x32_bf16 v[44:47], v[176:179], v[60:63], v[44:47]
    v_mfma_f32_16x16x32_bf16 v[48:51], v[176:179], v[64:67], v[48:51]
    v_mfma_f32_16x16x32_bf16 v[52:55], v[232:235], v[60:63], v[52:55]
    v_mfma_f32_16x16x32_bf16 v[56:59], v[232:235], v[64:67], v[56:59]
    s_waitcnt lgkmcnt(0)
    v_mfma_f32_16x16x32_bf16 v[4:7], a[36:39], v[68:71], v[4:7]
    v_mfma_f32_16x16x32_bf16 v[8:11], a[36:39], v[72:75], v[8:11]
    ds_read_b128 v[60:63], v105 offset:10240
    v_mfma_f32_16x16x32_bf16 v[12:15], a[92:95], v[68:71], v[12:15]
    ds_read_b128 v[64:67], v105 offset:24576
    v_mfma_f32_16x16x32_bf16 v[16:19], a[92:95], v[72:75], v[16:19]
    v_mfma_f32_16x16x32_bf16 v[20:23], a[148:151], v[68:71], v[20:23]
    v_mfma_f32_16x16x32_bf16 v[24:27], a[148:151], v[72:75], v[24:27]
    v_mfma_f32_16x16x32_bf16 v[28:31], a[204:207], v[68:71], v[28:31]
    v_mfma_f32_16x16x32_bf16 v[32:35], a[204:207], v[72:75], v[32:35]
    v_mfma_f32_16x16x32_bf16 v[36:39], v[124:127], v[68:71], v[36:39]
    v_mfma_f32_16x16x32_bf16 v[40:43], v[124:127], v[72:75], v[40:43]
    v_mfma_f32_16x16x32_bf16 v[44:47], v[180:183], v[68:71], v[44:47]
    v_mfma_f32_16x16x32_bf16 v[48:51], v[180:183], v[72:75], v[48:51]
    v_mfma_f32_16x16x32_bf16 v[52:55], v[236:239], v[68:71], v[52:55]
    v_mfma_f32_16x16x32_bf16 v[56:59], v[236:239], v[72:75], v[56:59]
    s_waitcnt lgkmcnt(0)
    v_mfma_f32_16x16x32_bf16 v[4:7], a[40:43], v[60:63], v[4:7]
    v_mfma_f32_16x16x32_bf16 v[8:11], a[40:43], v[64:67], v[8:11]
    ds_read_b128 v[68:71], v105 offset:11264
    v_mfma_f32_16x16x32_bf16 v[12:15], a[96:99], v[60:63], v[12:15]
    ds_read_b128 v[72:75], v105 offset:25600
    v_mfma_f32_16x16x32_bf16 v[16:19], a[96:99], v[64:67], v[16:19]
    v_mfma_f32_16x16x32_bf16 v[20:23], a[152:155], v[60:63], v[20:23]
    v_mfma_f32_16x16x32_bf16 v[24:27], a[152:155], v[64:67], v[24:27]
    v_mfma_f32_16x16x32_bf16 v[28:31], a[208:211], v[60:63], v[28:31]
    v_mfma_f32_16x16x32_bf16 v[32:35], a[208:211], v[64:67], v[32:35]
    v_mfma_f32_16x16x32_bf16 v[36:39], v[128:131], v[60:63], v[36:39]
    v_mfma_f32_16x16x32_bf16 v[40:43], v[128:131], v[64:67], v[40:43]
    v_mfma_f32_16x16x32_bf16 v[44:47], v[184:187], v[60:63], v[44:47]
    v_mfma_f32_16x16x32_bf16 v[48:51], v[184:187], v[64:67], v[48:51]
    v_mfma_f32_16x16x32_bf16 v[52:55], v[240:243], v[60:63], v[52:55]
    v_mfma_f32_16x16x32_bf16 v[56:59], v[240:243], v[64:67], v[56:59]
    s_waitcnt lgkmcnt(0)
    v_mfma_f32_16x16x32_bf16 v[4:7], a[44:47], v[68:71], v[4:7]
    v_mfma_f32_16x16x32_bf16 v[8:11], a[44:47], v[72:75], v[8:11]
    ds_read_b128 v[60:63], v105 offset:12288
    v_mfma_f32_16x16x32_bf16 v[12:15], a[100:103], v[68:71], v[12:15]
    ds_read_b128 v[64:67], v105 offset:26624
    v_mfma_f32_16x16x32_bf16 v[16:19], a[100:103], v[72:75], v[16:19]
    v_mfma_f32_16x16x32_bf16 v[20:23], a[156:159], v[68:71], v[20:23]
    v_mfma_f32_16x16x32_bf16 v[24:27], a[156:159], v[72:75], v[24:27]
    v_mfma_f32_16x16x32_bf16 v[28:31], a[212:215], v[68:71], v[28:31]
    v_mfma_f32_16x16x32_bf16 v[32:35], a[212:215], v[72:75], v[32:35]
    v_mfma_f32_16x16x32_bf16 v[36:39], v[132:135], v[68:71], v[36:39]
    v_mfma_f32_16x16x32_bf16 v[40:43], v[132:135], v[72:75], v[40:43]
    v_mfma_f32_16x16x32_bf16 v[44:47], v[188:191], v[68:71], v[44:47]
    v_mfma_f32_16x16x32_bf16 v[48:51], v[188:191], v[72:75], v[48:51]
    v_mfma_f32_16x16x32_bf16 v[52:55], v[244:247], v[68:71], v[52:55]
    v_mfma_f32_16x16x32_bf16 v[56:59], v[244:247], v[72:75], v[56:59]
    s_waitcnt lgkmcnt(0)
    v_mfma_f32_16x16x32_bf16 v[4:7], a[48:51], v[60:63], v[4:7]
    v_mfma_f32_16x16x32_bf16 v[8:11], a[48:51], v[64:67], v[8:11]
    ds_read_b128 v[68:71], v105 offset:13312
    v_mfma_f32_16x16x32_bf16 v[12:15], a[104:107], v[60:63], v[12:15]
    ds_read_b128 v[72:75], v105 offset:27648
    v_mfma_f32_16x16x32_bf16 v[16:19], a[104:107], v[64:67], v[16:19]
    v_mfma_f32_16x16x32_bf16 v[20:23], a[160:163], v[60:63], v[20:23]
    v_mfma_f32_16x16x32_bf16 v[24:27], a[160:163], v[64:67], v[24:27]
    v_mfma_f32_16x16x32_bf16 v[28:31], a[216:219], v[60:63], v[28:31]
    v_mfma_f32_16x16x32_bf16 v[32:35], a[216:219], v[64:67], v[32:35]
    v_mfma_f32_16x16x32_bf16 v[36:39], v[136:139], v[60:63], v[36:39]
    v_mfma_f32_16x16x32_bf16 v[40:43], v[136:139], v[64:67], v[40:43]
    v_mfma_f32_16x16x32_bf16 v[44:47], v[192:195], v[60:63], v[44:47]
    v_mfma_f32_16x16x32_bf16 v[48:51], v[192:195], v[64:67], v[48:51]
    v_mfma_f32_16x16x32_bf16 v[52:55], v[248:251], v[60:63], v[52:55]
    v_mfma_f32_16x16x32_bf16 v[56:59], v[248:251], v[64:67], v[56:59]
    s_waitcnt lgkmcnt(0)
    v_mfma_f32_16x16x32_bf16 v[4:7], a[52:55], v[68:71], v[4:7]
    v_mfma_f32_16x16x32_bf16 v[8:11], a[52:55], v[72:75], v[8:11]
    v_mfma_f32_16x16x32_bf16 v[12:15], a[108:111], v[68:71], v[12:15]
    v_mfma_f32_16x16x32_bf16 v[16:19], a[108:111], v[72:75], v[16:19]
    v_mfma_f32_16x16x32_bf16 v[20:23], a[164:167], v[68:71], v[20:23]
    v_mfma_f32_16x16x32_bf16 v[24:27], a[164:167], v[72:75], v[24:27]
    v_mfma_f32_16x16x32_bf16 v[28:31], a[220:223], v[68:71], v[28:31]
    v_mfma_f32_16x16x32_bf16 v[32:35], a[220:223], v[72:75], v[32:35]
    v_mfma_f32_16x16x32_bf16 v[36:39], v[140:143], v[68:71], v[36:39]
    v_mfma_f32_16x16x32_bf16 v[40:43], v[140:143], v[72:75], v[40:43]
    v_mfma_f32_16x16x32_bf16 v[44:47], v[196:199], v[68:71], v[44:47]
    v_mfma_f32_16x16x32_bf16 v[48:51], v[196:199], v[72:75], v[48:51]
    v_mfma_f32_16x16x32_bf16 v[52:55], v[252:255], v[68:71], v[52:55]
    v_mfma_f32_16x16x32_bf16 v[56:59], v[252:255], v[72:75], v[56:59]
    ds_read_b128 v[60:63], v106 offset:0
    ds_read_b128 v[64:67], v106 offset:14336
    ds_read_b128 v[68:71], v106 offset:1024
    ds_read_b128 v[72:75], v106 offset:15360
    v_cvt_pk_bf16_f32 v4, v4, v5
    v_cvt_pk_bf16_f32 v5, v12, v13
    v_cvt_pk_bf16_f32 v6, v6, v7
    v_cvt_pk_bf16_f32 v7, v14, v15
    v_cvt_pk_bf16_f32 v8, v8, v9
    v_cvt_pk_bf16_f32 v9, v16, v17
    v_cvt_pk_bf16_f32 v10, v10, v11
    v_cvt_pk_bf16_f32 v11, v18, v19
    v_cvt_pk_bf16_f32 v20, v20, v21
    v_cvt_pk_bf16_f32 v21, v28, v29
    v_cvt_pk_bf16_f32 v22, v22, v23
    v_cvt_pk_bf16_f32 v23, v30, v31
    v_cvt_pk_bf16_f32 v24, v24, v25
    v_cvt_pk_bf16_f32 v25, v32, v33
    v_cvt_pk_bf16_f32 v26, v26, v27
    v_cvt_pk_bf16_f32 v27, v34, v35
    v_cvt_pk_bf16_f32 v36, v36, v37
    v_cvt_pk_bf16_f32 v37, v44, v45
    v_cvt_pk_bf16_f32 v38, v38, v39
    v_cvt_pk_bf16_f32 v39, v46, v47
    v_cvt_pk_bf16_f32 v40, v40, v41
    v_cvt_pk_bf16_f32 v41, v48, v49
    v_cvt_pk_bf16_f32 v42, v42, v43
    v_cvt_pk_bf16_f32 v43, v50, v51
    v_cvt_pk_bf16_f32 v12, v52, v53
    v_cvt_pk_bf16_f32 v13, v54, v55
    v_cndmask_b32 v52, v12, 0, s[38:39]
    v_cndmask_b32 v53, 0, v12, s[38:39]
    v_cndmask_b32 v54, v13, 0, s[38:39]
    v_cndmask_b32 v55, 0, v13, s[38:39]
    v_cvt_pk_bf16_f32 v12, v56, v57
    v_cvt_pk_bf16_f32 v13, v58, v59
    v_cndmask_b32 v56, v12, 0, s[38:39]
    v_cndmask_b32 v57, 0, v12, s[38:39]
    v_cndmask_b32 v58, v13, 0, s[38:39]
    v_cndmask_b32 v59, 0, v13, s[38:39]
    s_waitcnt vmcnt(7)
    s_waitcnt lgkmcnt(2)
    v_mfma_f32_16x16x32_bf16 v[76:79], v[60:63], v[4:7], 0
    v_mfma_f32_16x16x32_bf16 v[80:83], v[60:63], v[8:11], 0
    v_mfma_f32_16x16x32_bf16 v[84:87], v[64:67], v[8:11], 0
    ds_read_b128 v[60:63], v106 offset:2048
    ds_read_b128 v[64:67], v106 offset:16384
    s_waitcnt lgkmcnt(2)
    v_mfma_f32_16x16x32_bf16 v[76:79], v[68:71], v[20:23], v[76:79]
    v_mfma_f32_16x16x32_bf16 v[80:83], v[68:71], v[24:27], v[80:83]
    v_mfma_f32_16x16x32_bf16 v[84:87], v[72:75], v[24:27], v[84:87]
    ds_read_b128 v[68:71], v107 offset:0
    ds_read_b128 v[72:75], v107 offset:14336
    s_waitcnt lgkmcnt(2)
    v_mfma_f32_16x16x32_bf16 v[76:79], v[60:63], v[36:39], v[76:79]
    v_mfma_f32_16x16x32_bf16 v[80:83], v[60:63], v[40:43], v[80:83]
    v_mfma_f32_16x16x32_bf16 v[84:87], v[64:67], v[40:43], v[84:87]
    s_waitcnt lgkmcnt(0)
    v_mfma_f32_16x16x32_bf16 v[76:79], v[68:71], v[52:55], v[76:79]
    v_mfma_f32_16x16x32_bf16 v[80:83], v[68:71], v[56:59], v[80:83]
    v_mfma_f32_16x16x32_bf16 v[84:87], v[72:75], v[56:59], v[84:87]
    s_nop 5
    ds_write_b128 v113, v[76:79] offset:8192
    ds_write_b128 v113, v[80:83] offset:12288
    ds_write_b128 v113, v[84:87] offset:16384
    s_waitcnt lgkmcnt(0)
    s_barrier
    ds_read_b128 v[12:15], v114 offset:8192
    ds_read_b128 v[16:19], v114 offset:9216
    ds_read_b128 v[28:31], v114 offset:10240
    ds_read_b128 v[32:35], v114 offset:11264
    s_waitcnt lgkmcnt(3)
    v_pk_add_f32 v[88:89], v[12:13], v[96:97]
    v_pk_add_f32 v[90:91], v[14:15], v[98:99]
    s_waitcnt lgkmcnt(2)
    v_pk_add_f32 v[88:89], v[16:17], v[88:89]
    v_pk_add_f32 v[90:91], v[18:19], v[90:91]
    s_waitcnt lgkmcnt(1)
    v_pk_add_f32 v[88:89], v[28:29], v[88:89]
    v_pk_add_f32 v[90:91], v[30:31], v[90:91]
    s_waitcnt lgkmcnt(0)
    v_pk_add_f32 v[88:89], v[32:33], v[88:89]
    v_pk_add_f32 v[90:91], v[34:35], v[90:91]
    ds_read_b128 v[12:15], v104 offset:16384
    ds_read_b128 v[16:19], v104 offset:17408
    ds_read_b128 v[28:31], v104 offset:18432
    ds_read_b128 v[32:35], v104 offset:19456
    s_waitcnt lgkmcnt(3)
    v_pk_add_f32 v[92:93], v[12:13], v[100:101]
    v_pk_add_f32 v[94:95], v[14:15], v[102:103]
    s_waitcnt lgkmcnt(2)
    v_pk_add_f32 v[92:93], v[16:17], v[92:93]
    v_pk_add_f32 v[94:95], v[18:19], v[94:95]
    s_waitcnt lgkmcnt(1)
    v_pk_add_f32 v[92:93], v[28:29], v[92:93]
    v_pk_add_f32 v[94:95], v[30:31], v[94:95]
    s_waitcnt lgkmcnt(0)
    v_pk_add_f32 v[92:93], v[32:33], v[92:93]
    v_pk_add_f32 v[94:95], v[34:35], v[94:95]
    s_sub_u32 s29, s21, 8192
    buffer_load_dword v62, v112, s[8:11], s29 offen sc1
    buffer_load_dwordx4 v[44:47], v111, s[8:11], s21 offen sc1
    buffer_load_dwordx4 v[48:51], v111, s[8:11], s21 offen offset:1024 sc1
    v_max3_f32 v84, v88, v89, v90
    v_max3_f32 v84, v84, v91, v92
    v_max3_f32 v84, v84, v93, v94
    v_max_f32 v84, v84, v95
    v_mov_b32 v85, v84
    s_nop 1
    v_permlane16_swap_b32 v84, v85
    v_max_f32 v84, v84, v85
    v_mov_b32 v85, v84
    s_nop 1
    v_permlane32_swap_b32 v84, v85
    v_max_f32 v84, v84, v85
    v_pk_add_f32 v[88:89], v[88:89], v[84:85] op_sel_hi:[1,0] neg_lo:[0,1] neg_hi:[0,1]
    v_pk_add_f32 v[90:91], v[90:91], v[84:85] op_sel_hi:[1,0] neg_lo:[0,1] neg_hi:[0,1]
    v_pk_add_f32 v[92:93], v[92:93], v[84:85] op_sel_hi:[1,0] neg_lo:[0,1] neg_hi:[0,1]
    v_pk_add_f32 v[94:95], v[94:95], v[84:85] op_sel_hi:[1,0] neg_lo:[0,1] neg_hi:[0,1]
    v_exp_f32 v88, v88
    v_exp_f32 v89, v89
    v_exp_f32 v90, v90
    v_exp_f32 v91, v91
    v_exp_f32 v92, v92
    v_exp_f32 v93, v93
    v_exp_f32 v94, v94
    v_exp_f32 v95, v95
    v_pk_add_f32 v[12:13], v[88:89], v[90:91]
    v_pk_add_f32 v[14:15], v[92:93], v[94:95]
    v_pk_add_f32 v[12:13], v[12:13], v[14:15]
    v_add_f32 v86, v12, v13
    v_cvt_pk_bf16_f32 v88, v88, v89
    v_cvt_pk_bf16_f32 v89, v90, v91
    v_cvt_pk_bf16_f32 v90, v92, v93
    v_cvt_pk_bf16_f32 v91, v94, v95
    buffer_store_dwordx4 v[88:91], v115, s[8:11], s24 offen sc1
    v_mov_b32 v87, v86
    s_nop 1
    v_permlane16_swap_b32 v86, v87
    v_add_f32 v86, v86, v87
    v_mov_b32 v87, v86
    s_nop 1
    v_permlane32_swap_b32 v86, v87
    v_add_f32 v86, v86, v87
    s_add_u32 s32, s25, 8192
    s_waitcnt vmcnt(0)
    buffer_store_dword v1, v2, s[8:11], s32 offen sc1
    v_add_u32 v105, s41, v105
    v_add_u32 v106, s41, v106
    v_add_u32 v107, s41, v107
    s_sub_u32 s41, 0, s41
    s_waitcnt vmcnt(0)
    v_pk_max_u16 v60, v44, v45
    v_pk_max_u16 v60, v60, v46
    v_pk_max_u16 v60, v60, v47
    v_pk_max_u16 v60, v60, v48
    v_pk_max_u16 v60, v60, v49
    v_pk_max_u16 v60, v60, v50
    v_pk_max_u16 v60, v60, v51
    v_lshlrev_b32 v61, 16, v60
    v_max_u32 v60, v60, v61
    v_cmp_le_u32 vcc, 0xffff0000, v60
    s_cbranch_vccz L_XAs_m_p_ok0
    v_cmp_eq_u32 vcc, -1, v62
    s_cbranch_vccz L_XAs_m_go
L_XAs_m_tr:
    s_sleep 4
    buffer_load_dword v60, v112, s[8:11], s29 offen sc1
    s_sub_u32 s26, s26, 1
    s_cbranch_scc1 L_fail
    s_waitcnt vmcnt(0)
    v_cmp_eq_u32 vcc, -1, v60
    s_cbranch_vccnz L_XAs_m_tr
    s_sleep 24
L_XAs_m_go:
L_XAs_m_p_loop:
    buffer_load_dwordx4 v[44:47], v111, s[8:11], s21 offen offset:0 sc1
    buffer_load_dwordx4 v[48:51], v111, s[8:11], s21 offen offset:1024 sc1
    s_sub_u32 s26, s26, 1
    s_cbranch_scc1 L_fail
    s_waitcnt vmcnt(0)
    v_pk_max_u16 v60, v44, v45
    v_pk_max_u16 v60, v60, v46
    v_pk_max_u16 v60, v60, v47
    v_pk_max_u16 v60, v60, v48
    v_pk_max_u16 v60, v60, v49
    v_pk_max_u16 v60, v60, v50
    v_pk_max_u16 v60, v60, v51
    v_lshlrev_b32 v61, 16, v60
    v_max_u32 v60, v60, v61
    v_cmp_le_u32 vcc, 0xffff0000, v60
    s_cbranch_vccnz L_XAs_m_p_loop
L_XAs_m_p_ok0:
    ds_write_b128 v111, v[44:47]
    ds_write_b128 v111, v[48:51] offset:1024
L_XAs_m_p_done:
    s_waitcnt lgkmcnt(0)
    s_barrier
    ds_read2_b32 v[60:61], v108 offset0:0 offset1:32
    ds_read2_b32 v[62:63], v108 offset0:1 offset1:33
    ds_read2_b32 v[64:65], v108 offset0:128 offset1:160
    ds_read2_b32 v[66:67], v108 offset0:129 offset1:161
    ds_read2_b32 v[68:69], v109 offset0:0 offset1:32
    ds_read2_b32 v[70:71], v109 offset0:1 offset1:33
    ds_read2_b32 v[72:73], v110 offset0:0 offset1:32
    ds_read2_b32 v[74:75], v110 offset0:1 offset1:33
    s_waitcnt lgkmcnt(6)
    v_mfma_f32_16x16x32_bf16 v[76:79], v[60:63], v[4:7], 0
    v_mfma_f32_16x16x32_bf16 v[80:83], v[60:63], v[8:11], 0
    s_waitcnt lgkmcnt(4)
    v_mfma_f32_16x16x32_bf16 v[76:79], v[64:67], v[20:23], v[76:79]
    v_mfma_f32_16x16x32_bf16 v[80:83], v[64:67], v[24:27], v[80:83]
    s_waitcnt lgkmcnt(2)
    v_mfma_f32_16x16x32_bf16 v[76:79], v[68:71], v[36:39], v[76:79]
    v_mfma_f32_16x16x32_bf16 v[80:83], v[68:71], v[40:43], v[80:83]
    s_waitcnt lgkmcnt(0)
    v_mfma_f32_16x16x32_bf16 v[76:79], v[72:75], v[52:55], v[76:79]
    v_mfma_f32_16x16x32_bf16 v[80:83], v[72:75], v[56:59], v[80:83]
    s_nop 6
    ds_write_b128 v113, v[76:79] offset:20480
    ds_write_b128 v113, v[80:83] offset:24576
    s_waitcnt lgkmcnt(0)
    s_barrier
    s_waitcnt vmcnt(0)
    ds_read_b128 v[12:15], v114 offset:20480
    ds_read_b128 v[16:19], v114 offset:21504
    ds_read_b128 v[28:31], v114 offset:22528
    ds_read_b128 v[32:35], v114 offset:23552
    s_waitcnt lgkmcnt(2)
    v_pk_add_f32 v[76:77], v[12:13], v[16:17]
    v_pk_add_f32 v[78:79], v[14:15], v[18:19]
    s_waitcnt lgkmcnt(0)
    v_pk_add_f32 v[28:29], v[28:29], v[32:33]
    v_pk_add_f32 v[30:31], v[30:31], v[34:35]
    v_pk_add_f32 v[76:77], v[76:77], v[28:29]
    v_pk_add_f32 v[78:79], v[78:79], v[30:31]
    v_max3_f32 v92, v84, v76, v77
    v_max3_f32 v92, v92, v78, v79
    v_mov_b32 v93, v92
    s_nop 1
    v_permlane16_swap_b32 v92, v93
    v_max_f32 v92, v92, v93
    v_pk_add_f32 v[76:77], v[76:77], v[92:93] op_sel_hi:[1,0] neg_lo:[0,1] neg_hi:[0,1]
    v_pk_add_f32 v[78:79], v[78:79], v[92:93] op_sel_hi:[1,0] neg_lo:[0,1] neg_hi:[0,1]
    v_sub_f32 v94, v84, v92
    v_exp_f32 v76, v76
    v_exp_f32 v77, v77
    v_exp_f32 v78, v78
    v_exp_f32 v79, v79
    v_exp_f32 v94, v94
    v_pk_add_f32 v[12:13], v[76:77], v[78:79]
    v_add_f32 v12, v12, v13
    v_mov_b32 v13, v12
    s_nop 1
    v_permlane16_swap_b32 v12, v13
    v_add_f32 v12, v12, v13
    v_fmac_f32 v12, v94, v86
    v_rcp_f32 v12, v12
    s_nop 0
    v_pk_mul_f32 v[76:77], v[76:77], v[12:13] op_sel_hi:[1,0]
    v_pk_mul_f32 v[78:79], v[78:79], v[12:13] op_sel_hi:[1,0]
    v_mul_f32 v94, v94, v12
    v_cvt_pk_bf16_f32 v76, v76, v77
    v_cvt_pk_bf16_f32 v77, v78, v79
    buffer_store_dwordx2 v[76:77], v116, s[8:11], s24 offen offset:1024 sc1
    buffer_store_dword v94, v117, s[8:11], s24 offen offset:1536 sc1
    s_waitcnt vmcnt(0)
    buffer_store_dword v1, v2, s[8:11], s25 offen sc1
    s_add_u32 s20, s20, 3
    s_add_u32 s21, s21, 24576
    s_add_u32 s24, s24, 159744
    s_add_u32 s25, s25, 384
    s_cmp_lt_u32 s20, 64
    s_cbranch_scc1 L_XAs_seg
    s_branch L_exit
L_code_end:
    s_endpgm
.section .rodata,"a"
.p2align 6
.amdhsa_kernel adaLN_cond__memory_aug_recurrent_mem_tr__dense_activation_mish__prompt_kernel
  .amdhsa_next_free_vgpr 512
  .amdhsa_next_free_sgpr 102
  .amdhsa_accum_offset 256
  .amdhsa_group_segment_fixed_size 0
  .amdhsa_kernarg_size 128
  .amdhsa_user_sgpr_count 2
  .amdhsa_user_sgpr_kernarg_segment_ptr 1
  .amdhsa_system_sgpr_workgroup_id_x 1
  .amdhsa_float_denorm_mode_32 3
.end_amdhsa_kernel
```
